```python
import torch

def _softmax(x, axis=-1):
    return torch.softmax(x, dim=axis)
def _gelu(x):
    return torch.nn.functional.gelu(x, approximate="tanh")
def _silu(x):
    return torch.nn.functional.silu(x)
def _sigmoid(x):
    return torch.sigmoid(x)
def _layernorm(x, axis=-1, eps=1e-5):
    m = x.mean(dim=axis, keepdim=True)
    v = x.var(dim=axis, keepdim=True, unbiased=False)
    return (x - m) / torch.sqrt(v + eps)
def _scatter_add(tgt, idx, src, axis=0):
    return tgt.clone().index_add_(axis, idx, src)
def _segment_sum(src, seg, n):
    out = torch.zeros((n,) + src.shape[1:], dtype=src.dtype)
    return out.index_add_(0, seg, src)
def _pad(x, pw):
    flat = tuple(v for pair in reversed(pw) for v in pair)
    return torch.nn.functional.pad(x, flat)

kernel_name = 'interleave_layers__sliding_local_dilated__dense_activation_gelu__prompt'

def setup_inputs():

    _w = (lambda a: (lambda t: t.to(torch.bfloat16) if t.is_floating_point() else t)(torch.as_tensor(a)))
    def _A_setup():
        B, S, D = 1, 2048, 512
        return {
            "x": _w((lambda *s: torch.randn(*s, dtype=torch.bfloat16) * 0.05)(B, S, D)),
            "wqkv": _w((lambda *s: torch.randn(*s, dtype=torch.bfloat16) * 0.05)(D, 3 * D)),
            "wo": _w((lambda *s: torch.randn(*s, dtype=torch.bfloat16) * 0.05)(D, D)),
        }
    _A_in = _A_setup()

    def _B_setup():
        B, S, D, F = 1, 2048, 512, 1376
        return {
            "x": _w((lambda *s: torch.randn(*s, dtype=torch.bfloat16) * 0.05)(B, S, D)),
            "w1": _w((lambda *s: torch.randn(*s, dtype=torch.bfloat16) * 0.8)(D, F) * (D ** -0.5)),
            "b1": _w((lambda *s: torch.randn(*s, dtype=torch.bfloat16) * 0.8)(F) * 0.01),
            "w2": _w((lambda *s: torch.randn(*s, dtype=torch.bfloat16) * 0.8)(F, D) * (F ** -0.5)),
            "b2": _w((lambda *s: torch.randn(*s, dtype=torch.bfloat16) * 0.8)(D) * 0.01),
        }
    _B_in = _B_setup()

    return {
        "A_x": _A_in["x"],
        "A_wqkv": _A_in["wqkv"],
        "A_wo": _A_in["wo"],
        "B_x": _B_in["x"],
        "B_w1": _B_in["w1"],
        "B_b1": _B_in["b1"],
        "B_w2": _B_in["w2"],
        "B_b2": _B_in["b2"],
    }

def reference(A_x, A_wqkv, A_wo, B_x, B_w1, B_b1, B_w2, B_b2):
    def _A_ref(x, wqkv, wo):
        B, S, D = x.shape
        H = 32; Dh = D // H
        W, dil = 8, 2
        qkv = (lambda x, *d: x.permute(*d))((x @ wqkv).reshape(B, S, 3, H, Dh), 2, 0, 3, 1, 4)
        q, k, v = qkv[0], qkv[1], qkv[2]
        scale = Dh ** -0.5
        pos = torch.arange(S)
        off = torch.arange(W) * dil
        idx = pos[:, None] - off[None, :]
        mask = idx >= 0
        idx_c = torch.where(mask, idx, 0).reshape(-1)
        kg = k[:, :, idx_c, :].reshape(B, H, S, W, Dh)
        vg = v[:, :, idx_c, :].reshape(B, H, S, W, Dh)
        logits = torch.einsum("bhsd,bhswd->bhsw", q, kg) * scale
        logits = torch.where(mask[None, None, :, :], logits, -1e9)
        attn = _softmax(logits, axis=-1)
        o = torch.einsum("bhsw,bhswd->bhsd", attn, vg)
        return (lambda x, *d: x.permute(*d))(o, 0, 2, 1, 3).reshape(B, S, D) @ wo

    def _B_ref(x, w1, b1, w2, b2):
        h = torch.einsum("bsd,df->bsf", x, w1) + b1
        h = _gelu(h)
        return torch.einsum("bsf,fd->bsd", h, w2) + b2

    x = A_x
    x = x + _A_ref(_layernorm(x, axis=-1), A_wqkv, A_wo)
    x = x + _B_ref(_layernorm(x, axis=-1), B_w1, B_b1, B_w2, B_b2)
    x = x + _A_ref(_layernorm(x, axis=-1), A_wqkv, A_wo)
    x = x + _B_ref(_layernorm(x, axis=-1), B_w1, B_b1, B_w2, B_b2)
    return x
```

```asm
; @launch grid=(256,1,1) block=(256,1,1) lds=163840
.amdgcn_target "amdgcn-amd-amdhsa--gfx950"
.text
.globl interleave_layers__sliding_local_dilated__dense_activation_gelu__prompt_kernel
.p2align 8
.type interleave_layers__sliding_local_dilated__dense_activation_gelu__prompt_kernel,@function
interleave_layers__sliding_local_dilated__dense_activation_gelu__prompt_kernel:
s_cmp_ge_u32 s2, 256
s_cbranch_scc1 L_abort
s_load_dwordx16 s[80:95], s[0:1], 0
s_load_dwordx4 s[40:43], s[0:1], 64
s_load_dwordx2 s[4:5], s[0:1], 80
s_memrealtime s[98:99]
s_getpc_b64 s[16:17]
s_lshr_b32 s15, s2, 3
s_and_b32 s9, s15, 7
v_lshrrev_b32 v1, 6, v0
v_and_b32 v0, 63, v0
v_lshlrev_b32 v2, 11, v1
v_lshl_add_u32 v2, v0, 7, v2
s_lshl_b32 s18, s9, 13
s_add_u32 s16, s16, s18
s_addc_u32 s17, s17, 0
v_readfirstlane_b32 s8, v1
s_mov_b64 exec, 0xffff
global_load_dword v18, v2, s[16:17]
s_mov_b64 exec, -1
v_lshrrev_b32 v104, 3, v0
v_and_b32 v105, 7, v0
v_lshrrev_b32 v111, 4, v0
s_lshr_b32 s44, s15, 3
s_lshl_b32 s14, s44, 4
s_and_b32 s31, s8, 1
s_lshl_b32 s19, s31, 2
v_and_b32 v106, 1, v111
v_lshl_add_u32 v106, v106, 1, s19
v_xor_b32 v106, v106, v105
v_mul_u32_u24 v254, 3072, v104
v_lshl_add_u32 v254, v106, 4, v254
s_mul_i32 s61, s8, 3072
s_lshl_b32 s55, s61, 3
s_lshl_b32 s15, s9, 7
s_add_u32 s55, s55, s15
s_lshl_b32 s16, s2, 2
s_add_u32 s16, s16, s8
s_mul_i32 s16, s16, 1536
v_lshlrev_b32 v2, 7, v0
s_mov_b32 s66, 0x180000
s_mov_b32 s67, 0x20000
s_waitcnt lgkmcnt(0)
s_mov_b32 s64, s82
s_mov_b32 s65, s83
s_mov_b64 exec, 0xfff
buffer_load_dword v18, v2, s[64:67], s16 offen
s_mov_b64 exec, -1
s_mov_b32 s66, 0x180000
s_mov_b32 s67, 0x20000
s_waitcnt lgkmcnt(0)
s_mov_b32 s64, s82
s_mov_b32 s65, s83
s_add_u32 s28, s14, 0
s_and_b32 s28, s28, 15
s_mul_i32 s28, s28, 98304
s_add_u32 s28, s28, s55
s_add_u32 m0, s61, 81920
s_nop 0
buffer_load_dwordx4 v254, s[64:67], s28 offen lds
buffer_load_dwordx4 v254, s[64:67], s28 offen offset:1024 lds
buffer_load_dwordx4 v254, s[64:67], s28 offen offset:2048 lds
v_add_u32 v106, s19, v111
v_xor_b32 v106, v106, v105
v_lshlrev_b32 v255, 11, v104
v_lshl_add_u32 v255, v106, 4, v255
s_and_b32 s10, s2, 7
s_lshl_b32 s10, s10, 2
s_add_u32 s10, s10, s44
s_lshr_b32 s30, s8, 1
v_lshlrev_b32 v1, 4, v0
v_and_b32 v110, 15, v0
v_mov_b32 v107, 0x40000000
v_cmp_eq_u32 vcc, 0, v0
s_nop 1
v_cndmask_b32 v13, v107, 0, vcc
v_lshlrev_b32 v12, 11, v110
v_lshl_add_u32 v12, v111, 4, v12
s_and_b32 s15, s10, 15
s_lshl_b32 s15, s15, 17
s_lshr_b32 s18, s10, 4
s_lshl_b32 s18, s18, 10
s_add_u32 s15, s15, s18
s_lshl_b32 s18, s30, 15
s_add_u32 s18, s15, s18
s_lshl_b32 s19, s31, 14
s_add_u32 s56, s18, s19
s_add_u32 s56, s56, 65536
s_add_u32 s15, s15, s19
s_sub_u32 s96, s15, 32768
s_lshl_b32 s15, s9, 7
s_lshl_b32 s19, s31, 6
s_add_u32 s97, s15, s19
s_add_u32 s54, s18, s97
s_add_u32 s53, s54, 65536
s_lshl_b32 s18, s8, 10
s_mov_b32 s48, s42
s_mov_b32 s49, s43
s_mov_b32 s50, 0x100
s_mov_b32 s51, 0x20000
s_or_b32 s15, s2, s8
s_cmp_lg_u32 s15, 0
s_cbranch_scc1 L_nononce
s_lshl_b32 s15, s98, 8
s_or_b32 s15, s15, 1
v_mov_b32 v106, s15
buffer_store_dword v106, v13, s[48:51], 0 offen sc1
L_nononce:
s_mov_b32 s68, s80
s_mov_b32 s69, s81
s_mov_b32 s70, 0x200000
s_mov_b32 s71, 0x20000
s_lshl_b32 s29, s14, 6
s_add_u32 s29, s29, 0
s_and_b32 s29, s29, 0x380
s_add_u32 m0, s18, 49152
s_add_u32 s29, s29, s56
buffer_load_dwordx4 v255, s[68:71], s29 offen lds
buffer_load_dwordx4 v[92:95], v12, s[68:71], s53 offen
buffer_load_dwordx4 v[96:99], v12, s[68:71], s54 offen
s_mov_b32 s76, 0
s_mov_b32 s74, 0x40000000
s_cmp_lt_u32 s2, 48
s_cbranch_scc1 L_p_q
s_cmp_lt_u32 s2, 136
s_cbranch_scc1 L_p_1
s_mov_b32 s28, 1024
s_mov_b32 s32, 2
s_mov_b32 s73, 2048
s_and_b32 s29, s2, 7
s_lshl_b32 s16, s29, 2
s_add_u32 s15, s30, s16
s_cmp_lt_u32 s2, 168
s_cbranch_scc1 L_p_o
s_sub_u32 s16, s2, 168
s_lshr_b32 s75, s16, 3
s_mul_i32 s15, s15, 44
s_add_u32 s15, s15, s31
s_lshl_b32 s15, s15, 10
s_add_u32 s72, s15, 0x480000
s_mov_b32 s76, 1
s_waitcnt lgkmcnt(0)
s_mov_b32 s84, s92
s_mov_b32 s85, s93
s_mov_b32 s86, 1409024
s_branch L_p_go
L_p_o:
s_sub_u32 s16, s2, 136
s_lshr_b32 s75, s16, 3
s_lshl_b32 s15, s15, 4
s_add_u32 s15, s15, s31
s_lshr_b32 s16, s75, 1
s_lshl_b32 s16, s16, 4
s_add_u32 s15, s15, s16
s_lshl_b32 s15, s15, 10
s_add_u32 s72, s15, 0x280000
s_waitcnt lgkmcnt(0)
s_mov_b32 s84, s84
s_mov_b32 s85, s85
s_mov_b32 s86, 524288
s_branch L_p_go
L_p_1:
s_movk_i32 s28, 2752
s_sub_u32 s15, s2, 48
s_lshr_b32 s29, s15, 2
s_and_b32 s75, s15, 3
s_mov_b32 s32, 1
s_lshl_b32 s15, s29, 2
s_add_u32 s15, s15, s8
s_mul_i32 s16, s15, 373
s_lshr_b32 s16, s16, 12
s_add_u32 s26, s15, s16
s_cmp_ge_u32 s15, 76
s_cselect_b32 s16, 8, 6
s_add_u32 s27, s15, s16
s_cmp_ge_u32 s15, 66
s_cselect_b32 s26, s27, s26
s_mul_i32 s16, s26, 171
s_lshr_b32 s16, s16, 9
s_mul_i32 s27, s16, 45
s_add_u32 s27, s27, s26
s_lshl_b32 s27, s27, 10
s_add_u32 s72, s27, 0x300000
s_movk_i32 s73, 3072
s_lshl_b32 s26, s26, 2
s_add_u32 s26, s26, s75
s_lshl_b32 s26, s26, 6
s_add_u32 s74, s26, 0x610000
s_cmp_ge_u32 s15, 86
s_cselect_b32 s72, 0x40000000, s72
s_cselect_b32 s74, 0x40000000, s74
s_waitcnt lgkmcnt(0)
s_mov_b32 s84, s88
s_mov_b32 s85, s89
s_mov_b32 s86, 1409024
s_branch L_p_go
L_p_q:
s_movk_i32 s28, 3072
s_lshr_b32 s29, s2, 1
s_and_b32 s75, s2, 1
s_add_u32 s75, s75, 2
s_lshr_b32 s15, s29, 3
s_cmp_eq_u32 s15, 2
s_cselect_b32 s32, 1, 0
s_and_b32 s16, s29, 7
s_lshl_b32 s16, s16, 2
s_add_u32 s16, s16, s8
s_mul_i32 s26, s16, 48
s_add_u32 s26, s26, s15
s_lshl_b32 s26, s26, 10
s_add_u32 s72, s26, 0x100000
s_movk_i32 s73, 3072
s_waitcnt lgkmcnt(0)
s_mov_b32 s84, s82
s_mov_b32 s85, s83
s_mov_b32 s86, 1572864
L_p_go:
s_mov_b32 s87, 0x20000
v_mul_lo_u32 v198, v104, s28
v_lshl_add_u32 v198, v105, 4, v198
s_lshl_b32 s15, s75, 2
s_add_u32 s15, s15, s8
s_lshl_b32 s15, s15, 5
s_mul_i32 s15, s15, s28
s_lshl_b32 s27, s29, 7
s_add_u32 s24, s15, s27
s_lshl_b32 s25, s28, 3
s_lshl_b32 s26, s8, 12
s_lshl_b32 s15, s8, 12
s_add_u32 m0, s15, 144384
s_nop 0
buffer_load_dwordx4 v198, s[84:87], s24 offen lds
s_add_u32 s24, s24, s25
s_lshl_b32 s15, s8, 12
s_add_u32 m0, s15, 145408
s_nop 0
buffer_load_dwordx4 v198, s[84:87], s24 offen lds
s_add_u32 s24, s24, s25
s_lshl_b32 s15, s8, 12
s_add_u32 m0, s15, 146432
s_nop 0
buffer_load_dwordx4 v198, s[84:87], s24 offen lds
s_add_u32 s24, s24, s25
s_lshl_b32 s15, s8, 12
s_add_u32 m0, s15, 147456
s_nop 0
buffer_load_dwordx4 v198, s[84:87], s24 offen lds
s_mov_b32 s79, s2
v_lshlrev_b32 v112, 10, v111
v_bfe_u32 v104, v0, 2, 2
v_lshl_add_u32 v112, v104, 7, v112
v_and_b32 v105, 3, v0
v_and_b32 v106, 1, v105
v_lshlrev_b32 v106, 1, v106
v_lshrrev_b32 v108, 1, v105
v_add_u32 v106, v106, v108
v_mul_u32_u24 v109, 3072, v111
v_lshl_add_u32 v109, v104, 7, v109
v_and_b32 v113, 2, v104
v_and_b32 v114, 1, v111
v_lshl_add_u32 v113, v114, 2, v113
s_lshl_b32 s15, s8, 1
v_lshrrev_b32 v114, 1, v105
v_add_u32 v114, s15, v114
v_xor_b32 v114, v114, v113
v_lshl_add_u32 v252, v114, 4, v109
v_and_b32 v114, 1, v105
v_lshl_add_u32 v252, v114, 3, v252
v_lshrrev_b32 v114, 1, v106
v_add_u32 v114, s15, v114
v_xor_b32 v114, v114, v113
v_lshl_add_u32 v253, v114, 4, v109
v_and_b32 v114, 1, v106
v_lshl_add_u32 v253, v114, 3, v253
v_lshlrev_b32 v108, 1, v105
s_lshl_b32 s15, s8, 2
s_lshl_b32 s16, s30, 3
s_add_u32 s16, s16, s31
s_cmp_eq_u32 s32, 2
s_cselect_b32 s15, s16, s15
s_cselect_b64 s[36:37], -1, 0
s_cmp_eq_u32 s32, 1
s_cselect_b64 s[38:39], -1, 0
v_cndmask_b32 v105, v105, v106, s[38:39]
v_cndmask_b32 v105, v105, v108, s[36:37]
v_add_u32 v105, s15, v105
v_lshl_add_u32 v112, v105, 3, v112
v_add_u32 v112, 0x23400, v112
v_add_u32 v196, 0x14000, v252
v_add_u32 v197, 0x14000, v253
v_lshrrev_b32 v104, 3, v110
v_lshlrev_b32 v104, 10, v104
v_and_b32 v105, 7, v110
v_lshl_add_u32 v104, v105, 7, v104
v_lshrrev_b32 v105, 1, v110
v_add_u32 v106, 0, v111
v_xor_b32 v106, v106, v105
v_lshl_add_u32 v106, v106, 4, v104
v_add_u32 v248, 0x8000, v106
v_add_u32 v250, 0x14000, v106
v_add_u32 v106, 4, v111
v_xor_b32 v106, v106, v105
v_lshl_add_u32 v106, v106, 4, v104
v_add_u32 v249, 0x8000, v106
v_add_u32 v251, 0x14000, v106
s_mul_i32 s15, s9, 11
s_cmp_eq_u32 s9, 7
s_cselect_b32 s15, 76, s15
s_mov_b32 s44, s15
s_cmp_ge_u32 s9, 6
s_cselect_b32 s16, 10, 11
s_mul_i32 s17, s8, 3
s_add_u32 s15, s15, s17
s_sub_u32 s16, s16, s17
s_lshl_b32 s27, s15, 5
s_mov_b32 s20, s40
s_mov_b32 s21, s41
s_mov_b32 s22, 0x200000
s_mov_b32 s23, 0x20000
s_mov_b32 s6, 0x10000000
s_mov_b32 s7, 0x20000
s_add_u32 s17, s15, 0
s_lshr_b32 s19, s17, 1
s_lshl_b32 s19, s19, 11
s_and_b32 s17, s17, 1
s_lshl_b32 s17, s17, 9
s_add_u32 s19, s19, s17
s_cmp_gt_u32 s16, 0
s_cselect_b32 s40, s19, 0x40000000
s_add_u32 s17, s15, 1
s_lshr_b32 s19, s17, 1
s_lshl_b32 s19, s19, 11
s_and_b32 s17, s17, 1
s_lshl_b32 s17, s17, 9
s_add_u32 s19, s19, s17
s_cmp_gt_u32 s16, 1
s_cselect_b32 s41, s19, 0x40000000
s_movk_i32 s17, 1024
s_cselect_b32 s88, s17, 0x40000000
s_add_u32 s17, s15, 2
s_lshr_b32 s19, s17, 1
s_lshl_b32 s19, s19, 11
s_and_b32 s17, s17, 1
s_lshl_b32 s17, s17, 9
s_add_u32 s19, s19, s17
s_cmp_gt_u32 s16, 2
s_cselect_b32 s42, s19, 0x40000000
s_movk_i32 s17, 2048
s_cselect_b32 s89, s17, 0x40000000
s_lshl_b32 s15, s10, 16
s_add_u32 s47, s15, 0x1000000
s_mul_i32 s15, s10, 0x2c000
s_add_u32 s12, s15, 0x1600000
s_mov_b32 s100, s47
s_lshl_b32 s15, s10, 18
s_add_u32 s47, s15, 0x3000000
s_lshl_b32 s16, s31, 7
s_lshl_b32 s52, s31, 6
s_lshl_b32 s15, s10, 13
s_add_u32 s15, s15, 0x1000000
s_add_u32 s13, s15, s16
s_lshl_b32 s17, s9, 1
s_add_u32 s17, s17, s31
s_lshl_b32 s15, s17, 8
s_lshl_b32 s19, s30, 7
s_add_u32 s15, s15, s19
s_sub_u32 s63, s15, s16
s_lshl_b32 s15, s17, 11
s_lshl_b32 s19, s30, 10
s_add_u32 s62, s15, s19
s_lshl_b32 s15, s9, 1
s_add_u32 s15, s15, s30
s_lshl_b32 s15, s15, 11
s_lshl_b32 s19, s31, 9
s_add_u32 s39, s15, s19
s_getreg_b32 s11, hwreg(HW_REG_XCC_ID, 0, 3)
s_and_b32 s15, s10, 15
s_cmp_eq_u32 s15, 0
s_cselect_b32 s33, 1, 0
s_cselect_b32 s38, 0xf149f2ca, 0
s_cselect_b32 s93, 0x40000000, s96
s_mov_b32 s95, s97
s_lshl_b32 s15, s9, 2
s_add_u32 s15, s15, s8
s_lshl_b32 s45, s15, 2
s_mul_i32 s43, s15, 768
s_mov_b32 s34, 0x3eb8aa3b
s_mov_b32 s35, 0x3eb8aa3b
s_mov_b32 s36, 0x409d30fc
s_mov_b32 s37, 0x3eeff558
s_lshl_b32 s15, s10, 14
s_add_u32 s15, s15, 0x1c00000
s_lshl_b32 s19, s17, 10
s_add_u32 s59, s15, s19
s_lshl_b32 s94, s8, 12
s_add_u32 s15, s15, s94
s_sub_u32 s57, s15, 16384
s_lshl_b32 s15, s10, 12
s_add_u32 s15, s15, 0x1d80000
s_lshl_b32 s19, s17, 8
s_add_u32 s60, s15, s19
s_sub_u32 s58, s15, 4096
s_cmp_eq_u32 s30, 0
s_cselect_b32 s59, 0x40000000, s59
s_cselect_b32 s60, 0x40000000, s60
s_cmp_lg_u32 s33, 0
s_cselect_b32 s57, 0x40000000, s57
s_cselect_b32 s58, 0x40000000, s58
s_lshl_b32 s92, s10, 12
s_add_u32 s92, s92, 4096
s_add_u32 s45, s45, s92
s_sub_u32 s92, s92, 2048
s_lshl_b32 s96, s8, 11
s_mov_b32 s3, s96
s_lshl_b32 s15, s30, 11
s_lshl_b32 s16, s31, 14
s_add_u32 s97, s15, s16
s_mul_i32 s16, s31, 43008
s_add_u32 s19, s15, s16
s_lshl_b32 s15, s30, 12
s_lshl_b32 s16, s31, 11
s_add_u32 s2, s15, s16
s_lshl_b32 s17, s30, 13
s_lshl_b32 s16, s31, 10
s_add_u32 s17, s17, s16
v_add_u32 v2, 0x10000, v1
v_lshrrev_b32 v3, 5, v0
v_lshlrev_b32 v3, 10, v3
v_and_b32 v106, 31, v0
v_lshl_add_u32 v3, v106, 4, v3
v_lshlrev_b32 v4, 2, v106
v_add_u32 v4, 2048, v4
v_lshlrev_b32 v5, 2, v110
v_add_u32 v5, 0x22000, v5
s_lshl_b32 s15, s8, 10
s_add_u32 s15, s15, 0x22400
v_lshlrev_b32 v6, 4, v111
v_add_u32 v6, s15, v6
s_mul_i32 s15, s30, 3072
v_add_u32 v7, s15, v1
v_add_u32 v9, s15, v2
s_lshl_b32 s15, s30, 10
s_add_u32 s15, s15, 1024
v_add_u32 v8, s15, v1
v_add_u32 v10, s15, v2
v_lshrrev_b32 v106, 1, v111
v_lshlrev_b32 v106, 2, v106
v_lshl_add_u32 v106, v110, 3, v106
v_and_b32 v108, 1, v111
v_cmp_eq_u32 vcc, 0, v108
s_nop 1
v_cndmask_b32 v11, v107, v106, vcc
v_lshlrev_b32 v106, 3, v110
v_lshl_add_u32 v14, v111, 10, v106
v_and_b32 v174, 48, v0
v_cmp_eq_u32 vcc, 0, v110
s_nop 1
v_cndmask_b32 v174, v107, v174, vcc
v_lshlrev_b32 v106, 2, v111
v_sub_u32 v106, v106, v110
v_mov_b32 v109, 0xf149f2ca
v_add_u32 v108, 0, v106
v_cmp_lt_i32 vcc, 8, v108
s_nop 1
v_cndmask_b32 v36, v109, 0, vcc
v_add_u32 v108, 7, v108
v_cmp_gt_u32 vcc, 8, v108
s_nop 1
v_cndmask_b32 v40, v109, 0, vcc
v_add_u32 v108, 1, v106
v_cmp_lt_i32 vcc, 8, v108
s_nop 1
v_cndmask_b32 v37, v109, 0, vcc
v_add_u32 v108, 7, v108
v_cmp_gt_u32 vcc, 8, v108
s_nop 1
v_cndmask_b32 v41, v109, 0, vcc
v_add_u32 v108, 2, v106
v_cmp_lt_i32 vcc, 8, v108
s_nop 1
v_cndmask_b32 v38, v109, 0, vcc
v_add_u32 v108, 7, v108
v_cmp_gt_u32 vcc, 8, v108
s_nop 1
v_cndmask_b32 v42, v109, 0, vcc
v_add_u32 v108, 3, v106
v_cmp_lt_i32 vcc, 8, v108
s_nop 1
v_cndmask_b32 v39, v109, 0, vcc
v_add_u32 v108, 7, v108
v_cmp_gt_u32 vcc, 8, v108
s_nop 1
v_cndmask_b32 v43, v109, 0, vcc
v_add_u32 v106, 0x27400, v1
ds_write_b128 v106, v[36:39]
ds_write_b128 v106, v[40:43] offset:1024
v_add_u32 v175, s92, v4
v_add_u32 v106, -1920, v175
s_cmp_eq_u32 s33, 0
s_cselect_b32 s16, 0, 64
s_add_u32 s16, s16, 31
v_cmp_lt_u32 vcc, s16, v0
s_nop 1
v_cndmask_b32 v175, v175, v106, vcc
v_lshrrev_b32 v106, 2, v0
s_lshr_b32 s15, s44, 2
v_add_u32 v106, s15, v106
v_min_u32 v106, 21, v106
v_and_b32 v108, 3, v0
v_lshl_add_u32 v106, v106, 2, v108
v_add_u32 v106, 48, v106
v_min_u32 v108, 30, v0
v_lshlrev_b32 v108, 3, v108
s_add_u32 s15, s9, 8
v_add_u32 v108, s15, v108
v_cmp_lt_u32 vcc, 15, v0
s_nop 1
v_cndmask_b32 v106, v106, v108, vcc
v_min_u32 v108, 37, v0
v_bfe_u32 v109, v108, 1, 2
v_lshlrev_b32 v109, 4, v109
v_and_b32 v108, 1, v108
v_add_u32 v108, v108, v109
s_lshl_b32 s15, s9, 1
v_add_u32 v108, s15, v108
v_cmp_lt_u32 vcc, 31, v0
s_nop 1
v_cndmask_b32 v106, v106, v108, vcc
v_lshlrev_b32 v106, 7, v106
v_add_u32 v19, 0x40000, v106
v_mov_b32 v168, 0x3f803f80
v_mov_b32 v169, 0x3f803f80
v_mov_b32 v170, 0x3f803f80
v_mov_b32 v171, 0x3f803f80
v_mov_b32 v0, -1
v_mov_b32 v108, 0
buffer_load_dword v16, v108, s[48:51], 0 offen sc1
s_add_u32 s28, s14, 1
s_and_b32 s28, s28, 15
s_mul_i32 s28, s28, 98304
s_add_u32 s28, s28, s55
s_add_u32 m0, s61, 94208
s_nop 0
buffer_load_dwordx4 v254, s[64:67], s28 offen lds
buffer_load_dwordx4 v254, s[64:67], s28 offen offset:1024 lds
buffer_load_dwordx4 v254, s[64:67], s28 offen offset:2048 lds
s_waitcnt vmcnt(8)
v_lshlrev_b32 v20, 16, v92
v_and_b32 v21, 0xffff0000, v92
v_lshlrev_b32 v22, 16, v93
v_and_b32 v23, 0xffff0000, v93
v_lshlrev_b32 v24, 16, v94
v_and_b32 v25, 0xffff0000, v94
v_lshlrev_b32 v26, 16, v95
v_and_b32 v27, 0xffff0000, v95
v_lshlrev_b32 v28, 16, v96
v_and_b32 v29, 0xffff0000, v96
v_lshlrev_b32 v30, 16, v97
v_and_b32 v31, 0xffff0000, v97
v_lshlrev_b32 v32, 16, v98
v_and_b32 v33, 0xffff0000, v98
v_lshlrev_b32 v34, 16, v99
v_and_b32 v35, 0xffff0000, v99
s_lshl_b32 s29, s14, 6
s_add_u32 s29, s29, 128
s_and_b32 s29, s29, 0x380
s_add_u32 m0, s18, 53248
s_add_u32 s29, s29, s56
buffer_load_dwordx4 v255, s[68:71], s29 offen lds
s_add_u32 s28, s14, 2
s_and_b32 s28, s28, 15
s_mul_i32 s28, s28, 98304
s_add_u32 s28, s28, s55
s_add_u32 m0, s61, 106496
s_nop 0
buffer_load_dwordx4 v254, s[64:67], s28 offen lds
buffer_load_dwordx4 v254, s[64:67], s28 offen offset:1024 lds
buffer_load_dwordx4 v254, s[64:67], s28 offen offset:2048 lds
s_mov_b32 s84, s90
s_mov_b32 s85, s91
s_movk_i32 s86, 2752
v_and_b32 v105, 1, v111
v_lshlrev_b32 v105, 4, v105
v_lshrrev_b32 v106, 1, v111
v_lshl_add_u32 v105, v106, 3, v105
buffer_load_dwordx2 v[176:177], v105, s[84:87], s27 offen offset:0
buffer_load_dwordx2 v[178:179], v105, s[84:87], s27 offen offset:32
buffer_load_dwordx2 v[180:181], v105, s[84:87], s27 offen offset:64
s_lshl_b32 s15, s9, 2
s_add_u32 s15, s15, s8
s_mul_i32 s24, s15, 49152
s_add_u32 s26, s24, 0x300000
s_add_u32 s24, s24, 0x100000
s_lshl_b32 s25, s15, 14
s_add_u32 s25, s25, 0x280000
s_mul_i32 s27, s15, 45056
s_add_u32 s27, s27, 0x480000
s_sub_u32 s90, s92, 1920
s_lshl_b32 s91, s8, 10
s_add_u32 s91, s91, 0x400
v_pk_add_f32 v[92:93], v[20:21], v[22:23]
v_pk_add_f32 v[94:95], v[24:25], v[26:27]
v_pk_mul_f32 v[96:97], v[20:21], v[20:21]
v_pk_add_f32 v[92:93], v[92:93], v[94:95]
v_pk_fma_f32 v[96:97], v[22:23], v[22:23], v[96:97]
v_pk_fma_f32 v[96:97], v[24:25], v[24:25], v[96:97]
v_pk_fma_f32 v[96:97], v[26:27], v[26:27], v[96:97]
v_add_f32 v92, v92, v93
v_add_f32 v96, v96, v97
s_add_u32 s16, s13, s63
s_add_u32 s16, s16, 0xd00000
v_permlane32_swap_b32 v92, v96
v_add_f32 v92, v92, v96
v_mov_b32 v96, v92
s_add_u32 s15, s59, 0x0
s_add_u32 s46, s60, 0x0
v_permlane16_swap_b32 v92, v96
v_add_f32 v92, v92, v96
buffer_store_dword v92, v11, s[4:7], s16 offen sc1
buffer_store_dword v92, v11, s[4:7], s46 offen sc1
v_pk_add_f32 v[98:99], v[28:29], v[30:31]
v_pk_add_f32 v[100:101], v[32:33], v[34:35]
v_pk_mul_f32 v[102:103], v[28:29], v[28:29]
v_pk_add_f32 v[98:99], v[98:99], v[100:101]
v_pk_fma_f32 v[102:103], v[30:31], v[30:31], v[102:103]
v_pk_fma_f32 v[102:103], v[32:33], v[32:33], v[102:103]
v_pk_fma_f32 v[102:103], v[34:35], v[34:35], v[102:103]
v_add_f32 v98, v98, v99
v_add_f32 v102, v102, v103
s_add_u32 s16, s13, s63
s_add_u32 s16, s16, 0xd01000
v_permlane32_swap_b32 v98, v102
v_add_f32 v98, v98, v102
v_mov_b32 v102, v98
s_nop 1
v_permlane16_swap_b32 v98, v102
v_add_f32 v98, v98, v102
buffer_store_dword v98, v11, s[4:7], s16 offen sc1
s_waitcnt vmcnt(14) lgkmcnt(0)
s_barrier
s_add_u32 s28, s14, 3
s_and_b32 s28, s28, 15
s_mul_i32 s28, s28, 98304
s_add_u32 s28, s28, s55
s_add_u32 m0, s61, 118784
s_nop 0
buffer_load_dwordx4 v254, s[64:67], s28 offen lds
ds_read_b64_tr_b16 a[0:1], v196 offset:0
ds_read_b64_tr_b16 a[2:3], v196 offset:512
ds_read_b64_tr_b16 a[4:5], v196 offset:1024
ds_read_b64_tr_b16 a[6:7], v196 offset:1536
ds_read_b64_tr_b16 a[8:9], v197 offset:2048
ds_read_b64_tr_b16 a[10:11], v197 offset:2560
ds_read_b128 v[68:71], v248 offset:16384
ds_read_b128 v[72:75], v248 offset:18432
buffer_load_dwordx4 v254, s[64:67], s28 offen offset:1024 lds
s_waitcnt lgkmcnt(7)
ds_read_b64_tr_b16 v[128:129], v112 offset:0
ds_read_b64_tr_b16 v[130:131], v112 offset:512
ds_read_b64_tr_b16 v[132:133], v112 offset:4096
ds_read_b64_tr_b16 v[134:135], v112 offset:4608
ds_read_b64_tr_b16 v[136:137], v112 offset:8192
ds_read_b64_tr_b16 v[138:139], v112 offset:8704
ds_read_b64_tr_b16 v[140:141], v112 offset:12288
ds_read_b64_tr_b16 v[142:143], v112 offset:12800
buffer_load_dwordx4 v254, s[64:67], s28 offen offset:2048 lds
s_lshl_b32 s29, s14, 6
s_add_u32 s29, s29, 256
s_and_b32 s29, s29, 0x380
s_add_u32 m0, s18, 57344
s_add_u32 s29, s29, s56
buffer_load_dwordx4 v255, s[68:71], s29 offen lds
s_add_u32 s28, s14, 4
s_and_b32 s28, s28, 15
s_mul_i32 s28, s28, 98304
s_add_u32 s28, s28, s55
s_add_u32 m0, s61, 0
s_nop 0
buffer_load_dwordx4 v254, s[64:67], s28 offen lds
s_waitcnt vmcnt(15) lgkmcnt(0)
s_barrier
buffer_load_dwordx4 v254, s[64:67], s28 offen offset:1024 lds
ds_read_b64_tr_b16 a[12:13], v196 offset:12288
ds_read_b64_tr_b16 a[14:15], v196 offset:12800
ds_read_b64_tr_b16 a[16:17], v196 offset:13312
ds_read_b64_tr_b16 a[18:19], v196 offset:13824
ds_read_b64_tr_b16 a[20:21], v197 offset:14336
ds_read_b64_tr_b16 a[22:23], v197 offset:14848
ds_read_b128 v[76:79], v249 offset:16384
ds_read_b128 v[80:83], v249 offset:18432
buffer_load_dwordx4 v254, s[64:67], s28 offen offset:2048 lds
v_mfma_f32_16x16x32_bf16 v[164:167], v[128:131], v[168:171], 0
v_mfma_f32_16x16x32_bf16 v[164:167], v[132:135], v[168:171], v[164:167]
v_mfma_f32_16x16x32_bf16 v[164:167], v[136:139], v[168:171], v[164:167]
v_mfma_f32_16x16x32_bf16 v[164:167], v[140:143], v[168:171], v[164:167]
v_cmp_eq_u32 vcc, 0, v16
s_cbranch_vccnz L_spin_2
L_ok_1:
v_readfirstlane_b32 s32, v16
s_and_b32 s32, s32, 0xffffff00
s_or_b32 s15, s32, s11
s_lshr_b32 s32, s32, 3
s_add_u32 s16, s15, 24
v_mov_b32 v15, s16
s_add_u32 s16, s15, 16
v_mov_b32 v160, s16
v_mov_b32 v161, s16
v_mov_b32 v162, s16
v_mov_b32 v163, s16
s_or_b32 s16, s15, 0xf8
v_mov_b32 v172, s16
s_cmp_eq_u32 s8, 0
s_cselect_b32 s15, 0, 0x40000000
v_add_u32 v173, s15, v13
v_mfma_f32_16x16x32_bf16 v[44:47], a[4:7], v[68:71], 0
v_mfma_f32_16x16x32_bf16 v[52:55], v[68:71], a[8:11], 0
s_add_u32 s28, s14, 5
s_and_b32 s28, s28, 15
s_mul_i32 s28, s28, 98304
s_add_u32 s28, s28, s55
s_add_u32 m0, s61, 12288
s_nop 0
buffer_load_dwordx4 v254, s[64:67], s28 offen lds
v_mfma_f32_16x16x32_bf16 v[36:39], a[0:3], v[68:71], 0
v_mfma_f32_16x16x32_bf16 v[48:51], a[4:7], v[72:75], 0
buffer_load_dwordx4 v254, s[64:67], s28 offen offset:1024 lds
v_mfma_f32_16x16x32_bf16 v[56:59], v[72:75], a[8:11], 0
v_mfma_f32_16x16x32_bf16 v[40:43], a[0:3], v[72:75], 0
buffer_load_dwordx4 v254, s[64:67], s28 offen offset:2048 lds
v_mfma_f32_16x16x32_bf16 v[200:203], a[0:3], v[168:171], 0
v_mfma_f32_16x16x32_bf16 v[204:207], a[4:7], v[168:171], 0
v_mfma_f32_16x16x32_bf16 v[208:211], a[8:11], v[168:171], 0
s_waitcnt vmcnt(16) lgkmcnt(0)
s_barrier
s_lshl_b32 s29, s14, 6
s_add_u32 s29, s29, 384
s_and_b32 s29, s29, 0x380
s_add_u32 m0, s18, 61440
s_add_u32 s29, s29, s56
buffer_load_dwordx4 v255, s[68:71], s29 offen lds
ds_read_b64_tr_b16 a[24:25], v196 offset:24576
ds_read_b64_tr_b16 a[26:27], v196 offset:25088
ds_read_b64_tr_b16 a[28:29], v196 offset:25600
ds_read_b64_tr_b16 a[30:31], v196 offset:26112
ds_read_b64_tr_b16 a[32:33], v197 offset:26624
ds_read_b64_tr_b16 a[34:35], v197 offset:27136
ds_read_b128 v[68:71], v248 offset:20480
ds_read_b128 v[72:75], v248 offset:22528
s_add_u32 s28, s14, 6
s_and_b32 s28, s28, 15
s_mul_i32 s28, s28, 98304
s_add_u32 s28, s28, s55
s_add_u32 m0, s61, 24576
s_nop 0
buffer_load_dwordx4 v254, s[64:67], s28 offen lds
v_mfma_f32_16x16x32_bf16 v[44:47], a[16:19], v[76:79], v[44:47]
v_mfma_f32_16x16x32_bf16 v[52:55], v[76:79], a[20:23], v[52:55]
buffer_load_dwordx4 v254, s[64:67], s28 offen offset:1024 lds
v_mfma_f32_16x16x32_bf16 v[36:39], a[12:15], v[76:79], v[36:39]
v_mfma_f32_16x16x32_bf16 v[48:51], a[16:19], v[80:83], v[48:51]
buffer_load_dwordx4 v254, s[64:67], s28 offen offset:2048 lds
v_mfma_f32_16x16x32_bf16 v[56:59], v[80:83], a[20:23], v[56:59]
v_mfma_f32_16x16x32_bf16 v[40:43], a[12:15], v[80:83], v[40:43]
s_add_u32 s28, s14, 7
s_and_b32 s28, s28, 15
s_mul_i32 s28, s28, 98304
s_add_u32 s28, s28, s55
s_add_u32 m0, s61, 36864
s_nop 0
buffer_load_dwordx4 v254, s[64:67], s28 offen lds
v_mfma_f32_16x16x32_bf16 v[200:203], a[12:15], v[168:171], v[200:203]
v_mfma_f32_16x16x32_bf16 v[204:207], a[16:19], v[168:171], v[204:207]
buffer_load_dwordx4 v254, s[64:67], s28 offen offset:1024 lds
v_mfma_f32_16x16x32_bf16 v[208:211], a[20:23], v[168:171], v[208:211]
s_waitcnt vmcnt(13) lgkmcnt(0)
s_barrier
buffer_load_dwordx4 v254, s[64:67], s28 offen offset:2048 lds
ds_read_b64_tr_b16 a[36:37], v196 offset:36864
ds_read_b64_tr_b16 a[38:39], v196 offset:37376
ds_read_b64_tr_b16 a[40:41], v196 offset:37888
ds_read_b64_tr_b16 a[42:43], v196 offset:38400
ds_read_b64_tr_b16 a[44:45], v197 offset:38912
ds_read_b64_tr_b16 a[46:47], v197 offset:39424
ds_read_b128 v[76:79], v249 offset:20480
ds_read_b128 v[80:83], v249 offset:22528
s_lshl_b32 s29, s14, 6
s_add_u32 s29, s29, 512
s_and_b32 s29, s29, 0x380
s_add_u32 m0, s18, 65536
s_add_u32 s29, s29, s56
buffer_load_dwordx4 v255, s[68:71], s29 offen lds
buffer_store_dwordx4 v[160:163], v173, s[4:7], s45 offen sc1
buffer_store_dwordx4 v[160:163], v173, s[4:7], s45 offen offset:2176 sc1
v_mfma_f32_16x16x32_bf16 v[44:47], a[28:31], v[68:71], v[44:47]
v_mfma_f32_16x16x32_bf16 v[52:55], v[68:71], a[32:35], v[52:55]
s_add_u32 s28, s14, 8
s_and_b32 s28, s28, 15
s_mul_i32 s28, s28, 98304
s_add_u32 s28, s28, s55
s_add_u32 m0, s61, 81920
s_nop 0
buffer_load_dwordx4 v254, s[64:67], s28 offen lds
v_mfma_f32_16x16x32_bf16 v[36:39], a[24:27], v[68:71], v[36:39]
v_mfma_f32_16x16x32_bf16 v[48:51], a[28:31], v[72:75], v[48:51]
buffer_load_dwordx4 v254, s[64:67], s28 offen offset:1024 lds
v_mfma_f32_16x16x32_bf16 v[56:59], v[72:75], a[32:35], v[56:59]
v_mfma_f32_16x16x32_bf16 v[40:43], a[24:27], v[72:75], v[40:43]
v_mfma_f32_16x16x32_bf16 v[200:203], a[24:27], v[168:171], v[200:203]
v_mfma_f32_16x16x32_bf16 v[204:207], a[28:31], v[168:171], v[204:207]
v_mfma_f32_16x16x32_bf16 v[208:211], a[32:35], v[168:171], v[208:211]
s_waitcnt vmcnt(15) lgkmcnt(0)
s_barrier
buffer_load_dwordx4 v254, s[64:67], s28 offen offset:2048 lds
ds_read_b64_tr_b16 a[48:49], v252 offset:0
ds_read_b64_tr_b16 a[50:51], v252 offset:512
ds_read_b64_tr_b16 a[52:53], v252 offset:1024
ds_read_b64_tr_b16 a[54:55], v252 offset:1536
ds_read_b64_tr_b16 a[56:57], v253 offset:2048
ds_read_b64_tr_b16 a[58:59], v253 offset:2560
ds_read_b128 v[68:71], v248 offset:24576
ds_read_b128 v[72:75], v248 offset:26624
s_add_u32 s28, s14, 9
s_and_b32 s28, s28, 15
s_mul_i32 s28, s28, 98304
s_add_u32 s28, s28, s55
s_add_u32 m0, s61, 94208
s_nop 0
buffer_load_dwordx4 v254, s[64:67], s28 offen lds
v_mfma_f32_16x16x32_bf16 v[44:47], a[40:43], v[76:79], v[44:47]
v_mfma_f32_16x16x32_bf16 v[52:55], v[76:79], a[44:47], v[52:55]
buffer_load_dwordx4 v254, s[64:67], s28 offen offset:1024 lds
v_mfma_f32_16x16x32_bf16 v[36:39], a[36:39], v[76:79], v[36:39]
v_mfma_f32_16x16x32_bf16 v[48:51], a[40:43], v[80:83], v[48:51]
buffer_load_dwordx4 v254, s[64:67], s28 offen offset:2048 lds
v_mfma_f32_16x16x32_bf16 v[56:59], v[80:83], a[44:47], v[56:59]
v_mfma_f32_16x16x32_bf16 v[40:43], a[36:39], v[80:83], v[40:43]
v_mfma_f32_16x16x32_bf16 v[200:203], a[36:39], v[168:171], v[200:203]
v_mfma_f32_16x16x32_bf16 v[204:207], a[40:43], v[168:171], v[204:207]
v_mfma_f32_16x16x32_bf16 v[208:211], a[44:47], v[168:171], v[208:211]
s_waitcnt vmcnt(16) lgkmcnt(0)
s_barrier
s_lshl_b32 s29, s14, 6
s_add_u32 s29, s29, 640
s_and_b32 s29, s29, 0x380
s_add_u32 m0, s18, 69632
s_add_u32 s29, s29, s56
buffer_load_dwordx4 v255, s[68:71], s29 offen lds
ds_read_b64_tr_b16 a[60:61], v252 offset:12288
ds_read_b64_tr_b16 a[62:63], v252 offset:12800
ds_read_b64_tr_b16 a[64:65], v252 offset:13312
ds_read_b64_tr_b16 a[66:67], v252 offset:13824
ds_read_b64_tr_b16 a[68:69], v253 offset:14336
ds_read_b64_tr_b16 a[70:71], v253 offset:14848
ds_read_b128 v[76:79], v249 offset:24576
ds_read_b128 v[80:83], v249 offset:26624
s_add_u32 s28, s14, 10
s_and_b32 s28, s28, 15
s_mul_i32 s28, s28, 98304
s_add_u32 s28, s28, s55
s_add_u32 m0, s61, 106496
s_nop 0
buffer_load_dwordx4 v254, s[64:67], s28 offen lds
v_lshlrev_b32 v184, 16, v176
v_and_b32 v185, 0xffff0000, v176
v_lshlrev_b32 v186, 16, v177
v_and_b32 v187, 0xffff0000, v177
v_mul_f32 v184, s37, v184
v_mul_f32 v185, s37, v185
v_mul_f32 v186, s37, v186
v_mul_f32 v187, s37, v187
ds_write_b128 v6, v[184:187] offset:512
v_lshlrev_b32 v188, 16, v178
v_and_b32 v189, 0xffff0000, v178
v_lshlrev_b32 v190, 16, v179
v_and_b32 v191, 0xffff0000, v179
v_mul_f32 v188, s37, v188
v_mul_f32 v189, s37, v189
v_mul_f32 v190, s37, v190
v_mul_f32 v191, s37, v191
ds_write_b128 v6, v[188:191] offset:576
v_lshlrev_b32 v192, 16, v180
v_and_b32 v193, 0xffff0000, v180
v_lshlrev_b32 v194, 16, v181
v_and_b32 v195, 0xffff0000, v181
v_mul_f32 v192, s37, v192
v_mul_f32 v193, s37, v193
v_mul_f32 v194, s37, v194
v_mul_f32 v195, s37, v195
ds_write_b128 v6, v[192:195] offset:640
v_mfma_f32_16x16x32_bf16 v[44:47], a[52:55], v[68:71], v[44:47]
v_mfma_f32_16x16x32_bf16 v[52:55], v[68:71], a[56:59], v[52:55]
buffer_load_dwordx4 v254, s[64:67], s28 offen offset:1024 lds
v_mfma_f32_16x16x32_bf16 v[36:39], a[48:51], v[68:71], v[36:39]
v_mfma_f32_16x16x32_bf16 v[48:51], a[52:55], v[72:75], v[48:51]
buffer_load_dwordx4 v254, s[64:67], s28 offen offset:2048 lds
v_mfma_f32_16x16x32_bf16 v[56:59], v[72:75], a[56:59], v[56:59]
v_mfma_f32_16x16x32_bf16 v[40:43], a[48:51], v[72:75], v[40:43]
s_add_u32 s28, s14, 11
s_and_b32 s28, s28, 15
s_mul_i32 s28, s28, 98304
s_add_u32 s28, s28, s55
s_add_u32 m0, s61, 118784
s_nop 0
buffer_load_dwordx4 v254, s[64:67], s28 offen lds
v_mfma_f32_16x16x32_bf16 v[200:203], a[48:51], v[168:171], v[200:203]
v_mfma_f32_16x16x32_bf16 v[204:207], a[52:55], v[168:171], v[204:207]
v_mfma_f32_16x16x32_bf16 v[208:211], a[56:59], v[168:171], v[208:211]
s_waitcnt vmcnt(17) lgkmcnt(0)
s_barrier
buffer_load_dwordx4 v254, s[64:67], s28 offen offset:1024 lds
ds_read_b64_tr_b16 a[72:73], v252 offset:24576
ds_read_b64_tr_b16 a[74:75], v252 offset:25088
ds_read_b64_tr_b16 a[76:77], v252 offset:25600
ds_read_b64_tr_b16 a[78:79], v252 offset:26112
ds_read_b64_tr_b16 a[80:81], v253 offset:26624
ds_read_b64_tr_b16 a[82:83], v253 offset:27136
ds_read_b128 v[68:71], v248 offset:28672
ds_read_b128 v[72:75], v248 offset:30720
buffer_load_dwordx4 v254, s[64:67], s28 offen offset:2048 lds
v_mfma_f32_16x16x32_bf16 v[44:47], a[64:67], v[76:79], v[44:47]
v_mfma_f32_16x16x32_bf16 v[52:55], v[76:79], a[68:71], v[52:55]
buffer_load_dword v17, v175, s[4:7], 0 offen sc1
v_mfma_f32_16x16x32_bf16 v[36:39], a[60:63], v[76:79], v[36:39]
v_mfma_f32_16x16x32_bf16 v[48:51], a[64:67], v[80:83], v[48:51]
s_lshl_b32 s29, s14, 6
s_add_u32 s29, s29, 768
s_and_b32 s29, s29, 0x380
s_add_u32 m0, s18, 73728
s_add_u32 s29, s29, s56
buffer_load_dwordx4 v255, s[68:71], s29 offen lds
v_mfma_f32_16x16x32_bf16 v[56:59], v[80:83], a[68:71], v[56:59]
v_mfma_f32_16x16x32_bf16 v[40:43], a[60:63], v[80:83], v[40:43]
s_add_u32 s28, s14, 12
s_and_b32 s28, s28, 15
s_mul_i32 s28, s28, 98304
s_add_u32 s28, s28, s55
s_add_u32 m0, s61, 0
s_nop 0
buffer_load_dwordx4 v254, s[64:67], s28 offen lds
v_mfma_f32_16x16x32_bf16 v[200:203], a[60:63], v[168:171], v[200:203]
v_mfma_f32_16x16x32_bf16 v[204:207], a[64:67], v[168:171], v[204:207]
s_lshl_b32 s15, s75, 2
s_add_u32 s15, s15, 0
s_mul_i32 s16, s15, s73
s_add_u32 s46, s16, 47104
s_cmp_eq_u32 s15, 43
s_cselect_b32 s46, 90112, s46
s_mul_i32 s15, s15, s76
s_cmp_ge_u32 s15, 22
s_cselect_b32 s16, s46, s16
s_add_u32 s16, s16, s72
buffer_store_dwordx4 v[128:131], v1, s[4:7], s16 offen sc1
v_mfma_f32_16x16x32_bf16 v[208:211], a[68:71], v[168:171], v[208:211]
s_lshl_b32 s15, s75, 2
s_add_u32 s15, s15, 1
s_mul_i32 s16, s15, s73
s_add_u32 s46, s16, 47104
s_cmp_eq_u32 s15, 43
s_cselect_b32 s46, 90112, s46
s_mul_i32 s15, s15, s76
s_cmp_ge_u32 s15, 22
s_cselect_b32 s16, s46, s16
s_add_u32 s16, s16, s72
buffer_store_dwordx4 v[132:135], v1, s[4:7], s16 offen sc1
s_lshl_b32 s15, s75, 2
s_add_u32 s15, s15, 2
s_mul_i32 s16, s15, s73
s_add_u32 s46, s16, 47104
s_cmp_eq_u32 s15, 43
s_cselect_b32 s46, 90112, s46
s_mul_i32 s15, s15, s76
s_cmp_ge_u32 s15, 22
s_cselect_b32 s16, s46, s16
s_add_u32 s16, s16, s72
buffer_store_dwordx4 v[136:139], v1, s[4:7], s16 offen sc1
s_lshl_b32 s15, s75, 2
s_add_u32 s15, s15, 3
s_mul_i32 s16, s15, s73
s_add_u32 s46, s16, 47104
s_cmp_eq_u32 s15, 43
s_cselect_b32 s46, 90112, s46
s_mul_i32 s15, s15, s76
s_cmp_ge_u32 s15, 22
s_cselect_b32 s16, s46, s16
s_add_u32 s16, s16, s72
buffer_store_dwordx4 v[140:143], v1, s[4:7], s16 offen sc1
buffer_store_dwordx4 v[164:167], v174, s[4:7], s74 offen sc1
s_waitcnt vmcnt(24) lgkmcnt(0)
s_barrier
buffer_load_dwordx4 v254, s[64:67], s28 offen offset:1024 lds
ds_read_b64_tr_b16 a[84:85], v252 offset:36864
ds_read_b64_tr_b16 a[86:87], v252 offset:37376
ds_read_b64_tr_b16 a[88:89], v252 offset:37888
ds_read_b64_tr_b16 a[90:91], v252 offset:38400
ds_read_b64_tr_b16 a[92:93], v253 offset:38912
ds_read_b64_tr_b16 a[94:95], v253 offset:39424
ds_read_b128 v[76:79], v249 offset:28672
ds_read_b128 v[80:83], v249 offset:30720
buffer_load_dwordx4 v254, s[64:67], s28 offen offset:2048 lds
v_mfma_f32_16x16x32_bf16 v[44:47], a[76:79], v[68:71], v[44:47]
v_mfma_f32_16x16x32_bf16 v[52:55], v[68:71], a[80:83], v[52:55]
s_add_u32 s28, s14, 13
s_and_b32 s28, s28, 15
s_mul_i32 s28, s28, 98304
s_add_u32 s28, s28, s55
s_add_u32 m0, s61, 12288
s_nop 0
buffer_load_dwordx4 v254, s[64:67], s28 offen lds
v_mfma_f32_16x16x32_bf16 v[36:39], a[72:75], v[68:71], v[36:39]
v_mfma_f32_16x16x32_bf16 v[48:51], a[76:79], v[72:75], v[48:51]
buffer_load_dwordx4 v254, s[64:67], s28 offen offset:1024 lds
v_mfma_f32_16x16x32_bf16 v[56:59], v[72:75], a[80:83], v[56:59]
v_mfma_f32_16x16x32_bf16 v[40:43], a[72:75], v[72:75], v[40:43]
v_mfma_f32_16x16x32_bf16 v[200:203], a[72:75], v[168:171], v[200:203]
v_mfma_f32_16x16x32_bf16 v[204:207], a[76:79], v[168:171], v[204:207]
v_mfma_f32_16x16x32_bf16 v[208:211], a[80:83], v[168:171], v[208:211]
s_waitcnt vmcnt(22) lgkmcnt(0)
s_barrier
buffer_load_dwordx4 v254, s[64:67], s28 offen offset:2048 lds
ds_read_b64_tr_b16 a[96:97], v196 offset:0
ds_read_b64_tr_b16 a[98:99], v196 offset:512
ds_read_b64_tr_b16 a[100:101], v196 offset:1024
ds_read_b64_tr_b16 a[102:103], v196 offset:1536
ds_read_b64_tr_b16 a[104:105], v197 offset:2048
ds_read_b64_tr_b16 a[106:107], v197 offset:2560
ds_read_b128 v[68:71], v248 offset:32768
ds_read_b128 v[72:75], v248 offset:34816
s_lshl_b32 s29, s14, 6
s_add_u32 s29, s29, 896
s_and_b32 s29, s29, 0x380
s_add_u32 m0, s18, 77824
s_add_u32 s29, s29, s56
buffer_load_dwordx4 v255, s[68:71], s29 offen lds
s_add_u32 s46, s32, 2
s_waitcnt vmcnt(13)
v_lshrrev_b32 v17, 3, v17
v_subrev_u32 v17, s46, v17
v_cmp_lt_u32 vcc, 31, v17
s_cbranch_vccnz L_spin_4
L_ok_3:
buffer_load_dword v16, v4, s[4:7], s92 offen sc1
v_mfma_f32_16x16x32_bf16 v[44:47], a[88:91], v[76:79], v[44:47]
v_mfma_f32_16x16x32_bf16 v[52:55], v[76:79], a[92:95], v[52:55]
s_add_u32 s46, s13, 0xd00000
buffer_load_dwordx2 v[120:121], v14, s[4:7], s46 offen sc1
buffer_load_dwordx2 v[122:123], v14, s[4:7], s46 offen offset:256 sc1
v_mfma_f32_16x16x32_bf16 v[36:39], a[84:87], v[76:79], v[36:39]
v_mfma_f32_16x16x32_bf16 v[48:51], a[88:91], v[80:83], v[48:51]
s_add_u32 s46, s13, 0xd00000
buffer_load_dwordx2 v[124:125], v14, s[4:7], s46 offen offset:512 sc1
buffer_load_dwordx2 v[126:127], v14, s[4:7], s46 offen offset:768 sc1
v_mfma_f32_16x16x32_bf16 v[56:59], v[80:83], a[92:95], v[56:59]
v_mfma_f32_16x16x32_bf16 v[40:43], a[84:87], v[80:83], v[40:43]
s_add_u32 s28, s14, 14
s_and_b32 s28, s28, 15
s_mul_i32 s28, s28, 98304
s_add_u32 s28, s28, s55
s_add_u32 m0, s61, 24576
s_nop 0
buffer_load_dwordx4 v254, s[64:67], s28 offen lds
v_mfma_f32_16x16x32_bf16 v[200:203], a[84:87], v[168:171], v[200:203]
v_mfma_f32_16x16x32_bf16 v[204:207], a[88:91], v[168:171], v[204:207]
buffer_load_dwordx4 v254, s[64:67], s28 offen offset:1024 lds
v_mfma_f32_16x16x32_bf16 v[208:211], a[92:95], v[168:171], v[208:211]
s_waitcnt vmcnt(13) lgkmcnt(0)
s_barrier
buffer_load_dwordx4 v254, s[64:67], s28 offen offset:2048 lds
ds_read_b64_tr_b16 a[108:109], v196 offset:12288
ds_read_b64_tr_b16 a[110:111], v196 offset:12800
ds_read_b64_tr_b16 a[112:113], v196 offset:13312
ds_read_b64_tr_b16 a[114:115], v196 offset:13824
ds_read_b64_tr_b16 a[116:117], v197 offset:14336
ds_read_b64_tr_b16 a[118:119], v197 offset:14848
ds_read_b128 v[76:79], v249 offset:32768
ds_read_b128 v[80:83], v249 offset:34816
s_add_u32 s28, s14, 15
s_and_b32 s28, s28, 15
s_mul_i32 s28, s28, 98304
s_add_u32 s28, s28, s55
s_add_u32 m0, s61, 36864
s_nop 0
buffer_load_dwordx4 v254, s[64:67], s28 offen lds
s_lshl_b32 s15, s79, 7
s_add_u32 s15, s15, 0x40000
buffer_store_dword v172, v173, s[4:7], s15 offen sc1
v_mfma_f32_16x16x32_bf16 v[44:47], a[100:103], v[68:71], v[44:47]
v_mfma_f32_16x16x32_bf16 v[52:55], v[68:71], a[104:107], v[52:55]
buffer_load_dwordx4 v254, s[64:67], s28 offen offset:1024 lds
v_mfma_f32_16x16x32_bf16 v[36:39], a[96:99], v[68:71], v[36:39]
v_mfma_f32_16x16x32_bf16 v[48:51], a[100:103], v[72:75], v[48:51]
buffer_load_dwordx4 v254, s[64:67], s28 offen offset:2048 lds
v_mfma_f32_16x16x32_bf16 v[56:59], v[72:75], a[104:107], v[56:59]
v_mfma_f32_16x16x32_bf16 v[40:43], a[96:99], v[72:75], v[40:43]
v_mfma_f32_16x16x32_bf16 v[200:203], a[96:99], v[168:171], v[200:203]
v_mfma_f32_16x16x32_bf16 v[204:207], a[100:103], v[168:171], v[204:207]
v_mfma_f32_16x16x32_bf16 v[208:211], a[104:107], v[168:171], v[208:211]
s_waitcnt lgkmcnt(0)
s_barrier
ds_read_b64_tr_b16 a[120:121], v196 offset:24576
ds_read_b64_tr_b16 a[122:123], v196 offset:25088
ds_read_b64_tr_b16 a[124:125], v196 offset:25600
ds_read_b64_tr_b16 a[126:127], v196 offset:26112
ds_read_b64_tr_b16 a[128:129], v197 offset:26624
ds_read_b64_tr_b16 a[130:131], v197 offset:27136
ds_read_b128 v[68:71], v248 offset:36864
ds_read_b128 v[72:75], v248 offset:38912
v_mfma_f32_16x16x32_bf16 v[44:47], a[112:115], v[76:79], v[44:47]
v_mfma_f32_16x16x32_bf16 v[52:55], v[76:79], a[116:119], v[52:55]
v_mfma_f32_16x16x32_bf16 v[36:39], a[108:111], v[76:79], v[36:39]
v_mfma_f32_16x16x32_bf16 v[48:51], a[112:115], v[80:83], v[48:51]
v_mfma_f32_16x16x32_bf16 v[56:59], v[80:83], a[116:119], v[56:59]
v_mfma_f32_16x16x32_bf16 v[40:43], a[108:111], v[80:83], v[40:43]
v_mfma_f32_16x16x32_bf16 v[200:203], a[108:111], v[168:171], v[200:203]
v_mfma_f32_16x16x32_bf16 v[204:207], a[112:115], v[168:171], v[204:207]
v_mfma_f32_16x16x32_bf16 v[208:211], a[116:119], v[168:171], v[208:211]
s_waitcnt lgkmcnt(0)
s_barrier
s_lshl_b32 s29, s14, 6
s_add_u32 s29, s29, 0
s_and_b32 s29, s29, 0x380
s_add_u32 m0, s18, 81920
s_add_u32 s29, s29, s56
s_add_u32 s29, s29, 0xffff0000
buffer_load_dwordx4 v255, s[68:71], s29 offen lds
ds_read_b64_tr_b16 a[132:133], v196 offset:36864
ds_read_b64_tr_b16 a[134:135], v196 offset:37376
ds_read_b64_tr_b16 a[136:137], v196 offset:37888
ds_read_b64_tr_b16 a[138:139], v196 offset:38400
ds_read_b64_tr_b16 a[140:141], v197 offset:38912
ds_read_b64_tr_b16 a[142:143], v197 offset:39424
ds_read_b128 v[76:79], v249 offset:36864
ds_read_b128 v[80:83], v249 offset:38912
s_lshl_b32 s29, s14, 6
s_add_u32 s29, s29, 128
s_and_b32 s29, s29, 0x380
s_add_u32 m0, s18, 86016
s_add_u32 s29, s29, s56
s_add_u32 s29, s29, 0xffff0000
buffer_load_dwordx4 v255, s[68:71], s29 offen lds
v_mfma_f32_16x16x32_bf16 v[44:47], a[124:127], v[68:71], v[44:47]
v_mfma_f32_16x16x32_bf16 v[52:55], v[68:71], a[128:131], v[52:55]
s_lshl_b32 s29, s14, 6
s_add_u32 s29, s29, 256
s_and_b32 s29, s29, 0x380
s_add_u32 m0, s18, 90112
s_add_u32 s29, s29, s56
s_add_u32 s29, s29, 0xffff0000
buffer_load_dwordx4 v255, s[68:71], s29 offen lds
v_mfma_f32_16x16x32_bf16 v[36:39], a[120:123], v[68:71], v[36:39]
v_mfma_f32_16x16x32_bf16 v[48:51], a[124:127], v[72:75], v[48:51]
s_lshl_b32 s29, s14, 6
s_add_u32 s29, s29, 384
s_and_b32 s29, s29, 0x380
s_add_u32 m0, s18, 94208
s_add_u32 s29, s29, s56
s_add_u32 s29, s29, 0xffff0000
buffer_load_dwordx4 v255, s[68:71], s29 offen lds
v_mfma_f32_16x16x32_bf16 v[56:59], v[72:75], a[128:131], v[56:59]
v_mfma_f32_16x16x32_bf16 v[40:43], a[120:123], v[72:75], v[40:43]
s_lshl_b32 s29, s14, 6
s_add_u32 s29, s29, 512
s_and_b32 s29, s29, 0x380
s_add_u32 m0, s18, 98304
s_add_u32 s29, s29, s56
s_add_u32 s29, s29, 0xffff0000
buffer_load_dwordx4 v255, s[68:71], s29 offen lds
v_mfma_f32_16x16x32_bf16 v[200:203], a[120:123], v[168:171], v[200:203]
v_mfma_f32_16x16x32_bf16 v[204:207], a[124:127], v[168:171], v[204:207]
v_mfma_f32_16x16x32_bf16 v[208:211], a[128:131], v[168:171], v[208:211]
s_waitcnt vmcnt(21) lgkmcnt(0)
s_barrier
s_lshl_b32 s29, s14, 6
s_add_u32 s29, s29, 640
s_and_b32 s29, s29, 0x380
s_add_u32 m0, s18, 102400
s_add_u32 s29, s29, s56
s_add_u32 s29, s29, 0xffff0000
buffer_load_dwordx4 v255, s[68:71], s29 offen lds
ds_read_b64_tr_b16 a[144:145], v252 offset:0
ds_read_b64_tr_b16 a[146:147], v252 offset:512
ds_read_b64_tr_b16 a[148:149], v252 offset:1024
ds_read_b64_tr_b16 a[150:151], v252 offset:1536
ds_read_b64_tr_b16 a[152:153], v253 offset:2048
ds_read_b64_tr_b16 a[154:155], v253 offset:2560
ds_read_b128 v[68:71], v248 offset:40960
ds_read_b128 v[72:75], v248 offset:43008
s_lshl_b32 s29, s14, 6
s_add_u32 s29, s29, 768
s_and_b32 s29, s29, 0x380
s_add_u32 m0, s18, 106496
s_add_u32 s29, s29, s56
s_add_u32 s29, s29, 0xffff0000
buffer_load_dwordx4 v255, s[68:71], s29 offen lds
v_mfma_f32_16x16x32_bf16 v[44:47], a[136:139], v[76:79], v[44:47]
v_mfma_f32_16x16x32_bf16 v[52:55], v[76:79], a[140:143], v[52:55]
s_lshl_b32 s29, s14, 6
s_add_u32 s29, s29, 896
s_and_b32 s29, s29, 0x380
s_add_u32 m0, s18, 110592
s_add_u32 s29, s29, s56
s_add_u32 s29, s29, 0xffff0000
buffer_load_dwordx4 v255, s[68:71], s29 offen lds
v_mfma_f32_16x16x32_bf16 v[36:39], a[132:135], v[76:79], v[36:39]
v_mfma_f32_16x16x32_bf16 v[48:51], a[136:139], v[80:83], v[48:51]
v_mfma_f32_16x16x32_bf16 v[56:59], v[80:83], a[140:143], v[56:59]
v_mfma_f32_16x16x32_bf16 v[40:43], a[132:135], v[80:83], v[40:43]
v_mfma_f32_16x16x32_bf16 v[200:203], a[132:135], v[168:171], v[200:203]
v_mfma_f32_16x16x32_bf16 v[204:207], a[136:139], v[168:171], v[204:207]
v_mfma_f32_16x16x32_bf16 v[208:211], a[140:143], v[168:171], v[208:211]
s_waitcnt vmcnt(21) lgkmcnt(0)
s_barrier
ds_read_b64_tr_b16 a[156:157], v252 offset:12288
ds_read_b64_tr_b16 a[158:159], v252 offset:12800
ds_read_b64_tr_b16 a[160:161], v252 offset:13312
ds_read_b64_tr_b16 a[162:163], v252 offset:13824
ds_read_b64_tr_b16 a[164:165], v253 offset:14336
ds_read_b64_tr_b16 a[166:167], v253 offset:14848
ds_read_b128 v[76:79], v249 offset:40960
ds_read_b128 v[80:83], v249 offset:43008
v_mfma_f32_16x16x32_bf16 v[44:47], a[148:151], v[68:71], v[44:47]
v_mfma_f32_16x16x32_bf16 v[52:55], v[68:71], a[152:155], v[52:55]
s_add_u32 s46, s47, s39
s_add_u32 s46, s46, 0x16000
buffer_load_dword v18, v3, s[4:7], s46 offen sc1
v_mfma_f32_16x16x32_bf16 v[36:39], a[144:147], v[68:71], v[36:39]
v_mfma_f32_16x16x32_bf16 v[48:51], a[148:151], v[72:75], v[48:51]
v_mfma_f32_16x16x32_bf16 v[56:59], v[72:75], a[152:155], v[56:59]
v_mfma_f32_16x16x32_bf16 v[40:43], a[144:147], v[72:75], v[40:43]
v_mfma_f32_16x16x32_bf16 v[200:203], a[144:147], v[168:171], v[200:203]
v_mfma_f32_16x16x32_bf16 v[204:207], a[148:151], v[168:171], v[204:207]
v_mfma_f32_16x16x32_bf16 v[208:211], a[152:155], v[168:171], v[208:211]
s_waitcnt vmcnt(13) lgkmcnt(0)
s_barrier
ds_read_b64_tr_b16 a[168:169], v252 offset:24576
ds_read_b64_tr_b16 a[170:171], v252 offset:25088
ds_read_b64_tr_b16 a[172:173], v252 offset:25600
ds_read_b64_tr_b16 a[174:175], v252 offset:26112
ds_read_b64_tr_b16 a[176:177], v253 offset:26624
ds_read_b64_tr_b16 a[178:179], v253 offset:27136
ds_read_b128 v[68:71], v248 offset:45056
ds_read_b128 v[72:75], v248 offset:47104
v_add_f32 v120, v120, v122
v_add_f32 v124, v124, v126
v_add_f32 v121, v121, v123
v_add_f32 v125, v125, v127
v_add_f32 v120, v120, v124
v_add_f32 v121, v121, v125
v_add_u32 v122, s52, v5
s_nop 0
v_permlane32_swap_b32 v120, v121
v_add_f32 v120, v120, v121
v_mov_b32 v121, v120
s_nop 1
v_permlane16_swap_b32 v120, v121
v_add_f32 v120, v120, v121
v_mov_b32 v121, v120
s_nop 1
v_permlane32_swap_b32 v120, v121
v_mul_f32 v120, 0x3b000000, v120
v_mul_f32 v121, 0x3b000000, v121
v_fma_f32 v121, -v120, v120, v121
v_max_f32 v121, 0, v121
v_add_f32 v121, 0x3727c5ac, v121
v_rsq_f32 v121, v121
v_sub_f32 v120, 0, v120
v_mul_f32 v120, v120, v121
ds_write_b32 v122, v121 offset:192
ds_write_b32 v122, v120 offset:512
v_mfma_f32_16x16x32_bf16 v[44:47], a[160:163], v[76:79], v[44:47]
v_mfma_f32_16x16x32_bf16 v[52:55], v[76:79], a[164:167], v[52:55]
s_add_u32 s46, s13, 0xd01000
buffer_load_dwordx2 v[120:121], v14, s[4:7], s46 offen sc1
buffer_load_dwordx2 v[122:123], v14, s[4:7], s46 offen offset:256 sc1
v_mfma_f32_16x16x32_bf16 v[36:39], a[156:159], v[76:79], v[36:39]
v_mfma_f32_16x16x32_bf16 v[48:51], a[160:163], v[80:83], v[48:51]
s_add_u32 s46, s13, 0xd01000
buffer_load_dwordx2 v[124:125], v14, s[4:7], s46 offen offset:512 sc1
buffer_load_dwordx2 v[126:127], v14, s[4:7], s46 offen offset:768 sc1
v_mfma_f32_16x16x32_bf16 v[56:59], v[80:83], a[164:167], v[56:59]
v_mfma_f32_16x16x32_bf16 v[40:43], a[156:159], v[80:83], v[40:43]
v_mfma_f32_16x16x32_bf16 v[200:203], a[156:159], v[168:171], v[200:203]
v_mfma_f32_16x16x32_bf16 v[204:207], a[160:163], v[168:171], v[204:207]
v_mfma_f32_16x16x32_bf16 v[208:211], a[164:167], v[168:171], v[208:211]
s_waitcnt vmcnt(13) lgkmcnt(0)
s_barrier
ds_read_b64_tr_b16 a[180:181], v252 offset:36864
ds_read_b64_tr_b16 a[182:183], v252 offset:37376
ds_read_b64_tr_b16 a[184:185], v252 offset:37888
ds_read_b64_tr_b16 a[186:187], v252 offset:38400
ds_read_b64_tr_b16 a[188:189], v253 offset:38912
ds_read_b64_tr_b16 a[190:191], v253 offset:39424
ds_read_b128 v[76:79], v249 offset:45056
ds_read_b128 v[80:83], v249 offset:47104
v_mfma_f32_16x16x32_bf16 v[44:47], a[172:175], v[68:71], v[44:47]
v_mfma_f32_16x16x32_bf16 v[52:55], v[68:71], a[176:179], v[52:55]
v_mfma_f32_16x16x32_bf16 v[36:39], a[168:171], v[68:71], v[36:39]
v_mfma_f32_16x16x32_bf16 v[48:51], a[172:175], v[72:75], v[48:51]
v_mfma_f32_16x16x32_bf16 v[56:59], v[72:75], a[176:179], v[56:59]
v_mfma_f32_16x16x32_bf16 v[40:43], a[168:171], v[72:75], v[40:43]
v_mfma_f32_16x16x32_bf16 v[200:203], a[168:171], v[168:171], v[200:203]
v_mfma_f32_16x16x32_bf16 v[204:207], a[172:175], v[168:171], v[204:207]
v_mfma_f32_16x16x32_bf16 v[208:211], a[176:179], v[168:171], v[208:211]
s_waitcnt lgkmcnt(0)
v_mfma_f32_16x16x32_bf16 v[44:47], a[184:187], v[76:79], v[44:47]
v_mfma_f32_16x16x32_bf16 v[52:55], v[76:79], a[188:191], v[52:55]
v_mfma_f32_16x16x32_bf16 v[36:39], a[180:183], v[76:79], v[36:39]
v_mfma_f32_16x16x32_bf16 v[48:51], a[184:187], v[80:83], v[48:51]
v_mfma_f32_16x16x32_bf16 v[56:59], v[80:83], a[188:191], v[56:59]
v_mfma_f32_16x16x32_bf16 v[40:43], a[180:183], v[80:83], v[40:43]
v_mfma_f32_16x16x32_bf16 v[200:203], a[180:183], v[168:171], v[200:203]
v_mfma_f32_16x16x32_bf16 v[204:207], a[184:187], v[168:171], v[204:207]
v_mfma_f32_16x16x32_bf16 v[208:211], a[188:191], v[168:171], v[208:211]
s_load_dwordx2 s[48:49], s[0:1], 56
s_nop 4
ds_write_b128 v6, v[200:203] offset:0
ds_write_b128 v6, v[204:207] offset:64
ds_write_b128 v6, v[208:211] offset:128
v_xor_b32 v16, s11, v16
v_and_b32 v16, 7, v16
v_cmp_ne_u32 vcc, 0, v16
s_waitcnt lgkmcnt(0)
s_mov_b32 s50, 1024
s_barrier
s_cbranch_vccnz L_body_slow
L_body_fast:
s_mov_b32 s12, s47
ds_read_b128 v[68:71], v6 offset:64
ds_read2_b32 v[88:89], v5 offset0:48 offset1:128
ds_read_b128 v[90:93], v6 offset:0
ds_read2_b32 v[94:95], v5 offset0:64 offset1:144
v_add_u32 v96, s91, v5
v_subrev_u32 v97, s91, v6
ds_read_b32 v96, v96 offset:128
ds_read_b128 v[72:75], v97 offset:192
ds_read_b128 v[76:79], v97 offset:512
ds_read_b128 v[80:83], v97 offset:256
ds_read_b128 v[84:87], v97 offset:576
s_lshl_b32 s29, s14, 6
s_add_u32 s29, s29, 0
s_lshl_b32 s46, s30, 9
s_add_u32 s29, s29, s46
s_and_b32 s29, s29, 0x380
s_add_u32 m0, s17, 114688
s_add_u32 s29, s29, s93
buffer_load_dwordx4 v255, s[68:71], s29 offen lds
s_waitcnt lgkmcnt(4)
v_pk_mul_f32 v[98:99], v[68:69], v[88:89] op_sel:[0,1] op_sel_hi:[1,1]
v_pk_mul_f32 v[100:101], v[70:71], v[88:89] op_sel:[0,1] op_sel_hi:[1,1]
v_pk_fma_f32 v[44:45], v[44:45], v[88:89], v[98:99] op_sel_hi:[1,0,1]
v_pk_fma_f32 v[46:47], v[46:47], v[88:89], v[100:101] op_sel_hi:[1,0,1]
v_cvt_pk_bf16_f32 v106, v44, v45
v_cvt_pk_bf16_f32 v107, v46, v47
v_pk_mul_f32 v[98:99], v[90:91], v[88:89] op_sel:[0,1] op_sel_hi:[1,1]
v_pk_mul_f32 v[100:101], v[92:93], v[88:89] op_sel:[0,1] op_sel_hi:[1,1]
v_pk_fma_f32 v[36:37], v[36:37], v[88:89], v[98:99] op_sel_hi:[1,0,1]
s_lshl_b32 s29, s14, 6
s_add_u32 s29, s29, 128
s_lshl_b32 s46, s30, 9
s_add_u32 s29, s29, s46
s_and_b32 s29, s29, 0x380
s_add_u32 m0, s17, 116736
s_add_u32 s29, s29, s93
buffer_load_dwordx4 v255, s[68:71], s29 offen lds
v_pk_fma_f32 v[38:39], v[38:39], v[88:89], v[100:101] op_sel_hi:[1,0,1]
v_cvt_pk_bf16_f32 v116, v36, v37
v_cvt_pk_bf16_f32 v117, v38, v39
v_pk_mul_f32 v[98:99], v[68:69], v[94:95] op_sel:[0,1] op_sel_hi:[1,1]
v_pk_mul_f32 v[100:101], v[70:71], v[94:95] op_sel:[0,1] op_sel_hi:[1,1]
v_pk_fma_f32 v[48:49], v[48:49], v[94:95], v[98:99] op_sel_hi:[1,0,1]
v_pk_fma_f32 v[50:51], v[50:51], v[94:95], v[100:101] op_sel_hi:[1,0,1]
v_cvt_pk_bf16_f32 v108, v48, v49
v_cvt_pk_bf16_f32 v109, v50, v51
s_lshl_b32 s29, s14, 6
s_add_u32 s29, s29, 256
s_lshl_b32 s46, s30, 9
s_add_u32 s29, s29, s46
s_and_b32 s29, s29, 0x380
s_add_u32 m0, s17, 118784
s_add_u32 s29, s29, s93
buffer_load_dwordx4 v255, s[68:71], s29 offen lds
v_pk_mul_f32 v[98:99], v[90:91], v[94:95] op_sel:[0,1] op_sel_hi:[1,1]
v_pk_mul_f32 v[100:101], v[92:93], v[94:95] op_sel:[0,1] op_sel_hi:[1,1]
v_pk_fma_f32 v[40:41], v[40:41], v[94:95], v[98:99] op_sel_hi:[1,0,1]
v_pk_fma_f32 v[42:43], v[42:43], v[94:95], v[100:101] op_sel_hi:[1,0,1]
v_cvt_pk_bf16_f32 v118, v40, v41
v_cvt_pk_bf16_f32 v119, v42, v43
s_waitcnt lgkmcnt(2)
v_pk_mul_f32 v[76:77], v[76:77], v[96:97] op_sel_hi:[1,0]
v_pk_mul_f32 v[78:79], v[78:79], v[96:97] op_sel_hi:[1,0]
v_pk_fma_f32 v[52:53], v[52:53], v[72:73], v[76:77]
s_lshl_b32 s29, s14, 6
s_add_u32 s29, s29, 384
s_lshl_b32 s46, s30, 9
s_add_u32 s29, s29, s46
s_and_b32 s29, s29, 0x380
s_add_u32 m0, s17, 120832
s_add_u32 s29, s29, s93
buffer_load_dwordx4 v255, s[68:71], s29 offen lds
v_pk_fma_f32 v[54:55], v[54:55], v[74:75], v[78:79]
v_cvt_pk_bf16_f32 v112, v52, v53
v_cvt_pk_bf16_f32 v113, v54, v55
s_waitcnt lgkmcnt(0)
v_pk_mul_f32 v[84:85], v[84:85], v[96:97] op_sel_hi:[1,0]
v_pk_mul_f32 v[86:87], v[86:87], v[96:97] op_sel_hi:[1,0]
v_pk_fma_f32 v[56:57], v[56:57], v[80:81], v[84:85]
v_pk_fma_f32 v[58:59], v[58:59], v[82:83], v[86:87]
v_cvt_pk_bf16_f32 v114, v56, v57
v_cvt_pk_bf16_f32 v115, v58, v59
s_waitcnt vmcnt(4)
v_add_f32 v120, v120, v122
v_add_f32 v124, v124, v126
v_add_f32 v121, v121, v123
v_add_f32 v125, v125, v127
v_add_f32 v120, v120, v124
v_add_f32 v121, v121, v125
v_add_u32 v122, s52, v5
s_nop 0
v_permlane32_swap_b32 v120, v121
v_add_f32 v120, v120, v121
v_mov_b32 v121, v120
s_nop 1
v_permlane16_swap_b32 v120, v121
v_add_f32 v120, v120, v121
v_mov_b32 v121, v120
s_nop 1
v_permlane32_swap_b32 v120, v121
v_mul_f32 v120, 0x3b000000, v120
v_mul_f32 v121, 0x3b000000, v121
v_fma_f32 v121, -v120, v120, v121
v_max_f32 v121, 0, v121
v_add_f32 v121, 0x3727c5ac, v121
v_rsq_f32 v121, v121
v_sub_f32 v120, 0, v120
v_mul_f32 v120, v120, v121
ds_write_b32 v122, v121 offset:64
ds_write_b32 v122, v120 offset:384
s_waitcnt lgkmcnt(0)
s_barrier
ds_read_b128 v[88:91], v250 offset:2048
ds_read_b128 v[92:95], v251 offset:2048
ds_read_b128 v[96:99], v250 offset:6144
s_waitcnt lgkmcnt(2)
v_mfma_f32_16x16x32_bf16 v[52:55], a[4:7], v[88:91], 0
ds_read_b128 v[100:103], v251 offset:6144
v_mfma_f32_16x16x32_bf16 v[56:59], v[88:91], a[8:11], 0
s_waitcnt lgkmcnt(2)
v_mfma_f32_16x16x32_bf16 v[52:55], a[16:19], v[92:95], v[52:55]
ds_read_b128 v[88:91], v250 offset:10240
v_mfma_f32_16x16x32_bf16 v[56:59], v[92:95], a[20:23], v[56:59]
s_waitcnt lgkmcnt(2)
v_mfma_f32_16x16x32_bf16 v[52:55], a[28:31], v[96:99], v[52:55]
ds_read_b128 v[92:95], v251 offset:10240
s_add_u32 s46, s58, 0x0
v_mfma_f32_16x16x32_bf16 v[56:59], v[96:99], a[32:35], v[56:59]
buffer_load_dwordx2 v[120:121], v14, s[4:7], s46 offen sc1
s_waitcnt lgkmcnt(2)
v_mfma_f32_16x16x32_bf16 v[52:55], a[40:43], v[100:103], v[52:55]
ds_read_b128 v[96:99], v250 offset:14336
buffer_load_dwordx2 v[122:123], v14, s[4:7], s46 offen offset:256 sc1
v_mfma_f32_16x16x32_bf16 v[56:59], v[100:103], a[44:47], v[56:59]
s_waitcnt lgkmcnt(2)
v_mfma_f32_16x16x32_bf16 v[52:55], a[52:55], v[88:91], v[52:55]
ds_read_b128 v[100:103], v251 offset:14336
v_mfma_f32_16x16x32_bf16 v[56:59], v[88:91], a[56:59], v[56:59]
s_add_u32 s46, s58, 0x0
s_waitcnt lgkmcnt(2)
v_mfma_f32_16x16x32_bf16 v[52:55], a[64:67], v[92:95], v[52:55]
ds_read_b128 v[88:91], v250 offset:18432
buffer_load_dwordx2 v[124:125], v14, s[4:7], s46 offen offset:512 sc1
v_mfma_f32_16x16x32_bf16 v[56:59], v[92:95], a[68:71], v[56:59]
buffer_load_dwordx2 v[126:127], v14, s[4:7], s46 offen offset:768 sc1
s_waitcnt lgkmcnt(2)
v_mfma_f32_16x16x32_bf16 v[52:55], a[76:79], v[96:99], v[52:55]
ds_read_b128 v[92:95], v251 offset:18432
v_mfma_f32_16x16x32_bf16 v[56:59], v[96:99], a[80:83], v[56:59]
s_waitcnt lgkmcnt(2)
v_mfma_f32_16x16x32_bf16 v[52:55], a[88:91], v[100:103], v[52:55]
ds_read_b128 v[96:99], v250 offset:22528
v_mfma_f32_16x16x32_bf16 v[56:59], v[100:103], a[92:95], v[56:59]
s_waitcnt lgkmcnt(2)
v_mfma_f32_16x16x32_bf16 v[52:55], a[100:103], v[88:91], v[52:55]
ds_read_b128 v[100:103], v251 offset:22528
v_mfma_f32_16x16x32_bf16 v[56:59], v[88:91], a[104:107], v[56:59]
s_waitcnt lgkmcnt(2)
v_mfma_f32_16x16x32_bf16 v[52:55], a[112:115], v[92:95], v[52:55]
ds_read_b128 v[88:91], v250 offset:26624
buffer_load_dword v17, v19, s[4:7], 0 offen sc1
v_mfma_f32_16x16x32_bf16 v[56:59], v[92:95], a[116:119], v[56:59]
s_waitcnt lgkmcnt(2)
v_mfma_f32_16x16x32_bf16 v[52:55], a[124:127], v[96:99], v[52:55]
ds_read_b128 v[92:95], v251 offset:26624
v_mfma_f32_16x16x32_bf16 v[56:59], v[96:99], a[128:131], v[56:59]
s_add_u32 s46, s47, s62
s_waitcnt lgkmcnt(2)
v_mfma_f32_16x16x32_bf16 v[52:55], a[136:139], v[100:103], v[52:55]
ds_read_b128 v[96:99], v250 offset:30720
s_add_u32 s46, s46, 0x8000
v_mfma_f32_16x16x32_bf16 v[56:59], v[100:103], a[140:143], v[56:59]
buffer_load_dword v18, v1, s[4:7], s46 offen sc1
s_waitcnt lgkmcnt(2)
v_mfma_f32_16x16x32_bf16 v[52:55], a[148:151], v[88:91], v[52:55]
ds_read_b128 v[100:103], v251 offset:30720
s_add_u32 s46, s12, s40
v_mfma_f32_16x16x32_bf16 v[56:59], v[88:91], a[152:155], v[56:59]
buffer_load_dword v18, v3, s[4:7], s46 offen sc1
s_waitcnt lgkmcnt(2)
v_mfma_f32_16x16x32_bf16 v[52:55], a[160:163], v[92:95], v[52:55]
s_add_u32 s46, s12, s41
buffer_load_dword v18, v3, s[4:7], s46 offen sc1
v_mfma_f32_16x16x32_bf16 v[56:59], v[92:95], a[164:167], v[56:59]
s_add_u32 s46, s12, s42
s_waitcnt lgkmcnt(1)
v_mfma_f32_16x16x32_bf16 v[52:55], a[172:175], v[96:99], v[52:55]
buffer_load_dword v18, v3, s[4:7], s46 offen sc1
ds_read_b128 v[68:71], v6 offset:64
v_mfma_f32_16x16x32_bf16 v[56:59], v[96:99], a[176:179], v[56:59]
s_add_u32 s46, s47, s39
s_waitcnt lgkmcnt(1)
v_mfma_f32_16x16x32_bf16 v[52:55], a[184:187], v[100:103], v[52:55]
buffer_load_dword v18, v3, s[4:7], s46 offen sc1
ds_read2_b32 v[72:73], v5 offset0:32 offset1:112
v_mfma_f32_16x16x32_bf16 v[56:59], v[100:103], a[188:191], v[56:59]
s_add_u32 s46, s12, s40
s_add_u32 s46, s46, 0x1e000
buffer_load_dword v18, v3, s[4:7], s46 offen sc1
v_add_u32 v74, s91, v5
v_subrev_u32 v75, s91, v6
ds_read_b32 v74, v74 offset:128
ds_read_b128 v[80:83], v75 offset:128
ds_read_b128 v[84:87], v75 offset:448
s_waitcnt lgkmcnt(2)
v_pk_mul_f32 v[76:77], v[68:69], v[72:73] op_sel:[0,1] op_sel_hi:[1,1]
s_add_u32 s46, s12, s41
s_add_u32 s46, s46, 0x1e000
buffer_load_dword v18, v3, s[4:7], s46 offen sc1
v_pk_mul_f32 v[78:79], v[70:71], v[72:73] op_sel:[0,1] op_sel_hi:[1,1]
s_add_u32 s46, s12, s42
s_add_u32 s46, s46, 0x1e000
buffer_load_dword v18, v3, s[4:7], s46 offen sc1
v_pk_fma_f32 v[52:53], v[52:53], v[72:73], v[76:77] op_sel_hi:[1,0,1]
v_pk_fma_f32 v[54:55], v[54:55], v[72:73], v[78:79] op_sel_hi:[1,0,1]
v_cvt_pk_bf16_f32 v104, v52, v53
v_cvt_pk_bf16_f32 v105, v54, v55
s_waitcnt lgkmcnt(0)
v_pk_mul_f32 v[84:85], v[84:85], v[74:75] op_sel_hi:[1,0]
v_pk_mul_f32 v[86:87], v[86:87], v[74:75] op_sel_hi:[1,0]
v_pk_fma_f32 v[56:57], v[56:57], v[80:81], v[84:85]
v_pk_fma_f32 v[58:59], v[58:59], v[82:83], v[86:87]
v_cvt_pk_bf16_f32 v110, v56, v57
v_cvt_pk_bf16_f32 v111, v58, v59
v_add_u32 v80, 0x27400, v1
ds_read_b128 v[84:87], v80 offset:1024
ds_read_b128 v[80:83], v80
v_mfma_f32_16x16x16_bf16 v[36:39], v[104:105], v[116:117], 0
v_mfma_f32_16x16x16_bf16 v[40:43], v[106:107], v[116:117], 0
v_mfma_f32_16x16x16_bf16 v[44:47], v[106:107], v[118:119], 0
v_mfma_f32_16x16x16_bf16 v[48:51], v[108:109], v[118:119], 0
v_mov_b32 v52, 0x3f803f80
v_mov_b32 v53, 0x3f803f80
v_mov_b32 v54, 0x3f803f80
v_mov_b32 v55, 0x3f803f80
v_mov_b32 v108, v104
v_mov_b32 v109, v105
s_waitcnt lgkmcnt(0)
v_pk_fma_f32 v[36:37], v[36:37], s[34:35], v[80:81]
v_pk_fma_f32 v[38:39], v[38:39], s[34:35], v[82:83]
v_pk_fma_f32 v[40:41], v[40:41], s[34:35], v[84:85]
v_pk_fma_f32 v[42:43], v[42:43], s[34:35], v[86:87]
v_pk_fma_f32 v[44:45], v[44:45], s[34:35], v[80:81]
v_pk_fma_f32 v[46:47], v[46:47], s[34:35], v[82:83]
v_pk_fma_f32 v[48:49], v[48:49], s[34:35], v[84:85]
v_pk_fma_f32 v[50:51], v[50:51], s[34:35], v[86:87]
v_max3_f32 v56, v36, v37, v38
v_max3_f32 v58, v44, v45, v46
v_max3_f32 v57, v39, v40, v41
v_max3_f32 v59, v47, v48, v49
v_max3_f32 v56, v56, v42, v43
v_max3_f32 v58, v58, v50, v51
v_max_f32 v56, v56, v57
v_max_f32 v58, v58, v59
s_add_u32 s15, s47, s39
s_add_u32 s15, s15, 0x16000
v_permlane32_swap_b32 v56, v58
v_max_f32 v56, v56, v58
v_mov_b32 v58, v56
s_nop 1
v_permlane16_swap_b32 v56, v58
v_max_f32 v56, v56, v58
v_mov_b32 v58, v56
s_nop 1
v_permlane32_swap_b32 v56, v58
v_pk_add_f32 v[36:37], v[36:37], v[56:57] op_sel_hi:[1,0] neg_lo:[0,1] neg_hi:[0,1]
v_pk_add_f32 v[38:39], v[38:39], v[56:57] op_sel_hi:[1,0] neg_lo:[0,1] neg_hi:[0,1]
v_pk_add_f32 v[40:41], v[40:41], v[56:57] op_sel_hi:[1,0] neg_lo:[0,1] neg_hi:[0,1]
v_pk_add_f32 v[42:43], v[42:43], v[56:57] op_sel_hi:[1,0] neg_lo:[0,1] neg_hi:[0,1]
v_exp_f32 v36, v36
v_exp_f32 v37, v37
v_exp_f32 v38, v38
v_exp_f32 v39, v39
v_exp_f32 v40, v40
v_exp_f32 v41, v41
v_exp_f32 v42, v42
v_exp_f32 v43, v43
v_pk_add_f32 v[44:45], v[44:45], v[58:59] op_sel_hi:[1,0] neg_lo:[0,1] neg_hi:[0,1]
v_pk_add_f32 v[46:47], v[46:47], v[58:59] op_sel_hi:[1,0] neg_lo:[0,1] neg_hi:[0,1]
v_pk_add_f32 v[48:49], v[48:49], v[58:59] op_sel_hi:[1,0] neg_lo:[0,1] neg_hi:[0,1]
v_pk_add_f32 v[50:51], v[50:51], v[58:59] op_sel_hi:[1,0] neg_lo:[0,1] neg_hi:[0,1]
v_exp_f32 v44, v44
v_exp_f32 v45, v45
v_exp_f32 v46, v46
v_exp_f32 v47, v47
v_exp_f32 v48, v48
v_exp_f32 v49, v49
v_exp_f32 v50, v50
v_exp_f32 v51, v51
s_add_u32 s46, s32, 1
s_waitcnt vmcnt(8)
v_lshrrev_b32 v17, 3, v17
v_subrev_u32 v17, s46, v17
v_cmp_lt_u32 vcc, 31, v17
s_cbranch_vccnz L_spin_6
L_ok_5:
s_barrier
ds_read_b128 v[92:95], v250 offset:40960
ds_read_b128 v[96:99], v250 offset:16384
ds_read_b128 v[100:103], v250 offset:18432
v_cvt_pk_bf16_f32 v68, v36, v37
v_cvt_pk_bf16_f32 v69, v38, v39
v_cvt_pk_bf16_f32 v70, v40, v41
v_cvt_pk_bf16_f32 v71, v42, v43
v_cvt_pk_bf16_f32 v72, v44, v45
v_cvt_pk_bf16_f32 v73, v46, v47
v_cvt_pk_bf16_f32 v74, v48, v49
v_cvt_pk_bf16_f32 v75, v50, v51
v_mfma_f32_16x16x32_bf16 v[40:43], v[52:55], v[68:71], 0
s_nop 0
v_mfma_f32_16x16x32_bf16 v[48:51], v[52:55], v[72:75], 0
v_mfma_f32_16x16x32_bf16 v[36:39], v[110:113], v[68:71], 0
v_mfma_f32_16x16x32_bf16 v[44:47], v[112:115], v[72:75], 0
v_mov_b32 v114, v110
v_mov_b32 v115, v111
s_nop 1
v_rcp_f32 v40, v40
s_nop 0
v_rcp_f32 v48, v48
v_pk_mul_f32 v[36:37], v[36:37], v[40:41] op_sel_hi:[1,0]
v_pk_mul_f32 v[38:39], v[38:39], v[40:41] op_sel_hi:[1,0]
v_pk_mul_f32 v[44:45], v[44:45], v[48:49] op_sel_hi:[1,0]
v_pk_mul_f32 v[46:47], v[46:47], v[48:49] op_sel_hi:[1,0]
v_cvt_pk_bf16_f32 v76, v36, v37
v_cvt_pk_bf16_f32 v77, v38, v39
v_cvt_pk_bf16_f32 v78, v44, v45
v_cvt_pk_bf16_f32 v79, v46, v47
s_nop 0
v_permlane32_swap_b32 v76, v78
v_permlane32_swap_b32 v77, v79
buffer_store_dwordx4 v[76:79], v3, s[4:7], s15 offen
ds_read_b128 v[80:83], v251 offset:40960
ds_read_b128 v[84:87], v251 offset:16384
ds_read_b128 v[88:91], v251 offset:18432
s_waitcnt lgkmcnt(3)
v_mfma_f32_16x16x32_bf16 v[44:47], a[100:103], v[92:95], 0
ds_read_b128 v[68:71], v250 offset:43008
ds_read_b128 v[72:75], v250 offset:20480
v_mfma_f32_16x16x32_bf16 v[48:51], v[92:95], a[104:107], 0
ds_read_b128 v[76:79], v250 offset:22528
v_mfma_f32_16x16x32_bf16 v[36:39], a[100:103], v[96:99], 0
s_add_u32 s28, s25, 0
buffer_load_dwordx4 a[192:195], v1, s[4:7], s28 offen sc1
v_mfma_f32_16x16x32_bf16 v[40:43], v[96:99], a[104:107], 0
v_mfma_f32_16x16x32_bf16 v[60:63], a[96:99], v[96:99], 0
v_mfma_f32_16x16x32_bf16 v[64:67], a[96:99], v[100:103], 0
buffer_load_dwordx4 a[196:199], v1, s[4:7], s28 offen offset:1024 sc1
s_waitcnt lgkmcnt(3)
v_mfma_f32_16x16x32_bf16 v[44:47], a[112:115], v[80:83], v[44:47]
ds_read_b128 v[92:95], v251 offset:43008
ds_read_b128 v[96:99], v251 offset:20480
v_mfma_f32_16x16x32_bf16 v[48:51], v[80:83], a[116:119], v[48:51]
ds_read_b128 v[100:103], v251 offset:22528
v_mfma_f32_16x16x32_bf16 v[36:39], a[112:115], v[84:87], v[36:39]
s_add_u32 s28, s25, 4096
buffer_load_dwordx4 a[96:99], v1, s[4:7], s28 offen sc1
v_mfma_f32_16x16x32_bf16 v[40:43], v[84:87], a[116:119], v[40:43]
v_mfma_f32_16x16x32_bf16 v[60:63], a[108:111], v[84:87], v[60:63]
v_mfma_f32_16x16x32_bf16 v[64:67], a[108:111], v[88:91], v[64:67]
buffer_load_dwordx4 a[100:103], v1, s[4:7], s28 offen offset:1024 sc1
s_waitcnt lgkmcnt(3)
v_mfma_f32_16x16x32_bf16 v[44:47], a[124:127], v[68:71], v[44:47]
ds_read_b128 v[80:83], v250 offset:45056
ds_read_b128 v[84:87], v250 offset:24576
v_mfma_f32_16x16x32_bf16 v[48:51], v[68:71], a[128:131], v[48:51]
ds_read_b128 v[88:91], v250 offset:26624
v_mfma_f32_16x16x32_bf16 v[36:39], a[124:127], v[72:75], v[36:39]
buffer_load_dwordx4 a[104:107], v1, s[4:7], s28 offen offset:2048 sc1
v_mfma_f32_16x16x32_bf16 v[40:43], v[72:75], a[128:131], v[40:43]
v_mfma_f32_16x16x32_bf16 v[60:63], a[120:123], v[72:75], v[60:63]
v_mfma_f32_16x16x32_bf16 v[64:67], a[120:123], v[76:79], v[64:67]
buffer_load_dwordx4 a[108:111], v1, s[4:7], s28 offen offset:3072 sc1
s_waitcnt lgkmcnt(3)
v_mfma_f32_16x16x32_bf16 v[44:47], a[136:139], v[92:95], v[44:47]
ds_read_b128 v[68:71], v251 offset:45056
ds_read_b128 v[72:75], v251 offset:24576
v_mfma_f32_16x16x32_bf16 v[48:51], v[92:95], a[140:143], v[48:51]
ds_read_b128 v[76:79], v251 offset:26624
s_add_u32 s28, s25, 8192
buffer_load_dwordx4 a[112:115], v1, s[4:7], s28 offen sc1
buffer_load_dwordx4 a[116:119], v1, s[4:7], s28 offen offset:1024 sc1
s_waitcnt vmcnt(8)
v_mfma_f32_16x16x32_bf16 v[36:39], a[136:139], v[96:99], v[36:39]
buffer_store_dword v15, v13, s[4:7], s45 offen
v_mfma_f32_16x16x32_bf16 v[40:43], v[96:99], a[140:143], v[40:43]
v_mfma_f32_16x16x32_bf16 v[60:63], a[132:135], v[96:99], v[60:63]
v_mfma_f32_16x16x32_bf16 v[64:67], a[132:135], v[100:103], v[64:67]
buffer_load_dwordx4 a[120:123], v1, s[4:7], s28 offen offset:2048 sc1
s_waitcnt lgkmcnt(3)
v_mfma_f32_16x16x32_bf16 v[44:47], a[148:151], v[80:83], v[44:47]
ds_read_b128 v[92:95], v250 offset:47104
ds_read_b128 v[96:99], v250 offset:28672
v_mfma_f32_16x16x32_bf16 v[48:51], v[80:83], a[152:155], v[48:51]
ds_read_b128 v[100:103], v250 offset:30720
v_mfma_f32_16x16x32_bf16 v[36:39], a[148:151], v[84:87], v[36:39]
buffer_load_dwordx4 a[124:127], v1, s[4:7], s28 offen offset:3072 sc1
v_mfma_f32_16x16x32_bf16 v[40:43], v[84:87], a[152:155], v[40:43]
v_mfma_f32_16x16x32_bf16 v[60:63], a[144:147], v[84:87], v[60:63]
v_mfma_f32_16x16x32_bf16 v[64:67], a[144:147], v[88:91], v[64:67]
s_add_u32 s28, s25, 12288
s_waitcnt lgkmcnt(3)
v_mfma_f32_16x16x32_bf16 v[44:47], a[160:163], v[68:71], v[44:47]
ds_read_b128 v[80:83], v251 offset:47104
ds_read_b128 v[84:87], v251 offset:28672
v_mfma_f32_16x16x32_bf16 v[48:51], v[68:71], a[164:167], v[48:51]
ds_read_b128 v[88:91], v251 offset:30720
buffer_load_dwordx4 a[128:131], v1, s[4:7], s28 offen sc1
v_mfma_f32_16x16x32_bf16 v[36:39], a[160:163], v[72:75], v[36:39]
v_mfma_f32_16x16x32_bf16 v[40:43], v[72:75], a[164:167], v[40:43]
v_mfma_f32_16x16x32_bf16 v[60:63], a[156:159], v[72:75], v[60:63]
buffer_load_dwordx4 a[132:135], v1, s[4:7], s28 offen offset:1024 sc1
v_mfma_f32_16x16x32_bf16 v[64:67], a[156:159], v[76:79], v[64:67]
s_waitcnt lgkmcnt(3)
v_mfma_f32_16x16x32_bf16 v[44:47], a[172:175], v[92:95], v[44:47]
ds_read_b128 v[68:71], v250 offset:32768
ds_read_b128 v[72:75], v250 offset:0
v_mfma_f32_16x16x32_bf16 v[48:51], v[92:95], a[176:179], v[48:51]
ds_read_b128 v[76:79], v250 offset:2048
buffer_load_dwordx4 a[136:139], v1, s[4:7], s28 offen offset:2048 sc1
v_mfma_f32_16x16x32_bf16 v[36:39], a[172:175], v[96:99], v[36:39]
v_mfma_f32_16x16x32_bf16 v[40:43], v[96:99], a[176:179], v[40:43]
v_mfma_f32_16x16x32_bf16 v[60:63], a[168:171], v[96:99], v[60:63]
buffer_load_dwordx4 a[140:143], v1, s[4:7], s28 offen offset:3072 sc1
v_mfma_f32_16x16x32_bf16 v[64:67], a[168:171], v[100:103], v[64:67]
s_waitcnt lgkmcnt(3)
v_mfma_f32_16x16x32_bf16 v[44:47], a[184:187], v[80:83], v[44:47]
ds_read_b128 v[92:95], v251 offset:32768
ds_read_b128 v[96:99], v251 offset:0
v_mfma_f32_16x16x32_bf16 v[48:51], v[80:83], a[188:191], v[48:51]
ds_read_b128 v[100:103], v251 offset:2048
s_add_u32 s28, s26, 24576
v_mfma_f32_16x16x32_bf16 v[36:39], a[184:187], v[84:87], v[36:39]
buffer_load_dwordx4 a[144:147], v1, s[4:7], s28 offen sc1
v_mfma_f32_16x16x32_bf16 v[40:43], v[84:87], a[188:191], v[40:43]
v_mfma_f32_16x16x32_bf16 v[60:63], a[180:183], v[84:87], v[60:63]
v_mfma_f32_16x16x32_bf16 v[64:67], a[180:183], v[88:91], v[64:67]
s_add_u32 s14, s28, s88
s_waitcnt lgkmcnt(3)
v_mfma_f32_16x16x32_bf16 v[44:47], a[4:7], v[68:71], v[44:47]
ds_read_b128 v[80:83], v250 offset:34816
ds_read_b128 v[84:87], v250 offset:4096
v_mfma_f32_16x16x32_bf16 v[48:51], v[68:71], a[8:11], v[48:51]
ds_read_b128 v[88:91], v250 offset:6144
buffer_load_dwordx4 a[148:151], v1, s[4:7], s14 offen sc1
v_mfma_f32_16x16x32_bf16 v[36:39], a[4:7], v[72:75], v[36:39]
v_mfma_f32_16x16x32_bf16 v[40:43], v[72:75], a[8:11], v[40:43]
v_mfma_f32_16x16x32_bf16 v[60:63], a[0:3], v[72:75], v[60:63]
s_add_u32 s14, s28, s89
buffer_load_dwordx4 a[152:155], v1, s[4:7], s14 offen sc1
v_mfma_f32_16x16x32_bf16 v[64:67], a[0:3], v[76:79], v[64:67]
s_waitcnt lgkmcnt(3)
v_mfma_f32_16x16x32_bf16 v[44:47], a[16:19], v[92:95], v[44:47]
ds_read_b128 v[68:71], v251 offset:34816
ds_read_b128 v[72:75], v251 offset:4096
v_mfma_f32_16x16x32_bf16 v[48:51], v[92:95], a[20:23], v[48:51]
ds_read_b128 v[76:79], v251 offset:6144
s_add_u32 s28, s26, 27648
v_mfma_f32_16x16x32_bf16 v[36:39], a[16:19], v[96:99], v[36:39]
buffer_load_dwordx4 a[156:159], v1, s[4:7], s28 offen sc1
v_mfma_f32_16x16x32_bf16 v[40:43], v[96:99], a[20:23], v[40:43]
v_mfma_f32_16x16x32_bf16 v[60:63], a[12:15], v[96:99], v[60:63]
v_mfma_f32_16x16x32_bf16 v[64:67], a[12:15], v[100:103], v[64:67]
s_add_u32 s14, s28, s88
s_waitcnt lgkmcnt(3)
v_mfma_f32_16x16x32_bf16 v[44:47], a[28:31], v[80:83], v[44:47]
ds_read_b128 v[92:95], v250 offset:36864
ds_read_b128 v[96:99], v250 offset:8192
v_mfma_f32_16x16x32_bf16 v[48:51], v[80:83], a[32:35], v[48:51]
ds_read_b128 v[100:103], v250 offset:10240
buffer_load_dwordx4 a[160:163], v1, s[4:7], s14 offen sc1
v_mfma_f32_16x16x32_bf16 v[36:39], a[28:31], v[84:87], v[36:39]
v_mfma_f32_16x16x32_bf16 v[40:43], v[84:87], a[32:35], v[40:43]
v_mfma_f32_16x16x32_bf16 v[60:63], a[24:27], v[84:87], v[60:63]
v_mfma_f32_16x16x32_bf16 v[64:67], a[24:27], v[88:91], v[64:67]
s_waitcnt lgkmcnt(3)
v_mfma_f32_16x16x32_bf16 v[44:47], a[40:43], v[68:71], v[44:47]
ds_read_b128 v[80:83], v251 offset:36864
ds_read_b128 v[84:87], v251 offset:8192
v_mfma_f32_16x16x32_bf16 v[48:51], v[68:71], a[44:47], v[48:51]
ds_read_b128 v[88:91], v251 offset:10240
buffer_load_dword v17, v4, s[4:7], s92 offen sc1
v_mfma_f32_16x16x32_bf16 v[36:39], a[40:43], v[72:75], v[36:39]
v_add_f32 v120, v120, v122
v_add_f32 v124, v124, v126
v_mfma_f32_16x16x32_bf16 v[40:43], v[72:75], a[44:47], v[40:43]
v_add_f32 v121, v121, v123
v_add_f32 v125, v125, v127
v_mfma_f32_16x16x32_bf16 v[60:63], a[36:39], v[72:75], v[60:63]
s_add_u32 s14, s28, s89
buffer_load_dwordx4 a[164:167], v1, s[4:7], s14 offen sc1
v_mfma_f32_16x16x32_bf16 v[64:67], a[36:39], v[76:79], v[64:67]
v_add_f32 v120, v120, v124
s_waitcnt lgkmcnt(3)
v_mfma_f32_16x16x32_bf16 v[44:47], a[52:55], v[92:95], v[44:47]
ds_read_b128 v[68:71], v250 offset:38912
ds_read_b128 v[72:75], v250 offset:12288
v_mfma_f32_16x16x32_bf16 v[48:51], v[92:95], a[56:59], v[48:51]
ds_read_b128 v[76:79], v250 offset:14336
s_add_u32 s28, s26, 30720
v_mfma_f32_16x16x32_bf16 v[36:39], a[52:55], v[96:99], v[36:39]
buffer_load_dwordx4 a[168:171], v1, s[4:7], s28 offen sc1
v_add_f32 v121, v121, v125
v_mfma_f32_16x16x32_bf16 v[40:43], v[96:99], a[56:59], v[40:43]
v_mov_b32 v122, v5
s_nop 0
v_mfma_f32_16x16x32_bf16 v[60:63], a[48:51], v[96:99], v[60:63]
v_permlane32_swap_b32 v120, v121
v_mfma_f32_16x16x32_bf16 v[64:67], a[48:51], v[100:103], v[64:67]
s_add_u32 s14, s28, s88
s_waitcnt lgkmcnt(3)
v_mfma_f32_16x16x32_bf16 v[44:47], a[64:67], v[80:83], v[44:47]
ds_read_b128 v[92:95], v251 offset:38912
ds_read_b128 v[96:99], v251 offset:12288
v_mfma_f32_16x16x32_bf16 v[48:51], v[80:83], a[68:71], v[48:51]
ds_read_b128 v[100:103], v251 offset:14336
buffer_load_dwordx4 a[172:175], v1, s[4:7], s14 offen sc1
v_mfma_f32_16x16x32_bf16 v[36:39], a[64:67], v[84:87], v[36:39]
v_add_f32 v120, v120, v121
v_mov_b32 v121, v120
v_mfma_f32_16x16x32_bf16 v[40:43], v[84:87], a[68:71], v[40:43]
s_nop 0
v_permlane16_swap_b32 v120, v121
v_mfma_f32_16x16x32_bf16 v[60:63], a[60:63], v[84:87], v[60:63]
s_add_u32 s14, s28, s89
buffer_load_dwordx4 a[176:179], v1, s[4:7], s14 offen sc1
v_mfma_f32_16x16x32_bf16 v[64:67], a[60:63], v[88:91], v[64:67]
v_add_f32 v120, v120, v121
s_waitcnt lgkmcnt(3)
v_mfma_f32_16x16x32_bf16 v[44:47], a[76:79], v[68:71], v[44:47]
v_mov_b32 v121, v120
v_mfma_f32_16x16x32_bf16 v[48:51], v[68:71], a[80:83], v[48:51]
s_add_u32 s28, s26, 33792
buffer_load_dwordx4 a[180:183], v1, s[4:7], s28 offen sc1
v_mfma_f32_16x16x32_bf16 v[36:39], a[76:79], v[72:75], v[36:39]
v_permlane32_swap_b32 v120, v121
v_mfma_f32_16x16x32_bf16 v[40:43], v[72:75], a[80:83], v[40:43]
v_mul_f32 v120, 0x3b000000, v120
v_mul_f32 v121, 0x3b000000, v121
v_mfma_f32_16x16x32_bf16 v[60:63], a[72:75], v[72:75], v[60:63]
s_add_u32 s14, s28, s88
buffer_load_dwordx4 a[184:187], v1, s[4:7], s14 offen sc1
v_mfma_f32_16x16x32_bf16 v[64:67], a[72:75], v[76:79], v[64:67]
v_fma_f32 v121, -v120, v120, v121
s_waitcnt lgkmcnt(0)
v_mfma_f32_16x16x32_bf16 v[44:47], a[88:91], v[92:95], v[44:47]
v_max_f32 v121, 0, v121
v_add_f32 v121, 0x3727c5ac, v121
v_mfma_f32_16x16x32_bf16 v[48:51], v[92:95], a[92:95], v[48:51]
s_add_u32 s14, s28, s89
buffer_load_dwordx4 a[188:191], v1, s[4:7], s14 offen sc1
v_mfma_f32_16x16x32_bf16 v[36:39], a[88:91], v[96:99], v[36:39]
v_rsq_f32 v121, v121
v_mfma_f32_16x16x32_bf16 v[40:43], v[96:99], a[92:95], v[40:43]
v_sub_f32 v120, 0, v120
v_mul_f32 v120, v120, v121
v_mfma_f32_16x16x32_bf16 v[60:63], a[84:87], v[96:99], v[60:63]
s_add_u32 s28, s25, 0
buffer_load_dwordx4 a[200:203], v1, s[4:7], s28 offen offset:2048 sc1
v_mfma_f32_16x16x32_bf16 v[64:67], a[84:87], v[100:103], v[64:67]
ds_write_b32 v122, v121 offset:0
ds_write_b32 v122, v120 offset:320
ds_read_b128 v[68:71], v6 offset:64
ds_read2_b32 v[72:73], v5 offset0:0 offset1:80
ds_read2_b32 v[74:75], v5 offset0:16 offset1:96
ds_read_b128 v[76:79], v6 offset:0
ds_read2_b32 v[80:81], v5 offset0:32 offset1:112
v_add_u32 v82, s91, v5
v_subrev_u32 v83, s91, v6
ds_read_b32 v82, v82 offset:128
ds_read_b128 v[88:91], v83 offset:0
ds_read_b128 v[92:95], v83 offset:320
ds_read_b128 v[96:99], v83 offset:64
ds_read_b128 v[100:103], v83 offset:384
s_waitcnt lgkmcnt(4)
v_pk_mul_f32 v[84:85], v[68:69], v[72:73] op_sel:[0,1] op_sel_hi:[1,1]
v_pk_mul_f32 v[86:87], v[70:71], v[72:73] op_sel:[0,1] op_sel_hi:[1,1]
v_pk_fma_f32 v[44:45], v[44:45], v[72:73], v[84:85] op_sel_hi:[1,0,1]
v_pk_fma_f32 v[46:47], v[46:47], v[72:73], v[86:87] op_sel_hi:[1,0,1]
v_cvt_pk_bf16_f32 v104, v44, v45
v_cvt_pk_bf16_f32 v105, v46, v47
v_pk_mul_f32 v[84:85], v[68:69], v[74:75] op_sel:[0,1] op_sel_hi:[1,1]
v_pk_mul_f32 v[86:87], v[70:71], v[74:75] op_sel:[0,1] op_sel_hi:[1,1]
v_pk_fma_f32 v[36:37], v[36:37], v[74:75], v[84:85] op_sel_hi:[1,0,1]
v_pk_fma_f32 v[38:39], v[38:39], v[74:75], v[86:87] op_sel_hi:[1,0,1]
v_cvt_pk_bf16_f32 v106, v36, v37
v_cvt_pk_bf16_f32 v107, v38, v39
v_pk_mul_f32 v[84:85], v[76:77], v[74:75] op_sel:[0,1] op_sel_hi:[1,1]
v_pk_mul_f32 v[86:87], v[78:79], v[74:75] op_sel:[0,1] op_sel_hi:[1,1]
v_pk_fma_f32 v[60:61], v[60:61], v[74:75], v[84:85] op_sel_hi:[1,0,1]
v_pk_fma_f32 v[62:63], v[62:63], v[74:75], v[86:87] op_sel_hi:[1,0,1]
buffer_load_dwordx4 a[204:207], v1, s[4:7], s28 offen offset:3072 sc1
v_cvt_pk_bf16_f32 v116, v60, v61
v_cvt_pk_bf16_f32 v117, v62, v63
v_pk_mul_f32 v[84:85], v[76:77], v[80:81] op_sel:[0,1] op_sel_hi:[1,1]
v_pk_mul_f32 v[86:87], v[78:79], v[80:81] op_sel:[0,1] op_sel_hi:[1,1]
v_pk_fma_f32 v[64:65], v[64:65], v[80:81], v[84:85] op_sel_hi:[1,0,1]
v_pk_fma_f32 v[66:67], v[66:67], v[80:81], v[86:87] op_sel_hi:[1,0,1]
v_cvt_pk_bf16_f32 v118, v64, v65
v_cvt_pk_bf16_f32 v119, v66, v67
s_waitcnt lgkmcnt(2)
v_pk_mul_f32 v[92:93], v[92:93], v[82:83] op_sel_hi:[1,0]
v_pk_mul_f32 v[94:95], v[94:95], v[82:83] op_sel_hi:[1,0]
v_pk_fma_f32 v[48:49], v[48:49], v[88:89], v[92:93]
v_pk_fma_f32 v[50:51], v[50:51], v[90:91], v[94:95]
v_cvt_pk_bf16_f32 v110, v48, v49
v_cvt_pk_bf16_f32 v111, v50, v51
s_waitcnt lgkmcnt(0)
v_pk_mul_f32 v[100:101], v[100:101], v[82:83] op_sel_hi:[1,0]
v_pk_mul_f32 v[102:103], v[102:103], v[82:83] op_sel_hi:[1,0]
v_pk_fma_f32 v[40:41], v[40:41], v[96:97], v[100:101]
v_pk_fma_f32 v[42:43], v[42:43], v[98:99], v[102:103]
v_cvt_pk_bf16_f32 v112, v40, v41
s_add_u32 s28, s26, 0
buffer_load_dwordx4 a[208:211], v1, s[4:7], s28 offen sc1
v_cvt_pk_bf16_f32 v113, v42, v43
s_add_u32 s46, s32, 3
s_waitcnt vmcnt(10)
v_lshrrev_b32 v17, 3, v17
v_subrev_u32 v17, s46, v17
v_cmp_lt_u32 vcc, 31, v17
s_cbranch_vccnz L_spin_8
L_ok_7:
s_add_u32 s17, s47, s97
v_add_u32 v80, 0x27400, v1
ds_read_b128 v[84:87], v80 offset:1024
ds_read_b128 v[80:83], v80
v_mfma_f32_16x16x16_bf16 v[36:39], v[104:105], v[116:117], 0
v_mfma_f32_16x16x16_bf16 v[40:43], v[106:107], v[116:117], 0
v_mfma_f32_16x16x16_bf16 v[44:47], v[106:107], v[118:119], 0
s_add_u32 m0, s2, 0
s_add_u32 s29, s17, 0x16000
v_mfma_f32_16x16x16_bf16 v[48:51], v[108:109], v[118:119], 0
buffer_load_dwordx4 v1, s[4:7], s29 offen sc1 lds
v_mov_b32 v60, 0x3f803f80
v_mov_b32 v61, 0x3f803f80
v_mov_b32 v62, 0x3f803f80
v_mov_b32 v63, 0x3f803f80
s_waitcnt lgkmcnt(0)
v_min_f32 v52, s38, v80
v_min_f32 v53, s38, v81
v_min_f32 v54, s38, v82
v_min_f32 v55, s38, v83
v_pk_fma_f32 v[36:37], v[36:37], s[34:35], v[52:53]
buffer_load_dwordx4 v1, s[4:7], s29 offen offset:1024 sc1 lds
v_pk_fma_f32 v[38:39], v[38:39], s[34:35], v[54:55]
v_pk_fma_f32 v[40:41], v[40:41], s[34:35], v[84:85]
v_pk_fma_f32 v[42:43], v[42:43], s[34:35], v[86:87]
v_pk_fma_f32 v[44:45], v[44:45], s[34:35], v[80:81]
v_pk_fma_f32 v[46:47], v[46:47], s[34:35], v[82:83]
v_pk_fma_f32 v[48:49], v[48:49], s[34:35], v[84:85]
v_pk_fma_f32 v[50:51], v[50:51], s[34:35], v[86:87]
v_max3_f32 v56, v36, v37, v38
v_max3_f32 v58, v44, v45, v46
s_add_u32 m0, s2, 8192
s_add_u32 s29, s17, 0x17000
buffer_load_dwordx4 v1, s[4:7], s29 offen sc1 lds
v_max3_f32 v57, v39, v40, v41
v_max3_f32 v59, v47, v48, v49
v_max3_f32 v56, v56, v42, v43
v_max3_f32 v58, v58, v50, v51
v_max_f32 v56, v56, v57
v_max_f32 v58, v58, v59
s_add_u32 s15, s47, s39
s_add_u32 s15, s15, 0x0
v_permlane32_swap_b32 v56, v58
v_max_f32 v56, v56, v58
buffer_load_dwordx4 v1, s[4:7], s29 offen offset:1024 sc1 lds
v_mov_b32 v58, v56
s_nop 1
v_permlane16_swap_b32 v56, v58
v_max_f32 v56, v56, v58
v_mov_b32 v58, v56
s_nop 1
v_permlane32_swap_b32 v56, v58
v_pk_add_f32 v[36:37], v[36:37], v[56:57] op_sel_hi:[1,0] neg_lo:[0,1] neg_hi:[0,1]
v_pk_add_f32 v[38:39], v[38:39], v[56:57] op_sel_hi:[1,0] neg_lo:[0,1] neg_hi:[0,1]
v_pk_add_f32 v[40:41], v[40:41], v[56:57] op_sel_hi:[1,0] neg_lo:[0,1] neg_hi:[0,1]
s_add_u32 m0, s2, 16384
s_add_u32 s29, s17, 0x18000
buffer_load_dwordx4 v1, s[4:7], s29 offen sc1 lds
v_pk_add_f32 v[42:43], v[42:43], v[56:57] op_sel_hi:[1,0] neg_lo:[0,1] neg_hi:[0,1]
v_exp_f32 v36, v36
v_exp_f32 v37, v37
v_exp_f32 v38, v38
v_exp_f32 v39, v39
v_exp_f32 v40, v40
buffer_load_dwordx4 v1, s[4:7], s29 offen offset:1024 sc1 lds
v_exp_f32 v41, v41
v_exp_f32 v42, v42
v_exp_f32 v43, v43
v_pk_add_f32 v[44:45], v[44:45], v[58:59] op_sel_hi:[1,0] neg_lo:[0,1] neg_hi:[0,1]
v_pk_add_f32 v[46:47], v[46:47], v[58:59] op_sel_hi:[1,0] neg_lo:[0,1] neg_hi:[0,1]
v_pk_add_f32 v[48:49], v[48:49], v[58:59] op_sel_hi:[1,0] neg_lo:[0,1] neg_hi:[0,1]
v_pk_add_f32 v[50:51], v[50:51], v[58:59] op_sel_hi:[1,0] neg_lo:[0,1] neg_hi:[0,1]
s_add_u32 m0, s2, 24576
s_add_u32 s29, s17, 0x19000
buffer_load_dwordx4 v1, s[4:7], s29 offen sc1 lds
v_exp_f32 v44, v44
v_exp_f32 v45, v45
v_exp_f32 v46, v46
v_exp_f32 v47, v47
v_exp_f32 v48, v48
buffer_load_dwordx4 v1, s[4:7], s29 offen offset:1024 sc1 lds
v_exp_f32 v49, v49
v_exp_f32 v50, v50
v_exp_f32 v51, v51
v_cvt_pk_bf16_f32 v68, v36, v37
v_cvt_pk_bf16_f32 v69, v38, v39
v_cvt_pk_bf16_f32 v70, v40, v41
v_cvt_pk_bf16_f32 v71, v42, v43
v_cvt_pk_bf16_f32 v72, v44, v45
v_cvt_pk_bf16_f32 v73, v46, v47
v_cvt_pk_bf16_f32 v74, v48, v49
v_cvt_pk_bf16_f32 v75, v50, v51
v_mfma_f32_16x16x32_bf16 v[40:43], v[60:63], v[68:71], 0
s_nop 0
v_mfma_f32_16x16x32_bf16 v[48:51], v[60:63], v[72:75], 0
s_add_u32 s14, s28, s88
buffer_load_dwordx4 a[212:215], v1, s[4:7], s14 offen sc1
v_mfma_f32_16x16x32_bf16 v[36:39], v[110:113], v[68:71], 0
v_mfma_f32_16x16x32_bf16 v[44:47], v[112:115], v[72:75], 0
s_nop 1
v_rcp_f32 v40, v40
s_nop 0
v_rcp_f32 v48, v48
s_nop 1
v_pk_mul_f32 v[36:37], v[36:37], v[40:41] op_sel_hi:[1,0]
v_pk_mul_f32 v[38:39], v[38:39], v[40:41] op_sel_hi:[1,0]
v_pk_mul_f32 v[44:45], v[44:45], v[48:49] op_sel_hi:[1,0]
v_pk_mul_f32 v[46:47], v[46:47], v[48:49] op_sel_hi:[1,0]
v_cvt_pk_bf16_f32 v76, v36, v37
v_cvt_pk_bf16_f32 v77, v38, v39
v_cvt_pk_bf16_f32 v78, v44, v45
v_cvt_pk_bf16_f32 v79, v46, v47
s_nop 0
v_permlane32_swap_b32 v76, v78
v_permlane32_swap_b32 v77, v79
buffer_store_dwordx4 v[76:79], v3, s[4:7], s15 offen
s_add_u32 s14, s28, s89
buffer_load_dwordx4 a[216:219], v1, s[4:7], s14 offen sc1
s_waitcnt vmcnt(3)
s_barrier
ds_read_b128 v[88:91], v7 offset:0
ds_read_b128 v[92:95], v8 offset:0
ds_read_b128 v[96:99], v7 offset:4096
ds_read_b128 v[100:103], v8 offset:4096
ds_read_b128 v[72:75], v7 offset:8192
ds_read_b128 v[76:79], v8 offset:8192
s_add_u32 s28, s26, 3072
buffer_load_dwordx4 a[220:223], v1, s[4:7], s28 offen sc1
s_add_u32 s14, s28, s88
buffer_load_dwordx4 a[224:227], v1, s[4:7], s14 offen sc1
s_waitcnt lgkmcnt(4)
v_mfma_f32_16x16x32_bf16 v[36:39], a[192:195], v[88:91], 0
ds_read_b128 v[80:83], v7 offset:12288
ds_read_b128 v[84:87], v8 offset:12288
v_mfma_f32_16x16x32_bf16 v[40:43], a[196:199], v[88:91], 0
v_mfma_f32_16x16x32_bf16 v[44:47], a[192:195], v[92:95], 0
v_mfma_f32_16x16x32_bf16 v[48:51], a[196:199], v[92:95], 0
s_add_u32 s14, s28, s89
s_waitcnt lgkmcnt(4)
v_mfma_f32_16x16x32_bf16 v[36:39], a[200:203], v[96:99], v[36:39]
ds_read_b128 v[88:91], v7 offset:16384
ds_read_b128 v[92:95], v8 offset:16384
v_mfma_f32_16x16x32_bf16 v[40:43], a[204:207], v[96:99], v[40:43]
buffer_load_dwordx4 a[228:231], v1, s[4:7], s14 offen sc1
v_mfma_f32_16x16x32_bf16 v[44:47], a[200:203], v[100:103], v[44:47]
v_mfma_f32_16x16x32_bf16 v[48:51], a[204:207], v[100:103], v[48:51]
s_waitcnt lgkmcnt(4)
v_mfma_f32_16x16x32_bf16 v[36:39], a[96:99], v[72:75], v[36:39]
ds_read_b128 v[96:99], v7 offset:20480
ds_read_b128 v[100:103], v8 offset:20480
v_mfma_f32_16x16x32_bf16 v[40:43], a[100:103], v[72:75], v[40:43]
s_add_u32 s28, s26, 6144
buffer_load_dwordx4 a[232:235], v1, s[4:7], s28 offen sc1
v_mfma_f32_16x16x32_bf16 v[44:47], a[96:99], v[76:79], v[44:47]
v_mfma_f32_16x16x32_bf16 v[48:51], a[100:103], v[76:79], v[48:51]
s_waitcnt lgkmcnt(4)
v_mfma_f32_16x16x32_bf16 v[36:39], a[104:107], v[80:83], v[36:39]
ds_read_b128 v[72:75], v7 offset:24576
ds_read_b128 v[76:79], v8 offset:24576
v_mfma_f32_16x16x32_bf16 v[40:43], a[108:111], v[80:83], v[40:43]
s_add_u32 s14, s28, s88
buffer_load_dwordx4 a[236:239], v1, s[4:7], s14 offen sc1
v_mfma_f32_16x16x32_bf16 v[44:47], a[104:107], v[84:87], v[44:47]
v_mfma_f32_16x16x32_bf16 v[48:51], a[108:111], v[84:87], v[48:51]
s_waitcnt lgkmcnt(4)
v_mfma_f32_16x16x32_bf16 v[36:39], a[112:115], v[88:91], v[36:39]
ds_read_b128 v[80:83], v7 offset:28672
ds_read_b128 v[84:87], v8 offset:28672
v_mfma_f32_16x16x32_bf16 v[40:43], a[116:119], v[88:91], v[40:43]
s_add_u32 s14, s28, s89
buffer_load_dwordx4 a[240:243], v1, s[4:7], s14 offen sc1
v_mfma_f32_16x16x32_bf16 v[44:47], a[112:115], v[92:95], v[44:47]
v_add_u32 v15, 8, v15
s_add_u32 s28, s26, 9216
buffer_load_dwordx4 a[244:247], v1, s[4:7], s28 offen sc1
s_add_u32 s14, s28, s88
buffer_load_dwordx4 a[248:251], v1, s[4:7], s14 offen sc1
s_waitcnt vmcnt(9)
v_mfma_f32_16x16x32_bf16 v[48:51], a[116:119], v[92:95], v[48:51]
buffer_store_dword v15, v13, s[4:7], s45 offen
s_waitcnt lgkmcnt(4)
v_mfma_f32_16x16x32_bf16 v[44:47], a[120:123], v[100:103], v[44:47]
v_mfma_f32_16x16x32_bf16 v[48:51], a[124:127], v[100:103], v[48:51]
s_waitcnt lgkmcnt(2)
v_mfma_f32_16x16x32_bf16 v[44:47], a[128:131], v[76:79], v[44:47]
v_mfma_f32_16x16x32_bf16 v[48:51], a[132:135], v[76:79], v[48:51]
s_add_u32 s14, s28, s89
buffer_load_dwordx4 a[252:255], v1, s[4:7], s14 offen sc1
s_waitcnt lgkmcnt(0)
v_mfma_f32_16x16x32_bf16 v[44:47], a[136:139], v[84:87], v[44:47]
v_mfma_f32_16x16x32_bf16 v[48:51], a[140:143], v[84:87], v[48:51]
v_mfma_f32_16x16x32_bf16 v[36:39], a[120:123], v[96:99], v[36:39]
s_lshl_b32 s15, s8, 11
s_add_u32 s15, s15, 0x20000
v_mfma_f32_16x16x32_bf16 v[40:43], a[124:127], v[96:99], v[40:43]
s_add_u32 s28, s26, 12288
buffer_load_dwordx4 v[128:131], v1, s[4:7], s28 offen sc1
s_xor_b32 s16, s15, 0x1000
v_add_u32 v104, s15, v1
v_mfma_f32_16x16x32_bf16 v[36:39], a[128:131], v[72:75], v[36:39]
v_add_u32 v105, s16, v1
v_mfma_f32_16x16x32_bf16 v[40:43], a[132:135], v[72:75], v[40:43]
ds_write_b128 v104, v[44:47] offset:0
ds_write_b128 v104, v[48:51] offset:1024
v_mfma_f32_16x16x32_bf16 v[36:39], a[136:139], v[80:83], v[36:39]
v_mfma_f32_16x16x32_bf16 v[40:43], a[140:143], v[80:83], v[40:43]
s_add_u32 s14, s28, s88
buffer_load_dwordx4 v[132:135], v1, s[4:7], s14 offen sc1
s_waitcnt lgkmcnt(0)
s_barrier
ds_read_b128 v[68:71], v105 offset:0
ds_read_b128 v[72:75], v105 offset:1024
s_add_u32 s14, s28, s89
buffer_load_dwordx4 v[136:139], v1, s[4:7], s14 offen sc1
s_add_u32 s28, s26, 15360
buffer_load_dwordx4 v[140:143], v1, s[4:7], s28 offen sc1
v_pk_add_f32 v[20:21], v[20:21], v[36:37]
v_pk_add_f32 v[22:23], v[22:23], v[38:39]
v_pk_add_f32 v[24:25], v[24:25], v[40:41]
v_pk_add_f32 v[26:27], v[26:27], v[42:43]
s_add_u32 s14, s28, s88
buffer_load_dwordx4 v[144:147], v1, s[4:7], s14 offen sc1
s_add_u32 s14, s28, s89
buffer_load_dwordx4 v[148:151], v1, s[4:7], s14 offen sc1
s_waitcnt lgkmcnt(1)
v_pk_add_f32 v[20:21], v[20:21], v[68:69]
v_pk_add_f32 v[22:23], v[22:23], v[70:71]
s_waitcnt lgkmcnt(0)
v_pk_add_f32 v[24:25], v[24:25], v[72:73]
v_pk_add_f32 v[26:27], v[26:27], v[74:75]
buffer_load_dword v17, v4, s[4:7], s92 offen sc1
s_add_u32 s15, s47, s62
s_add_u32 s15, s15, 0x8000
v_cvt_pk_bf16_f32 v76, v20, v21
v_cvt_pk_bf16_f32 v77, v22, v23
v_cvt_pk_bf16_f32 v78, v24, v25
v_cvt_pk_bf16_f32 v79, v26, v27
buffer_store_dwordx4 v[76:79], v1, s[4:7], s15 offen
v_pk_add_f32 v[68:69], v[20:21], v[22:23]
v_pk_add_f32 v[70:71], v[24:25], v[26:27]
v_pk_mul_f32 v[72:73], v[20:21], v[20:21]
v_pk_add_f32 v[68:69], v[68:69], v[70:71]
v_pk_fma_f32 v[72:73], v[22:23], v[22:23], v[72:73]
v_pk_fma_f32 v[72:73], v[24:25], v[24:25], v[72:73]
v_pk_fma_f32 v[72:73], v[26:27], v[26:27], v[72:73]
v_add_f32 v68, v68, v69
v_add_f32 v72, v72, v73
s_add_u32 s16, s13, s63
s_add_u32 s16, s16, 0xd00000
v_permlane32_swap_b32 v68, v72
v_add_f32 v68, v68, v72
v_mov_b32 v72, v68
s_nop 1
v_permlane16_swap_b32 v68, v72
v_add_f32 v68, v68, v72
buffer_store_dword v68, v11, s[4:7], s16 offen
s_add_u32 s46, s32, 4
s_add_u32 s28, s26, 18432
buffer_load_dwordx4 v[152:155], v1, s[4:7], s28 offen sc1
s_add_u32 s14, s28, s88
buffer_load_dwordx4 v[156:159], v1, s[4:7], s14 offen sc1
s_add_u32 s14, s28, s89
buffer_load_dwordx4 v[160:163], v1, s[4:7], s14 offen sc1
s_add_u32 s28, s26, 21504
buffer_load_dwordx4 v[164:167], v1, s[4:7], s28 offen sc1
s_add_u32 s14, s28, s88
buffer_load_dwordx4 v[168:171], v1, s[4:7], s14 offen sc1
s_add_u32 s14, s28, s89
buffer_load_dwordx4 v[172:175], v1, s[4:7], s14 offen sc1
s_waitcnt vmcnt(8)
v_lshrrev_b32 v17, 3, v17
v_subrev_u32 v17, s46, v17
v_cmp_lt_u32 vcc, 31, v17
s_cbranch_vccnz L_spin_10
L_ok_9:
s_add_u32 s17, s47, s97
s_add_u32 m0, s2, 32768
s_add_u32 s29, s17, 0x1000
buffer_load_dwordx4 v1, s[4:7], s29 offen sc1 lds
buffer_load_dwordx4 v1, s[4:7], s29 offen offset:1024 sc1 lds
s_add_u32 m0, s2, 40960
s_add_u32 s29, s17, 0x2000
buffer_load_dwordx4 v1, s[4:7], s29 offen sc1 lds
buffer_load_dwordx4 v1, s[4:7], s29 offen offset:1024 sc1 lds
v_add_u32 v15, 8, v15
s_waitcnt vmcnt(10)
buffer_store_dword v15, v13, s[4:7], s45 offen
s_add_u32 m0, s2, 49152
s_add_u32 s29, s17, 0x3000
buffer_load_dwordx4 v1, s[4:7], s29 offen sc1 lds
buffer_load_dwordx4 v1, s[4:7], s29 offen offset:1024 sc1 lds
s_add_u32 m0, s2, 57344
s_add_u32 s29, s17, 0x0
buffer_load_dwordx4 v1, s[4:7], s29 offen sc1 lds
buffer_load_dwordx4 v1, s[4:7], s29 offen offset:1024 sc1 lds
s_waitcnt vmcnt(7)
s_barrier
ds_read_b128 v[88:91], v7 offset:32768
ds_read_b128 v[92:95], v8 offset:32768
ds_read_b128 v[96:99], v7 offset:36864
ds_read_b128 v[100:103], v8 offset:36864
s_add_u32 s28, s27, 0
buffer_load_dwordx4 v[176:179], v1, s[4:7], s28 offen sc1
buffer_load_dwordx4 v[180:183], v1, s[4:7], s28 offen offset:1024 sc1
buffer_load_dwordx4 v[184:187], v1, s[4:7], s28 offen offset:2048 sc1
s_waitcnt vmcnt(8)
s_barrier
ds_read_b128 v[72:75], v7 offset:40960
ds_read_b128 v[76:79], v8 offset:40960
buffer_load_dwordx4 v[188:191], v1, s[4:7], s28 offen offset:3072 sc1
s_add_u32 s28, s27, 4096
buffer_load_dwordx4 v[192:195], v1, s[4:7], s28 offen sc1
s_waitcnt lgkmcnt(4)
v_mfma_f32_16x16x32_bf16 v[36:39], a[96:99], v[88:91], 0
ds_read_b128 v[80:83], v7 offset:45056
ds_read_b128 v[84:87], v8 offset:45056
v_mfma_f32_16x16x32_bf16 v[40:43], a[100:103], v[88:91], 0
v_mfma_f32_16x16x32_bf16 v[44:47], a[96:99], v[92:95], 0
buffer_load_dword v17, v4, s[4:7], s92 offen sc1
v_mfma_f32_16x16x32_bf16 v[48:51], a[100:103], v[92:95], 0
s_waitcnt lgkmcnt(4)
v_mfma_f32_16x16x32_bf16 v[36:39], a[104:107], v[96:99], v[36:39]
s_add_u32 s28, s26, 36864
buffer_load_dwordx4 a[96:99], v1, s[4:7], s28 offen sc1
s_add_u32 s14, s28, s88
buffer_load_dwordx4 a[100:103], v1, s[4:7], s14 offen sc1
s_waitcnt vmcnt(8)
s_barrier
v_mfma_f32_16x16x32_bf16 v[40:43], a[108:111], v[96:99], v[40:43]
ds_read_b128 v[88:91], v7 offset:49152
ds_read_b128 v[92:95], v8 offset:49152
v_mfma_f32_16x16x32_bf16 v[44:47], a[104:107], v[100:103], v[44:47]
v_mfma_f32_16x16x32_bf16 v[48:51], a[108:111], v[100:103], v[48:51]
s_waitcnt lgkmcnt(4)
v_mfma_f32_16x16x32_bf16 v[36:39], a[112:115], v[72:75], v[36:39]
ds_read_b128 v[96:99], v7 offset:53248
ds_read_b128 v[100:103], v8 offset:53248
v_mfma_f32_16x16x32_bf16 v[40:43], a[116:119], v[72:75], v[40:43]
s_add_u32 s14, s28, s89
buffer_load_dwordx4 a[104:107], v1, s[4:7], s14 offen sc1
v_mfma_f32_16x16x32_bf16 v[44:47], a[112:115], v[76:79], v[44:47]
v_mfma_f32_16x16x32_bf16 v[48:51], a[116:119], v[76:79], v[48:51]
s_waitcnt lgkmcnt(4)
v_mfma_f32_16x16x32_bf16 v[36:39], a[120:123], v[80:83], v[36:39]
ds_read_b128 v[72:75], v7 offset:57344
ds_read_b128 v[76:79], v8 offset:57344
v_mfma_f32_16x16x32_bf16 v[40:43], a[124:127], v[80:83], v[40:43]
s_add_u32 s28, s26, 39936
buffer_load_dwordx4 a[108:111], v1, s[4:7], s28 offen sc1
v_mfma_f32_16x16x32_bf16 v[44:47], a[120:123], v[84:87], v[44:47]
v_mfma_f32_16x16x32_bf16 v[48:51], a[124:127], v[84:87], v[48:51]
s_waitcnt lgkmcnt(4)
v_mfma_f32_16x16x32_bf16 v[36:39], a[128:131], v[88:91], v[36:39]
ds_read_b128 v[80:83], v7 offset:61440
ds_read_b128 v[84:87], v8 offset:61440
v_mfma_f32_16x16x32_bf16 v[40:43], a[132:135], v[88:91], v[40:43]
s_add_u32 s14, s28, s88
buffer_load_dwordx4 a[112:115], v1, s[4:7], s14 offen sc1
v_mfma_f32_16x16x32_bf16 v[44:47], a[128:131], v[92:95], v[44:47]
s_add_u32 s44, s32, 5
s_add_u32 s14, s28, s89
buffer_load_dwordx4 a[116:119], v1, s[4:7], s14 offen sc1
s_add_u32 s28, s26, 43008
buffer_load_dwordx4 a[120:123], v1, s[4:7], s28 offen sc1
s_waitcnt vmcnt(7)
v_lshrrev_b32 v17, 3, v17
v_mfma_f32_16x16x32_bf16 v[48:51], a[132:135], v[92:95], v[48:51]
v_subrev_u32 v17, s44, v17
s_waitcnt lgkmcnt(4)
v_mfma_f32_16x16x32_bf16 v[44:47], a[136:139], v[100:103], v[44:47]
v_cmp_lt_u32 vcc, 31, v17
s_cbranch_vccnz L_spin_12
L_ok_11:
s_add_u32 s17, s47, s96
s_add_u32 m0, s3, 65536
s_add_u32 s29, s17, 0x8000
buffer_load_dwordx4 v1, s[4:7], s29 offen sc1 lds
buffer_load_dwordx4 v1, s[4:7], s29 offen offset:1024 sc1 lds
v_mfma_f32_16x16x32_bf16 v[48:51], a[140:143], v[100:103], v[48:51]
s_waitcnt lgkmcnt(2)
v_mfma_f32_16x16x32_bf16 v[44:47], a[192:195], v[76:79], v[44:47]
v_mfma_f32_16x16x32_bf16 v[48:51], a[196:199], v[76:79], v[48:51]
s_add_u32 s46, s13, 0xd00000
buffer_load_dwordx2 v[120:121], v14, s[4:7], s46 offen sc1
s_waitcnt lgkmcnt(0)
v_mfma_f32_16x16x32_bf16 v[44:47], a[200:203], v[84:87], v[44:47]
buffer_load_dwordx2 v[122:123], v14, s[4:7], s46 offen offset:256 sc1
v_mfma_f32_16x16x32_bf16 v[48:51], a[204:207], v[84:87], v[48:51]
v_mfma_f32_16x16x32_bf16 v[36:39], a[136:139], v[96:99], v[36:39]
s_lshl_b32 s15, s8, 11
s_add_u32 s15, s15, 0x20000
v_mfma_f32_16x16x32_bf16 v[40:43], a[140:143], v[96:99], v[40:43]
s_add_u32 m0, s3, 73728
s_add_u32 s29, s17, 0xa000
s_xor_b32 s16, s15, 0x1000
v_add_u32 v104, s15, v1
v_mfma_f32_16x16x32_bf16 v[36:39], a[192:195], v[72:75], v[36:39]
buffer_load_dwordx4 v1, s[4:7], s29 offen sc1 lds
v_add_u32 v105, s16, v1
v_mfma_f32_16x16x32_bf16 v[40:43], a[196:199], v[72:75], v[40:43]
ds_write_b128 v104, v[44:47] offset:0
ds_write_b128 v104, v[48:51] offset:1024
v_mfma_f32_16x16x32_bf16 v[36:39], a[200:203], v[80:83], v[36:39]
v_mfma_f32_16x16x32_bf16 v[40:43], a[204:207], v[80:83], v[40:43]
buffer_load_dwordx4 v1, s[4:7], s29 offen offset:1024 sc1 lds
s_waitcnt lgkmcnt(0)
s_barrier
ds_read_b128 v[68:71], v105 offset:0
ds_read_b128 v[72:75], v105 offset:1024
s_nop 1
v_pk_add_f32 v[28:29], v[28:29], v[36:37]
v_pk_add_f32 v[30:31], v[30:31], v[38:39]
v_pk_add_f32 v[32:33], v[32:33], v[40:41]
v_pk_add_f32 v[34:35], v[34:35], v[42:43]
s_add_u32 s46, s13, 0xd00000
buffer_load_dwordx2 v[124:125], v14, s[4:7], s46 offen offset:512 sc1
buffer_load_dwordx2 v[126:127], v14, s[4:7], s46 offen offset:768 sc1
s_add_u32 m0, s3, 81920
s_add_u32 s29, s17, 0xc000
buffer_load_dwordx4 v1, s[4:7], s29 offen sc1 lds
s_waitcnt lgkmcnt(1)
v_pk_add_f32 v[28:29], v[28:29], v[68:69]
v_pk_add_f32 v[30:31], v[30:31], v[70:71]
s_waitcnt lgkmcnt(0)
v_pk_add_f32 v[32:33], v[32:33], v[72:73]
v_pk_add_f32 v[34:35], v[34:35], v[74:75]
s_add_u32 s15, s47, s62
s_add_u32 s15, s15, 0x16000
v_cvt_pk_bf16_f32 v76, v28, v29
v_cvt_pk_bf16_f32 v77, v30, v31
v_cvt_pk_bf16_f32 v78, v32, v33
v_cvt_pk_bf16_f32 v79, v34, v35
buffer_store_dwordx4 v[76:79], v1, s[4:7], s15 offen
v_pk_add_f32 v[68:69], v[28:29], v[30:31]
v_pk_add_f32 v[70:71], v[32:33], v[34:35]
v_pk_mul_f32 v[72:73], v[28:29], v[28:29]
v_pk_add_f32 v[68:69], v[68:69], v[70:71]
v_pk_fma_f32 v[72:73], v[30:31], v[30:31], v[72:73]
v_pk_fma_f32 v[72:73], v[32:33], v[32:33], v[72:73]
v_pk_fma_f32 v[72:73], v[34:35], v[34:35], v[72:73]
v_add_f32 v68, v68, v69
v_add_f32 v72, v72, v73
s_add_u32 s16, s13, s63
s_add_u32 s16, s16, 0xd01000
v_permlane32_swap_b32 v68, v72
v_add_f32 v68, v68, v72
v_mov_b32 v72, v68
s_nop 1
v_permlane16_swap_b32 v68, v72
v_add_f32 v68, v68, v72
buffer_store_dword v68, v11, s[4:7], s16 offen
buffer_load_dwordx4 v1, s[4:7], s29 offen offset:1024 sc1 lds
s_add_u32 m0, s3, 90112
s_add_u32 s29, s17, 0xe000
buffer_load_dwordx4 v1, s[4:7], s29 offen sc1 lds
s_waitcnt vmcnt(11)
s_barrier
ds_read_b128 v[88:91], v2 offset:0
ds_read_b128 v[92:95], v2 offset:1024
ds_read_b128 v[96:99], v2 offset:2048
ds_read_b128 v[100:103], v2 offset:3072
ds_read_b128 v[72:75], v2 offset:4096
ds_read_b128 v[76:79], v2 offset:5120
buffer_load_dwordx4 v1, s[4:7], s29 offen offset:1024 sc1 lds
s_add_u32 s14, s28, s88
buffer_load_dwordx4 a[124:127], v1, s[4:7], s14 offen sc1
s_waitcnt lgkmcnt(4)
v_mfma_f32_16x16x32_bf16 v[36:39], a[208:211], v[88:91], 0
ds_read_b128 v[80:83], v2 offset:6144
ds_read_b128 v[84:87], v2 offset:7168
v_mfma_f32_16x16x32_bf16 v[44:47], a[212:215], v[88:91], 0
v_mfma_f32_16x16x32_bf16 v[52:55], a[216:219], v[88:91], 0
s_add_u32 s14, s28, s89
buffer_load_dwordx4 a[128:131], v1, s[4:7], s14 offen sc1
v_mfma_f32_16x16x32_bf16 v[40:43], a[208:211], v[92:95], 0
v_mfma_f32_16x16x32_bf16 v[48:51], a[212:215], v[92:95], 0
v_mfma_f32_16x16x32_bf16 v[56:59], a[216:219], v[92:95], 0
s_add_u32 s28, s26, 46080
s_waitcnt lgkmcnt(4)
v_mfma_f32_16x16x32_bf16 v[36:39], a[220:223], v[96:99], v[36:39]
buffer_load_dwordx4 a[132:135], v1, s[4:7], s28 offen sc1
s_add_u32 s14, s28, s88
buffer_load_dwordx4 a[136:139], v1, s[4:7], s14 offen sc1
s_waitcnt vmcnt(12)
s_barrier
v_mfma_f32_16x16x32_bf16 v[44:47], a[224:227], v[96:99], v[44:47]
ds_read_b128 v[88:91], v2 offset:8192
ds_read_b128 v[92:95], v2 offset:9216
v_mfma_f32_16x16x32_bf16 v[52:55], a[228:231], v[96:99], v[52:55]
v_mfma_f32_16x16x32_bf16 v[40:43], a[220:223], v[100:103], v[40:43]
s_add_u32 s14, s28, s89
buffer_load_dwordx4 a[140:143], v1, s[4:7], s14 offen sc1
v_mfma_f32_16x16x32_bf16 v[48:51], a[224:227], v[100:103], v[48:51]
v_mfma_f32_16x16x32_bf16 v[56:59], a[228:231], v[100:103], v[56:59]
s_waitcnt lgkmcnt(4)
v_mfma_f32_16x16x32_bf16 v[36:39], a[232:235], v[72:75], v[36:39]
ds_read_b128 v[96:99], v2 offset:10240
ds_read_b128 v[100:103], v2 offset:11264
v_mfma_f32_16x16x32_bf16 v[44:47], a[236:239], v[72:75], v[44:47]
s_add_u32 s28, s27, 4096
buffer_load_dwordx4 v[196:199], v1, s[4:7], s28 offen offset:1024 sc1
v_mfma_f32_16x16x32_bf16 v[52:55], a[240:243], v[72:75], v[52:55]
v_mfma_f32_16x16x32_bf16 v[40:43], a[232:235], v[76:79], v[40:43]
v_mfma_f32_16x16x32_bf16 v[48:51], a[236:239], v[76:79], v[48:51]
buffer_load_dwordx4 v[200:203], v1, s[4:7], s28 offen offset:2048 sc1
v_mfma_f32_16x16x32_bf16 v[56:59], a[240:243], v[76:79], v[56:59]
s_waitcnt lgkmcnt(4)
v_mfma_f32_16x16x32_bf16 v[36:39], a[244:247], v[80:83], v[36:39]
ds_read_b128 v[72:75], v2 offset:12288
ds_read_b128 v[76:79], v2 offset:13312
v_mfma_f32_16x16x32_bf16 v[44:47], a[248:251], v[80:83], v[44:47]
buffer_load_dwordx4 v[204:207], v1, s[4:7], s28 offen offset:3072 sc1
s_waitcnt vmcnt(14)
v_mfma_f32_16x16x32_bf16 v[52:55], a[252:255], v[80:83], v[52:55]
v_add_f32 v120, v120, v122
v_add_f32 v124, v124, v126
v_mfma_f32_16x16x32_bf16 v[40:43], a[244:247], v[84:87], v[40:43]
v_add_f32 v121, v121, v123
v_add_f32 v125, v125, v127
v_mfma_f32_16x16x32_bf16 v[48:51], a[248:251], v[84:87], v[48:51]
s_add_u32 s28, s27, 8192
buffer_load_dwordx4 v[208:211], v1, s[4:7], s28 offen sc1
v_mfma_f32_16x16x32_bf16 v[56:59], a[252:255], v[84:87], v[56:59]
v_add_f32 v120, v120, v124
s_waitcnt lgkmcnt(4)
v_mfma_f32_16x16x32_bf16 v[36:39], v[128:131], v[88:91], v[36:39]
ds_read_b128 v[80:83], v2 offset:14336
ds_read_b128 v[84:87], v2 offset:15360
v_mfma_f32_16x16x32_bf16 v[44:47], v[132:135], v[88:91], v[44:47]
buffer_load_dwordx4 v[212:215], v1, s[4:7], s28 offen offset:1024 sc1
v_add_f32 v121, v121, v125
v_mfma_f32_16x16x32_bf16 v[52:55], v[136:139], v[88:91], v[52:55]
v_add_u32 v122, s52, v5
s_nop 0
v_mfma_f32_16x16x32_bf16 v[40:43], v[128:131], v[92:95], v[40:43]
v_permlane32_swap_b32 v120, v121
v_mfma_f32_16x16x32_bf16 v[48:51], v[132:135], v[92:95], v[48:51]
buffer_load_dwordx4 v[216:219], v1, s[4:7], s28 offen offset:2048 sc1
v_add_f32 v120, v120, v121
v_mfma_f32_16x16x32_bf16 v[56:59], v[136:139], v[92:95], v[56:59]
v_mov_b32 v121, v120
s_waitcnt lgkmcnt(4)
v_mfma_f32_16x16x32_bf16 v[36:39], v[140:143], v[96:99], v[36:39]
v_permlane16_swap_b32 v120, v121
v_add_f32 v120, v120, v121
v_mov_b32 v121, v120
s_add_u32 s46, s43, 0x610000
buffer_load_dwordx4 v[104:107], v1, s[4:7], s46 offen sc1
v_permlane32_swap_b32 v120, v121
v_mul_f32 v120, 0x3b000000, v120
v_mul_f32 v121, 0x3b000000, v121
v_fma_f32 v121, -v120, v120, v121
v_max_f32 v121, 0, v121
v_add_f32 v121, 0x3727c5ac, v121
v_rsq_f32 v121, v121
v_sub_f32 v120, 0, v120
v_mul_f32 v120, v120, v121
buffer_load_dwordx4 v[220:223], v1, s[4:7], s28 offen offset:3072 sc1
ds_write_b32 v122, v121 offset:192
ds_write_b32 v122, v120 offset:512
s_add_u32 s28, s27, 12288
buffer_load_dwordx4 v[224:227], v1, s[4:7], s28 offen sc1
buffer_load_dwordx4 v[228:231], v1, s[4:7], s28 offen offset:1024 sc1
buffer_load_dwordx4 v[232:235], v1, s[4:7], s28 offen offset:2048 sc1
buffer_load_dwordx4 v[236:239], v1, s[4:7], s28 offen offset:3072 sc1
s_add_u32 s28, s27, 16384
buffer_load_dwordx4 v[240:243], v1, s[4:7], s28 offen sc1
buffer_load_dwordx4 v[244:247], v1, s[4:7], s28 offen offset:1024 sc1
s_waitcnt vmcnt(19) lgkmcnt(0)
s_barrier
v_mfma_f32_16x16x32_bf16 v[44:47], v[144:147], v[96:99], v[44:47]
ds_read_b128 v[88:91], v2 offset:16384
ds_read_b128 v[92:95], v2 offset:17408
v_mfma_f32_16x16x32_bf16 v[52:55], v[148:151], v[96:99], v[52:55]
v_mfma_f32_16x16x32_bf16 v[40:43], v[140:143], v[100:103], v[40:43]
buffer_load_dwordx4 v[248:251], v1, s[4:7], s28 offen offset:2048 sc1
v_mfma_f32_16x16x32_bf16 v[48:51], v[144:147], v[100:103], v[48:51]
v_mfma_f32_16x16x32_bf16 v[56:59], v[148:151], v[100:103], v[56:59]
v_mfma_f32_16x16x32_bf16 v[36:39], v[152:155], v[72:75], v[36:39]
ds_read_b128 v[96:99], v2 offset:18432
ds_read_b128 v[100:103], v2 offset:19456
v_mfma_f32_16x16x32_bf16 v[44:47], v[156:159], v[72:75], v[44:47]
buffer_load_dwordx4 v[252:255], v1, s[4:7], s28 offen offset:3072 sc1
v_add_u32 v15, 8, v15
v_mfma_f32_16x16x32_bf16 v[52:55], v[160:163], v[72:75], v[52:55]
buffer_store_dword v15, v13, s[4:7], s45 offen
v_mfma_f32_16x16x32_bf16 v[40:43], v[152:155], v[76:79], v[40:43]
v_mfma_f32_16x16x32_bf16 v[48:51], v[156:159], v[76:79], v[48:51]
v_mfma_f32_16x16x32_bf16 v[56:59], v[160:163], v[76:79], v[56:59]
v_mfma_f32_16x16x32_bf16 v[36:39], v[164:167], v[80:83], v[36:39]
ds_read_b128 v[72:75], v2 offset:20480
ds_read_b128 v[76:79], v2 offset:21504
v_mfma_f32_16x16x32_bf16 v[44:47], v[168:171], v[80:83], v[44:47]
v_mfma_f32_16x16x32_bf16 v[52:55], v[172:175], v[80:83], v[52:55]
v_mfma_f32_16x16x32_bf16 v[40:43], v[164:167], v[84:87], v[40:43]
v_mfma_f32_16x16x32_bf16 v[48:51], v[168:171], v[84:87], v[48:51]
v_mfma_f32_16x16x32_bf16 v[56:59], v[172:175], v[84:87], v[56:59]
s_waitcnt lgkmcnt(4)
v_mfma_f32_16x16x32_bf16 v[36:39], a[144:147], v[88:91], v[36:39]
ds_read_b128 v[80:83], v2 offset:22528
ds_read_b128 v[84:87], v2 offset:23552
v_mfma_f32_16x16x32_bf16 v[44:47], a[148:151], v[88:91], v[44:47]
v_mfma_f32_16x16x32_bf16 v[52:55], a[152:155], v[88:91], v[52:55]
v_mfma_f32_16x16x32_bf16 v[40:43], a[144:147], v[92:95], v[40:43]
v_mfma_f32_16x16x32_bf16 v[48:51], a[148:151], v[92:95], v[48:51]
v_mfma_f32_16x16x32_bf16 v[56:59], a[152:155], v[92:95], v[56:59]
s_waitcnt lgkmcnt(4)
v_mfma_f32_16x16x32_bf16 v[36:39], a[156:159], v[96:99], v[36:39]
ds_read_b128 v[88:91], v2 offset:24576
ds_read_b128 v[92:95], v2 offset:25600
v_mfma_f32_16x16x32_bf16 v[44:47], a[160:163], v[96:99], v[44:47]
v_mfma_f32_16x16x32_bf16 v[52:55], a[164:167], v[96:99], v[52:55]
v_mfma_f32_16x16x32_bf16 v[40:43], a[156:159], v[100:103], v[40:43]
v_mfma_f32_16x16x32_bf16 v[48:51], a[160:163], v[100:103], v[48:51]
v_mfma_f32_16x16x32_bf16 v[56:59], a[164:167], v[100:103], v[56:59]
s_waitcnt lgkmcnt(4)
v_mfma_f32_16x16x32_bf16 v[36:39], a[168:171], v[72:75], v[36:39]
ds_read_b128 v[96:99], v2 offset:26624
ds_read_b128 v[100:103], v2 offset:27648
v_mfma_f32_16x16x32_bf16 v[44:47], a[172:175], v[72:75], v[44:47]
v_mfma_f32_16x16x32_bf16 v[52:55], a[176:179], v[72:75], v[52:55]
v_mfma_f32_16x16x32_bf16 v[40:43], a[168:171], v[76:79], v[40:43]
v_mfma_f32_16x16x32_bf16 v[48:51], a[172:175], v[76:79], v[48:51]
v_mfma_f32_16x16x32_bf16 v[56:59], a[176:179], v[76:79], v[56:59]
s_waitcnt lgkmcnt(4)
v_mfma_f32_16x16x32_bf16 v[36:39], a[180:183], v[80:83], v[36:39]
ds_read_b128 v[72:75], v2 offset:28672
ds_read_b128 v[76:79], v2 offset:29696
v_mfma_f32_16x16x32_bf16 v[44:47], a[184:187], v[80:83], v[44:47]
buffer_load_dword v17, v4, s[4:7], s92 offen sc1
s_waitcnt vmcnt(11)
v_mfma_f32_16x16x32_bf16 v[52:55], a[188:191], v[80:83], v[52:55]
v_add_f32_dpp v104, v104, v104 row_ror:4 row_mask:0xf bank_mask:0xf
v_add_f32_dpp v105, v105, v105 row_ror:4 row_mask:0xf bank_mask:0xf
v_mfma_f32_16x16x32_bf16 v[40:43], a[180:183], v[84:87], v[40:43]
v_add_f32_dpp v106, v106, v106 row_ror:4 row_mask:0xf bank_mask:0xf
v_add_f32_dpp v107, v107, v107 row_ror:4 row_mask:0xf bank_mask:0xf
v_mfma_f32_16x16x32_bf16 v[48:51], a[184:187], v[84:87], v[48:51]
v_add_f32_dpp v104, v104, v104 row_ror:8 row_mask:0xf bank_mask:0xf
v_add_f32_dpp v105, v105, v105 row_ror:8 row_mask:0xf bank_mask:0xf
v_mfma_f32_16x16x32_bf16 v[56:59], a[188:191], v[84:87], v[56:59]
v_add_f32_dpp v106, v106, v106 row_ror:8 row_mask:0xf bank_mask:0xf
s_waitcnt lgkmcnt(4)
v_mfma_f32_16x16x32_bf16 v[36:39], a[96:99], v[88:91], v[36:39]
ds_read_b128 v[80:83], v2 offset:30720
ds_read_b128 v[84:87], v2 offset:31744
v_mfma_f32_16x16x32_bf16 v[44:47], a[100:103], v[88:91], v[44:47]
v_add_f32_dpp v107, v107, v107 row_ror:8 row_mask:0xf bank_mask:0xf
v_and_b32 v108, 48, v1
v_mfma_f32_16x16x32_bf16 v[52:55], a[104:107], v[88:91], v[52:55]
v_lshrrev_b32 v109, 4, v1
v_and_b32 v109, 48, v109
v_mfma_f32_16x16x32_bf16 v[40:43], a[96:99], v[92:95], v[40:43]
v_lshl_add_u32 v108, v109, 2, v108
v_sub_u32 v109, v6, v109
v_mfma_f32_16x16x32_bf16 v[48:51], a[100:103], v[92:95], v[48:51]
v_add_u32 v108, v108, v109
ds_write_b128 v108, v[104:107] offset:256
v_mfma_f32_16x16x32_bf16 v[56:59], a[104:107], v[92:95], v[56:59]
s_waitcnt lgkmcnt(5)
v_mfma_f32_16x16x32_bf16 v[36:39], a[108:111], v[96:99], v[36:39]
v_mfma_f32_16x16x32_bf16 v[44:47], a[112:115], v[96:99], v[44:47]
v_mfma_f32_16x16x32_bf16 v[52:55], a[116:119], v[96:99], v[52:55]
v_mfma_f32_16x16x32_bf16 v[40:43], a[108:111], v[100:103], v[40:43]
v_mfma_f32_16x16x32_bf16 v[48:51], a[112:115], v[100:103], v[48:51]
v_mfma_f32_16x16x32_bf16 v[56:59], a[116:119], v[100:103], v[56:59]
s_waitcnt lgkmcnt(3)
v_mfma_f32_16x16x32_bf16 v[36:39], a[120:123], v[72:75], v[36:39]
v_mov_b32 v116, s36
v_mov_b32 v117, s37
v_mfma_f32_16x16x32_bf16 v[44:47], a[124:127], v[72:75], v[44:47]
ds_read2_b32 v[68:69], v5 offset0:48 offset1:128
ds_read2_b32 v[70:71], v5 offset0:64 offset1:144
v_mfma_f32_16x16x32_bf16 v[52:55], a[128:131], v[72:75], v[52:55]
ds_read_b128 v[104:107], v6 offset:256
ds_read_b128 v[88:91], v6 offset:512
v_mfma_f32_16x16x32_bf16 v[40:43], a[120:123], v[76:79], v[40:43]
ds_read_b128 v[108:111], v6 offset:320
ds_read_b128 v[92:95], v6 offset:576
v_mfma_f32_16x16x32_bf16 v[48:51], a[124:127], v[76:79], v[48:51]
ds_read_b128 v[112:115], v6 offset:384
ds_read_b128 v[96:99], v6 offset:640
v_mfma_f32_16x16x32_bf16 v[56:59], a[128:131], v[76:79], v[56:59]
s_waitcnt lgkmcnt(9)
v_mfma_f32_16x16x32_bf16 v[36:39], a[132:135], v[80:83], v[36:39]
s_add_u32 s44, s32, 6
s_waitcnt vmcnt(0)
v_lshrrev_b32 v17, 3, v17
v_mfma_f32_16x16x32_bf16 v[44:47], a[136:139], v[80:83], v[44:47]
v_subrev_u32 v17, s44, v17
v_cmp_lt_u32 vcc, 31, v17
s_cbranch_vccnz L_spin_14
L_ok_13:
s_add_u32 s17, s47, s96
v_mfma_f32_16x16x32_bf16 v[52:55], a[140:143], v[80:83], v[52:55]
s_add_u32 m0, s3, 98304
s_add_u32 s29, s17, 0x16000
v_mfma_f32_16x16x32_bf16 v[40:43], a[132:135], v[84:87], v[40:43]
buffer_load_dwordx4 v1, s[4:7], s29 offen sc1 lds
v_mfma_f32_16x16x32_bf16 v[48:51], a[136:139], v[84:87], v[48:51]
v_mfma_f32_16x16x32_bf16 v[56:59], a[140:143], v[84:87], v[56:59]
s_waitcnt lgkmcnt(0)
v_pk_mul_f32 v[68:69], v[68:69], v[116:117] op_sel:[0,1] op_sel_hi:[1,1]
v_pk_mul_f32 v[70:71], v[70:71], v[116:117] op_sel:[0,1] op_sel_hi:[1,1]
v_pk_fma_f32 v[72:73], v[104:105], v[68:69], v[88:89] op_sel:[0,1,0] op_sel_hi:[1,1,1]
buffer_load_dwordx4 v1, s[4:7], s29 offen offset:1024 sc1 lds
v_pk_fma_f32 v[74:75], v[106:107], v[68:69], v[90:91] op_sel:[0,1,0] op_sel_hi:[1,1,1]
v_pk_fma_f32 v[76:77], v[104:105], v[70:71], v[88:89] op_sel:[0,1,0] op_sel_hi:[1,1,1]
v_pk_fma_f32 v[78:79], v[106:107], v[70:71], v[90:91] op_sel:[0,1,0] op_sel_hi:[1,1,1]
v_pk_fma_f32 v[36:37], v[36:37], v[68:69], v[72:73] op_sel_hi:[1,0,1]
v_pk_fma_f32 v[38:39], v[38:39], v[68:69], v[74:75] op_sel_hi:[1,0,1]
v_pk_fma_f32 v[40:41], v[40:41], v[70:71], v[76:77] op_sel_hi:[1,0,1]
v_pk_fma_f32 v[42:43], v[42:43], v[70:71], v[78:79] op_sel_hi:[1,0,1]
v_pk_fma_f32 v[72:73], v[36:37], v[36:37], v[116:117] op_sel_hi:[1,1,0]
v_pk_fma_f32 v[74:75], v[38:39], v[38:39], v[116:117] op_sel_hi:[1,1,0]
s_add_u32 m0, s3, 106496
s_add_u32 s29, s17, 0x18000
buffer_load_dwordx4 v1, s[4:7], s29 offen sc1 lds
v_pk_fma_f32 v[76:77], v[40:41], v[40:41], v[116:117] op_sel_hi:[1,1,0]
v_pk_fma_f32 v[78:79], v[42:43], v[42:43], v[116:117] op_sel_hi:[1,1,0]
v_pk_mul_f32 v[72:73], v[72:73], v[36:37] neg_lo:[0,1] neg_hi:[0,1]
v_pk_mul_f32 v[74:75], v[74:75], v[38:39] neg_lo:[0,1] neg_hi:[0,1]
v_pk_mul_f32 v[76:77], v[76:77], v[40:41] neg_lo:[0,1] neg_hi:[0,1]
v_pk_mul_f32 v[78:79], v[78:79], v[42:43] neg_lo:[0,1] neg_hi:[0,1]
v_exp_f32 v80, v72
v_exp_f32 v81, v73
buffer_load_dwordx4 v1, s[4:7], s29 offen offset:1024 sc1 lds
v_exp_f32 v82, v74
v_exp_f32 v83, v75
v_exp_f32 v84, v76
v_exp_f32 v85, v77
v_exp_f32 v86, v78
s_add_u32 m0, s3, 114688
s_add_u32 s29, s17, 0x1a000
buffer_load_dwordx4 v1, s[4:7], s29 offen sc1 lds
v_exp_f32 v87, v79
v_pk_fma_f32 v[80:81], v[80:81], v[116:117], v[116:117] op_sel:[0,1,1] op_sel_hi:[1,1,1]
v_pk_fma_f32 v[82:83], v[82:83], v[116:117], v[116:117] op_sel:[0,1,1] op_sel_hi:[1,1,1]
v_pk_fma_f32 v[84:85], v[84:85], v[116:117], v[116:117] op_sel:[0,1,1] op_sel_hi:[1,1,1]
v_pk_fma_f32 v[86:87], v[86:87], v[116:117], v[116:117] op_sel:[0,1,1] op_sel_hi:[1,1,1]
v_rcp_f32 v80, v80
v_rcp_f32 v81, v81
buffer_load_dwordx4 v1, s[4:7], s29 offen offset:1024 sc1 lds
v_rcp_f32 v82, v82
v_rcp_f32 v83, v83
v_rcp_f32 v84, v84
v_rcp_f32 v85, v85
v_rcp_f32 v86, v86
s_add_u32 m0, s3, 122880
s_add_u32 s29, s17, 0x1c000
buffer_load_dwordx4 v1, s[4:7], s29 offen sc1 lds
v_rcp_f32 v87, v87
s_add_u32 s15, s40, s12
v_pk_mul_f32 v[36:37], v[36:37], v[80:81]
v_pk_mul_f32 v[38:39], v[38:39], v[82:83]
v_pk_mul_f32 v[40:41], v[40:41], v[84:85]
v_pk_mul_f32 v[42:43], v[42:43], v[86:87]
v_cvt_pk_bf16_f32 v36, v36, v37
v_cvt_pk_bf16_f32 v37, v38, v39
v_cvt_pk_bf16_f32 v38, v40, v41
buffer_load_dwordx4 v1, s[4:7], s29 offen offset:1024 sc1 lds
v_cvt_pk_bf16_f32 v39, v42, v43
v_permlane32_swap_b32 v36, v38
s_nop 0
v_permlane32_swap_b32 v37, v39
buffer_store_dwordx4 v[36:39], v3, s[4:7], s15 offen
v_pk_fma_f32 v[72:73], v[108:109], v[68:69], v[92:93] op_sel:[0,1,0] op_sel_hi:[1,1,1]
v_pk_fma_f32 v[74:75], v[110:111], v[68:69], v[94:95] op_sel:[0,1,0] op_sel_hi:[1,1,1]
v_pk_fma_f32 v[76:77], v[108:109], v[70:71], v[92:93] op_sel:[0,1,0] op_sel_hi:[1,1,1]
v_pk_fma_f32 v[78:79], v[110:111], v[70:71], v[94:95] op_sel:[0,1,0] op_sel_hi:[1,1,1]
v_pk_fma_f32 v[44:45], v[44:45], v[68:69], v[72:73] op_sel_hi:[1,0,1]
v_pk_fma_f32 v[46:47], v[46:47], v[68:69], v[74:75] op_sel_hi:[1,0,1]
v_pk_fma_f32 v[48:49], v[48:49], v[70:71], v[76:77] op_sel_hi:[1,0,1]
v_pk_fma_f32 v[50:51], v[50:51], v[70:71], v[78:79] op_sel_hi:[1,0,1]
v_pk_fma_f32 v[72:73], v[44:45], v[44:45], v[116:117] op_sel_hi:[1,1,0]
s_add_u32 s46, s13, 0xd01000
buffer_load_dwordx2 v[120:121], v14, s[4:7], s46 offen sc1
buffer_load_dwordx2 v[122:123], v14, s[4:7], s46 offen offset:256 sc1
v_pk_fma_f32 v[74:75], v[46:47], v[46:47], v[116:117] op_sel_hi:[1,1,0]
v_pk_fma_f32 v[76:77], v[48:49], v[48:49], v[116:117] op_sel_hi:[1,1,0]
v_pk_fma_f32 v[78:79], v[50:51], v[50:51], v[116:117] op_sel_hi:[1,1,0]
v_pk_mul_f32 v[72:73], v[72:73], v[44:45] neg_lo:[0,1] neg_hi:[0,1]
v_pk_mul_f32 v[74:75], v[74:75], v[46:47] neg_lo:[0,1] neg_hi:[0,1]
v_pk_mul_f32 v[76:77], v[76:77], v[48:49] neg_lo:[0,1] neg_hi:[0,1]
v_pk_mul_f32 v[78:79], v[78:79], v[50:51] neg_lo:[0,1] neg_hi:[0,1]
v_exp_f32 v80, v72
s_add_u32 s46, s13, 0xd01000
buffer_load_dwordx2 v[124:125], v14, s[4:7], s46 offen offset:512 sc1
buffer_load_dwordx2 v[126:127], v14, s[4:7], s46 offen offset:768 sc1
v_exp_f32 v81, v73
v_exp_f32 v82, v74
v_exp_f32 v83, v75
v_exp_f32 v84, v76
v_exp_f32 v85, v77
v_exp_f32 v86, v78
v_exp_f32 v87, v79
v_pk_fma_f32 v[80:81], v[80:81], v[116:117], v[116:117] op_sel:[0,1,1] op_sel_hi:[1,1,1]
v_pk_fma_f32 v[82:83], v[82:83], v[116:117], v[116:117] op_sel:[0,1,1] op_sel_hi:[1,1,1]
v_pk_fma_f32 v[84:85], v[84:85], v[116:117], v[116:117] op_sel:[0,1,1] op_sel_hi:[1,1,1]
v_pk_fma_f32 v[86:87], v[86:87], v[116:117], v[116:117] op_sel:[0,1,1] op_sel_hi:[1,1,1]
v_rcp_f32 v80, v80
v_rcp_f32 v81, v81
v_rcp_f32 v82, v82
v_rcp_f32 v83, v83
v_rcp_f32 v84, v84
v_rcp_f32 v85, v85
v_rcp_f32 v86, v86
v_rcp_f32 v87, v87
s_add_u32 s15, s41, s12
v_pk_mul_f32 v[44:45], v[44:45], v[80:81]
v_pk_mul_f32 v[46:47], v[46:47], v[82:83]
v_pk_mul_f32 v[48:49], v[48:49], v[84:85]
v_pk_mul_f32 v[50:51], v[50:51], v[86:87]
v_cvt_pk_bf16_f32 v44, v44, v45
v_cvt_pk_bf16_f32 v45, v46, v47
v_cvt_pk_bf16_f32 v46, v48, v49
v_cvt_pk_bf16_f32 v47, v50, v51
s_nop 0
v_permlane32_swap_b32 v44, v46
v_permlane32_swap_b32 v45, v47
buffer_store_dwordx4 v[44:47], v3, s[4:7], s15 offen
v_pk_fma_f32 v[72:73], v[112:113], v[68:69], v[96:97] op_sel:[0,1,0] op_sel_hi:[1,1,1]
v_pk_fma_f32 v[74:75], v[114:115], v[68:69], v[98:99] op_sel:[0,1,0] op_sel_hi:[1,1,1]
v_pk_fma_f32 v[76:77], v[112:113], v[70:71], v[96:97] op_sel:[0,1,0] op_sel_hi:[1,1,1]
v_pk_fma_f32 v[78:79], v[114:115], v[70:71], v[98:99] op_sel:[0,1,0] op_sel_hi:[1,1,1]
v_pk_fma_f32 v[52:53], v[52:53], v[68:69], v[72:73] op_sel_hi:[1,0,1]
v_pk_fma_f32 v[54:55], v[54:55], v[68:69], v[74:75] op_sel_hi:[1,0,1]
v_pk_fma_f32 v[56:57], v[56:57], v[70:71], v[76:77] op_sel_hi:[1,0,1]
v_pk_fma_f32 v[58:59], v[58:59], v[70:71], v[78:79] op_sel_hi:[1,0,1]
v_pk_fma_f32 v[72:73], v[52:53], v[52:53], v[116:117] op_sel_hi:[1,1,0]
v_pk_fma_f32 v[74:75], v[54:55], v[54:55], v[116:117] op_sel_hi:[1,1,0]
v_pk_fma_f32 v[76:77], v[56:57], v[56:57], v[116:117] op_sel_hi:[1,1,0]
v_pk_fma_f32 v[78:79], v[58:59], v[58:59], v[116:117] op_sel_hi:[1,1,0]
v_pk_mul_f32 v[72:73], v[72:73], v[52:53] neg_lo:[0,1] neg_hi:[0,1]
v_pk_mul_f32 v[74:75], v[74:75], v[54:55] neg_lo:[0,1] neg_hi:[0,1]
v_pk_mul_f32 v[76:77], v[76:77], v[56:57] neg_lo:[0,1] neg_hi:[0,1]
v_pk_mul_f32 v[78:79], v[78:79], v[58:59] neg_lo:[0,1] neg_hi:[0,1]
v_exp_f32 v80, v72
v_exp_f32 v81, v73
v_exp_f32 v82, v74
v_exp_f32 v83, v75
v_exp_f32 v84, v76
v_exp_f32 v85, v77
v_exp_f32 v86, v78
v_exp_f32 v87, v79
v_pk_fma_f32 v[80:81], v[80:81], v[116:117], v[116:117] op_sel:[0,1,1] op_sel_hi:[1,1,1]
v_pk_fma_f32 v[82:83], v[82:83], v[116:117], v[116:117] op_sel:[0,1,1] op_sel_hi:[1,1,1]
v_pk_fma_f32 v[84:85], v[84:85], v[116:117], v[116:117] op_sel:[0,1,1] op_sel_hi:[1,1,1]
v_pk_fma_f32 v[86:87], v[86:87], v[116:117], v[116:117] op_sel:[0,1,1] op_sel_hi:[1,1,1]
s_waitcnt vmcnt(6)
s_barrier
ds_read_b128 v[88:91], v2 offset:49152
ds_read_b128 v[92:95], v2 offset:50176
ds_read_b128 v[96:99], v2 offset:51200
ds_read_b128 v[100:103], v2 offset:52224
v_rcp_f32 v80, v80
v_rcp_f32 v81, v81
v_rcp_f32 v82, v82
v_rcp_f32 v83, v83
v_rcp_f32 v84, v84
v_rcp_f32 v85, v85
v_rcp_f32 v86, v86
v_rcp_f32 v87, v87
s_add_u32 s15, s42, s12
v_pk_mul_f32 v[52:53], v[52:53], v[80:81]
v_pk_mul_f32 v[54:55], v[54:55], v[82:83]
v_pk_mul_f32 v[56:57], v[56:57], v[84:85]
v_pk_mul_f32 v[58:59], v[58:59], v[86:87]
v_cvt_pk_bf16_f32 v52, v52, v53
v_cvt_pk_bf16_f32 v53, v54, v55
v_cvt_pk_bf16_f32 v54, v56, v57
v_cvt_pk_bf16_f32 v55, v58, v59
s_nop 0
v_permlane32_swap_b32 v52, v54
v_permlane32_swap_b32 v53, v55
buffer_store_dwordx4 v[52:55], v3, s[4:7], s15 offen
ds_read_b128 v[72:75], v2 offset:53248
ds_read_b128 v[76:79], v2 offset:54272
s_waitcnt lgkmcnt(4)
v_mfma_f32_16x16x32_bf16 v[36:39], a[144:147], v[88:91], 0
ds_read_b128 v[80:83], v2 offset:55296
ds_read_b128 v[84:87], v2 offset:56320
v_mfma_f32_16x16x32_bf16 v[44:47], a[148:151], v[88:91], 0
v_mfma_f32_16x16x32_bf16 v[52:55], a[152:155], v[88:91], 0
v_mfma_f32_16x16x32_bf16 v[40:43], a[144:147], v[92:95], 0
v_mfma_f32_16x16x32_bf16 v[48:51], a[148:151], v[92:95], 0
v_mfma_f32_16x16x32_bf16 v[56:59], a[152:155], v[92:95], 0
s_waitcnt lgkmcnt(4)
v_mfma_f32_16x16x32_bf16 v[36:39], a[156:159], v[96:99], v[36:39]
ds_read_b128 v[88:91], v2 offset:57344
ds_read_b128 v[92:95], v2 offset:58368
v_mfma_f32_16x16x32_bf16 v[44:47], a[160:163], v[96:99], v[44:47]
s_add_u32 s28, s27, 20480
buffer_load_dwordx4 a[144:147], v1, s[4:7], s28 offen sc1
v_mfma_f32_16x16x32_bf16 v[52:55], a[164:167], v[96:99], v[52:55]
v_mfma_f32_16x16x32_bf16 v[40:43], a[156:159], v[100:103], v[40:43]
v_mfma_f32_16x16x32_bf16 v[48:51], a[160:163], v[100:103], v[48:51]
v_mfma_f32_16x16x32_bf16 v[56:59], a[164:167], v[100:103], v[56:59]
buffer_load_dwordx4 a[148:151], v1, s[4:7], s28 offen offset:1024 sc1
s_waitcnt lgkmcnt(4)
v_mfma_f32_16x16x32_bf16 v[36:39], a[168:171], v[72:75], v[36:39]
ds_read_b128 v[96:99], v2 offset:59392
ds_read_b128 v[100:103], v2 offset:60416
v_mfma_f32_16x16x32_bf16 v[44:47], a[172:175], v[72:75], v[44:47]
s_waitcnt vmcnt(4)
v_add_f32 v120, v120, v122
v_mfma_f32_16x16x32_bf16 v[52:55], a[176:179], v[72:75], v[52:55]
v_add_f32 v124, v124, v126
v_add_f32 v121, v121, v123
v_mfma_f32_16x16x32_bf16 v[40:43], a[168:171], v[76:79], v[40:43]
buffer_load_dwordx4 a[152:155], v1, s[4:7], s28 offen offset:2048 sc1
v_add_f32 v125, v125, v127
v_mfma_f32_16x16x32_bf16 v[48:51], a[172:175], v[76:79], v[48:51]
v_add_f32 v120, v120, v124
v_add_f32 v121, v121, v125
v_mfma_f32_16x16x32_bf16 v[56:59], a[176:179], v[76:79], v[56:59]
v_add_u32 v122, s52, v5
s_waitcnt lgkmcnt(4)
v_mfma_f32_16x16x32_bf16 v[36:39], a[180:183], v[80:83], v[36:39]
ds_read_b128 v[72:75], v2 offset:61440
ds_read_b128 v[76:79], v2 offset:62464
v_mfma_f32_16x16x32_bf16 v[44:47], a[184:187], v[80:83], v[44:47]
buffer_load_dwordx4 a[156:159], v1, s[4:7], s28 offen offset:3072 sc1
s_nop 0
v_mfma_f32_16x16x32_bf16 v[52:55], a[188:191], v[80:83], v[52:55]
v_permlane32_swap_b32 v120, v121
v_mfma_f32_16x16x32_bf16 v[40:43], a[180:183], v[84:87], v[40:43]
v_add_f32 v120, v120, v121
v_mov_b32 v121, v120
v_mfma_f32_16x16x32_bf16 v[48:51], a[184:187], v[84:87], v[48:51]
s_nop 0
v_permlane16_swap_b32 v120, v121
v_mfma_f32_16x16x32_bf16 v[56:59], a[188:191], v[84:87], v[56:59]
s_add_u32 s28, s27, 24576
s_waitcnt lgkmcnt(4)
v_mfma_f32_16x16x32_bf16 v[36:39], a[96:99], v[88:91], v[36:39]
ds_read_b128 v[80:83], v2 offset:63488
ds_read_b128 v[84:87], v2 offset:64512
v_mfma_f32_16x16x32_bf16 v[44:47], a[100:103], v[88:91], v[44:47]
buffer_load_dwordx4 a[160:163], v1, s[4:7], s28 offen sc1
v_add_u32 v15, 8, v15
v_mfma_f32_16x16x32_bf16 v[52:55], a[104:107], v[88:91], v[52:55]
buffer_load_dwordx4 a[164:167], v1, s[4:7], s28 offen offset:1024 sc1
s_waitcnt vmcnt(6)
v_mfma_f32_16x16x32_bf16 v[40:43], a[96:99], v[92:95], v[40:43]
buffer_store_dword v15, v13, s[4:7], s45 offen
v_add_f32 v120, v120, v121
v_mfma_f32_16x16x32_bf16 v[48:51], a[100:103], v[92:95], v[48:51]
v_mov_b32 v121, v120
v_mfma_f32_16x16x32_bf16 v[56:59], a[104:107], v[92:95], v[56:59]
s_waitcnt lgkmcnt(4)
v_mfma_f32_16x16x32_bf16 v[36:39], a[108:111], v[96:99], v[36:39]
ds_read_b128 v[88:91], v2 offset:32768
ds_read_b128 v[92:95], v2 offset:33792
v_mfma_f32_16x16x32_bf16 v[44:47], a[112:115], v[96:99], v[44:47]
buffer_load_dwordx4 a[168:171], v1, s[4:7], s28 offen offset:2048 sc1
v_mfma_f32_16x16x32_bf16 v[52:55], a[116:119], v[96:99], v[52:55]
v_permlane32_swap_b32 v120, v121
v_mfma_f32_16x16x32_bf16 v[40:43], a[108:111], v[100:103], v[40:43]
v_mul_f32 v120, 0x3b000000, v120
v_mul_f32 v121, 0x3b000000, v121
v_mfma_f32_16x16x32_bf16 v[48:51], a[112:115], v[100:103], v[48:51]
v_fma_f32 v121, -v120, v120, v121
v_max_f32 v121, 0, v121
v_mfma_f32_16x16x32_bf16 v[56:59], a[116:119], v[100:103], v[56:59]
buffer_load_dwordx4 a[172:175], v1, s[4:7], s28 offen offset:3072 sc1
s_waitcnt lgkmcnt(4)
v_mfma_f32_16x16x32_bf16 v[36:39], a[120:123], v[72:75], v[36:39]
ds_read_b128 v[96:99], v2 offset:34816
ds_read_b128 v[100:103], v2 offset:35840
v_mfma_f32_16x16x32_bf16 v[44:47], a[124:127], v[72:75], v[44:47]
v_add_f32 v121, 0x3727c5ac, v121
v_mfma_f32_16x16x32_bf16 v[52:55], a[128:131], v[72:75], v[52:55]
v_rsq_f32 v121, v121
v_mfma_f32_16x16x32_bf16 v[40:43], a[120:123], v[76:79], v[40:43]
s_add_u32 s28, s27, 28672
buffer_load_dwordx4 a[176:179], v1, s[4:7], s28 offen sc1
v_mfma_f32_16x16x32_bf16 v[48:51], a[124:127], v[76:79], v[48:51]
v_sub_f32 v120, 0, v120
v_mul_f32 v120, v120, v121
v_mfma_f32_16x16x32_bf16 v[56:59], a[128:131], v[76:79], v[56:59]
ds_write_b32 v122, v121 offset:64
s_waitcnt lgkmcnt(5)
v_mfma_f32_16x16x32_bf16 v[36:39], a[132:135], v[80:83], v[36:39]
ds_read_b128 v[72:75], v2 offset:36864
ds_read_b128 v[76:79], v2 offset:37888
v_mfma_f32_16x16x32_bf16 v[44:47], a[136:139], v[80:83], v[44:47]
buffer_load_dwordx4 a[180:183], v1, s[4:7], s28 offen offset:1024 sc1
ds_write_b32 v122, v120 offset:384
v_mfma_f32_16x16x32_bf16 v[52:55], a[140:143], v[80:83], v[52:55]
s_waitcnt lgkmcnt(0)
s_barrier
v_mfma_f32_16x16x32_bf16 v[40:43], a[132:135], v[84:87], v[40:43]
v_mfma_f32_16x16x32_bf16 v[48:51], a[136:139], v[84:87], v[48:51]
v_mfma_f32_16x16x32_bf16 v[56:59], a[140:143], v[84:87], v[56:59]
buffer_load_dwordx4 a[184:187], v1, s[4:7], s28 offen offset:2048 sc1
v_mfma_f32_16x16x32_bf16 v[36:39], a[208:211], v[88:91], v[36:39]
ds_read_b128 v[80:83], v2 offset:38912
ds_read_b128 v[84:87], v2 offset:39936
v_mfma_f32_16x16x32_bf16 v[44:47], a[212:215], v[88:91], v[44:47]
v_mfma_f32_16x16x32_bf16 v[52:55], a[216:219], v[88:91], v[52:55]
v_mfma_f32_16x16x32_bf16 v[40:43], a[208:211], v[92:95], v[40:43]
buffer_load_dwordx4 a[188:191], v1, s[4:7], s28 offen offset:3072 sc1
v_mfma_f32_16x16x32_bf16 v[48:51], a[212:215], v[92:95], v[48:51]
v_mfma_f32_16x16x32_bf16 v[56:59], a[216:219], v[92:95], v[56:59]
v_mfma_f32_16x16x32_bf16 v[36:39], a[220:223], v[96:99], v[36:39]
ds_read_b128 v[88:91], v2 offset:40960
ds_read_b128 v[92:95], v2 offset:41984
v_mfma_f32_16x16x32_bf16 v[44:47], a[224:227], v[96:99], v[44:47]
buffer_load_dword v17, v4, s[4:7], s92 offen sc1
v_mfma_f32_16x16x32_bf16 v[52:55], a[228:231], v[96:99], v[52:55]
v_mfma_f32_16x16x32_bf16 v[40:43], a[220:223], v[100:103], v[40:43]
v_mfma_f32_16x16x32_bf16 v[48:51], a[224:227], v[100:103], v[48:51]
v_mfma_f32_16x16x32_bf16 v[56:59], a[228:231], v[100:103], v[56:59]
s_add_u32 s28, s27, 32768
v_mfma_f32_16x16x32_bf16 v[36:39], a[232:235], v[72:75], v[36:39]
ds_read_b128 v[96:99], v2 offset:43008
ds_read_b128 v[100:103], v2 offset:44032
v_mfma_f32_16x16x32_bf16 v[44:47], a[236:239], v[72:75], v[44:47]
buffer_load_dwordx4 a[96:99], v1, s[4:7], s28 offen sc1
v_mfma_f32_16x16x32_bf16 v[52:55], a[240:243], v[72:75], v[52:55]
v_mfma_f32_16x16x32_bf16 v[40:43], a[232:235], v[76:79], v[40:43]
v_mfma_f32_16x16x32_bf16 v[48:51], a[236:239], v[76:79], v[48:51]
v_mfma_f32_16x16x32_bf16 v[56:59], a[240:243], v[76:79], v[56:59]
buffer_load_dwordx4 a[100:103], v1, s[4:7], s28 offen offset:1024 sc1
s_waitcnt lgkmcnt(4)
v_mfma_f32_16x16x32_bf16 v[36:39], a[244:247], v[80:83], v[36:39]
ds_read_b128 v[72:75], v2 offset:45056
ds_read_b128 v[76:79], v2 offset:46080
v_mfma_f32_16x16x32_bf16 v[44:47], a[248:251], v[80:83], v[44:47]
v_mfma_f32_16x16x32_bf16 v[52:55], a[252:255], v[80:83], v[52:55]
v_mfma_f32_16x16x32_bf16 v[40:43], a[244:247], v[84:87], v[40:43]
buffer_load_dwordx4 a[104:107], v1, s[4:7], s28 offen offset:2048 sc1
v_mfma_f32_16x16x32_bf16 v[48:51], a[248:251], v[84:87], v[48:51]
v_mfma_f32_16x16x32_bf16 v[56:59], a[252:255], v[84:87], v[56:59]
s_waitcnt lgkmcnt(4)
v_mfma_f32_16x16x32_bf16 v[36:39], v[128:131], v[88:91], v[36:39]
ds_read_b128 v[80:83], v2 offset:47104
ds_read_b128 v[84:87], v2 offset:48128
v_mfma_f32_16x16x32_bf16 v[44:47], v[132:135], v[88:91], v[44:47]
buffer_load_dwordx4 a[108:111], v1, s[4:7], s28 offen offset:3072 sc1
v_mfma_f32_16x16x32_bf16 v[52:55], v[136:139], v[88:91], v[52:55]
v_mfma_f32_16x16x32_bf16 v[40:43], v[128:131], v[92:95], v[40:43]
v_mfma_f32_16x16x32_bf16 v[48:51], v[132:135], v[92:95], v[48:51]
v_mfma_f32_16x16x32_bf16 v[56:59], v[136:139], v[92:95], v[56:59]
s_add_u32 s28, s27, 36864
s_waitcnt lgkmcnt(4)
v_mfma_f32_16x16x32_bf16 v[36:39], v[140:143], v[96:99], v[36:39]
buffer_load_dwordx4 a[112:115], v1, s[4:7], s28 offen sc1
v_mfma_f32_16x16x32_bf16 v[44:47], v[144:147], v[96:99], v[44:47]
v_mfma_f32_16x16x32_bf16 v[52:55], v[148:151], v[96:99], v[52:55]
v_mfma_f32_16x16x32_bf16 v[40:43], v[140:143], v[100:103], v[40:43]
v_mfma_f32_16x16x32_bf16 v[48:51], v[144:147], v[100:103], v[48:51]
buffer_load_dwordx4 a[116:119], v1, s[4:7], s28 offen offset:1024 sc1
v_mfma_f32_16x16x32_bf16 v[56:59], v[148:151], v[100:103], v[56:59]
s_waitcnt lgkmcnt(2)
v_mfma_f32_16x16x32_bf16 v[36:39], v[152:155], v[72:75], v[36:39]
v_mov_b32 v116, s36
v_mov_b32 v117, s37
v_mfma_f32_16x16x32_bf16 v[44:47], v[156:159], v[72:75], v[44:47]
ds_read2_b32 v[68:69], v5 offset0:16 offset1:96
ds_read2_b32 v[70:71], v5 offset0:32 offset1:112
v_mfma_f32_16x16x32_bf16 v[52:55], v[160:163], v[72:75], v[52:55]
buffer_load_dwordx4 a[120:123], v1, s[4:7], s28 offen offset:2048 sc1
ds_read_b128 v[104:107], v6 offset:256
v_mfma_f32_16x16x32_bf16 v[40:43], v[152:155], v[76:79], v[40:43]
ds_read_b128 v[88:91], v6 offset:512
ds_read_b128 v[108:111], v6 offset:320
v_mfma_f32_16x16x32_bf16 v[48:51], v[156:159], v[76:79], v[48:51]
ds_read_b128 v[92:95], v6 offset:576
ds_read_b128 v[112:115], v6 offset:384
v_mfma_f32_16x16x32_bf16 v[56:59], v[160:163], v[76:79], v[56:59]
ds_read_b128 v[96:99], v6 offset:640
s_waitcnt lgkmcnt(8)
v_mfma_f32_16x16x32_bf16 v[36:39], v[164:167], v[80:83], v[36:39]
buffer_load_dwordx4 a[124:127], v1, s[4:7], s28 offen offset:3072 sc1
v_mfma_f32_16x16x32_bf16 v[44:47], v[168:171], v[80:83], v[44:47]
v_mfma_f32_16x16x32_bf16 v[52:55], v[172:175], v[80:83], v[52:55]
v_mfma_f32_16x16x32_bf16 v[40:43], v[164:167], v[84:87], v[40:43]
v_mfma_f32_16x16x32_bf16 v[48:51], v[168:171], v[84:87], v[48:51]
s_add_u32 s28, s27, 40960
buffer_load_dwordx4 a[128:131], v1, s[4:7], s28 offen sc1
v_mfma_f32_16x16x32_bf16 v[56:59], v[172:175], v[84:87], v[56:59]
s_add_u32 s46, s32, 7
buffer_load_dwordx4 a[132:135], v1, s[4:7], s28 offen offset:1024 sc1
s_waitcnt vmcnt(10)
v_lshrrev_b32 v17, 3, v17
v_subrev_u32 v17, s46, v17
v_cmp_lt_u32 vcc, 31, v17
s_cbranch_vccnz L_spin_16
L_ok_15:
s_add_u32 s17, s12, s19
s_waitcnt lgkmcnt(0)
v_pk_mul_f32 v[68:69], v[68:69], v[116:117] op_sel:[0,1] op_sel_hi:[1,1]
v_pk_mul_f32 v[70:71], v[70:71], v[116:117] op_sel:[0,1] op_sel_hi:[1,1]
v_pk_fma_f32 v[72:73], v[104:105], v[68:69], v[88:89] op_sel:[0,1,0] op_sel_hi:[1,1,1]
v_pk_fma_f32 v[74:75], v[106:107], v[68:69], v[90:91] op_sel:[0,1,0] op_sel_hi:[1,1,1]
v_pk_fma_f32 v[76:77], v[104:105], v[70:71], v[88:89] op_sel:[0,1,0] op_sel_hi:[1,1,1]
v_pk_fma_f32 v[78:79], v[106:107], v[70:71], v[90:91] op_sel:[0,1,0] op_sel_hi:[1,1,1]
v_pk_fma_f32 v[36:37], v[36:37], v[68:69], v[72:73] op_sel_hi:[1,0,1]
v_pk_fma_f32 v[38:39], v[38:39], v[68:69], v[74:75] op_sel_hi:[1,0,1]
v_pk_fma_f32 v[40:41], v[40:41], v[70:71], v[76:77] op_sel_hi:[1,0,1]
s_add_u32 m0, s2, 0
s_add_u32 s29, s17, 0x0
buffer_load_dwordx4 v1, s[4:7], s29 offen sc1 lds
v_pk_fma_f32 v[42:43], v[42:43], v[70:71], v[78:79] op_sel_hi:[1,0,1]
v_pk_fma_f32 v[72:73], v[36:37], v[36:37], v[116:117] op_sel_hi:[1,1,0]
v_pk_fma_f32 v[74:75], v[38:39], v[38:39], v[116:117] op_sel_hi:[1,1,0]
v_pk_fma_f32 v[76:77], v[40:41], v[40:41], v[116:117] op_sel_hi:[1,1,0]
v_pk_fma_f32 v[78:79], v[42:43], v[42:43], v[116:117] op_sel_hi:[1,1,0]
v_pk_mul_f32 v[72:73], v[72:73], v[36:37] neg_lo:[0,1] neg_hi:[0,1]
v_pk_mul_f32 v[74:75], v[74:75], v[38:39] neg_lo:[0,1] neg_hi:[0,1]
v_pk_mul_f32 v[76:77], v[76:77], v[40:41] neg_lo:[0,1] neg_hi:[0,1]
v_pk_mul_f32 v[78:79], v[78:79], v[42:43] neg_lo:[0,1] neg_hi:[0,1]
buffer_load_dwordx4 v1, s[4:7], s29 offen offset:1024 sc1 lds
v_exp_f32 v80, v72
v_exp_f32 v81, v73
v_exp_f32 v82, v74
v_exp_f32 v83, v75
v_exp_f32 v84, v76
s_add_u32 m0, s2, 8192
s_add_u32 s29, s17, 0x1000
buffer_load_dwordx4 v1, s[4:7], s29 offen sc1 lds
v_exp_f32 v85, v77
v_exp_f32 v86, v78
v_exp_f32 v87, v79
v_pk_fma_f32 v[80:81], v[80:81], v[116:117], v[116:117] op_sel:[0,1,1] op_sel_hi:[1,1,1]
v_pk_fma_f32 v[82:83], v[82:83], v[116:117], v[116:117] op_sel:[0,1,1] op_sel_hi:[1,1,1]
v_pk_fma_f32 v[84:85], v[84:85], v[116:117], v[116:117] op_sel:[0,1,1] op_sel_hi:[1,1,1]
v_pk_fma_f32 v[86:87], v[86:87], v[116:117], v[116:117] op_sel:[0,1,1] op_sel_hi:[1,1,1]
buffer_load_dwordx4 v1, s[4:7], s29 offen offset:1024 sc1 lds
v_rcp_f32 v80, v80
v_rcp_f32 v81, v81
v_rcp_f32 v82, v82
v_rcp_f32 v83, v83
v_rcp_f32 v84, v84
s_add_u32 m0, s2, 16384
s_add_u32 s29, s17, 0x2000
buffer_load_dwordx4 v1, s[4:7], s29 offen sc1 lds
v_rcp_f32 v85, v85
v_rcp_f32 v86, v86
v_rcp_f32 v87, v87
s_add_u32 s15, s40, s12
v_pk_mul_f32 v[36:37], v[36:37], v[80:81]
v_pk_mul_f32 v[38:39], v[38:39], v[82:83]
v_pk_mul_f32 v[40:41], v[40:41], v[84:85]
v_pk_mul_f32 v[42:43], v[42:43], v[86:87]
buffer_load_dwordx4 v1, s[4:7], s29 offen offset:1024 sc1 lds
s_add_u32 s15, s15, 0x1e000
v_cvt_pk_bf16_f32 v36, v36, v37
v_cvt_pk_bf16_f32 v37, v38, v39
v_cvt_pk_bf16_f32 v38, v40, v41
v_cvt_pk_bf16_f32 v39, v42, v43
s_nop 0
v_permlane32_swap_b32 v36, v38
v_permlane32_swap_b32 v37, v39
buffer_store_dwordx4 v[36:39], v3, s[4:7], s15 offen
v_pk_fma_f32 v[72:73], v[108:109], v[68:69], v[92:93] op_sel:[0,1,0] op_sel_hi:[1,1,1]
v_pk_fma_f32 v[74:75], v[110:111], v[68:69], v[94:95] op_sel:[0,1,0] op_sel_hi:[1,1,1]
v_pk_fma_f32 v[76:77], v[108:109], v[70:71], v[92:93] op_sel:[0,1,0] op_sel_hi:[1,1,1]
v_pk_fma_f32 v[78:79], v[110:111], v[70:71], v[94:95] op_sel:[0,1,0] op_sel_hi:[1,1,1]
v_pk_fma_f32 v[44:45], v[44:45], v[68:69], v[72:73] op_sel_hi:[1,0,1]
v_pk_fma_f32 v[46:47], v[46:47], v[68:69], v[74:75] op_sel_hi:[1,0,1]
v_pk_fma_f32 v[48:49], v[48:49], v[70:71], v[76:77] op_sel_hi:[1,0,1]
v_pk_fma_f32 v[50:51], v[50:51], v[70:71], v[78:79] op_sel_hi:[1,0,1]
v_pk_fma_f32 v[72:73], v[44:45], v[44:45], v[116:117] op_sel_hi:[1,1,0]
s_add_u32 m0, s2, 24576
s_add_u32 s29, s17, 0x3000
buffer_load_dwordx4 v1, s[4:7], s29 offen sc1 lds
v_pk_fma_f32 v[74:75], v[46:47], v[46:47], v[116:117] op_sel_hi:[1,1,0]
v_pk_fma_f32 v[76:77], v[48:49], v[48:49], v[116:117] op_sel_hi:[1,1,0]
v_pk_fma_f32 v[78:79], v[50:51], v[50:51], v[116:117] op_sel_hi:[1,1,0]
v_pk_mul_f32 v[72:73], v[72:73], v[44:45] neg_lo:[0,1] neg_hi:[0,1]
v_pk_mul_f32 v[74:75], v[74:75], v[46:47] neg_lo:[0,1] neg_hi:[0,1]
v_pk_mul_f32 v[76:77], v[76:77], v[48:49] neg_lo:[0,1] neg_hi:[0,1]
v_pk_mul_f32 v[78:79], v[78:79], v[50:51] neg_lo:[0,1] neg_hi:[0,1]
v_exp_f32 v80, v72
buffer_load_dwordx4 v1, s[4:7], s29 offen offset:1024 sc1 lds
v_exp_f32 v81, v73
v_exp_f32 v82, v74
v_exp_f32 v83, v75
v_exp_f32 v84, v76
v_exp_f32 v85, v77
s_add_u32 m0, s2, 32768
s_add_u32 s29, s17, 0x4000
buffer_load_dwordx4 v1, s[4:7], s29 offen sc1 lds
v_exp_f32 v86, v78
v_exp_f32 v87, v79
v_pk_fma_f32 v[80:81], v[80:81], v[116:117], v[116:117] op_sel:[0,1,1] op_sel_hi:[1,1,1]
v_pk_fma_f32 v[82:83], v[82:83], v[116:117], v[116:117] op_sel:[0,1,1] op_sel_hi:[1,1,1]
v_pk_fma_f32 v[84:85], v[84:85], v[116:117], v[116:117] op_sel:[0,1,1] op_sel_hi:[1,1,1]
v_pk_fma_f32 v[86:87], v[86:87], v[116:117], v[116:117] op_sel:[0,1,1] op_sel_hi:[1,1,1]
v_rcp_f32 v80, v80
buffer_load_dwordx4 v1, s[4:7], s29 offen offset:1024 sc1 lds
v_rcp_f32 v81, v81
v_rcp_f32 v82, v82
v_rcp_f32 v83, v83
v_rcp_f32 v84, v84
v_rcp_f32 v85, v85
s_add_u32 m0, s2, 40960
s_add_u32 s29, s17, 0x5000
buffer_load_dwordx4 v1, s[4:7], s29 offen sc1 lds
v_rcp_f32 v86, v86
v_rcp_f32 v87, v87
s_add_u32 s15, s41, s12
v_pk_mul_f32 v[44:45], v[44:45], v[80:81]
v_pk_mul_f32 v[46:47], v[46:47], v[82:83]
v_pk_mul_f32 v[48:49], v[48:49], v[84:85]
v_pk_mul_f32 v[50:51], v[50:51], v[86:87]
s_add_u32 s15, s15, 0x1e000
v_cvt_pk_bf16_f32 v44, v44, v45
v_cvt_pk_bf16_f32 v45, v46, v47
buffer_load_dwordx4 v1, s[4:7], s29 offen offset:1024 sc1 lds
v_cvt_pk_bf16_f32 v46, v48, v49
v_cvt_pk_bf16_f32 v47, v50, v51
s_nop 0
v_permlane32_swap_b32 v44, v46
v_permlane32_swap_b32 v45, v47
buffer_store_dwordx4 v[44:47], v3, s[4:7], s15 offen
v_pk_fma_f32 v[72:73], v[112:113], v[68:69], v[96:97] op_sel:[0,1,0] op_sel_hi:[1,1,1]
v_pk_fma_f32 v[74:75], v[114:115], v[68:69], v[98:99] op_sel:[0,1,0] op_sel_hi:[1,1,1]
v_pk_fma_f32 v[76:77], v[112:113], v[70:71], v[96:97] op_sel:[0,1,0] op_sel_hi:[1,1,1]
v_pk_fma_f32 v[78:79], v[114:115], v[70:71], v[98:99] op_sel:[0,1,0] op_sel_hi:[1,1,1]
v_pk_fma_f32 v[52:53], v[52:53], v[68:69], v[72:73] op_sel_hi:[1,0,1]
v_pk_fma_f32 v[54:55], v[54:55], v[68:69], v[74:75] op_sel_hi:[1,0,1]
v_pk_fma_f32 v[56:57], v[56:57], v[70:71], v[76:77] op_sel_hi:[1,0,1]
v_pk_fma_f32 v[58:59], v[58:59], v[70:71], v[78:79] op_sel_hi:[1,0,1]
v_pk_fma_f32 v[72:73], v[52:53], v[52:53], v[116:117] op_sel_hi:[1,1,0]
s_add_u32 m0, s2, 49152
s_add_u32 s29, s17, 0x6000
buffer_load_dwordx4 v1, s[4:7], s29 offen sc1 lds
v_pk_fma_f32 v[74:75], v[54:55], v[54:55], v[116:117] op_sel_hi:[1,1,0]
v_pk_fma_f32 v[76:77], v[56:57], v[56:57], v[116:117] op_sel_hi:[1,1,0]
v_pk_fma_f32 v[78:79], v[58:59], v[58:59], v[116:117] op_sel_hi:[1,1,0]
v_pk_mul_f32 v[72:73], v[72:73], v[52:53] neg_lo:[0,1] neg_hi:[0,1]
v_pk_mul_f32 v[74:75], v[74:75], v[54:55] neg_lo:[0,1] neg_hi:[0,1]
v_pk_mul_f32 v[76:77], v[76:77], v[56:57] neg_lo:[0,1] neg_hi:[0,1]
v_pk_mul_f32 v[78:79], v[78:79], v[58:59] neg_lo:[0,1] neg_hi:[0,1]
v_exp_f32 v80, v72
buffer_load_dwordx4 v1, s[4:7], s29 offen offset:1024 sc1 lds
v_exp_f32 v81, v73
v_exp_f32 v82, v74
v_exp_f32 v83, v75
v_exp_f32 v84, v76
v_exp_f32 v85, v77
s_add_u32 m0, s2, 57344
s_add_u32 s29, s17, 0x7000
buffer_load_dwordx4 v1, s[4:7], s29 offen sc1 lds
v_exp_f32 v86, v78
v_exp_f32 v87, v79
v_pk_fma_f32 v[80:81], v[80:81], v[116:117], v[116:117] op_sel:[0,1,1] op_sel_hi:[1,1,1]
v_pk_fma_f32 v[82:83], v[82:83], v[116:117], v[116:117] op_sel:[0,1,1] op_sel_hi:[1,1,1]
v_pk_fma_f32 v[84:85], v[84:85], v[116:117], v[116:117] op_sel:[0,1,1] op_sel_hi:[1,1,1]
v_pk_fma_f32 v[86:87], v[86:87], v[116:117], v[116:117] op_sel:[0,1,1] op_sel_hi:[1,1,1]
buffer_load_dwordx4 a[136:139], v1, s[4:7], s28 offen offset:2048 sc1
s_waitcnt vmcnt(9)
s_barrier
ds_read_b128 v[88:91], v7 offset:0
ds_read_b128 v[92:95], v8 offset:0
ds_read_b128 v[96:99], v7 offset:4096
ds_read_b128 v[100:103], v8 offset:4096
v_rcp_f32 v80, v80
v_rcp_f32 v81, v81
v_rcp_f32 v82, v82
v_rcp_f32 v83, v83
v_rcp_f32 v84, v84
buffer_load_dwordx4 v1, s[4:7], s29 offen offset:1024 sc1 lds
v_rcp_f32 v85, v85
v_rcp_f32 v86, v86
v_rcp_f32 v87, v87
s_add_u32 s15, s42, s12
v_pk_mul_f32 v[52:53], v[52:53], v[80:81]
v_pk_mul_f32 v[54:55], v[54:55], v[82:83]
v_pk_mul_f32 v[56:57], v[56:57], v[84:85]
v_pk_mul_f32 v[58:59], v[58:59], v[86:87]
s_add_u32 m0, s2, 65536
s_add_u32 s29, s17, 0x8000
buffer_load_dwordx4 v1, s[4:7], s29 offen sc1 lds
s_add_u32 s15, s15, 0x1e000
v_cvt_pk_bf16_f32 v52, v52, v53
v_cvt_pk_bf16_f32 v53, v54, v55
v_cvt_pk_bf16_f32 v54, v56, v57
v_cvt_pk_bf16_f32 v55, v58, v59
s_nop 0
v_permlane32_swap_b32 v52, v54
v_permlane32_swap_b32 v53, v55
buffer_store_dwordx4 v[52:55], v3, s[4:7], s15 offen
ds_read_b128 v[72:75], v7 offset:8192
ds_read_b128 v[76:79], v8 offset:8192
s_waitcnt lgkmcnt(4)
v_mfma_f32_16x16x32_bf16 v[36:39], v[176:179], v[88:91], 0
ds_read_b128 v[80:83], v7 offset:12288
ds_read_b128 v[84:87], v8 offset:12288
v_mfma_f32_16x16x32_bf16 v[40:43], v[180:183], v[88:91], 0
v_mfma_f32_16x16x32_bf16 v[44:47], v[176:179], v[92:95], 0
buffer_load_dwordx4 v1, s[4:7], s29 offen offset:1024 sc1 lds
v_mfma_f32_16x16x32_bf16 v[48:51], v[180:183], v[92:95], 0
v_lshrrev_b32 v106, 4, v1
v_and_b32 v106, 48, v106
s_waitcnt lgkmcnt(4)
v_mfma_f32_16x16x32_bf16 v[36:39], v[184:187], v[96:99], v[36:39]
ds_read_b128 v[88:91], v7 offset:16384
ds_read_b128 v[92:95], v8 offset:16384
v_mfma_f32_16x16x32_bf16 v[40:43], v[188:191], v[96:99], v[40:43]
s_add_u32 m0, s2, 73728
s_add_u32 s29, s17, 0x9000
v_mfma_f32_16x16x32_bf16 v[44:47], v[184:187], v[100:103], v[44:47]
buffer_load_dwordx4 v1, s[4:7], s29 offen sc1 lds
v_mfma_f32_16x16x32_bf16 v[48:51], v[188:191], v[100:103], v[48:51]
s_waitcnt lgkmcnt(4)
v_mfma_f32_16x16x32_bf16 v[36:39], v[192:195], v[72:75], v[36:39]
ds_read_b128 v[96:99], v7 offset:20480
ds_read_b128 v[100:103], v8 offset:20480
v_mfma_f32_16x16x32_bf16 v[40:43], v[196:199], v[72:75], v[40:43]
buffer_load_dwordx4 v1, s[4:7], s29 offen offset:1024 sc1 lds
v_mfma_f32_16x16x32_bf16 v[44:47], v[192:195], v[76:79], v[44:47]
v_mfma_f32_16x16x32_bf16 v[48:51], v[196:199], v[76:79], v[48:51]
s_waitcnt lgkmcnt(4)
v_mfma_f32_16x16x32_bf16 v[36:39], v[200:203], v[80:83], v[36:39]
ds_read_b128 v[72:75], v7 offset:24576
ds_read_b128 v[76:79], v8 offset:24576
v_mfma_f32_16x16x32_bf16 v[40:43], v[204:207], v[80:83], v[40:43]
s_add_u32 m0, s2, 81920
s_add_u32 s29, s17, 0xa000
v_mfma_f32_16x16x32_bf16 v[44:47], v[200:203], v[84:87], v[44:47]
buffer_load_dwordx4 v1, s[4:7], s29 offen sc1 lds
v_mfma_f32_16x16x32_bf16 v[48:51], v[204:207], v[84:87], v[48:51]
s_waitcnt lgkmcnt(4)
v_mfma_f32_16x16x32_bf16 v[36:39], v[208:211], v[88:91], v[36:39]
ds_read_b128 v[80:83], v7 offset:28672
ds_read_b128 v[84:87], v8 offset:28672
v_mfma_f32_16x16x32_bf16 v[40:43], v[212:215], v[88:91], v[40:43]
buffer_load_dwordx4 v1, s[4:7], s29 offen offset:1024 sc1 lds
v_mfma_f32_16x16x32_bf16 v[44:47], v[208:211], v[92:95], v[44:47]
v_mfma_f32_16x16x32_bf16 v[48:51], v[212:215], v[92:95], v[48:51]
s_waitcnt lgkmcnt(4)
v_mfma_f32_16x16x32_bf16 v[36:39], v[216:219], v[96:99], v[36:39]
buffer_load_dwordx4 a[140:143], v1, s[4:7], s28 offen offset:3072 sc1
s_waitcnt vmcnt(8)
s_barrier
v_mfma_f32_16x16x32_bf16 v[40:43], v[220:223], v[96:99], v[40:43]
ds_read_b128 v[88:91], v7 offset:32768
ds_read_b128 v[92:95], v8 offset:32768
v_mfma_f32_16x16x32_bf16 v[44:47], v[216:219], v[100:103], v[44:47]
v_mfma_f32_16x16x32_bf16 v[48:51], v[220:223], v[100:103], v[48:51]
buffer_load_dwordx4 v[108:111], v106, s[48:51], s95 offen
s_waitcnt lgkmcnt(4)
v_mfma_f32_16x16x32_bf16 v[36:39], v[224:227], v[72:75], v[36:39]
ds_read_b128 v[96:99], v7 offset:36864
ds_read_b128 v[100:103], v8 offset:36864
v_mfma_f32_16x16x32_bf16 v[40:43], v[228:231], v[72:75], v[40:43]
v_add_u32 v15, 8, v15
s_waitcnt vmcnt(7)
v_mfma_f32_16x16x32_bf16 v[44:47], v[224:227], v[76:79], v[44:47]
buffer_store_dword v15, v13, s[4:7], s45 offen
v_mfma_f32_16x16x32_bf16 v[48:51], v[228:231], v[76:79], v[48:51]
s_waitcnt lgkmcnt(4)
v_mfma_f32_16x16x32_bf16 v[36:39], v[232:235], v[80:83], v[36:39]
ds_read_b128 v[72:75], v7 offset:40960
ds_read_b128 v[76:79], v8 offset:40960
v_mfma_f32_16x16x32_bf16 v[40:43], v[236:239], v[80:83], v[40:43]
buffer_load_dword v17, v4, s[4:7], s92 offen sc1
v_mfma_f32_16x16x32_bf16 v[44:47], v[232:235], v[84:87], v[44:47]
v_mfma_f32_16x16x32_bf16 v[48:51], v[236:239], v[84:87], v[48:51]
s_waitcnt lgkmcnt(4)
v_mfma_f32_16x16x32_bf16 v[36:39], v[240:243], v[88:91], v[36:39]
ds_read_b128 v[80:83], v7 offset:45056
ds_read_b128 v[84:87], v8 offset:45056
v_mfma_f32_16x16x32_bf16 v[40:43], v[244:247], v[88:91], v[40:43]
v_mfma_f32_16x16x32_bf16 v[44:47], v[240:243], v[92:95], v[44:47]
v_mfma_f32_16x16x32_bf16 v[48:51], v[244:247], v[92:95], v[48:51]
s_waitcnt lgkmcnt(4)
v_mfma_f32_16x16x32_bf16 v[36:39], v[248:251], v[96:99], v[36:39]
ds_read_b128 v[88:91], v7 offset:49152
ds_read_b128 v[92:95], v8 offset:49152
v_mfma_f32_16x16x32_bf16 v[40:43], v[252:255], v[96:99], v[40:43]
v_mfma_f32_16x16x32_bf16 v[44:47], v[248:251], v[100:103], v[44:47]
v_mfma_f32_16x16x32_bf16 v[48:51], v[252:255], v[100:103], v[48:51]
s_waitcnt lgkmcnt(4)
v_mfma_f32_16x16x32_bf16 v[36:39], a[144:147], v[72:75], v[36:39]
ds_read_b128 v[96:99], v7 offset:53248
ds_read_b128 v[100:103], v8 offset:53248
v_mfma_f32_16x16x32_bf16 v[40:43], a[148:151], v[72:75], v[40:43]
v_mfma_f32_16x16x32_bf16 v[44:47], a[144:147], v[76:79], v[44:47]
v_mfma_f32_16x16x32_bf16 v[48:51], a[148:151], v[76:79], v[48:51]
s_waitcnt lgkmcnt(4)
v_mfma_f32_16x16x32_bf16 v[36:39], a[152:155], v[80:83], v[36:39]
ds_read_b128 v[72:75], v7 offset:57344
ds_read_b128 v[76:79], v8 offset:57344
v_mfma_f32_16x16x32_bf16 v[40:43], a[156:159], v[80:83], v[40:43]
v_mfma_f32_16x16x32_bf16 v[44:47], a[152:155], v[84:87], v[44:47]
v_mfma_f32_16x16x32_bf16 v[48:51], a[156:159], v[84:87], v[48:51]
s_waitcnt lgkmcnt(4)
v_mfma_f32_16x16x32_bf16 v[36:39], a[160:163], v[88:91], v[36:39]
ds_read_b128 v[80:83], v7 offset:61440
ds_read_b128 v[84:87], v8 offset:61440
v_mfma_f32_16x16x32_bf16 v[40:43], a[164:167], v[88:91], v[40:43]
s_add_u32 s44, s32, 8
s_waitcnt vmcnt(0)
v_lshrrev_b32 v17, 3, v17
v_mfma_f32_16x16x32_bf16 v[44:47], a[160:163], v[92:95], v[44:47]
v_subrev_u32 v17, s44, v17
v_cmp_lt_u32 vcc, 31, v17
s_cbranch_vccnz L_spin_18
L_ok_17:
s_add_u32 s18, s12, s19
v_mfma_f32_16x16x32_bf16 v[48:51], a[164:167], v[92:95], v[48:51]
s_add_u32 m0, s2, 90112
s_waitcnt lgkmcnt(4)
v_mfma_f32_16x16x32_bf16 v[36:39], a[168:171], v[96:99], v[36:39]
s_add_u32 s29, s18, 0x23000
buffer_load_dwordx4 v1, s[4:7], s29 offen sc1 lds
s_barrier
v_mfma_f32_16x16x32_bf16 v[40:43], a[172:175], v[96:99], v[40:43]
ds_read_b128 v[88:91], v9 offset:0
ds_read_b128 v[92:95], v10 offset:0
v_mfma_f32_16x16x32_bf16 v[44:47], a[168:171], v[100:103], v[44:47]
v_lshlrev_b32 v112, 16, v108
v_and_b32 v113, 0xffff0000, v108
v_mfma_f32_16x16x32_bf16 v[48:51], a[172:175], v[100:103], v[48:51]
buffer_load_dwordx4 v1, s[4:7], s29 offen offset:1024 sc1 lds
s_waitcnt lgkmcnt(4)
v_mfma_f32_16x16x32_bf16 v[36:39], a[176:179], v[72:75], v[36:39]
ds_read_b128 v[96:99], v9 offset:4096
ds_read_b128 v[100:103], v10 offset:4096
v_mfma_f32_16x16x32_bf16 v[40:43], a[180:183], v[72:75], v[40:43]
v_add_f32 v20, v20, v112
v_add_f32 v21, v21, v113
v_mfma_f32_16x16x32_bf16 v[44:47], a[176:179], v[76:79], v[44:47]
s_add_u32 m0, s2, 98304
s_add_u32 s29, s18, 0x24000
v_mfma_f32_16x16x32_bf16 v[48:51], a[180:183], v[76:79], v[48:51]
buffer_load_dwordx4 v1, s[4:7], s29 offen sc1 lds
s_waitcnt lgkmcnt(4)
v_mfma_f32_16x16x32_bf16 v[36:39], a[184:187], v[80:83], v[36:39]
ds_read_b128 v[72:75], v9 offset:8192
ds_read_b128 v[76:79], v10 offset:8192
v_mfma_f32_16x16x32_bf16 v[40:43], a[188:191], v[80:83], v[40:43]
v_add_f32 v28, v28, v112
v_add_f32 v29, v29, v113
v_mfma_f32_16x16x32_bf16 v[44:47], a[184:187], v[84:87], v[44:47]
buffer_load_dwordx4 v1, s[4:7], s29 offen offset:1024 sc1 lds
v_lshlrev_b32 v112, 16, v109
v_mfma_f32_16x16x32_bf16 v[48:51], a[188:191], v[84:87], v[48:51]
v_and_b32 v113, 0xffff0000, v109
s_waitcnt lgkmcnt(4)
v_mfma_f32_16x16x32_bf16 v[36:39], a[96:99], v[88:91], v[36:39]
ds_read_b128 v[80:83], v9 offset:12288
ds_read_b128 v[84:87], v10 offset:12288
v_mfma_f32_16x16x32_bf16 v[40:43], a[100:103], v[88:91], v[40:43]
s_add_u32 m0, s2, 106496
s_add_u32 s29, s18, 0x25000
v_mfma_f32_16x16x32_bf16 v[44:47], a[96:99], v[92:95], v[44:47]
buffer_load_dwordx4 v1, s[4:7], s29 offen sc1 lds
v_add_f32 v22, v22, v112
v_mfma_f32_16x16x32_bf16 v[48:51], a[100:103], v[92:95], v[48:51]
v_add_f32 v23, v23, v113
s_waitcnt lgkmcnt(4)
v_mfma_f32_16x16x32_bf16 v[36:39], a[104:107], v[96:99], v[36:39]
ds_read_b128 v[88:91], v9 offset:16384
ds_read_b128 v[92:95], v10 offset:16384
v_mfma_f32_16x16x32_bf16 v[40:43], a[108:111], v[96:99], v[40:43]
buffer_load_dwordx4 v1, s[4:7], s29 offen offset:1024 sc1 lds
v_add_f32 v30, v30, v112
v_mfma_f32_16x16x32_bf16 v[44:47], a[104:107], v[100:103], v[44:47]
v_add_f32 v31, v31, v113
v_lshlrev_b32 v112, 16, v110
v_mfma_f32_16x16x32_bf16 v[48:51], a[108:111], v[100:103], v[48:51]
v_and_b32 v113, 0xffff0000, v110
s_waitcnt lgkmcnt(4)
v_mfma_f32_16x16x32_bf16 v[36:39], a[112:115], v[72:75], v[36:39]
ds_read_b128 v[96:99], v9 offset:20480
ds_read_b128 v[100:103], v10 offset:20480
v_mfma_f32_16x16x32_bf16 v[40:43], a[116:119], v[72:75], v[40:43]
s_add_u32 m0, s2, 114688
s_add_u32 s29, s18, 0x26000
v_mfma_f32_16x16x32_bf16 v[44:47], a[112:115], v[76:79], v[44:47]
buffer_load_dwordx4 v1, s[4:7], s29 offen sc1 lds
v_add_f32 v24, v24, v112
v_mfma_f32_16x16x32_bf16 v[48:51], a[116:119], v[76:79], v[48:51]
v_add_f32 v25, v25, v113
s_waitcnt lgkmcnt(4)
v_mfma_f32_16x16x32_bf16 v[44:47], a[120:123], v[84:87], v[44:47]
v_add_f32 v32, v32, v112
v_add_f32 v33, v33, v113
v_mfma_f32_16x16x32_bf16 v[48:51], a[124:127], v[84:87], v[48:51]
buffer_load_dwordx4 v1, s[4:7], s29 offen offset:1024 sc1 lds
v_lshlrev_b32 v112, 16, v111
s_waitcnt lgkmcnt(2)
v_mfma_f32_16x16x32_bf16 v[44:47], a[128:131], v[92:95], v[44:47]
v_and_b32 v113, 0xffff0000, v111
v_add_f32 v26, v26, v112
v_mfma_f32_16x16x32_bf16 v[48:51], a[132:135], v[92:95], v[48:51]
v_add_f32 v27, v27, v113
v_add_f32 v34, v34, v112
s_waitcnt lgkmcnt(0)
v_mfma_f32_16x16x32_bf16 v[44:47], a[136:139], v[100:103], v[44:47]
s_add_u32 m0, s2, 122880
s_add_u32 s29, s18, 0x27000
v_mfma_f32_16x16x32_bf16 v[48:51], a[140:143], v[100:103], v[48:51]
buffer_load_dwordx4 v1, s[4:7], s29 offen sc1 lds
v_add_f32 v35, v35, v113
v_mfma_f32_16x16x32_bf16 v[36:39], a[120:123], v[80:83], v[36:39]
s_lshl_b32 s15, s8, 11
s_add_u32 s15, s15, 0x20000
v_mfma_f32_16x16x32_bf16 v[40:43], a[124:127], v[80:83], v[40:43]
s_xor_b32 s16, s15, 0x1000
v_add_u32 v104, s15, v1
v_mfma_f32_16x16x32_bf16 v[36:39], a[128:131], v[88:91], v[36:39]
buffer_load_dwordx4 v1, s[4:7], s29 offen offset:1024 sc1 lds
v_add_u32 v105, s16, v1
v_mfma_f32_16x16x32_bf16 v[40:43], a[132:135], v[88:91], v[40:43]
ds_write_b128 v104, v[44:47] offset:0
ds_write_b128 v104, v[48:51] offset:1024
v_mfma_f32_16x16x32_bf16 v[36:39], a[136:139], v[96:99], v[36:39]
v_mfma_f32_16x16x32_bf16 v[40:43], a[140:143], v[96:99], v[40:43]
s_add_u32 m0, s2, 0
s_add_u32 s29, s18, 0x28000
buffer_load_dwordx4 v1, s[4:7], s29 offen sc1 lds
s_waitcnt lgkmcnt(0)
s_barrier
ds_read_b128 v[68:71], v105 offset:0
ds_read_b128 v[72:75], v105 offset:1024
v_pk_add_f32 v[20:21], v[20:21], v[36:37]
v_pk_add_f32 v[22:23], v[22:23], v[38:39]
v_pk_add_f32 v[24:25], v[24:25], v[40:41]
v_pk_add_f32 v[26:27], v[26:27], v[42:43]
buffer_load_dwordx4 v1, s[4:7], s29 offen offset:1024 sc1 lds
s_add_u32 m0, s2, 8192
s_add_u32 s29, s18, 0x1e000
buffer_load_dwordx4 v1, s[4:7], s29 offen sc1 lds
s_waitcnt lgkmcnt(1)
v_pk_add_f32 v[20:21], v[20:21], v[68:69]
v_pk_add_f32 v[22:23], v[22:23], v[70:71]
s_waitcnt lgkmcnt(0)
v_pk_add_f32 v[24:25], v[24:25], v[72:73]
v_pk_add_f32 v[26:27], v[26:27], v[74:75]
s_add_u32 s15, s47, s62
s_add_u32 s15, s15, 0x16000
v_cvt_pk_bf16_f32 v76, v20, v21
v_cvt_pk_bf16_f32 v77, v22, v23
v_cvt_pk_bf16_f32 v78, v24, v25
v_cvt_pk_bf16_f32 v79, v26, v27
buffer_store_dwordx4 v[76:79], v1, s[4:7], s15 offen
v_pk_add_f32 v[68:69], v[20:21], v[22:23]
v_pk_add_f32 v[70:71], v[24:25], v[26:27]
v_pk_mul_f32 v[72:73], v[20:21], v[20:21]
v_pk_add_f32 v[68:69], v[68:69], v[70:71]
v_pk_fma_f32 v[72:73], v[22:23], v[22:23], v[72:73]
v_pk_fma_f32 v[72:73], v[24:25], v[24:25], v[72:73]
v_pk_fma_f32 v[72:73], v[26:27], v[26:27], v[72:73]
v_add_f32 v68, v68, v69
v_add_f32 v72, v72, v73
s_add_u32 s16, s13, s63
s_add_u32 s16, s16, 0xd00000
v_permlane32_swap_b32 v68, v72
v_add_f32 v68, v68, v72
v_mov_b32 v72, v68
s_add_u32 s15, s59, 0x1000000
s_add_u32 s46, s60, 0x1000000
v_permlane16_swap_b32 v68, v72
v_add_f32 v68, v68, v72
buffer_store_dword v68, v11, s[4:7], s16 offen
buffer_store_dwordx4 v[76:79], v1, s[4:7], s15 offen sc1
buffer_store_dword v68, v11, s[4:7], s46 offen sc1
buffer_load_dwordx4 v1, s[4:7], s29 offen offset:1024 sc1 lds
s_add_u32 m0, s2, 16384
s_add_u32 s29, s18, 0x1f000
buffer_load_dwordx4 v1, s[4:7], s29 offen sc1 lds
s_waitcnt vmcnt(15)
s_barrier
ds_read_b128 v[88:91], v9 offset:24576
ds_read_b128 v[92:95], v10 offset:24576
ds_read_b128 v[96:99], v9 offset:28672
ds_read_b128 v[100:103], v10 offset:28672
ds_read_b128 v[72:75], v9 offset:32768
ds_read_b128 v[76:79], v10 offset:32768
buffer_load_dwordx4 v1, s[4:7], s29 offen offset:1024 sc1 lds
s_add_u32 m0, s2, 24576
s_add_u32 s29, s18, 0x20000
buffer_load_dwordx4 v1, s[4:7], s29 offen sc1 lds
s_waitcnt lgkmcnt(4)
v_mfma_f32_16x16x32_bf16 v[36:39], a[144:147], v[88:91], 0
ds_read_b128 v[80:83], v9 offset:36864
ds_read_b128 v[84:87], v10 offset:36864
v_mfma_f32_16x16x32_bf16 v[40:43], a[148:151], v[88:91], 0
v_add_u32 v15, 8, v15
s_waitcnt vmcnt(6)
v_mfma_f32_16x16x32_bf16 v[44:47], a[144:147], v[92:95], 0
buffer_load_dwordx4 v1, s[4:7], s29 offen offset:1024 sc1 lds
buffer_store_dword v15, v13, s[4:7], s45 offen
v_mfma_f32_16x16x32_bf16 v[48:51], a[148:151], v[92:95], 0
s_waitcnt lgkmcnt(4)
v_mfma_f32_16x16x32_bf16 v[36:39], a[152:155], v[96:99], v[36:39]
s_add_u32 s28, s24, 24576
buffer_load_dwordx4 a[144:147], v1, s[4:7], s28 offen sc1
buffer_load_dwordx4 a[148:151], v1, s[4:7], s28 offen offset:1024 sc1
s_barrier
v_mfma_f32_16x16x32_bf16 v[40:43], a[156:159], v[96:99], v[40:43]
ds_read_b128 v[88:91], v9 offset:40960
ds_read_b128 v[92:95], v10 offset:40960
v_mfma_f32_16x16x32_bf16 v[44:47], a[152:155], v[100:103], v[44:47]
v_mfma_f32_16x16x32_bf16 v[48:51], a[156:159], v[100:103], v[48:51]
s_add_u32 m0, s2, 32768
s_waitcnt lgkmcnt(4)
v_mfma_f32_16x16x32_bf16 v[36:39], a[160:163], v[72:75], v[36:39]
ds_read_b128 v[96:99], v9 offset:45056
ds_read_b128 v[100:103], v10 offset:45056
v_mfma_f32_16x16x32_bf16 v[40:43], a[164:167], v[72:75], v[40:43]
s_add_u32 s29, s18, 0x21000
buffer_load_dwordx4 v1, s[4:7], s29 offen sc1 lds
v_mfma_f32_16x16x32_bf16 v[44:47], a[160:163], v[76:79], v[44:47]
v_mfma_f32_16x16x32_bf16 v[48:51], a[164:167], v[76:79], v[48:51]
s_waitcnt lgkmcnt(4)
v_mfma_f32_16x16x32_bf16 v[36:39], a[168:171], v[80:83], v[36:39]
ds_read_b128 v[72:75], v9 offset:49152
ds_read_b128 v[76:79], v10 offset:49152
v_mfma_f32_16x16x32_bf16 v[40:43], a[172:175], v[80:83], v[40:43]
buffer_load_dwordx4 v1, s[4:7], s29 offen offset:1024 sc1 lds
v_mfma_f32_16x16x32_bf16 v[44:47], a[168:171], v[84:87], v[44:47]
v_mfma_f32_16x16x32_bf16 v[48:51], a[172:175], v[84:87], v[48:51]
s_waitcnt lgkmcnt(4)
v_mfma_f32_16x16x32_bf16 v[36:39], a[176:179], v[88:91], v[36:39]
ds_read_b128 v[80:83], v9 offset:53248
ds_read_b128 v[84:87], v10 offset:53248
v_mfma_f32_16x16x32_bf16 v[40:43], a[180:183], v[88:91], v[40:43]
s_add_u32 m0, s2, 40960
s_add_u32 s29, s18, 0x22000
v_mfma_f32_16x16x32_bf16 v[44:47], a[176:179], v[92:95], v[44:47]
buffer_load_dwordx4 v1, s[4:7], s29 offen sc1 lds
v_mfma_f32_16x16x32_bf16 v[48:51], a[180:183], v[92:95], v[48:51]
s_waitcnt lgkmcnt(4)
v_mfma_f32_16x16x32_bf16 v[36:39], a[184:187], v[96:99], v[36:39]
ds_read_b128 v[88:91], v9 offset:57344
ds_read_b128 v[92:95], v10 offset:57344
v_mfma_f32_16x16x32_bf16 v[40:43], a[188:191], v[96:99], v[40:43]
buffer_load_dwordx4 v1, s[4:7], s29 offen offset:1024 sc1 lds
v_mfma_f32_16x16x32_bf16 v[44:47], a[184:187], v[100:103], v[44:47]
v_mfma_f32_16x16x32_bf16 v[48:51], a[188:191], v[100:103], v[48:51]
s_waitcnt lgkmcnt(4)
v_mfma_f32_16x16x32_bf16 v[36:39], a[96:99], v[72:75], v[36:39]
ds_read_b128 v[96:99], v9 offset:61440
ds_read_b128 v[100:103], v10 offset:61440
v_mfma_f32_16x16x32_bf16 v[40:43], a[100:103], v[72:75], v[40:43]
v_mfma_f32_16x16x32_bf16 v[44:47], a[96:99], v[76:79], v[44:47]
v_mfma_f32_16x16x32_bf16 v[48:51], a[100:103], v[76:79], v[48:51]
buffer_load_dwordx4 a[152:155], v1, s[4:7], s28 offen offset:2048 sc1
s_waitcnt lgkmcnt(4)
v_mfma_f32_16x16x32_bf16 v[36:39], a[104:107], v[80:83], v[36:39]
s_add_u32 s28, s24, 27648
buffer_load_dwordx4 a[156:159], v1, s[4:7], s28 offen sc1
buffer_load_dwordx4 a[160:163], v1, s[4:7], s28 offen offset:1024 sc1
s_waitcnt vmcnt(12)
s_barrier
v_mfma_f32_16x16x32_bf16 v[40:43], a[108:111], v[80:83], v[40:43]
ds_read_b128 v[72:75], v7 offset:0
ds_read_b128 v[76:79], v8 offset:0
v_mfma_f32_16x16x32_bf16 v[44:47], a[104:107], v[84:87], v[44:47]
v_mfma_f32_16x16x32_bf16 v[48:51], a[108:111], v[84:87], v[48:51]
s_waitcnt lgkmcnt(4)
v_mfma_f32_16x16x32_bf16 v[36:39], a[112:115], v[88:91], v[36:39]
ds_read_b128 v[80:83], v7 offset:4096
ds_read_b128 v[84:87], v8 offset:4096
v_mfma_f32_16x16x32_bf16 v[40:43], a[116:119], v[88:91], v[40:43]
buffer_store_dword v15, v13, s[4:7], s45 offen offset:2176 sc1
v_mfma_f32_16x16x32_bf16 v[44:47], a[112:115], v[92:95], v[44:47]
v_mfma_f32_16x16x32_bf16 v[48:51], a[116:119], v[92:95], v[48:51]
s_waitcnt lgkmcnt(4)
v_mfma_f32_16x16x32_bf16 v[36:39], a[120:123], v[96:99], v[36:39]
ds_read_b128 v[88:91], v7 offset:8192
ds_read_b128 v[92:95], v8 offset:8192
v_mfma_f32_16x16x32_bf16 v[40:43], a[124:127], v[96:99], v[40:43]
v_mfma_f32_16x16x32_bf16 v[44:47], a[120:123], v[100:103], v[44:47]
v_mfma_f32_16x16x32_bf16 v[48:51], a[124:127], v[100:103], v[48:51]
buffer_load_dwordx4 a[164:167], v1, s[4:7], s28 offen offset:2048 sc1
s_waitcnt lgkmcnt(4)
v_mfma_f32_16x16x32_bf16 v[36:39], a[128:131], v[72:75], v[36:39]
ds_read_b128 v[96:99], v7 offset:12288
ds_read_b128 v[100:103], v8 offset:12288
v_mfma_f32_16x16x32_bf16 v[40:43], a[132:135], v[72:75], v[40:43]
v_mfma_f32_16x16x32_bf16 v[44:47], a[128:131], v[76:79], v[44:47]
v_mfma_f32_16x16x32_bf16 v[48:51], a[132:135], v[76:79], v[48:51]
s_waitcnt lgkmcnt(4)
v_mfma_f32_16x16x32_bf16 v[36:39], a[136:139], v[80:83], v[36:39]
ds_read_b128 v[72:75], v7 offset:16384
ds_read_b128 v[76:79], v8 offset:16384
v_mfma_f32_16x16x32_bf16 v[40:43], a[140:143], v[80:83], v[40:43]
s_add_u32 s28, s24, 30720
buffer_load_dwordx4 a[168:171], v1, s[4:7], s28 offen sc1
v_mfma_f32_16x16x32_bf16 v[44:47], a[136:139], v[84:87], v[44:47]
v_mfma_f32_16x16x32_bf16 v[48:51], a[140:143], v[84:87], v[48:51]
s_waitcnt lgkmcnt(4)
v_mfma_f32_16x16x32_bf16 v[36:39], v[176:179], v[88:91], v[36:39]
ds_read_b128 v[80:83], v7 offset:20480
ds_read_b128 v[84:87], v8 offset:20480
v_mfma_f32_16x16x32_bf16 v[40:43], v[180:183], v[88:91], v[40:43]
buffer_load_dword v17, v4, s[4:7], s92 offen sc1
v_mfma_f32_16x16x32_bf16 v[44:47], v[176:179], v[92:95], v[44:47]
v_mfma_f32_16x16x32_bf16 v[48:51], v[180:183], v[92:95], v[48:51]
s_waitcnt lgkmcnt(4)
v_mfma_f32_16x16x32_bf16 v[36:39], v[184:187], v[96:99], v[36:39]
buffer_load_dwordx4 a[172:175], v1, s[4:7], s28 offen offset:1024 sc1
buffer_load_dwordx4 a[176:179], v1, s[4:7], s28 offen offset:2048 sc1
s_add_u32 s28, s24, 33792
buffer_load_dwordx4 a[180:183], v1, s[4:7], s28 offen sc1
buffer_load_dwordx4 a[184:187], v1, s[4:7], s28 offen offset:1024 sc1
s_waitcnt vmcnt(11)
s_barrier
v_mfma_f32_16x16x32_bf16 v[40:43], v[188:191], v[96:99], v[40:43]
ds_read_b128 v[88:91], v7 offset:24576
ds_read_b128 v[92:95], v8 offset:24576
v_mfma_f32_16x16x32_bf16 v[44:47], v[184:187], v[100:103], v[44:47]
v_mfma_f32_16x16x32_bf16 v[48:51], v[188:191], v[100:103], v[48:51]
s_waitcnt lgkmcnt(4)
v_mfma_f32_16x16x32_bf16 v[36:39], v[192:195], v[72:75], v[36:39]
ds_read_b128 v[96:99], v7 offset:28672
ds_read_b128 v[100:103], v8 offset:28672
v_mfma_f32_16x16x32_bf16 v[40:43], v[196:199], v[72:75], v[40:43]
v_mfma_f32_16x16x32_bf16 v[44:47], v[192:195], v[76:79], v[44:47]
buffer_load_dwordx4 a[188:191], v1, s[4:7], s28 offen offset:2048 sc1
v_mfma_f32_16x16x32_bf16 v[48:51], v[196:199], v[76:79], v[48:51]
s_waitcnt lgkmcnt(4)
v_mfma_f32_16x16x32_bf16 v[36:39], v[200:203], v[80:83], v[36:39]
ds_read_b128 v[72:75], v7 offset:32768
ds_read_b128 v[76:79], v8 offset:32768
v_mfma_f32_16x16x32_bf16 v[40:43], v[204:207], v[80:83], v[40:43]
v_mfma_f32_16x16x32_bf16 v[44:47], v[200:203], v[84:87], v[44:47]
v_mfma_f32_16x16x32_bf16 v[48:51], v[204:207], v[84:87], v[48:51]
s_waitcnt lgkmcnt(4)
v_mfma_f32_16x16x32_bf16 v[36:39], v[208:211], v[88:91], v[36:39]
ds_read_b128 v[80:83], v7 offset:36864
ds_read_b128 v[84:87], v8 offset:36864
v_mfma_f32_16x16x32_bf16 v[40:43], v[212:215], v[88:91], v[40:43]
s_add_u32 s28, s24, 36864
buffer_load_dwordx4 a[96:99], v1, s[4:7], s28 offen sc1
v_mfma_f32_16x16x32_bf16 v[44:47], v[208:211], v[92:95], v[44:47]
s_add_u32 s44, s32, 9
buffer_load_dwordx4 a[100:103], v1, s[4:7], s28 offen offset:1024 sc1
buffer_load_dwordx4 a[104:107], v1, s[4:7], s28 offen offset:2048 sc1
s_add_u32 s28, s24, 39936
buffer_load_dwordx4 a[108:111], v1, s[4:7], s28 offen sc1
buffer_load_dwordx4 a[112:115], v1, s[4:7], s28 offen offset:1024 sc1
s_waitcnt vmcnt(10)
v_lshrrev_b32 v17, 3, v17
v_mfma_f32_16x16x32_bf16 v[48:51], v[212:215], v[92:95], v[48:51]
v_subrev_u32 v17, s44, v17
s_waitcnt lgkmcnt(4)
v_mfma_f32_16x16x32_bf16 v[36:39], v[216:219], v[96:99], v[36:39]
ds_read_b128 v[88:91], v7 offset:40960
ds_read_b128 v[92:95], v8 offset:40960
v_mfma_f32_16x16x32_bf16 v[40:43], v[220:223], v[96:99], v[40:43]
v_cmp_lt_u32 vcc, 31, v17
s_cbranch_vccnz L_spin_20
L_ok_19:
s_add_u32 s17, s47, s96
v_mfma_f32_16x16x32_bf16 v[44:47], v[216:219], v[100:103], v[44:47]
s_add_u32 m0, s3, 49152
s_add_u32 s29, s17, 0x16000
v_mfma_f32_16x16x32_bf16 v[48:51], v[220:223], v[100:103], v[48:51]
buffer_load_dwordx4 v1, s[4:7], s29 offen sc1 lds
s_waitcnt lgkmcnt(4)
v_mfma_f32_16x16x32_bf16 v[36:39], v[224:227], v[72:75], v[36:39]
ds_read_b128 v[96:99], v7 offset:45056
ds_read_b128 v[100:103], v8 offset:45056
v_mfma_f32_16x16x32_bf16 v[40:43], v[228:231], v[72:75], v[40:43]
v_mfma_f32_16x16x32_bf16 v[44:47], v[224:227], v[76:79], v[44:47]
buffer_load_dwordx4 v1, s[4:7], s29 offen offset:1024 sc1 lds
v_mfma_f32_16x16x32_bf16 v[48:51], v[228:231], v[76:79], v[48:51]
s_waitcnt lgkmcnt(4)
v_mfma_f32_16x16x32_bf16 v[44:47], v[232:235], v[84:87], v[44:47]
v_mfma_f32_16x16x32_bf16 v[48:51], v[236:239], v[84:87], v[48:51]
s_add_u32 s46, s13, 0xd00000
buffer_load_dwordx2 v[120:121], v14, s[4:7], s46 offen sc1
s_waitcnt lgkmcnt(2)
v_mfma_f32_16x16x32_bf16 v[44:47], v[240:243], v[92:95], v[44:47]
buffer_load_dwordx2 v[122:123], v14, s[4:7], s46 offen offset:256 sc1
v_mfma_f32_16x16x32_bf16 v[48:51], v[244:247], v[92:95], v[48:51]
s_waitcnt lgkmcnt(0)
v_mfma_f32_16x16x32_bf16 v[44:47], v[248:251], v[100:103], v[44:47]
v_mfma_f32_16x16x32_bf16 v[48:51], v[252:255], v[100:103], v[48:51]
s_add_u32 m0, s3, 57344
s_add_u32 s29, s17, 0x18000
buffer_load_dwordx4 v1, s[4:7], s29 offen sc1 lds
v_mfma_f32_16x16x32_bf16 v[36:39], v[232:235], v[80:83], v[36:39]
s_lshl_b32 s15, s8, 11
s_add_u32 s15, s15, 0x20000
v_mfma_f32_16x16x32_bf16 v[40:43], v[236:239], v[80:83], v[40:43]
s_xor_b32 s16, s15, 0x1000
v_add_u32 v104, s15, v1
v_mfma_f32_16x16x32_bf16 v[36:39], v[240:243], v[88:91], v[36:39]
buffer_load_dwordx4 v1, s[4:7], s29 offen offset:1024 sc1 lds
v_add_u32 v105, s16, v1
v_mfma_f32_16x16x32_bf16 v[40:43], v[244:247], v[88:91], v[40:43]
ds_write_b128 v104, v[44:47] offset:0
ds_write_b128 v104, v[48:51] offset:1024
v_mfma_f32_16x16x32_bf16 v[36:39], v[248:251], v[96:99], v[36:39]
v_mfma_f32_16x16x32_bf16 v[40:43], v[252:255], v[96:99], v[40:43]
s_add_u32 s46, s13, 0xd00000
buffer_load_dwordx2 v[124:125], v14, s[4:7], s46 offen offset:512 sc1
buffer_load_dwordx2 v[126:127], v14, s[4:7], s46 offen offset:768 sc1
s_waitcnt lgkmcnt(0)
s_barrier
ds_read_b128 v[68:71], v105 offset:0
ds_read_b128 v[72:75], v105 offset:1024
buffer_load_dwordx4 a[116:119], v1, s[4:7], s28 offen offset:2048 sc1
s_add_u32 s28, s24, 43008
buffer_load_dwordx4 a[120:123], v1, s[4:7], s28 offen sc1
buffer_load_dwordx4 a[124:127], v1, s[4:7], s28 offen offset:1024 sc1
buffer_load_dwordx4 a[128:131], v1, s[4:7], s28 offen offset:2048 sc1
v_pk_add_f32 v[28:29], v[28:29], v[36:37]
v_pk_add_f32 v[30:31], v[30:31], v[38:39]
v_pk_add_f32 v[32:33], v[32:33], v[40:41]
v_pk_add_f32 v[34:35], v[34:35], v[42:43]
s_add_u32 m0, s3, 65536
s_add_u32 s29, s17, 0x1a000
buffer_load_dwordx4 v1, s[4:7], s29 offen sc1 lds
buffer_load_dwordx4 v1, s[4:7], s29 offen offset:1024 sc1 lds
s_waitcnt lgkmcnt(1)
v_pk_add_f32 v[28:29], v[28:29], v[68:69]
v_pk_add_f32 v[30:31], v[30:31], v[70:71]
s_waitcnt lgkmcnt(0)
v_pk_add_f32 v[32:33], v[32:33], v[72:73]
v_pk_add_f32 v[34:35], v[34:35], v[74:75]
s_add_u32 s15, s47, s62
s_add_u32 s15, s15, 0x8000
v_cvt_pk_bf16_f32 v76, v28, v29
v_cvt_pk_bf16_f32 v77, v30, v31
v_cvt_pk_bf16_f32 v78, v32, v33
v_cvt_pk_bf16_f32 v79, v34, v35
buffer_store_dwordx4 v[76:79], v1, s[4:7], s15 offen
v_pk_add_f32 v[68:69], v[28:29], v[30:31]
v_pk_add_f32 v[70:71], v[32:33], v[34:35]
v_pk_mul_f32 v[72:73], v[28:29], v[28:29]
v_pk_add_f32 v[68:69], v[68:69], v[70:71]
v_pk_fma_f32 v[72:73], v[30:31], v[30:31], v[72:73]
v_pk_fma_f32 v[72:73], v[32:33], v[32:33], v[72:73]
v_pk_fma_f32 v[72:73], v[34:35], v[34:35], v[72:73]
v_add_f32 v68, v68, v69
v_add_f32 v72, v72, v73
s_add_u32 s16, s13, s63
s_add_u32 s16, s16, 0xd01000
v_permlane32_swap_b32 v68, v72
v_add_f32 v68, v68, v72
v_mov_b32 v72, v68
s_nop 1
v_permlane16_swap_b32 v68, v72
v_add_f32 v68, v68, v72
buffer_store_dword v68, v11, s[4:7], s16 offen
s_add_u32 m0, s3, 73728
s_add_u32 s29, s17, 0x1c000
buffer_load_dwordx4 v1, s[4:7], s29 offen sc1 lds
buffer_load_dwordx4 v1, s[4:7], s29 offen offset:1024 sc1 lds
s_add_u32 s28, s24, 46080
buffer_load_dwordx4 a[132:135], v1, s[4:7], s28 offen sc1
buffer_load_dwordx4 a[136:139], v1, s[4:7], s28 offen offset:1024 sc1
s_waitcnt vmcnt(18)
s_barrier
ds_read_b128 v[88:91], v1 offset:49152
ds_read_b128 v[92:95], v1 offset:50176
ds_read_b128 v[96:99], v1 offset:51200
ds_read_b128 v[100:103], v1 offset:52224
ds_read_b128 v[72:75], v1 offset:53248
ds_read_b128 v[76:79], v1 offset:54272
s_waitcnt lgkmcnt(4)
v_mfma_f32_16x16x32_bf16 v[44:47], a[4:7], v[88:91], 0
ds_read_b128 v[80:83], v1 offset:55296
ds_read_b128 v[84:87], v1 offset:56320
v_mfma_f32_16x16x32_bf16 v[52:55], v[88:91], a[8:11], 0
buffer_load_dword v17, v4, s[4:7], s90 offen sc1
v_mfma_f32_16x16x32_bf16 v[36:39], a[0:3], v[88:91], 0
v_mfma_f32_16x16x32_bf16 v[48:51], a[4:7], v[92:95], 0
v_mfma_f32_16x16x32_bf16 v[56:59], v[92:95], a[8:11], 0
v_mfma_f32_16x16x32_bf16 v[40:43], a[0:3], v[92:95], 0
s_waitcnt lgkmcnt(4)
v_mfma_f32_16x16x32_bf16 v[44:47], a[16:19], v[96:99], v[44:47]
s_waitcnt vmcnt(13)
v_add_f32 v120, v120, v122
v_add_f32 v124, v124, v126
v_add_f32 v121, v121, v123
v_add_f32 v125, v125, v127
v_add_f32 v120, v120, v124
v_add_f32 v121, v121, v125
v_add_u32 v122, s52, v5
s_nop 0
v_permlane32_swap_b32 v120, v121
v_add_f32 v120, v120, v121
v_mov_b32 v121, v120
s_nop 1
v_permlane16_swap_b32 v120, v121
v_add_f32 v120, v120, v121
v_mov_b32 v121, v120
s_nop 1
v_permlane32_swap_b32 v120, v121
v_mul_f32 v120, 0x3b000000, v120
v_mul_f32 v121, 0x3b000000, v121
v_fma_f32 v121, -v120, v120, v121
v_max_f32 v121, 0, v121
v_add_f32 v121, 0x3727c5ac, v121
v_rsq_f32 v121, v121
v_sub_f32 v120, 0, v120
v_mul_f32 v120, v120, v121
ds_write_b32 v122, v121 offset:192
ds_write_b32 v122, v120 offset:512
buffer_load_dwordx4 a[140:143], v1, s[4:7], s28 offen offset:2048 sc1
s_waitcnt vmcnt(4) lgkmcnt(0)
s_barrier
v_mfma_f32_16x16x32_bf16 v[52:55], v[96:99], a[20:23], v[52:55]
ds_read_b128 v[88:91], v1 offset:57344
ds_read_b128 v[92:95], v1 offset:58368
v_mfma_f32_16x16x32_bf16 v[36:39], a[12:15], v[96:99], v[36:39]
v_mfma_f32_16x16x32_bf16 v[48:51], a[16:19], v[100:103], v[48:51]
v_mfma_f32_16x16x32_bf16 v[56:59], v[100:103], a[20:23], v[56:59]
v_mfma_f32_16x16x32_bf16 v[40:43], a[12:15], v[100:103], v[40:43]
v_mfma_f32_16x16x32_bf16 v[44:47], a[28:31], v[72:75], v[44:47]
ds_read_b128 v[96:99], v1 offset:59392
ds_read_b128 v[100:103], v1 offset:60416
v_mfma_f32_16x16x32_bf16 v[52:55], v[72:75], a[32:35], v[52:55]
v_add_u32 v15, 8, v15
buffer_store_dword v15, v13, s[4:7], s45 offen
v_mfma_f32_16x16x32_bf16 v[36:39], a[24:27], v[72:75], v[36:39]
v_mfma_f32_16x16x32_bf16 v[48:51], a[28:31], v[76:79], v[48:51]
v_mfma_f32_16x16x32_bf16 v[56:59], v[76:79], a[32:35], v[56:59]
v_mfma_f32_16x16x32_bf16 v[40:43], a[24:27], v[76:79], v[40:43]
v_mfma_f32_16x16x32_bf16 v[44:47], a[40:43], v[80:83], v[44:47]
ds_read_b128 v[72:75], v1 offset:61440
ds_read_b128 v[76:79], v1 offset:62464
v_mfma_f32_16x16x32_bf16 v[52:55], v[80:83], a[44:47], v[52:55]
s_add_u32 s44, s32, 9
s_waitcnt vmcnt(2)
v_lshrrev_b32 v17, 3, v17
v_mfma_f32_16x16x32_bf16 v[36:39], a[36:39], v[80:83], v[36:39]
v_subrev_u32 v17, s44, v17
v_cmp_lt_u32 vcc, 31, v17
s_cbranch_vccnz L_spin_22
L_ok_21:
v_mfma_f32_16x16x32_bf16 v[48:51], a[40:43], v[84:87], v[48:51]
v_mfma_f32_16x16x32_bf16 v[56:59], v[84:87], a[44:47], v[56:59]
v_mfma_f32_16x16x32_bf16 v[40:43], a[36:39], v[84:87], v[40:43]
s_waitcnt lgkmcnt(4)
v_mfma_f32_16x16x32_bf16 v[44:47], a[52:55], v[88:91], v[44:47]
ds_read_b128 v[80:83], v1 offset:63488
ds_read_b128 v[84:87], v1 offset:64512
v_mfma_f32_16x16x32_bf16 v[52:55], v[88:91], a[56:59], v[52:55]
v_mfma_f32_16x16x32_bf16 v[36:39], a[48:51], v[88:91], v[36:39]
v_mfma_f32_16x16x32_bf16 v[48:51], a[52:55], v[92:95], v[48:51]
v_mfma_f32_16x16x32_bf16 v[56:59], v[92:95], a[56:59], v[56:59]
v_mfma_f32_16x16x32_bf16 v[40:43], a[48:51], v[92:95], v[40:43]
s_waitcnt lgkmcnt(4)
v_mfma_f32_16x16x32_bf16 v[44:47], a[64:67], v[96:99], v[44:47]
ds_read_b128 v[88:91], v2 offset:0
ds_read_b128 v[92:95], v2 offset:1024
v_mfma_f32_16x16x32_bf16 v[52:55], v[96:99], a[68:71], v[52:55]
buffer_load_dword v17, v4, s[4:7], s92 offen sc1
v_mfma_f32_16x16x32_bf16 v[36:39], a[60:63], v[96:99], v[36:39]
v_mfma_f32_16x16x32_bf16 v[48:51], a[64:67], v[100:103], v[48:51]
v_mfma_f32_16x16x32_bf16 v[56:59], v[100:103], a[68:71], v[56:59]
v_mfma_f32_16x16x32_bf16 v[40:43], a[60:63], v[100:103], v[40:43]
s_waitcnt lgkmcnt(4)
v_mfma_f32_16x16x32_bf16 v[44:47], a[76:79], v[72:75], v[44:47]
ds_read_b128 v[96:99], v2 offset:2048
ds_read_b128 v[100:103], v2 offset:3072
v_mfma_f32_16x16x32_bf16 v[52:55], v[72:75], a[80:83], v[52:55]
v_mfma_f32_16x16x32_bf16 v[36:39], a[72:75], v[72:75], v[36:39]
v_mfma_f32_16x16x32_bf16 v[48:51], a[76:79], v[76:79], v[48:51]
v_mfma_f32_16x16x32_bf16 v[56:59], v[76:79], a[80:83], v[56:59]
v_mfma_f32_16x16x32_bf16 v[40:43], a[72:75], v[76:79], v[40:43]
s_waitcnt lgkmcnt(4)
v_mfma_f32_16x16x32_bf16 v[44:47], a[88:91], v[80:83], v[44:47]
ds_read_b128 v[72:75], v2 offset:4096
ds_read_b128 v[76:79], v2 offset:5120
v_mfma_f32_16x16x32_bf16 v[52:55], v[80:83], a[92:95], v[52:55]
v_mfma_f32_16x16x32_bf16 v[36:39], a[84:87], v[80:83], v[36:39]
v_mfma_f32_16x16x32_bf16 v[48:51], a[88:91], v[84:87], v[48:51]
v_mfma_f32_16x16x32_bf16 v[56:59], v[84:87], a[92:95], v[56:59]
v_mfma_f32_16x16x32_bf16 v[40:43], a[84:87], v[84:87], v[40:43]
s_waitcnt lgkmcnt(4)
v_mfma_f32_16x16x32_bf16 v[44:47], a[148:151], v[88:91], v[44:47]
ds_read_b128 v[80:83], v2 offset:6144
ds_read_b128 v[84:87], v2 offset:7168
v_mfma_f32_16x16x32_bf16 v[52:55], v[88:91], a[152:155], v[52:55]
s_add_u32 s44, s32, 10
s_waitcnt vmcnt(0)
v_lshrrev_b32 v17, 3, v17
v_mfma_f32_16x16x32_bf16 v[36:39], a[144:147], v[88:91], v[36:39]
v_subrev_u32 v17, s44, v17
v_cmp_lt_u32 vcc, 31, v17
s_cbranch_vccnz L_spin_24
L_ok_23:
s_add_u32 s17, s47, s96
v_mfma_f32_16x16x32_bf16 v[48:51], a[148:151], v[92:95], v[48:51]
s_add_u32 m0, s3, 81920
s_add_u32 s29, s17, 0x8000
v_mfma_f32_16x16x32_bf16 v[56:59], v[92:95], a[152:155], v[56:59]
buffer_load_dwordx4 v1, s[4:7], s29 offen offset:1024 sc1 lds
v_mfma_f32_16x16x32_bf16 v[40:43], a[144:147], v[92:95], v[40:43]
s_waitcnt lgkmcnt(4)
v_mfma_f32_16x16x32_bf16 v[44:47], a[160:163], v[96:99], v[44:47]
ds_read_b128 v[88:91], v2 offset:8192
ds_read_b128 v[92:95], v2 offset:9216
v_mfma_f32_16x16x32_bf16 v[52:55], v[96:99], a[164:167], v[52:55]
s_add_u32 m0, s3, 90112
s_add_u32 s29, s17, 0xa000
v_mfma_f32_16x16x32_bf16 v[36:39], a[156:159], v[96:99], v[36:39]
buffer_load_dwordx4 v1, s[4:7], s29 offen offset:1024 sc1 lds
v_mfma_f32_16x16x32_bf16 v[48:51], a[160:163], v[100:103], v[48:51]
v_mfma_f32_16x16x32_bf16 v[56:59], v[100:103], a[164:167], v[56:59]
v_mfma_f32_16x16x32_bf16 v[40:43], a[156:159], v[100:103], v[40:43]
s_add_u32 m0, s3, 98304
s_waitcnt lgkmcnt(4)
v_mfma_f32_16x16x32_bf16 v[44:47], a[172:175], v[72:75], v[44:47]
ds_read_b128 v[96:99], v2 offset:10240
ds_read_b128 v[100:103], v2 offset:11264
v_mfma_f32_16x16x32_bf16 v[52:55], v[72:75], a[176:179], v[52:55]
s_add_u32 s29, s17, 0xc000
buffer_load_dwordx4 v1, s[4:7], s29 offen offset:1024 sc1 lds
v_mfma_f32_16x16x32_bf16 v[36:39], a[168:171], v[72:75], v[36:39]
v_mfma_f32_16x16x32_bf16 v[48:51], a[172:175], v[76:79], v[48:51]
v_mfma_f32_16x16x32_bf16 v[56:59], v[76:79], a[176:179], v[56:59]
s_add_u32 m0, s3, 106496
s_add_u32 s29, s17, 0xe000
v_mfma_f32_16x16x32_bf16 v[40:43], a[168:171], v[76:79], v[40:43]
buffer_load_dwordx4 v1, s[4:7], s29 offen offset:1024 sc1 lds
s_waitcnt lgkmcnt(4)
v_mfma_f32_16x16x32_bf16 v[44:47], a[184:187], v[80:83], v[44:47]
ds_read_b128 v[72:75], v2 offset:12288
ds_read_b128 v[76:79], v2 offset:13312
v_mfma_f32_16x16x32_bf16 v[52:55], v[80:83], a[188:191], v[52:55]
v_mfma_f32_16x16x32_bf16 v[36:39], a[180:183], v[80:83], v[36:39]
s_add_u32 s46, s13, 0xd01000
buffer_load_dwordx2 v[120:121], v14, s[4:7], s46 offen sc1
v_mfma_f32_16x16x32_bf16 v[48:51], a[184:187], v[84:87], v[48:51]
buffer_load_dwordx2 v[122:123], v14, s[4:7], s46 offen offset:256 sc1
v_mfma_f32_16x16x32_bf16 v[56:59], v[84:87], a[188:191], v[56:59]
v_mfma_f32_16x16x32_bf16 v[40:43], a[180:183], v[84:87], v[40:43]
s_waitcnt lgkmcnt(4)
v_mfma_f32_16x16x32_bf16 v[44:47], a[100:103], v[88:91], v[44:47]
ds_read_b128 v[80:83], v2 offset:14336
ds_read_b128 v[84:87], v2 offset:15360
v_mfma_f32_16x16x32_bf16 v[52:55], v[88:91], a[104:107], v[52:55]
s_add_u32 s46, s13, 0xd01000
buffer_load_dwordx2 v[124:125], v14, s[4:7], s46 offen offset:512 sc1
v_mfma_f32_16x16x32_bf16 v[36:39], a[96:99], v[88:91], v[36:39]
buffer_load_dwordx2 v[126:127], v14, s[4:7], s46 offen offset:768 sc1
v_mfma_f32_16x16x32_bf16 v[48:51], a[100:103], v[92:95], v[48:51]
v_mfma_f32_16x16x32_bf16 v[56:59], v[92:95], a[104:107], v[56:59]
v_mfma_f32_16x16x32_bf16 v[40:43], a[96:99], v[92:95], v[40:43]
s_add_u32 m0, s3, 81920
s_waitcnt lgkmcnt(4)
v_mfma_f32_16x16x32_bf16 v[44:47], a[112:115], v[96:99], v[44:47]
s_add_u32 s29, s17, 0x8000
buffer_load_dwordx4 v1, s[4:7], s29 offen sc1 lds
v_mfma_f32_16x16x32_bf16 v[52:55], v[96:99], a[116:119], v[52:55]
v_mfma_f32_16x16x32_bf16 v[36:39], a[108:111], v[96:99], v[36:39]
v_mfma_f32_16x16x32_bf16 v[48:51], a[112:115], v[100:103], v[48:51]
s_add_u32 m0, s3, 90112
s_add_u32 s29, s17, 0xa000
v_mfma_f32_16x16x32_bf16 v[56:59], v[100:103], a[116:119], v[56:59]
buffer_load_dwordx4 v1, s[4:7], s29 offen sc1 lds
v_mfma_f32_16x16x32_bf16 v[40:43], a[108:111], v[100:103], v[40:43]
s_waitcnt lgkmcnt(2)
v_mfma_f32_16x16x32_bf16 v[44:47], a[124:127], v[72:75], v[44:47]
ds_read_b128 v[68:71], v6 offset:64
ds_read2_b32 v[88:89], v5 offset0:48 offset1:128
v_mfma_f32_16x16x32_bf16 v[52:55], v[72:75], a[128:131], v[52:55]
s_add_u32 m0, s3, 98304
s_add_u32 s29, s17, 0xc000
v_mfma_f32_16x16x32_bf16 v[36:39], a[120:123], v[72:75], v[36:39]
buffer_load_dwordx4 v1, s[4:7], s29 offen sc1 lds
ds_read_b128 v[90:93], v6 offset:0
v_mfma_f32_16x16x32_bf16 v[48:51], a[124:127], v[76:79], v[48:51]
ds_read2_b32 v[94:95], v5 offset0:64 offset1:144
v_add_u32 v96, s91, v5
v_mfma_f32_16x16x32_bf16 v[56:59], v[76:79], a[128:131], v[56:59]
v_subrev_u32 v97, s91, v6
ds_read_b32 v96, v96 offset:128
v_mfma_f32_16x16x32_bf16 v[40:43], a[120:123], v[76:79], v[40:43]
s_add_u32 m0, s3, 106496
s_waitcnt lgkmcnt(5)
v_mfma_f32_16x16x32_bf16 v[44:47], a[136:139], v[80:83], v[44:47]
s_add_u32 s29, s17, 0xe000
buffer_load_dwordx4 v1, s[4:7], s29 offen sc1 lds
v_mfma_f32_16x16x32_bf16 v[52:55], v[80:83], a[140:143], v[52:55]
s_waitcnt vmcnt(4)
v_add_f32 v120, v120, v122
v_mfma_f32_16x16x32_bf16 v[36:39], a[132:135], v[80:83], v[36:39]
v_add_f32 v124, v124, v126
v_add_f32 v121, v121, v123
v_mfma_f32_16x16x32_bf16 v[48:51], a[136:139], v[84:87], v[48:51]
s_add_u32 m0, s94, 114688
s_add_u32 s29, s57, 0x1000000
v_mfma_f32_16x16x32_bf16 v[56:59], v[84:87], a[140:143], v[56:59]
buffer_load_dwordx4 v1, s[4:7], s29 offen sc1 lds
v_add_f32 v125, v125, v127
v_mfma_f32_16x16x32_bf16 v[40:43], a[132:135], v[84:87], v[40:43]
v_add_f32 v120, v120, v124
v_add_f32 v121, v121, v125
v_add_u32 v122, s52, v5
s_nop 0
v_permlane32_swap_b32 v120, v121
v_add_f32 v120, v120, v121
v_mov_b32 v121, v120
buffer_load_dwordx4 v1, s[4:7], s29 offen offset:1024 sc1 lds
s_nop 0
v_permlane16_swap_b32 v120, v121
v_add_f32 v120, v120, v121
v_mov_b32 v121, v120
s_nop 1
v_permlane32_swap_b32 v120, v121
v_mul_f32 v120, 0x3b000000, v120
v_mul_f32 v121, 0x3b000000, v121
v_fma_f32 v121, -v120, v120, v121
v_max_f32 v121, 0, v121
v_add_f32 v121, 0x3727c5ac, v121
buffer_load_dwordx4 v1, s[4:7], s29 offen offset:2048 sc1 lds
v_rsq_f32 v121, v121
v_sub_f32 v120, 0, v120
v_mul_f32 v120, v120, v121
ds_write_b32 v122, v121 offset:64
ds_write_b32 v122, v120 offset:384
ds_read_b128 v[72:75], v97 offset:192
ds_read_b128 v[76:79], v97 offset:512
ds_read_b128 v[80:83], v97 offset:256
ds_read_b128 v[84:87], v97 offset:576
s_waitcnt lgkmcnt(6)
v_pk_mul_f32 v[98:99], v[68:69], v[88:89] op_sel:[0,1] op_sel_hi:[1,1]
v_pk_mul_f32 v[100:101], v[70:71], v[88:89] op_sel:[0,1] op_sel_hi:[1,1]
v_pk_fma_f32 v[44:45], v[44:45], v[88:89], v[98:99] op_sel_hi:[1,0,1]
v_pk_fma_f32 v[46:47], v[46:47], v[88:89], v[100:101] op_sel_hi:[1,0,1]
v_cvt_pk_bf16_f32 v106, v44, v45
v_cvt_pk_bf16_f32 v107, v46, v47
buffer_load_dwordx4 v1, s[4:7], s29 offen offset:3072 sc1 lds
v_pk_mul_f32 v[98:99], v[90:91], v[88:89] op_sel:[0,1] op_sel_hi:[1,1]
v_pk_mul_f32 v[100:101], v[92:93], v[88:89] op_sel:[0,1] op_sel_hi:[1,1]
v_pk_fma_f32 v[36:37], v[36:37], v[88:89], v[98:99] op_sel_hi:[1,0,1]
v_pk_fma_f32 v[38:39], v[38:39], v[88:89], v[100:101] op_sel_hi:[1,0,1]
v_cvt_pk_bf16_f32 v116, v36, v37
v_cvt_pk_bf16_f32 v117, v38, v39
v_pk_mul_f32 v[98:99], v[68:69], v[94:95] op_sel:[0,1] op_sel_hi:[1,1]
v_pk_mul_f32 v[100:101], v[70:71], v[94:95] op_sel:[0,1] op_sel_hi:[1,1]
v_pk_fma_f32 v[48:49], v[48:49], v[94:95], v[98:99] op_sel_hi:[1,0,1]
v_pk_fma_f32 v[50:51], v[50:51], v[94:95], v[100:101] op_sel_hi:[1,0,1]
v_cvt_pk_bf16_f32 v108, v48, v49
v_cvt_pk_bf16_f32 v109, v50, v51
v_pk_mul_f32 v[98:99], v[90:91], v[94:95] op_sel:[0,1] op_sel_hi:[1,1]
v_pk_mul_f32 v[100:101], v[92:93], v[94:95] op_sel:[0,1] op_sel_hi:[1,1]
v_pk_fma_f32 v[40:41], v[40:41], v[94:95], v[98:99] op_sel_hi:[1,0,1]
v_pk_fma_f32 v[42:43], v[42:43], v[94:95], v[100:101] op_sel_hi:[1,0,1]
v_cvt_pk_bf16_f32 v118, v40, v41
v_cvt_pk_bf16_f32 v119, v42, v43
s_waitcnt lgkmcnt(2)
v_pk_mul_f32 v[76:77], v[76:77], v[96:97] op_sel_hi:[1,0]
v_pk_mul_f32 v[78:79], v[78:79], v[96:97] op_sel_hi:[1,0]
v_pk_fma_f32 v[52:53], v[52:53], v[72:73], v[76:77]
v_pk_fma_f32 v[54:55], v[54:55], v[74:75], v[78:79]
v_cvt_pk_bf16_f32 v112, v52, v53
v_cvt_pk_bf16_f32 v113, v54, v55
s_waitcnt lgkmcnt(0)
v_pk_mul_f32 v[84:85], v[84:85], v[96:97] op_sel_hi:[1,0]
v_pk_mul_f32 v[86:87], v[86:87], v[96:97] op_sel_hi:[1,0]
v_pk_fma_f32 v[56:57], v[56:57], v[80:81], v[84:85]
v_pk_fma_f32 v[58:59], v[58:59], v[82:83], v[86:87]
v_cvt_pk_bf16_f32 v114, v56, v57
v_cvt_pk_bf16_f32 v115, v58, v59
s_barrier
ds_read_b128 v[88:91], v2 offset:17408
ds_read_b128 v[92:95], v2 offset:19456
ds_read_b128 v[96:99], v2 offset:21504
s_waitcnt lgkmcnt(2)
v_mfma_f32_16x16x32_bf16 v[52:55], a[4:7], v[88:91], 0
ds_read_b128 v[100:103], v2 offset:23552
v_mfma_f32_16x16x32_bf16 v[56:59], v[88:91], a[8:11], 0
s_waitcnt lgkmcnt(2)
v_mfma_f32_16x16x32_bf16 v[52:55], a[16:19], v[92:95], v[52:55]
ds_read_b128 v[88:91], v2 offset:25600
v_mfma_f32_16x16x32_bf16 v[56:59], v[92:95], a[20:23], v[56:59]
s_waitcnt lgkmcnt(2)
v_mfma_f32_16x16x32_bf16 v[52:55], a[28:31], v[96:99], v[52:55]
ds_read_b128 v[92:95], v2 offset:27648
s_add_u32 s46, s58, 0x1000000
v_mfma_f32_16x16x32_bf16 v[56:59], v[96:99], a[32:35], v[56:59]
buffer_load_dwordx2 v[120:121], v14, s[4:7], s46 offen sc1
s_waitcnt lgkmcnt(2)
v_mfma_f32_16x16x32_bf16 v[52:55], a[40:43], v[100:103], v[52:55]
ds_read_b128 v[96:99], v2 offset:29696
buffer_load_dwordx2 v[122:123], v14, s[4:7], s46 offen offset:256 sc1
v_mfma_f32_16x16x32_bf16 v[56:59], v[100:103], a[44:47], v[56:59]
s_waitcnt lgkmcnt(2)
v_mfma_f32_16x16x32_bf16 v[52:55], a[52:55], v[88:91], v[52:55]
ds_read_b128 v[100:103], v2 offset:31744
v_mfma_f32_16x16x32_bf16 v[56:59], v[88:91], a[56:59], v[56:59]
s_add_u32 s46, s58, 0x1000000
s_waitcnt lgkmcnt(2)
v_mfma_f32_16x16x32_bf16 v[52:55], a[64:67], v[92:95], v[52:55]
ds_read_b128 v[88:91], v2 offset:33792
buffer_load_dwordx2 v[124:125], v14, s[4:7], s46 offen offset:512 sc1
v_mfma_f32_16x16x32_bf16 v[56:59], v[92:95], a[68:71], v[56:59]
buffer_load_dwordx2 v[126:127], v14, s[4:7], s46 offen offset:768 sc1
s_waitcnt lgkmcnt(2)
v_mfma_f32_16x16x32_bf16 v[52:55], a[76:79], v[96:99], v[52:55]
ds_read_b128 v[92:95], v2 offset:35840
v_mfma_f32_16x16x32_bf16 v[56:59], v[96:99], a[80:83], v[56:59]
s_waitcnt lgkmcnt(2)
v_mfma_f32_16x16x32_bf16 v[52:55], a[88:91], v[100:103], v[52:55]
ds_read_b128 v[96:99], v2 offset:37888
v_mfma_f32_16x16x32_bf16 v[56:59], v[100:103], a[92:95], v[56:59]
s_waitcnt lgkmcnt(2)
v_mfma_f32_16x16x32_bf16 v[52:55], a[148:151], v[88:91], v[52:55]
ds_read_b128 v[100:103], v2 offset:39936
v_mfma_f32_16x16x32_bf16 v[56:59], v[88:91], a[152:155], v[56:59]
s_waitcnt lgkmcnt(2)
v_mfma_f32_16x16x32_bf16 v[52:55], a[160:163], v[92:95], v[52:55]
ds_read_b128 v[88:91], v2 offset:41984
v_mfma_f32_16x16x32_bf16 v[56:59], v[92:95], a[164:167], v[56:59]
s_waitcnt lgkmcnt(2)
v_mfma_f32_16x16x32_bf16 v[52:55], a[172:175], v[96:99], v[52:55]
ds_read_b128 v[92:95], v2 offset:44032
v_mfma_f32_16x16x32_bf16 v[56:59], v[96:99], a[176:179], v[56:59]
s_waitcnt lgkmcnt(2)
v_mfma_f32_16x16x32_bf16 v[52:55], a[184:187], v[100:103], v[52:55]
ds_read_b128 v[96:99], v2 offset:46080
v_mfma_f32_16x16x32_bf16 v[56:59], v[100:103], a[188:191], v[56:59]
s_waitcnt lgkmcnt(2)
v_mfma_f32_16x16x32_bf16 v[52:55], a[100:103], v[88:91], v[52:55]
ds_read_b128 v[100:103], v2 offset:48128
v_mfma_f32_16x16x32_bf16 v[56:59], v[88:91], a[104:107], v[56:59]
s_waitcnt lgkmcnt(2)
v_mfma_f32_16x16x32_bf16 v[52:55], a[112:115], v[92:95], v[52:55]
v_mfma_f32_16x16x32_bf16 v[56:59], v[92:95], a[116:119], v[56:59]
s_waitcnt lgkmcnt(1)
v_mfma_f32_16x16x32_bf16 v[52:55], a[124:127], v[96:99], v[52:55]
ds_read_b128 v[68:71], v6 offset:64
ds_read2_b32 v[72:73], v5 offset0:32 offset1:112
v_mfma_f32_16x16x32_bf16 v[56:59], v[96:99], a[128:131], v[56:59]
v_add_u32 v74, s91, v5
s_waitcnt lgkmcnt(2)
v_mfma_f32_16x16x32_bf16 v[52:55], a[136:139], v[100:103], v[52:55]
v_subrev_u32 v75, s91, v6
ds_read_b32 v74, v74 offset:128
v_mfma_f32_16x16x32_bf16 v[56:59], v[100:103], a[140:143], v[56:59]
ds_read_b128 v[80:83], v75 offset:128
ds_read_b128 v[84:87], v75 offset:448
s_waitcnt lgkmcnt(2)
v_pk_mul_f32 v[76:77], v[68:69], v[72:73] op_sel:[0,1] op_sel_hi:[1,1]
v_pk_mul_f32 v[78:79], v[70:71], v[72:73] op_sel:[0,1] op_sel_hi:[1,1]
v_pk_fma_f32 v[52:53], v[52:53], v[72:73], v[76:77] op_sel_hi:[1,0,1]
v_pk_fma_f32 v[54:55], v[54:55], v[72:73], v[78:79] op_sel_hi:[1,0,1]
v_cvt_pk_bf16_f32 v104, v52, v53
v_cvt_pk_bf16_f32 v105, v54, v55
s_waitcnt lgkmcnt(0)
v_pk_mul_f32 v[84:85], v[84:85], v[74:75] op_sel_hi:[1,0]
v_pk_mul_f32 v[86:87], v[86:87], v[74:75] op_sel_hi:[1,0]
v_pk_fma_f32 v[56:57], v[56:57], v[80:81], v[84:85]
v_pk_fma_f32 v[58:59], v[58:59], v[82:83], v[86:87]
v_cvt_pk_bf16_f32 v110, v56, v57
v_cvt_pk_bf16_f32 v111, v58, v59
v_add_u32 v80, 0x27400, v1
ds_read_b128 v[84:87], v80 offset:1024
ds_read_b128 v[80:83], v80
v_mfma_f32_16x16x16_bf16 v[36:39], v[104:105], v[116:117], 0
v_mfma_f32_16x16x16_bf16 v[40:43], v[106:107], v[116:117], 0
v_mfma_f32_16x16x16_bf16 v[44:47], v[106:107], v[118:119], 0
v_mfma_f32_16x16x16_bf16 v[48:51], v[108:109], v[118:119], 0
v_mov_b32 v52, 0x3f803f80
v_mov_b32 v53, 0x3f803f80
v_mov_b32 v54, 0x3f803f80
v_mov_b32 v55, 0x3f803f80
v_mov_b32 v108, v104
v_mov_b32 v109, v105
s_waitcnt lgkmcnt(0)
v_pk_fma_f32 v[36:37], v[36:37], s[34:35], v[80:81]
v_pk_fma_f32 v[38:39], v[38:39], s[34:35], v[82:83]
v_pk_fma_f32 v[40:41], v[40:41], s[34:35], v[84:85]
v_pk_fma_f32 v[42:43], v[42:43], s[34:35], v[86:87]
v_pk_fma_f32 v[44:45], v[44:45], s[34:35], v[80:81]
v_pk_fma_f32 v[46:47], v[46:47], s[34:35], v[82:83]
v_pk_fma_f32 v[48:49], v[48:49], s[34:35], v[84:85]
v_pk_fma_f32 v[50:51], v[50:51], s[34:35], v[86:87]
v_max3_f32 v56, v36, v37, v38
v_max3_f32 v58, v44, v45, v46
v_max3_f32 v57, v39, v40, v41
v_max3_f32 v59, v47, v48, v49
v_max3_f32 v56, v56, v42, v43
v_max3_f32 v58, v58, v50, v51
v_max_f32 v56, v56, v57
v_max_f32 v58, v58, v59
s_add_u32 s15, s47, s39
s_add_u32 s15, s15, 0x16000
v_permlane32_swap_b32 v56, v58
v_max_f32 v56, v56, v58
v_mov_b32 v58, v56
s_nop 1
v_permlane16_swap_b32 v56, v58
v_max_f32 v56, v56, v58
v_mov_b32 v58, v56
s_nop 1
v_permlane32_swap_b32 v56, v58
v_pk_add_f32 v[36:37], v[36:37], v[56:57] op_sel_hi:[1,0] neg_lo:[0,1] neg_hi:[0,1]
v_pk_add_f32 v[38:39], v[38:39], v[56:57] op_sel_hi:[1,0] neg_lo:[0,1] neg_hi:[0,1]
v_pk_add_f32 v[40:41], v[40:41], v[56:57] op_sel_hi:[1,0] neg_lo:[0,1] neg_hi:[0,1]
v_pk_add_f32 v[42:43], v[42:43], v[56:57] op_sel_hi:[1,0] neg_lo:[0,1] neg_hi:[0,1]
v_exp_f32 v36, v36
v_exp_f32 v37, v37
v_exp_f32 v38, v38
v_exp_f32 v39, v39
v_exp_f32 v40, v40
v_exp_f32 v41, v41
v_exp_f32 v42, v42
v_exp_f32 v43, v43
v_pk_add_f32 v[44:45], v[44:45], v[58:59] op_sel_hi:[1,0] neg_lo:[0,1] neg_hi:[0,1]
v_pk_add_f32 v[46:47], v[46:47], v[58:59] op_sel_hi:[1,0] neg_lo:[0,1] neg_hi:[0,1]
v_pk_add_f32 v[48:49], v[48:49], v[58:59] op_sel_hi:[1,0] neg_lo:[0,1] neg_hi:[0,1]
v_pk_add_f32 v[50:51], v[50:51], v[58:59] op_sel_hi:[1,0] neg_lo:[0,1] neg_hi:[0,1]
v_exp_f32 v44, v44
v_exp_f32 v45, v45
v_exp_f32 v46, v46
v_exp_f32 v47, v47
v_exp_f32 v48, v48
v_exp_f32 v49, v49
v_exp_f32 v50, v50
v_exp_f32 v51, v51
s_waitcnt vmcnt(4)
s_barrier
ds_read_b128 v[92:95], v2 offset:57344
ds_read_b128 v[96:99], v2 offset:32768
ds_read_b128 v[100:103], v2 offset:33792
v_cvt_pk_bf16_f32 v68, v36, v37
v_cvt_pk_bf16_f32 v69, v38, v39
v_cvt_pk_bf16_f32 v70, v40, v41
v_cvt_pk_bf16_f32 v71, v42, v43
v_cvt_pk_bf16_f32 v72, v44, v45
v_cvt_pk_bf16_f32 v73, v46, v47
v_cvt_pk_bf16_f32 v74, v48, v49
v_cvt_pk_bf16_f32 v75, v50, v51
v_mfma_f32_16x16x32_bf16 v[40:43], v[52:55], v[68:71], 0
s_nop 0
v_mfma_f32_16x16x32_bf16 v[48:51], v[52:55], v[72:75], 0
v_mfma_f32_16x16x32_bf16 v[36:39], v[110:113], v[68:71], 0
v_mfma_f32_16x16x32_bf16 v[44:47], v[112:115], v[72:75], 0
v_mov_b32 v114, v110
v_mov_b32 v115, v111
s_nop 1
v_rcp_f32 v40, v40
s_nop 0
v_rcp_f32 v48, v48
v_pk_mul_f32 v[36:37], v[36:37], v[40:41] op_sel_hi:[1,0]
v_pk_mul_f32 v[38:39], v[38:39], v[40:41] op_sel_hi:[1,0]
v_pk_mul_f32 v[44:45], v[44:45], v[48:49] op_sel_hi:[1,0]
v_pk_mul_f32 v[46:47], v[46:47], v[48:49] op_sel_hi:[1,0]
v_cvt_pk_bf16_f32 v76, v36, v37
v_cvt_pk_bf16_f32 v77, v38, v39
v_cvt_pk_bf16_f32 v78, v44, v45
v_cvt_pk_bf16_f32 v79, v46, v47
s_nop 0
v_permlane32_swap_b32 v76, v78
v_permlane32_swap_b32 v77, v79
buffer_store_dwordx4 v[76:79], v3, s[4:7], s15 offen
ds_read_b128 v[80:83], v2 offset:58368
ds_read_b128 v[84:87], v2 offset:34816
ds_read_b128 v[88:91], v2 offset:35840
s_waitcnt lgkmcnt(3)
v_mfma_f32_16x16x32_bf16 v[44:47], a[148:151], v[92:95], 0
ds_read_b128 v[68:71], v2 offset:59392
ds_read_b128 v[72:75], v2 offset:36864
v_mfma_f32_16x16x32_bf16 v[48:51], v[92:95], a[152:155], 0
ds_read_b128 v[76:79], v2 offset:37888
v_mfma_f32_16x16x32_bf16 v[36:39], a[148:151], v[96:99], 0
v_mfma_f32_16x16x32_bf16 v[40:43], v[96:99], a[152:155], 0
v_mfma_f32_16x16x32_bf16 v[60:63], a[144:147], v[96:99], 0
v_mfma_f32_16x16x32_bf16 v[64:67], a[144:147], v[100:103], 0
s_waitcnt lgkmcnt(3)
v_mfma_f32_16x16x32_bf16 v[44:47], a[160:163], v[80:83], v[44:47]
ds_read_b128 v[92:95], v2 offset:60416
ds_read_b128 v[96:99], v2 offset:38912
v_mfma_f32_16x16x32_bf16 v[48:51], v[80:83], a[164:167], v[48:51]
ds_read_b128 v[100:103], v2 offset:39936
s_add_u32 s28, s25, 4096
v_mfma_f32_16x16x32_bf16 v[36:39], a[160:163], v[84:87], v[36:39]
buffer_load_dwordx4 a[144:147], v1, s[4:7], s28 offen sc1
v_mfma_f32_16x16x32_bf16 v[40:43], v[84:87], a[164:167], v[40:43]
v_mfma_f32_16x16x32_bf16 v[60:63], a[156:159], v[84:87], v[60:63]
buffer_load_dwordx4 a[148:151], v1, s[4:7], s28 offen offset:1024 sc1
v_mfma_f32_16x16x32_bf16 v[64:67], a[156:159], v[88:91], v[64:67]
s_waitcnt lgkmcnt(3)
v_mfma_f32_16x16x32_bf16 v[44:47], a[172:175], v[68:71], v[44:47]
ds_read_b128 v[80:83], v2 offset:61440
ds_read_b128 v[84:87], v2 offset:40960
v_mfma_f32_16x16x32_bf16 v[48:51], v[68:71], a[176:179], v[48:51]
ds_read_b128 v[88:91], v2 offset:41984
buffer_load_dwordx4 a[152:155], v1, s[4:7], s28 offen offset:2048 sc1
v_mfma_f32_16x16x32_bf16 v[36:39], a[172:175], v[72:75], v[36:39]
v_mfma_f32_16x16x32_bf16 v[40:43], v[72:75], a[176:179], v[40:43]
buffer_load_dwordx4 a[156:159], v1, s[4:7], s28 offen offset:3072 sc1
v_mfma_f32_16x16x32_bf16 v[60:63], a[168:171], v[72:75], v[60:63]
v_mfma_f32_16x16x32_bf16 v[64:67], a[168:171], v[76:79], v[64:67]
s_add_u32 s28, s25, 8192
s_waitcnt lgkmcnt(3)
v_mfma_f32_16x16x32_bf16 v[44:47], a[184:187], v[92:95], v[44:47]
ds_read_b128 v[68:71], v2 offset:62464
ds_read_b128 v[72:75], v2 offset:43008
v_mfma_f32_16x16x32_bf16 v[48:51], v[92:95], a[188:191], v[48:51]
ds_read_b128 v[76:79], v2 offset:44032
buffer_load_dwordx4 a[160:163], v1, s[4:7], s28 offen sc1
v_mfma_f32_16x16x32_bf16 v[36:39], a[184:187], v[96:99], v[36:39]
v_add_u32 v15, 8, v15
s_waitcnt vmcnt(5)
v_mfma_f32_16x16x32_bf16 v[40:43], v[96:99], a[188:191], v[40:43]
buffer_load_dwordx4 a[164:167], v1, s[4:7], s28 offen offset:1024 sc1
buffer_store_dword v15, v13, s[4:7], s45 offen
v_mfma_f32_16x16x32_bf16 v[60:63], a[180:183], v[96:99], v[60:63]
v_mfma_f32_16x16x32_bf16 v[64:67], a[180:183], v[100:103], v[64:67]
buffer_load_dwordx4 a[168:171], v1, s[4:7], s28 offen offset:2048 sc1
s_waitcnt lgkmcnt(3)
v_mfma_f32_16x16x32_bf16 v[44:47], a[100:103], v[80:83], v[44:47]
ds_read_b128 v[92:95], v2 offset:63488
ds_read_b128 v[96:99], v2 offset:45056
v_mfma_f32_16x16x32_bf16 v[48:51], v[80:83], a[104:107], v[48:51]
ds_read_b128 v[100:103], v2 offset:46080
buffer_load_dwordx4 a[172:175], v1, s[4:7], s28 offen offset:3072 sc1
v_mfma_f32_16x16x32_bf16 v[36:39], a[100:103], v[84:87], v[36:39]
v_mfma_f32_16x16x32_bf16 v[40:43], v[84:87], a[104:107], v[40:43]
s_add_u32 s28, s25, 12288
buffer_load_dwordx4 a[176:179], v1, s[4:7], s28 offen sc1
v_mfma_f32_16x16x32_bf16 v[60:63], a[96:99], v[84:87], v[60:63]
v_mfma_f32_16x16x32_bf16 v[64:67], a[96:99], v[88:91], v[64:67]
buffer_load_dwordx4 a[180:183], v1, s[4:7], s28 offen offset:1024 sc1
s_waitcnt lgkmcnt(3)
v_mfma_f32_16x16x32_bf16 v[44:47], a[112:115], v[68:71], v[44:47]
ds_read_b128 v[80:83], v2 offset:64512
ds_read_b128 v[84:87], v2 offset:47104
v_mfma_f32_16x16x32_bf16 v[48:51], v[68:71], a[116:119], v[48:51]
ds_read_b128 v[88:91], v2 offset:48128
buffer_load_dwordx4 a[184:187], v1, s[4:7], s28 offen offset:2048 sc1
v_mfma_f32_16x16x32_bf16 v[36:39], a[112:115], v[72:75], v[36:39]
v_add_f32 v120, v120, v122
v_add_f32 v124, v124, v126
v_mfma_f32_16x16x32_bf16 v[40:43], v[72:75], a[116:119], v[40:43]
buffer_load_dwordx4 a[188:191], v1, s[4:7], s28 offen offset:3072 sc1
v_add_f32 v121, v121, v123
v_mfma_f32_16x16x32_bf16 v[60:63], a[108:111], v[72:75], v[60:63]
v_add_f32 v125, v125, v127
v_add_f32 v120, v120, v124
v_mfma_f32_16x16x32_bf16 v[64:67], a[108:111], v[76:79], v[64:67]
s_add_u32 s28, s26, 24576
s_waitcnt lgkmcnt(3)
v_mfma_f32_16x16x32_bf16 v[44:47], a[124:127], v[92:95], v[44:47]
ds_read_b128 v[68:71], v2 offset:49152
ds_read_b128 v[72:75], v2 offset:16384
v_mfma_f32_16x16x32_bf16 v[48:51], v[92:95], a[128:131], v[48:51]
ds_read_b128 v[76:79], v2 offset:17408
buffer_load_dwordx4 a[96:99], v1, s[4:7], s28 offen sc1
v_mfma_f32_16x16x32_bf16 v[36:39], a[124:127], v[96:99], v[36:39]
v_add_f32 v121, v121, v125
v_mov_b32 v122, v5
v_mfma_f32_16x16x32_bf16 v[40:43], v[96:99], a[128:131], v[40:43]
s_add_u32 s14, s28, s88
buffer_load_dwordx4 a[100:103], v1, s[4:7], s14 offen sc1
v_mfma_f32_16x16x32_bf16 v[60:63], a[120:123], v[96:99], v[60:63]
s_nop 0
v_permlane32_swap_b32 v120, v121
v_mfma_f32_16x16x32_bf16 v[64:67], a[120:123], v[100:103], v[64:67]
s_add_u32 s14, s28, s89
s_waitcnt lgkmcnt(3)
v_mfma_f32_16x16x32_bf16 v[44:47], a[136:139], v[80:83], v[44:47]
ds_read_b128 v[92:95], v2 offset:50176
ds_read_b128 v[96:99], v2 offset:18432
v_mfma_f32_16x16x32_bf16 v[48:51], v[80:83], a[140:143], v[48:51]
ds_read_b128 v[100:103], v2 offset:19456
buffer_load_dwordx4 a[104:107], v1, s[4:7], s14 offen sc1
v_mfma_f32_16x16x32_bf16 v[36:39], a[136:139], v[84:87], v[36:39]
v_add_f32 v120, v120, v121
v_mov_b32 v121, v120
v_mfma_f32_16x16x32_bf16 v[40:43], v[84:87], a[140:143], v[40:43]
s_add_u32 s28, s26, 27648
buffer_load_dwordx4 a[108:111], v1, s[4:7], s28 offen sc1
v_mfma_f32_16x16x32_bf16 v[60:63], a[132:135], v[84:87], v[60:63]
v_permlane16_swap_b32 v120, v121
v_mfma_f32_16x16x32_bf16 v[64:67], a[132:135], v[88:91], v[64:67]
s_add_u32 s14, s28, s88
s_waitcnt lgkmcnt(3)
v_mfma_f32_16x16x32_bf16 v[44:47], a[4:7], v[68:71], v[44:47]
ds_read_b128 v[80:83], v2 offset:51200
ds_read_b128 v[84:87], v2 offset:20480
v_mfma_f32_16x16x32_bf16 v[48:51], v[68:71], a[8:11], v[48:51]
ds_read_b128 v[88:91], v2 offset:21504
buffer_load_dwordx4 a[112:115], v1, s[4:7], s14 offen sc1
v_mfma_f32_16x16x32_bf16 v[36:39], a[4:7], v[72:75], v[36:39]
v_add_f32 v120, v120, v121
v_mov_b32 v121, v120
v_mfma_f32_16x16x32_bf16 v[40:43], v[72:75], a[8:11], v[40:43]
s_add_u32 s14, s28, s89
buffer_load_dwordx4 a[116:119], v1, s[4:7], s14 offen sc1
v_mfma_f32_16x16x32_bf16 v[60:63], a[0:3], v[72:75], v[60:63]
v_permlane32_swap_b32 v120, v121
v_mfma_f32_16x16x32_bf16 v[64:67], a[0:3], v[76:79], v[64:67]
s_add_u32 s28, s26, 30720
s_waitcnt lgkmcnt(3)
v_mfma_f32_16x16x32_bf16 v[44:47], a[16:19], v[92:95], v[44:47]
ds_read_b128 v[68:71], v2 offset:52224
ds_read_b128 v[72:75], v2 offset:22528
v_mfma_f32_16x16x32_bf16 v[48:51], v[92:95], a[20:23], v[48:51]
ds_read_b128 v[76:79], v2 offset:23552
buffer_load_dwordx4 a[120:123], v1, s[4:7], s28 offen sc1
v_mfma_f32_16x16x32_bf16 v[36:39], a[16:19], v[96:99], v[36:39]
v_mul_f32 v120, 0x3b000000, v120
v_mul_f32 v121, 0x3b000000, v121
v_mfma_f32_16x16x32_bf16 v[40:43], v[96:99], a[20:23], v[40:43]
v_fma_f32 v121, -v120, v120, v121
v_max_f32 v121, 0, v121
v_mfma_f32_16x16x32_bf16 v[60:63], a[12:15], v[96:99], v[60:63]
buffer_load_dword v17, v4, s[4:7], s92 offen sc1
v_add_f32 v121, 0x3727c5ac, v121
v_mfma_f32_16x16x32_bf16 v[64:67], a[12:15], v[100:103], v[64:67]
s_waitcnt lgkmcnt(3)
v_mfma_f32_16x16x32_bf16 v[44:47], a[28:31], v[80:83], v[44:47]
ds_read_b128 v[92:95], v2 offset:53248
ds_read_b128 v[96:99], v2 offset:24576
v_mfma_f32_16x16x32_bf16 v[48:51], v[80:83], a[32:35], v[48:51]
ds_read_b128 v[100:103], v2 offset:25600
s_add_u32 s14, s28, s88
v_mfma_f32_16x16x32_bf16 v[36:39], a[28:31], v[84:87], v[36:39]
buffer_load_dwordx4 a[124:127], v1, s[4:7], s14 offen sc1
v_mfma_f32_16x16x32_bf16 v[40:43], v[84:87], a[32:35], v[40:43]
v_rsq_f32 v121, v121
v_mfma_f32_16x16x32_bf16 v[60:63], a[24:27], v[84:87], v[60:63]
s_add_u32 s14, s28, s89
buffer_load_dwordx4 a[128:131], v1, s[4:7], s14 offen sc1
v_mfma_f32_16x16x32_bf16 v[64:67], a[24:27], v[88:91], v[64:67]
v_sub_f32 v120, 0, v120
s_waitcnt lgkmcnt(3)
v_mfma_f32_16x16x32_bf16 v[44:47], a[40:43], v[68:71], v[44:47]
ds_read_b128 v[80:83], v2 offset:54272
ds_read_b128 v[84:87], v2 offset:26624
v_mfma_f32_16x16x32_bf16 v[48:51], v[68:71], a[44:47], v[48:51]
ds_read_b128 v[88:91], v2 offset:27648
s_add_u32 s28, s26, 33792
v_mfma_f32_16x16x32_bf16 v[36:39], a[40:43], v[72:75], v[36:39]
buffer_load_dwordx4 a[132:135], v1, s[4:7], s28 offen sc1
v_mul_f32 v120, v120, v121
v_mfma_f32_16x16x32_bf16 v[40:43], v[72:75], a[44:47], v[40:43]
ds_write_b32 v122, v121 offset:0
ds_write_b32 v122, v120 offset:320
v_mfma_f32_16x16x32_bf16 v[60:63], a[36:39], v[72:75], v[60:63]
s_add_u32 s14, s28, s88
buffer_load_dwordx4 a[136:139], v1, s[4:7], s14 offen sc1
v_mfma_f32_16x16x32_bf16 v[64:67], a[36:39], v[76:79], v[64:67]
s_waitcnt lgkmcnt(5)
v_mfma_f32_16x16x32_bf16 v[44:47], a[52:55], v[92:95], v[44:47]
ds_read_b128 v[68:71], v2 offset:55296
ds_read_b128 v[72:75], v2 offset:28672
v_mfma_f32_16x16x32_bf16 v[48:51], v[92:95], a[56:59], v[48:51]
ds_read_b128 v[76:79], v2 offset:29696
s_add_u32 s14, s28, s89
v_mfma_f32_16x16x32_bf16 v[36:39], a[52:55], v[96:99], v[36:39]
buffer_load_dwordx4 a[140:143], v1, s[4:7], s14 offen sc1
v_mfma_f32_16x16x32_bf16 v[40:43], v[96:99], a[56:59], v[40:43]
v_mfma_f32_16x16x32_bf16 v[60:63], a[48:51], v[96:99], v[60:63]
v_mfma_f32_16x16x32_bf16 v[64:67], a[48:51], v[100:103], v[64:67]
s_waitcnt lgkmcnt(5)
v_mfma_f32_16x16x32_bf16 v[44:47], a[64:67], v[80:83], v[44:47]
ds_read_b128 v[92:95], v2 offset:56320
ds_read_b128 v[96:99], v2 offset:30720
v_mfma_f32_16x16x32_bf16 v[48:51], v[80:83], a[68:71], v[48:51]
ds_read_b128 v[100:103], v2 offset:31744
v_mfma_f32_16x16x32_bf16 v[36:39], a[64:67], v[84:87], v[36:39]
v_mfma_f32_16x16x32_bf16 v[40:43], v[84:87], a[68:71], v[40:43]
v_mfma_f32_16x16x32_bf16 v[60:63], a[60:63], v[84:87], v[60:63]
v_mfma_f32_16x16x32_bf16 v[64:67], a[60:63], v[88:91], v[64:67]
s_waitcnt lgkmcnt(3)
v_mfma_f32_16x16x32_bf16 v[44:47], a[76:79], v[68:71], v[44:47]
v_mfma_f32_16x16x32_bf16 v[48:51], v[68:71], a[80:83], v[48:51]
v_mfma_f32_16x16x32_bf16 v[36:39], a[76:79], v[72:75], v[36:39]
v_mfma_f32_16x16x32_bf16 v[40:43], v[72:75], a[80:83], v[40:43]
v_mfma_f32_16x16x32_bf16 v[60:63], a[72:75], v[72:75], v[60:63]
v_mfma_f32_16x16x32_bf16 v[64:67], a[72:75], v[76:79], v[64:67]
s_waitcnt lgkmcnt(0)
v_mfma_f32_16x16x32_bf16 v[44:47], a[88:91], v[92:95], v[44:47]
ds_read_b128 v[68:71], v6 offset:64
ds_read2_b32 v[72:73], v5 offset0:0 offset1:80
v_mfma_f32_16x16x32_bf16 v[48:51], v[92:95], a[92:95], v[48:51]
ds_read2_b32 v[74:75], v5 offset0:16 offset1:96
ds_read_b128 v[76:79], v6 offset:0
v_mfma_f32_16x16x32_bf16 v[36:39], a[88:91], v[96:99], v[36:39]
ds_read2_b32 v[80:81], v5 offset0:32 offset1:112
v_add_u32 v82, s91, v5
v_mfma_f32_16x16x32_bf16 v[40:43], v[96:99], a[92:95], v[40:43]
v_subrev_u32 v83, s91, v6
ds_read_b32 v82, v82 offset:128
v_mfma_f32_16x16x32_bf16 v[60:63], a[84:87], v[96:99], v[60:63]
v_mfma_f32_16x16x32_bf16 v[64:67], a[84:87], v[100:103], v[64:67]
ds_read_b128 v[88:91], v83 offset:0
ds_read_b128 v[92:95], v83 offset:320
ds_read_b128 v[96:99], v83 offset:64
ds_read_b128 v[100:103], v83 offset:384
s_waitcnt lgkmcnt(4)
v_pk_mul_f32 v[84:85], v[68:69], v[72:73] op_sel:[0,1] op_sel_hi:[1,1]
v_pk_mul_f32 v[86:87], v[70:71], v[72:73] op_sel:[0,1] op_sel_hi:[1,1]
v_pk_fma_f32 v[44:45], v[44:45], v[72:73], v[84:85] op_sel_hi:[1,0,1]
v_pk_fma_f32 v[46:47], v[46:47], v[72:73], v[86:87] op_sel_hi:[1,0,1]
v_cvt_pk_bf16_f32 v104, v44, v45
v_cvt_pk_bf16_f32 v105, v46, v47
v_pk_mul_f32 v[84:85], v[68:69], v[74:75] op_sel:[0,1] op_sel_hi:[1,1]
v_pk_mul_f32 v[86:87], v[70:71], v[74:75] op_sel:[0,1] op_sel_hi:[1,1]
v_pk_fma_f32 v[36:37], v[36:37], v[74:75], v[84:85] op_sel_hi:[1,0,1]
v_pk_fma_f32 v[38:39], v[38:39], v[74:75], v[86:87] op_sel_hi:[1,0,1]
v_cvt_pk_bf16_f32 v106, v36, v37
v_cvt_pk_bf16_f32 v107, v38, v39
v_pk_mul_f32 v[84:85], v[76:77], v[74:75] op_sel:[0,1] op_sel_hi:[1,1]
v_pk_mul_f32 v[86:87], v[78:79], v[74:75] op_sel:[0,1] op_sel_hi:[1,1]
v_pk_fma_f32 v[60:61], v[60:61], v[74:75], v[84:85] op_sel_hi:[1,0,1]
v_pk_fma_f32 v[62:63], v[62:63], v[74:75], v[86:87] op_sel_hi:[1,0,1]
v_cvt_pk_bf16_f32 v116, v60, v61
v_cvt_pk_bf16_f32 v117, v62, v63
v_pk_mul_f32 v[84:85], v[76:77], v[80:81] op_sel:[0,1] op_sel_hi:[1,1]
v_pk_mul_f32 v[86:87], v[78:79], v[80:81] op_sel:[0,1] op_sel_hi:[1,1]
v_pk_fma_f32 v[64:65], v[64:65], v[80:81], v[84:85] op_sel_hi:[1,0,1]
v_pk_fma_f32 v[66:67], v[66:67], v[80:81], v[86:87] op_sel_hi:[1,0,1]
v_cvt_pk_bf16_f32 v118, v64, v65
v_cvt_pk_bf16_f32 v119, v66, v67
s_waitcnt lgkmcnt(2)
v_pk_mul_f32 v[92:93], v[92:93], v[82:83] op_sel_hi:[1,0]
v_pk_mul_f32 v[94:95], v[94:95], v[82:83] op_sel_hi:[1,0]
v_pk_fma_f32 v[48:49], v[48:49], v[88:89], v[92:93]
v_pk_fma_f32 v[50:51], v[50:51], v[90:91], v[94:95]
v_cvt_pk_bf16_f32 v110, v48, v49
v_cvt_pk_bf16_f32 v111, v50, v51
s_waitcnt lgkmcnt(0)
v_pk_mul_f32 v[100:101], v[100:101], v[82:83] op_sel_hi:[1,0]
v_pk_mul_f32 v[102:103], v[102:103], v[82:83] op_sel_hi:[1,0]
v_pk_fma_f32 v[40:41], v[40:41], v[96:97], v[100:101]
v_pk_fma_f32 v[42:43], v[42:43], v[98:99], v[102:103]
v_cvt_pk_bf16_f32 v112, v40, v41
v_cvt_pk_bf16_f32 v113, v42, v43
s_add_u32 s46, s32, 11
s_waitcnt vmcnt(5)
v_lshrrev_b32 v17, 3, v17
v_subrev_u32 v17, s46, v17
v_cmp_lt_u32 vcc, 31, v17
s_cbranch_vccnz L_spin_26
L_ok_25:
s_add_u32 s17, s47, s97
v_add_u32 v80, 0x27400, v1
ds_read_b128 v[84:87], v80 offset:1024
ds_read_b128 v[80:83], v80
v_mfma_f32_16x16x16_bf16 v[36:39], v[104:105], v[116:117], 0
s_add_u32 m0, s2, 0
s_add_u32 s29, s17, 0x16000
v_mfma_f32_16x16x16_bf16 v[40:43], v[106:107], v[116:117], 0
buffer_load_dwordx4 v1, s[4:7], s29 offen sc1 lds
v_mfma_f32_16x16x16_bf16 v[44:47], v[106:107], v[118:119], 0
v_mfma_f32_16x16x16_bf16 v[48:51], v[108:109], v[118:119], 0
v_mov_b32 v60, 0x3f803f80
v_mov_b32 v61, 0x3f803f80
v_mov_b32 v62, 0x3f803f80
buffer_load_dwordx4 v1, s[4:7], s29 offen offset:1024 sc1 lds
v_mov_b32 v63, 0x3f803f80
s_waitcnt lgkmcnt(0)
v_min_f32 v52, s38, v80
v_min_f32 v53, s38, v81
v_min_f32 v54, s38, v82
v_min_f32 v55, s38, v83
v_pk_fma_f32 v[36:37], v[36:37], s[34:35], v[52:53]
v_pk_fma_f32 v[38:39], v[38:39], s[34:35], v[54:55]
v_pk_fma_f32 v[40:41], v[40:41], s[34:35], v[84:85]
v_pk_fma_f32 v[42:43], v[42:43], s[34:35], v[86:87]
s_add_u32 m0, s2, 8192
s_add_u32 s29, s17, 0x17000
buffer_load_dwordx4 v1, s[4:7], s29 offen sc1 lds
v_pk_fma_f32 v[44:45], v[44:45], s[34:35], v[80:81]
v_pk_fma_f32 v[46:47], v[46:47], s[34:35], v[82:83]
v_pk_fma_f32 v[48:49], v[48:49], s[34:35], v[84:85]
v_pk_fma_f32 v[50:51], v[50:51], s[34:35], v[86:87]
v_max3_f32 v56, v36, v37, v38
v_max3_f32 v58, v44, v45, v46
v_max3_f32 v57, v39, v40, v41
v_max3_f32 v59, v47, v48, v49
v_max3_f32 v56, v56, v42, v43
buffer_load_dwordx4 v1, s[4:7], s29 offen offset:1024 sc1 lds
v_max3_f32 v58, v58, v50, v51
v_max_f32 v56, v56, v57
v_max_f32 v58, v58, v59
s_add_u32 s15, s47, s39
s_add_u32 s15, s15, 0x8000
v_permlane32_swap_b32 v56, v58
v_max_f32 v56, v56, v58
v_mov_b32 v58, v56
s_nop 1
v_permlane16_swap_b32 v56, v58
v_max_f32 v56, v56, v58
s_add_u32 m0, s2, 16384
s_add_u32 s29, s17, 0x18000
buffer_load_dwordx4 v1, s[4:7], s29 offen sc1 lds
v_mov_b32 v58, v56
s_nop 1
v_permlane32_swap_b32 v56, v58
v_pk_add_f32 v[36:37], v[36:37], v[56:57] op_sel_hi:[1,0] neg_lo:[0,1] neg_hi:[0,1]
v_pk_add_f32 v[38:39], v[38:39], v[56:57] op_sel_hi:[1,0] neg_lo:[0,1] neg_hi:[0,1]
v_pk_add_f32 v[40:41], v[40:41], v[56:57] op_sel_hi:[1,0] neg_lo:[0,1] neg_hi:[0,1]
v_pk_add_f32 v[42:43], v[42:43], v[56:57] op_sel_hi:[1,0] neg_lo:[0,1] neg_hi:[0,1]
v_exp_f32 v36, v36
v_exp_f32 v37, v37
buffer_load_dwordx4 v1, s[4:7], s29 offen offset:1024 sc1 lds
v_exp_f32 v38, v38
v_exp_f32 v39, v39
v_exp_f32 v40, v40
v_exp_f32 v41, v41
v_exp_f32 v42, v42
s_add_u32 m0, s2, 24576
s_add_u32 s29, s17, 0x19000
buffer_load_dwordx4 v1, s[4:7], s29 offen sc1 lds
v_exp_f32 v43, v43
v_pk_add_f32 v[44:45], v[44:45], v[58:59] op_sel_hi:[1,0] neg_lo:[0,1] neg_hi:[0,1]
v_pk_add_f32 v[46:47], v[46:47], v[58:59] op_sel_hi:[1,0] neg_lo:[0,1] neg_hi:[0,1]
v_pk_add_f32 v[48:49], v[48:49], v[58:59] op_sel_hi:[1,0] neg_lo:[0,1] neg_hi:[0,1]
v_pk_add_f32 v[50:51], v[50:51], v[58:59] op_sel_hi:[1,0] neg_lo:[0,1] neg_hi:[0,1]
v_exp_f32 v44, v44
v_exp_f32 v45, v45
buffer_load_dwordx4 v1, s[4:7], s29 offen offset:1024 sc1 lds
v_exp_f32 v46, v46
v_exp_f32 v47, v47
v_exp_f32 v48, v48
v_exp_f32 v49, v49
v_exp_f32 v50, v50
v_exp_f32 v51, v51
v_cvt_pk_bf16_f32 v68, v36, v37
v_cvt_pk_bf16_f32 v69, v38, v39
v_cvt_pk_bf16_f32 v70, v40, v41
v_cvt_pk_bf16_f32 v71, v42, v43
v_cvt_pk_bf16_f32 v72, v44, v45
v_cvt_pk_bf16_f32 v73, v46, v47
v_cvt_pk_bf16_f32 v74, v48, v49
v_cvt_pk_bf16_f32 v75, v50, v51
v_mfma_f32_16x16x32_bf16 v[40:43], v[60:63], v[68:71], 0
s_nop 0
v_mfma_f32_16x16x32_bf16 v[48:51], v[60:63], v[72:75], 0
v_mfma_f32_16x16x32_bf16 v[36:39], v[110:113], v[68:71], 0
v_mfma_f32_16x16x32_bf16 v[44:47], v[112:115], v[72:75], 0
s_nop 3
v_rcp_f32 v40, v40
s_nop 0
v_rcp_f32 v48, v48
v_pk_mul_f32 v[36:37], v[36:37], v[40:41] op_sel_hi:[1,0]
v_pk_mul_f32 v[38:39], v[38:39], v[40:41] op_sel_hi:[1,0]
v_pk_mul_f32 v[44:45], v[44:45], v[48:49] op_sel_hi:[1,0]
v_pk_mul_f32 v[46:47], v[46:47], v[48:49] op_sel_hi:[1,0]
v_cvt_pk_bf16_f32 v76, v36, v37
v_cvt_pk_bf16_f32 v77, v38, v39
v_cvt_pk_bf16_f32 v78, v44, v45
v_cvt_pk_bf16_f32 v79, v46, v47
s_nop 0
v_permlane32_swap_b32 v76, v78
v_permlane32_swap_b32 v77, v79
buffer_store_dwordx4 v[76:79], v3, s[4:7], s15 offen
s_waitcnt vmcnt(1)
s_barrier
ds_read_b128 v[88:91], v7 offset:0
ds_read_b128 v[92:95], v8 offset:0
ds_read_b128 v[96:99], v7 offset:4096
ds_read_b128 v[100:103], v8 offset:4096
ds_read_b128 v[72:75], v7 offset:8192
ds_read_b128 v[76:79], v8 offset:8192
s_waitcnt lgkmcnt(4)
v_mfma_f32_16x16x32_bf16 v[36:39], a[192:195], v[88:91], 0
ds_read_b128 v[80:83], v7 offset:12288
ds_read_b128 v[84:87], v8 offset:12288
v_mfma_f32_16x16x32_bf16 v[40:43], a[196:199], v[88:91], 0
v_mfma_f32_16x16x32_bf16 v[44:47], a[192:195], v[92:95], 0
v_mfma_f32_16x16x32_bf16 v[48:51], a[196:199], v[92:95], 0
s_waitcnt lgkmcnt(4)
v_mfma_f32_16x16x32_bf16 v[36:39], a[200:203], v[96:99], v[36:39]
ds_read_b128 v[88:91], v7 offset:16384
ds_read_b128 v[92:95], v8 offset:16384
v_mfma_f32_16x16x32_bf16 v[40:43], a[204:207], v[96:99], v[40:43]
v_add_u32 v15, 8, v15
s_waitcnt vmcnt(0)
v_mfma_f32_16x16x32_bf16 v[44:47], a[200:203], v[100:103], v[44:47]
buffer_store_dword v15, v13, s[4:7], s45 offen
v_mfma_f32_16x16x32_bf16 v[48:51], a[204:207], v[100:103], v[48:51]
s_waitcnt lgkmcnt(4)
v_mfma_f32_16x16x32_bf16 v[36:39], a[144:147], v[72:75], v[36:39]
ds_read_b128 v[96:99], v7 offset:20480
ds_read_b128 v[100:103], v8 offset:20480
v_mfma_f32_16x16x32_bf16 v[40:43], a[148:151], v[72:75], v[40:43]
v_mfma_f32_16x16x32_bf16 v[44:47], a[144:147], v[76:79], v[44:47]
v_mfma_f32_16x16x32_bf16 v[48:51], a[148:151], v[76:79], v[48:51]
s_waitcnt lgkmcnt(4)
v_mfma_f32_16x16x32_bf16 v[36:39], a[152:155], v[80:83], v[36:39]
ds_read_b128 v[72:75], v7 offset:24576
ds_read_b128 v[76:79], v8 offset:24576
v_mfma_f32_16x16x32_bf16 v[40:43], a[156:159], v[80:83], v[40:43]
v_mfma_f32_16x16x32_bf16 v[44:47], a[152:155], v[84:87], v[44:47]
v_mfma_f32_16x16x32_bf16 v[48:51], a[156:159], v[84:87], v[48:51]
s_waitcnt lgkmcnt(4)
v_mfma_f32_16x16x32_bf16 v[36:39], a[160:163], v[88:91], v[36:39]
ds_read_b128 v[80:83], v7 offset:28672
ds_read_b128 v[84:87], v8 offset:28672
v_mfma_f32_16x16x32_bf16 v[40:43], a[164:167], v[88:91], v[40:43]
v_mfma_f32_16x16x32_bf16 v[44:47], a[160:163], v[92:95], v[44:47]
v_mfma_f32_16x16x32_bf16 v[48:51], a[164:167], v[92:95], v[48:51]
s_waitcnt lgkmcnt(4)
v_mfma_f32_16x16x32_bf16 v[44:47], a[168:171], v[100:103], v[44:47]
v_mfma_f32_16x16x32_bf16 v[48:51], a[172:175], v[100:103], v[48:51]
s_waitcnt lgkmcnt(2)
v_mfma_f32_16x16x32_bf16 v[44:47], a[176:179], v[76:79], v[44:47]
v_mfma_f32_16x16x32_bf16 v[48:51], a[180:183], v[76:79], v[48:51]
s_waitcnt lgkmcnt(0)
v_mfma_f32_16x16x32_bf16 v[44:47], a[184:187], v[84:87], v[44:47]
v_mfma_f32_16x16x32_bf16 v[48:51], a[188:191], v[84:87], v[48:51]
v_mfma_f32_16x16x32_bf16 v[36:39], a[168:171], v[96:99], v[36:39]
s_lshl_b32 s15, s8, 11
s_add_u32 s15, s15, 0x20000
v_mfma_f32_16x16x32_bf16 v[40:43], a[172:175], v[96:99], v[40:43]
s_xor_b32 s16, s15, 0x1000
v_add_u32 v104, s15, v1
v_mfma_f32_16x16x32_bf16 v[36:39], a[176:179], v[72:75], v[36:39]
v_add_u32 v105, s16, v1
v_mfma_f32_16x16x32_bf16 v[40:43], a[180:183], v[72:75], v[40:43]
ds_write_b128 v104, v[44:47] offset:0
ds_write_b128 v104, v[48:51] offset:1024
v_mfma_f32_16x16x32_bf16 v[36:39], a[184:187], v[80:83], v[36:39]
v_mfma_f32_16x16x32_bf16 v[40:43], a[188:191], v[80:83], v[40:43]
s_waitcnt lgkmcnt(0)
s_barrier
ds_read_b128 v[68:71], v105 offset:0
ds_read_b128 v[72:75], v105 offset:1024
buffer_load_dword v17, v4, s[4:7], s92 offen sc1
s_nop 1
v_pk_add_f32 v[20:21], v[20:21], v[36:37]
v_pk_add_f32 v[22:23], v[22:23], v[38:39]
v_pk_add_f32 v[24:25], v[24:25], v[40:41]
v_pk_add_f32 v[26:27], v[26:27], v[42:43]
s_waitcnt lgkmcnt(1)
v_pk_add_f32 v[20:21], v[20:21], v[68:69]
v_pk_add_f32 v[22:23], v[22:23], v[70:71]
s_waitcnt lgkmcnt(0)
v_pk_add_f32 v[24:25], v[24:25], v[72:73]
v_pk_add_f32 v[26:27], v[26:27], v[74:75]
s_add_u32 s15, s47, s62
s_add_u32 s15, s15, 0x0
v_cvt_pk_bf16_f32 v76, v20, v21
v_cvt_pk_bf16_f32 v77, v22, v23
v_cvt_pk_bf16_f32 v78, v24, v25
v_cvt_pk_bf16_f32 v79, v26, v27
buffer_store_dwordx4 v[76:79], v1, s[4:7], s15 offen
v_pk_add_f32 v[68:69], v[20:21], v[22:23]
v_pk_add_f32 v[70:71], v[24:25], v[26:27]
v_pk_mul_f32 v[72:73], v[20:21], v[20:21]
v_pk_add_f32 v[68:69], v[68:69], v[70:71]
v_pk_fma_f32 v[72:73], v[22:23], v[22:23], v[72:73]
v_pk_fma_f32 v[72:73], v[24:25], v[24:25], v[72:73]
v_pk_fma_f32 v[72:73], v[26:27], v[26:27], v[72:73]
v_add_f32 v68, v68, v69
v_add_f32 v72, v72, v73
s_add_u32 s16, s13, s63
s_add_u32 s16, s16, 0xd00000
v_permlane32_swap_b32 v68, v72
v_add_f32 v68, v68, v72
v_mov_b32 v72, v68
s_nop 1
v_permlane16_swap_b32 v68, v72
v_add_f32 v68, v68, v72
buffer_store_dword v68, v11, s[4:7], s16 offen
s_add_u32 s46, s32, 12
s_waitcnt vmcnt(2)
v_lshrrev_b32 v17, 3, v17
v_subrev_u32 v17, s46, v17
v_cmp_lt_u32 vcc, 31, v17
s_cbranch_vccnz L_spin_28
L_ok_27:
s_add_u32 s17, s47, s97
s_add_u32 m0, s2, 32768
s_add_u32 s29, s17, 0x9000
buffer_load_dwordx4 v1, s[4:7], s29 offen sc1 lds
buffer_load_dwordx4 v1, s[4:7], s29 offen offset:1024 sc1 lds
s_add_u32 m0, s2, 40960
s_add_u32 s29, s17, 0xa000
buffer_load_dwordx4 v1, s[4:7], s29 offen sc1 lds
buffer_load_dwordx4 v1, s[4:7], s29 offen offset:1024 sc1 lds
v_add_u32 v15, 8, v15
s_waitcnt vmcnt(4)
buffer_store_dword v15, v13, s[4:7], s45 offen
s_add_u32 m0, s2, 49152
s_add_u32 s29, s17, 0xb000
buffer_load_dwordx4 v1, s[4:7], s29 offen sc1 lds
buffer_load_dwordx4 v1, s[4:7], s29 offen offset:1024 sc1 lds
s_add_u32 m0, s2, 57344
s_add_u32 s29, s17, 0x8000
buffer_load_dwordx4 v1, s[4:7], s29 offen sc1 lds
buffer_load_dwordx4 v1, s[4:7], s29 offen offset:1024 sc1 lds
s_waitcnt vmcnt(7)
s_barrier
ds_read_b128 v[88:91], v7 offset:32768
ds_read_b128 v[92:95], v8 offset:32768
ds_read_b128 v[96:99], v7 offset:36864
ds_read_b128 v[100:103], v8 offset:36864
s_waitcnt vmcnt(5)
s_barrier
ds_read_b128 v[72:75], v7 offset:40960
ds_read_b128 v[76:79], v8 offset:40960
s_waitcnt lgkmcnt(4)
v_mfma_f32_16x16x32_bf16 v[36:39], a[144:147], v[88:91], 0
ds_read_b128 v[80:83], v7 offset:45056
ds_read_b128 v[84:87], v8 offset:45056
v_mfma_f32_16x16x32_bf16 v[40:43], a[148:151], v[88:91], 0
v_mfma_f32_16x16x32_bf16 v[44:47], a[144:147], v[92:95], 0
v_mfma_f32_16x16x32_bf16 v[48:51], a[148:151], v[92:95], 0
s_waitcnt lgkmcnt(4)
v_mfma_f32_16x16x32_bf16 v[36:39], a[152:155], v[96:99], v[36:39]
s_add_u32 s28, s26, 36864
buffer_load_dwordx4 a[144:147], v1, s[4:7], s28 offen sc1
s_waitcnt vmcnt(1)
s_barrier
v_mfma_f32_16x16x32_bf16 v[40:43], a[156:159], v[96:99], v[40:43]
ds_read_b128 v[88:91], v7 offset:49152
ds_read_b128 v[92:95], v8 offset:49152
v_mfma_f32_16x16x32_bf16 v[44:47], a[152:155], v[100:103], v[44:47]
v_mfma_f32_16x16x32_bf16 v[48:51], a[156:159], v[100:103], v[48:51]
buffer_load_dword v17, v4, s[4:7], s92 offen sc1
s_waitcnt lgkmcnt(4)
v_mfma_f32_16x16x32_bf16 v[36:39], a[160:163], v[72:75], v[36:39]
ds_read_b128 v[96:99], v7 offset:53248
ds_read_b128 v[100:103], v8 offset:53248
v_mfma_f32_16x16x32_bf16 v[40:43], a[164:167], v[72:75], v[40:43]
v_mfma_f32_16x16x32_bf16 v[44:47], a[160:163], v[76:79], v[44:47]
v_mfma_f32_16x16x32_bf16 v[48:51], a[164:167], v[76:79], v[48:51]
s_waitcnt lgkmcnt(4)
v_mfma_f32_16x16x32_bf16 v[36:39], a[168:171], v[80:83], v[36:39]
ds_read_b128 v[72:75], v7 offset:57344
ds_read_b128 v[76:79], v8 offset:57344
v_mfma_f32_16x16x32_bf16 v[40:43], a[172:175], v[80:83], v[40:43]
s_add_u32 s14, s28, s88
buffer_load_dwordx4 a[148:151], v1, s[4:7], s14 offen sc1
v_mfma_f32_16x16x32_bf16 v[44:47], a[168:171], v[84:87], v[44:47]
v_mfma_f32_16x16x32_bf16 v[48:51], a[172:175], v[84:87], v[48:51]
s_waitcnt lgkmcnt(4)
v_mfma_f32_16x16x32_bf16 v[36:39], a[176:179], v[88:91], v[36:39]
ds_read_b128 v[80:83], v7 offset:61440
ds_read_b128 v[84:87], v8 offset:61440
v_mfma_f32_16x16x32_bf16 v[40:43], a[180:183], v[88:91], v[40:43]
v_mfma_f32_16x16x32_bf16 v[44:47], a[176:179], v[92:95], v[44:47]
v_mfma_f32_16x16x32_bf16 v[48:51], a[180:183], v[92:95], v[48:51]
s_add_u32 s14, s28, s89
s_waitcnt lgkmcnt(4)
v_mfma_f32_16x16x32_bf16 v[44:47], a[184:187], v[100:103], v[44:47]
buffer_load_dwordx4 a[152:155], v1, s[4:7], s14 offen sc1
v_mfma_f32_16x16x32_bf16 v[48:51], a[188:191], v[100:103], v[48:51]
s_waitcnt lgkmcnt(2)
v_mfma_f32_16x16x32_bf16 v[44:47], a[192:195], v[76:79], v[44:47]
v_mfma_f32_16x16x32_bf16 v[48:51], a[196:199], v[76:79], v[48:51]
s_waitcnt lgkmcnt(0)
v_mfma_f32_16x16x32_bf16 v[44:47], a[200:203], v[84:87], v[44:47]
v_mfma_f32_16x16x32_bf16 v[48:51], a[204:207], v[84:87], v[48:51]
v_mfma_f32_16x16x32_bf16 v[36:39], a[184:187], v[96:99], v[36:39]
s_lshl_b32 s15, s8, 11
s_add_u32 s15, s15, 0x20000
v_mfma_f32_16x16x32_bf16 v[40:43], a[188:191], v[96:99], v[40:43]
s_xor_b32 s16, s15, 0x1000
v_add_u32 v104, s15, v1
v_mfma_f32_16x16x32_bf16 v[36:39], a[192:195], v[72:75], v[36:39]
v_add_u32 v105, s16, v1
v_mfma_f32_16x16x32_bf16 v[40:43], a[196:199], v[72:75], v[40:43]
ds_write_b128 v104, v[44:47] offset:0
ds_write_b128 v104, v[48:51] offset:1024
v_mfma_f32_16x16x32_bf16 v[36:39], a[200:203], v[80:83], v[36:39]
v_mfma_f32_16x16x32_bf16 v[40:43], a[204:207], v[80:83], v[40:43]
s_add_u32 s46, s32, 13
s_waitcnt vmcnt(2)
v_lshrrev_b32 v17, 3, v17
v_subrev_u32 v17, s46, v17
v_cmp_lt_u32 vcc, 31, v17
s_cbranch_vccnz L_spin_30
L_ok_29:
s_add_u32 s17, s47, s96
s_add_u32 m0, s3, 65536
s_add_u32 s29, s17, 0x0
buffer_load_dwordx4 v1, s[4:7], s29 offen sc1 lds
buffer_load_dwordx4 v1, s[4:7], s29 offen offset:1024 sc1 lds
s_waitcnt lgkmcnt(0)
s_barrier
ds_read_b128 v[68:71], v105 offset:0
ds_read_b128 v[72:75], v105 offset:1024
v_pk_add_f32 v[28:29], v[28:29], v[36:37]
v_pk_add_f32 v[30:31], v[30:31], v[38:39]
v_pk_add_f32 v[32:33], v[32:33], v[40:41]
v_pk_add_f32 v[34:35], v[34:35], v[42:43]
s_add_u32 s46, s13, 0xd00000
buffer_load_dwordx2 v[120:121], v14, s[4:7], s46 offen sc1
buffer_load_dwordx2 v[122:123], v14, s[4:7], s46 offen offset:256 sc1
s_add_u32 m0, s3, 73728
s_add_u32 s29, s17, 0x2000
buffer_load_dwordx4 v1, s[4:7], s29 offen sc1 lds
s_waitcnt lgkmcnt(1)
v_pk_add_f32 v[28:29], v[28:29], v[68:69]
v_pk_add_f32 v[30:31], v[30:31], v[70:71]
s_waitcnt lgkmcnt(0)
v_pk_add_f32 v[32:33], v[32:33], v[72:73]
v_pk_add_f32 v[34:35], v[34:35], v[74:75]
s_add_u32 s15, s47, s62
s_add_u32 s15, s15, 0x16000
v_cvt_pk_bf16_f32 v76, v28, v29
v_cvt_pk_bf16_f32 v77, v30, v31
v_cvt_pk_bf16_f32 v78, v32, v33
v_cvt_pk_bf16_f32 v79, v34, v35
buffer_store_dwordx4 v[76:79], v1, s[4:7], s15 offen
v_pk_add_f32 v[68:69], v[28:29], v[30:31]
v_pk_add_f32 v[70:71], v[32:33], v[34:35]
v_pk_mul_f32 v[72:73], v[28:29], v[28:29]
v_pk_add_f32 v[68:69], v[68:69], v[70:71]
v_pk_fma_f32 v[72:73], v[30:31], v[30:31], v[72:73]
v_pk_fma_f32 v[72:73], v[32:33], v[32:33], v[72:73]
v_pk_fma_f32 v[72:73], v[34:35], v[34:35], v[72:73]
v_add_f32 v68, v68, v69
v_add_f32 v72, v72, v73
s_add_u32 s16, s13, s63
s_add_u32 s16, s16, 0xd01000
v_permlane32_swap_b32 v68, v72
v_add_f32 v68, v68, v72
v_mov_b32 v72, v68
s_nop 1
v_permlane16_swap_b32 v68, v72
v_add_f32 v68, v68, v72
buffer_store_dword v68, v11, s[4:7], s16 offen
buffer_load_dwordx4 v1, s[4:7], s29 offen offset:1024 sc1 lds
s_add_u32 s46, s13, 0xd00000
buffer_load_dwordx2 v[124:125], v14, s[4:7], s46 offen offset:512 sc1
buffer_load_dwordx2 v[126:127], v14, s[4:7], s46 offen offset:768 sc1
s_waitcnt vmcnt(8)
s_barrier
ds_read_b128 v[88:91], v2 offset:0
ds_read_b128 v[92:95], v2 offset:1024
ds_read_b128 v[96:99], v2 offset:2048
ds_read_b128 v[100:103], v2 offset:3072
ds_read_b128 v[72:75], v2 offset:4096
ds_read_b128 v[76:79], v2 offset:5120
s_add_u32 m0, s3, 81920
s_add_u32 s29, s17, 0x4000
buffer_load_dwordx4 v1, s[4:7], s29 offen sc1 lds
buffer_load_dwordx4 v1, s[4:7], s29 offen offset:1024 sc1 lds
s_waitcnt lgkmcnt(4)
v_mfma_f32_16x16x32_bf16 v[36:39], a[208:211], v[88:91], 0
ds_read_b128 v[80:83], v2 offset:6144
ds_read_b128 v[84:87], v2 offset:7168
v_mfma_f32_16x16x32_bf16 v[44:47], a[212:215], v[88:91], 0
v_mfma_f32_16x16x32_bf16 v[52:55], a[216:219], v[88:91], 0
s_add_u32 m0, s3, 90112
s_add_u32 s29, s17, 0x6000
v_mfma_f32_16x16x32_bf16 v[40:43], a[208:211], v[92:95], 0
buffer_load_dwordx4 v1, s[4:7], s29 offen sc1 lds
v_mfma_f32_16x16x32_bf16 v[48:51], a[212:215], v[92:95], 0
v_mfma_f32_16x16x32_bf16 v[56:59], a[216:219], v[92:95], 0
s_waitcnt lgkmcnt(4)
v_mfma_f32_16x16x32_bf16 v[36:39], a[220:223], v[96:99], v[36:39]
s_waitcnt vmcnt(5)
s_barrier
v_mfma_f32_16x16x32_bf16 v[44:47], a[224:227], v[96:99], v[44:47]
ds_read_b128 v[88:91], v2 offset:8192
ds_read_b128 v[92:95], v2 offset:9216
v_mfma_f32_16x16x32_bf16 v[52:55], a[228:231], v[96:99], v[52:55]
buffer_load_dwordx4 v1, s[4:7], s29 offen offset:1024 sc1 lds
v_mfma_f32_16x16x32_bf16 v[40:43], a[220:223], v[100:103], v[40:43]
v_mfma_f32_16x16x32_bf16 v[48:51], a[224:227], v[100:103], v[48:51]
v_mfma_f32_16x16x32_bf16 v[56:59], a[228:231], v[100:103], v[56:59]
s_waitcnt lgkmcnt(4)
v_mfma_f32_16x16x32_bf16 v[36:39], a[232:235], v[72:75], v[36:39]
ds_read_b128 v[96:99], v2 offset:10240
ds_read_b128 v[100:103], v2 offset:11264
v_mfma_f32_16x16x32_bf16 v[44:47], a[236:239], v[72:75], v[44:47]
s_add_u32 s28, s26, 39936
buffer_load_dwordx4 a[156:159], v1, s[4:7], s28 offen sc1
v_mfma_f32_16x16x32_bf16 v[52:55], a[240:243], v[72:75], v[52:55]
v_mfma_f32_16x16x32_bf16 v[40:43], a[232:235], v[76:79], v[40:43]
s_add_u32 s14, s28, s88
buffer_load_dwordx4 a[160:163], v1, s[4:7], s14 offen sc1
v_mfma_f32_16x16x32_bf16 v[48:51], a[236:239], v[76:79], v[48:51]
v_mfma_f32_16x16x32_bf16 v[56:59], a[240:243], v[76:79], v[56:59]
s_add_u32 s14, s28, s89
s_waitcnt lgkmcnt(4)
v_mfma_f32_16x16x32_bf16 v[36:39], a[244:247], v[80:83], v[36:39]
ds_read_b128 v[72:75], v2 offset:12288
ds_read_b128 v[76:79], v2 offset:13312
v_mfma_f32_16x16x32_bf16 v[44:47], a[248:251], v[80:83], v[44:47]
buffer_load_dwordx4 a[164:167], v1, s[4:7], s14 offen sc1
v_mfma_f32_16x16x32_bf16 v[52:55], a[252:255], v[80:83], v[52:55]
v_mfma_f32_16x16x32_bf16 v[40:43], a[244:247], v[84:87], v[40:43]
s_add_u32 s28, s26, 43008
buffer_load_dwordx4 a[168:171], v1, s[4:7], s28 offen sc1
v_mfma_f32_16x16x32_bf16 v[48:51], a[248:251], v[84:87], v[48:51]
v_mfma_f32_16x16x32_bf16 v[56:59], a[252:255], v[84:87], v[56:59]
s_add_u32 s14, s28, s88
s_waitcnt lgkmcnt(4)
v_mfma_f32_16x16x32_bf16 v[36:39], v[128:131], v[88:91], v[36:39]
ds_read_b128 v[80:83], v2 offset:14336
ds_read_b128 v[84:87], v2 offset:15360
v_mfma_f32_16x16x32_bf16 v[44:47], v[132:135], v[88:91], v[44:47]
buffer_load_dwordx4 a[172:175], v1, s[4:7], s14 offen sc1
s_waitcnt vmcnt(9)
v_mfma_f32_16x16x32_bf16 v[52:55], v[136:139], v[88:91], v[52:55]
v_add_f32 v120, v120, v122
v_add_f32 v124, v124, v126
v_mfma_f32_16x16x32_bf16 v[40:43], v[128:131], v[92:95], v[40:43]
s_add_u32 s14, s28, s89
buffer_load_dwordx4 a[176:179], v1, s[4:7], s14 offen sc1
v_mfma_f32_16x16x32_bf16 v[48:51], v[132:135], v[92:95], v[48:51]
v_add_f32 v121, v121, v123
v_add_f32 v125, v125, v127
v_mfma_f32_16x16x32_bf16 v[56:59], v[136:139], v[92:95], v[56:59]
s_add_u32 s28, s26, 46080
s_waitcnt lgkmcnt(4)
v_mfma_f32_16x16x32_bf16 v[36:39], v[140:143], v[96:99], v[36:39]
buffer_load_dwordx4 a[180:183], v1, s[4:7], s28 offen sc1
v_add_f32 v120, v120, v124
v_add_f32 v121, v121, v125
v_add_u32 v122, s52, v5
s_nop 0
v_permlane32_swap_b32 v120, v121
v_add_f32 v120, v120, v121
s_add_u32 s14, s28, s88
buffer_load_dwordx4 a[184:187], v1, s[4:7], s14 offen sc1
v_mov_b32 v121, v120
s_nop 1
v_permlane16_swap_b32 v120, v121
v_add_f32 v120, v120, v121
v_mov_b32 v121, v120
s_nop 1
v_permlane32_swap_b32 v120, v121
v_mul_f32 v120, 0x3b000000, v120
s_add_u32 s14, s28, s89
buffer_load_dwordx4 a[188:191], v1, s[4:7], s14 offen sc1
v_mul_f32 v121, 0x3b000000, v121
v_fma_f32 v121, -v120, v120, v121
v_max_f32 v121, 0, v121
v_add_f32 v121, 0x3727c5ac, v121
v_rsq_f32 v121, v121
v_sub_f32 v120, 0, v120
v_mul_f32 v120, v120, v121
ds_write_b32 v122, v121 offset:192
ds_write_b32 v122, v120 offset:512
s_waitcnt vmcnt(9) lgkmcnt(0)
s_barrier
v_mfma_f32_16x16x32_bf16 v[44:47], v[144:147], v[96:99], v[44:47]
ds_read_b128 v[88:91], v2 offset:16384
ds_read_b128 v[92:95], v2 offset:17408
v_mfma_f32_16x16x32_bf16 v[52:55], v[148:151], v[96:99], v[52:55]
v_mfma_f32_16x16x32_bf16 v[40:43], v[140:143], v[100:103], v[40:43]
v_mfma_f32_16x16x32_bf16 v[48:51], v[144:147], v[100:103], v[48:51]
v_mfma_f32_16x16x32_bf16 v[56:59], v[148:151], v[100:103], v[56:59]
v_mfma_f32_16x16x32_bf16 v[36:39], v[152:155], v[72:75], v[36:39]
ds_read_b128 v[96:99], v2 offset:18432
ds_read_b128 v[100:103], v2 offset:19456
v_mfma_f32_16x16x32_bf16 v[44:47], v[156:159], v[72:75], v[44:47]
v_add_u32 v15, 8, v15
buffer_store_dword v15, v13, s[4:7], s45 offen
v_mfma_f32_16x16x32_bf16 v[52:55], v[160:163], v[72:75], v[52:55]
v_mfma_f32_16x16x32_bf16 v[40:43], v[152:155], v[76:79], v[40:43]
v_mfma_f32_16x16x32_bf16 v[48:51], v[156:159], v[76:79], v[48:51]
v_mfma_f32_16x16x32_bf16 v[56:59], v[160:163], v[76:79], v[56:59]
v_mfma_f32_16x16x32_bf16 v[36:39], v[164:167], v[80:83], v[36:39]
ds_read_b128 v[72:75], v2 offset:20480
ds_read_b128 v[76:79], v2 offset:21504
v_mfma_f32_16x16x32_bf16 v[44:47], v[168:171], v[80:83], v[44:47]
v_mfma_f32_16x16x32_bf16 v[52:55], v[172:175], v[80:83], v[52:55]
v_mfma_f32_16x16x32_bf16 v[40:43], v[164:167], v[84:87], v[40:43]
v_mfma_f32_16x16x32_bf16 v[48:51], v[168:171], v[84:87], v[48:51]
v_mfma_f32_16x16x32_bf16 v[56:59], v[172:175], v[84:87], v[56:59]
s_waitcnt lgkmcnt(4)
v_mfma_f32_16x16x32_bf16 v[36:39], a[96:99], v[88:91], v[36:39]
ds_read_b128 v[80:83], v2 offset:22528
ds_read_b128 v[84:87], v2 offset:23552
v_mfma_f32_16x16x32_bf16 v[44:47], a[100:103], v[88:91], v[44:47]
v_mfma_f32_16x16x32_bf16 v[52:55], a[104:107], v[88:91], v[52:55]
v_mfma_f32_16x16x32_bf16 v[40:43], a[96:99], v[92:95], v[40:43]
v_mfma_f32_16x16x32_bf16 v[48:51], a[100:103], v[92:95], v[48:51]
v_mfma_f32_16x16x32_bf16 v[56:59], a[104:107], v[92:95], v[56:59]
s_waitcnt lgkmcnt(4)
v_mfma_f32_16x16x32_bf16 v[36:39], a[108:111], v[96:99], v[36:39]
ds_read_b128 v[88:91], v2 offset:24576
ds_read_b128 v[92:95], v2 offset:25600
v_mfma_f32_16x16x32_bf16 v[44:47], a[112:115], v[96:99], v[44:47]
v_mfma_f32_16x16x32_bf16 v[52:55], a[116:119], v[96:99], v[52:55]
v_mfma_f32_16x16x32_bf16 v[40:43], a[108:111], v[100:103], v[40:43]
v_mfma_f32_16x16x32_bf16 v[48:51], a[112:115], v[100:103], v[48:51]
v_mfma_f32_16x16x32_bf16 v[56:59], a[116:119], v[100:103], v[56:59]
s_waitcnt lgkmcnt(4)
v_mfma_f32_16x16x32_bf16 v[36:39], a[120:123], v[72:75], v[36:39]
ds_read_b128 v[96:99], v2 offset:26624
ds_read_b128 v[100:103], v2 offset:27648
v_mfma_f32_16x16x32_bf16 v[44:47], a[124:127], v[72:75], v[44:47]
v_mfma_f32_16x16x32_bf16 v[52:55], a[128:131], v[72:75], v[52:55]
v_mfma_f32_16x16x32_bf16 v[40:43], a[120:123], v[76:79], v[40:43]
v_mfma_f32_16x16x32_bf16 v[48:51], a[124:127], v[76:79], v[48:51]
v_mfma_f32_16x16x32_bf16 v[56:59], a[128:131], v[76:79], v[56:59]
s_waitcnt lgkmcnt(4)
v_mfma_f32_16x16x32_bf16 v[36:39], a[132:135], v[80:83], v[36:39]
ds_read_b128 v[72:75], v2 offset:28672
ds_read_b128 v[76:79], v2 offset:29696
v_mfma_f32_16x16x32_bf16 v[44:47], a[136:139], v[80:83], v[44:47]
buffer_load_dword v17, v4, s[4:7], s92 offen sc1
v_mfma_f32_16x16x32_bf16 v[52:55], a[140:143], v[80:83], v[52:55]
v_mfma_f32_16x16x32_bf16 v[40:43], a[132:135], v[84:87], v[40:43]
v_mfma_f32_16x16x32_bf16 v[48:51], a[136:139], v[84:87], v[48:51]
v_mfma_f32_16x16x32_bf16 v[56:59], a[140:143], v[84:87], v[56:59]
s_waitcnt lgkmcnt(4)
v_mfma_f32_16x16x32_bf16 v[36:39], a[144:147], v[88:91], v[36:39]
ds_read_b128 v[80:83], v2 offset:30720
ds_read_b128 v[84:87], v2 offset:31744
v_mfma_f32_16x16x32_bf16 v[44:47], a[148:151], v[88:91], v[44:47]
v_mfma_f32_16x16x32_bf16 v[52:55], a[152:155], v[88:91], v[52:55]
v_mfma_f32_16x16x32_bf16 v[40:43], a[144:147], v[92:95], v[40:43]
v_mfma_f32_16x16x32_bf16 v[48:51], a[148:151], v[92:95], v[48:51]
v_mfma_f32_16x16x32_bf16 v[56:59], a[152:155], v[92:95], v[56:59]
s_waitcnt vmcnt(8) lgkmcnt(4)
v_mfma_f32_16x16x32_bf16 v[36:39], a[156:159], v[96:99], v[36:39]
v_mfma_f32_16x16x32_bf16 v[44:47], a[160:163], v[96:99], v[44:47]
v_mfma_f32_16x16x32_bf16 v[52:55], a[164:167], v[96:99], v[52:55]
v_mfma_f32_16x16x32_bf16 v[40:43], a[156:159], v[100:103], v[40:43]
v_mfma_f32_16x16x32_bf16 v[48:51], a[160:163], v[100:103], v[48:51]
v_mfma_f32_16x16x32_bf16 v[56:59], a[164:167], v[100:103], v[56:59]
s_waitcnt vmcnt(5) lgkmcnt(2)
v_mfma_f32_16x16x32_bf16 v[36:39], a[168:171], v[72:75], v[36:39]
v_mov_b32 v116, s36
v_mov_b32 v117, s37
v_mfma_f32_16x16x32_bf16 v[44:47], a[172:175], v[72:75], v[44:47]
ds_read2_b32 v[68:69], v5 offset0:48 offset1:128
ds_read2_b32 v[70:71], v5 offset0:64 offset1:144
v_mfma_f32_16x16x32_bf16 v[52:55], a[176:179], v[72:75], v[52:55]
ds_read_b128 v[104:107], v6 offset:256
ds_read_b128 v[88:91], v6 offset:512
v_mfma_f32_16x16x32_bf16 v[40:43], a[168:171], v[76:79], v[40:43]
ds_read_b128 v[108:111], v6 offset:320
ds_read_b128 v[92:95], v6 offset:576
v_mfma_f32_16x16x32_bf16 v[48:51], a[172:175], v[76:79], v[48:51]
ds_read_b128 v[112:115], v6 offset:384
ds_read_b128 v[96:99], v6 offset:640
v_mfma_f32_16x16x32_bf16 v[56:59], a[176:179], v[76:79], v[56:59]
s_waitcnt vmcnt(2) lgkmcnt(8)
v_mfma_f32_16x16x32_bf16 v[36:39], a[180:183], v[80:83], v[36:39]
s_add_u32 s44, s32, 14
s_waitcnt vmcnt(0)
v_lshrrev_b32 v17, 3, v17
v_mfma_f32_16x16x32_bf16 v[44:47], a[184:187], v[80:83], v[44:47]
v_subrev_u32 v17, s44, v17
v_cmp_lt_u32 vcc, 31, v17
s_cbranch_vccnz L_spin_32
L_ok_31:
s_add_u32 s17, s47, s96
v_mfma_f32_16x16x32_bf16 v[52:55], a[188:191], v[80:83], v[52:55]
s_add_u32 m0, s3, 98304
s_add_u32 s29, s17, 0x16000
v_mfma_f32_16x16x32_bf16 v[40:43], a[180:183], v[84:87], v[40:43]
buffer_load_dwordx4 v1, s[4:7], s29 offen sc1 lds
v_mfma_f32_16x16x32_bf16 v[48:51], a[184:187], v[84:87], v[48:51]
v_mfma_f32_16x16x32_bf16 v[56:59], a[188:191], v[84:87], v[56:59]
s_waitcnt lgkmcnt(0)
v_pk_mul_f32 v[68:69], v[68:69], v[116:117] op_sel:[0,1] op_sel_hi:[1,1]
v_pk_mul_f32 v[70:71], v[70:71], v[116:117] op_sel:[0,1] op_sel_hi:[1,1]
v_pk_fma_f32 v[72:73], v[104:105], v[68:69], v[88:89] op_sel:[0,1,0] op_sel_hi:[1,1,1]
buffer_load_dwordx4 v1, s[4:7], s29 offen offset:1024 sc1 lds
v_pk_fma_f32 v[74:75], v[106:107], v[68:69], v[90:91] op_sel:[0,1,0] op_sel_hi:[1,1,1]
v_pk_fma_f32 v[76:77], v[104:105], v[70:71], v[88:89] op_sel:[0,1,0] op_sel_hi:[1,1,1]
v_pk_fma_f32 v[78:79], v[106:107], v[70:71], v[90:91] op_sel:[0,1,0] op_sel_hi:[1,1,1]
v_pk_fma_f32 v[36:37], v[36:37], v[68:69], v[72:73] op_sel_hi:[1,0,1]
v_pk_fma_f32 v[38:39], v[38:39], v[68:69], v[74:75] op_sel_hi:[1,0,1]
v_pk_fma_f32 v[40:41], v[40:41], v[70:71], v[76:77] op_sel_hi:[1,0,1]
v_pk_fma_f32 v[42:43], v[42:43], v[70:71], v[78:79] op_sel_hi:[1,0,1]
v_pk_fma_f32 v[72:73], v[36:37], v[36:37], v[116:117] op_sel_hi:[1,1,0]
v_pk_fma_f32 v[74:75], v[38:39], v[38:39], v[116:117] op_sel_hi:[1,1,0]
s_add_u32 m0, s3, 106496
s_add_u32 s29, s17, 0x18000
buffer_load_dwordx4 v1, s[4:7], s29 offen sc1 lds
v_pk_fma_f32 v[76:77], v[40:41], v[40:41], v[116:117] op_sel_hi:[1,1,0]
v_pk_fma_f32 v[78:79], v[42:43], v[42:43], v[116:117] op_sel_hi:[1,1,0]
v_pk_mul_f32 v[72:73], v[72:73], v[36:37] neg_lo:[0,1] neg_hi:[0,1]
v_pk_mul_f32 v[74:75], v[74:75], v[38:39] neg_lo:[0,1] neg_hi:[0,1]
v_pk_mul_f32 v[76:77], v[76:77], v[40:41] neg_lo:[0,1] neg_hi:[0,1]
v_pk_mul_f32 v[78:79], v[78:79], v[42:43] neg_lo:[0,1] neg_hi:[0,1]
v_exp_f32 v80, v72
v_exp_f32 v81, v73
buffer_load_dwordx4 v1, s[4:7], s29 offen offset:1024 sc1 lds
v_exp_f32 v82, v74
v_exp_f32 v83, v75
v_exp_f32 v84, v76
v_exp_f32 v85, v77
v_exp_f32 v86, v78
s_add_u32 m0, s3, 114688
s_add_u32 s29, s17, 0x1a000
buffer_load_dwordx4 v1, s[4:7], s29 offen sc1 lds
v_exp_f32 v87, v79
v_pk_fma_f32 v[80:81], v[80:81], v[116:117], v[116:117] op_sel:[0,1,1] op_sel_hi:[1,1,1]
v_pk_fma_f32 v[82:83], v[82:83], v[116:117], v[116:117] op_sel:[0,1,1] op_sel_hi:[1,1,1]
v_pk_fma_f32 v[84:85], v[84:85], v[116:117], v[116:117] op_sel:[0,1,1] op_sel_hi:[1,1,1]
v_pk_fma_f32 v[86:87], v[86:87], v[116:117], v[116:117] op_sel:[0,1,1] op_sel_hi:[1,1,1]
v_rcp_f32 v80, v80
v_rcp_f32 v81, v81
buffer_load_dwordx4 v1, s[4:7], s29 offen offset:1024 sc1 lds
v_rcp_f32 v82, v82
v_rcp_f32 v83, v83
v_rcp_f32 v84, v84
v_rcp_f32 v85, v85
v_rcp_f32 v86, v86
s_add_u32 m0, s3, 122880
s_add_u32 s29, s17, 0x1c000
buffer_load_dwordx4 v1, s[4:7], s29 offen sc1 lds
v_rcp_f32 v87, v87
s_add_u32 s15, s40, s12
v_pk_mul_f32 v[36:37], v[36:37], v[80:81]
v_pk_mul_f32 v[38:39], v[38:39], v[82:83]
v_pk_mul_f32 v[40:41], v[40:41], v[84:85]
v_pk_mul_f32 v[42:43], v[42:43], v[86:87]
v_cvt_pk_bf16_f32 v36, v36, v37
v_cvt_pk_bf16_f32 v37, v38, v39
v_cvt_pk_bf16_f32 v38, v40, v41
buffer_load_dwordx4 v1, s[4:7], s29 offen offset:1024 sc1 lds
v_cvt_pk_bf16_f32 v39, v42, v43
v_permlane32_swap_b32 v36, v38
s_nop 0
v_permlane32_swap_b32 v37, v39
buffer_store_dwordx4 v[36:39], v3, s[4:7], s15 offen
v_pk_fma_f32 v[72:73], v[108:109], v[68:69], v[92:93] op_sel:[0,1,0] op_sel_hi:[1,1,1]
v_pk_fma_f32 v[74:75], v[110:111], v[68:69], v[94:95] op_sel:[0,1,0] op_sel_hi:[1,1,1]
v_pk_fma_f32 v[76:77], v[108:109], v[70:71], v[92:93] op_sel:[0,1,0] op_sel_hi:[1,1,1]
v_pk_fma_f32 v[78:79], v[110:111], v[70:71], v[94:95] op_sel:[0,1,0] op_sel_hi:[1,1,1]
v_pk_fma_f32 v[44:45], v[44:45], v[68:69], v[72:73] op_sel_hi:[1,0,1]
v_pk_fma_f32 v[46:47], v[46:47], v[68:69], v[74:75] op_sel_hi:[1,0,1]
v_pk_fma_f32 v[48:49], v[48:49], v[70:71], v[76:77] op_sel_hi:[1,0,1]
v_pk_fma_f32 v[50:51], v[50:51], v[70:71], v[78:79] op_sel_hi:[1,0,1]
v_pk_fma_f32 v[72:73], v[44:45], v[44:45], v[116:117] op_sel_hi:[1,1,0]
s_add_u32 s46, s13, 0xd01000
buffer_load_dwordx2 v[120:121], v14, s[4:7], s46 offen sc1
buffer_load_dwordx2 v[122:123], v14, s[4:7], s46 offen offset:256 sc1
v_pk_fma_f32 v[74:75], v[46:47], v[46:47], v[116:117] op_sel_hi:[1,1,0]
v_pk_fma_f32 v[76:77], v[48:49], v[48:49], v[116:117] op_sel_hi:[1,1,0]
v_pk_fma_f32 v[78:79], v[50:51], v[50:51], v[116:117] op_sel_hi:[1,1,0]
v_pk_mul_f32 v[72:73], v[72:73], v[44:45] neg_lo:[0,1] neg_hi:[0,1]
v_pk_mul_f32 v[74:75], v[74:75], v[46:47] neg_lo:[0,1] neg_hi:[0,1]
v_pk_mul_f32 v[76:77], v[76:77], v[48:49] neg_lo:[0,1] neg_hi:[0,1]
v_pk_mul_f32 v[78:79], v[78:79], v[50:51] neg_lo:[0,1] neg_hi:[0,1]
v_exp_f32 v80, v72
s_add_u32 s46, s13, 0xd01000
buffer_load_dwordx2 v[124:125], v14, s[4:7], s46 offen offset:512 sc1
buffer_load_dwordx2 v[126:127], v14, s[4:7], s46 offen offset:768 sc1
v_exp_f32 v81, v73
v_exp_f32 v82, v74
v_exp_f32 v83, v75
v_exp_f32 v84, v76
v_exp_f32 v85, v77
v_exp_f32 v86, v78
v_exp_f32 v87, v79
v_pk_fma_f32 v[80:81], v[80:81], v[116:117], v[116:117] op_sel:[0,1,1] op_sel_hi:[1,1,1]
v_pk_fma_f32 v[82:83], v[82:83], v[116:117], v[116:117] op_sel:[0,1,1] op_sel_hi:[1,1,1]
v_pk_fma_f32 v[84:85], v[84:85], v[116:117], v[116:117] op_sel:[0,1,1] op_sel_hi:[1,1,1]
v_pk_fma_f32 v[86:87], v[86:87], v[116:117], v[116:117] op_sel:[0,1,1] op_sel_hi:[1,1,1]
v_rcp_f32 v80, v80
v_rcp_f32 v81, v81
v_rcp_f32 v82, v82
v_rcp_f32 v83, v83
v_rcp_f32 v84, v84
v_rcp_f32 v85, v85
v_rcp_f32 v86, v86
v_rcp_f32 v87, v87
s_add_u32 s15, s41, s12
v_pk_mul_f32 v[44:45], v[44:45], v[80:81]
v_pk_mul_f32 v[46:47], v[46:47], v[82:83]
v_pk_mul_f32 v[48:49], v[48:49], v[84:85]
v_pk_mul_f32 v[50:51], v[50:51], v[86:87]
v_cvt_pk_bf16_f32 v44, v44, v45
v_cvt_pk_bf16_f32 v45, v46, v47
v_cvt_pk_bf16_f32 v46, v48, v49
v_cvt_pk_bf16_f32 v47, v50, v51
s_nop 0
v_permlane32_swap_b32 v44, v46
v_permlane32_swap_b32 v45, v47
buffer_store_dwordx4 v[44:47], v3, s[4:7], s15 offen
v_pk_fma_f32 v[72:73], v[112:113], v[68:69], v[96:97] op_sel:[0,1,0] op_sel_hi:[1,1,1]
v_pk_fma_f32 v[74:75], v[114:115], v[68:69], v[98:99] op_sel:[0,1,0] op_sel_hi:[1,1,1]
v_pk_fma_f32 v[76:77], v[112:113], v[70:71], v[96:97] op_sel:[0,1,0] op_sel_hi:[1,1,1]
v_pk_fma_f32 v[78:79], v[114:115], v[70:71], v[98:99] op_sel:[0,1,0] op_sel_hi:[1,1,1]
v_pk_fma_f32 v[52:53], v[52:53], v[68:69], v[72:73] op_sel_hi:[1,0,1]
v_pk_fma_f32 v[54:55], v[54:55], v[68:69], v[74:75] op_sel_hi:[1,0,1]
v_pk_fma_f32 v[56:57], v[56:57], v[70:71], v[76:77] op_sel_hi:[1,0,1]
v_pk_fma_f32 v[58:59], v[58:59], v[70:71], v[78:79] op_sel_hi:[1,0,1]
v_pk_fma_f32 v[72:73], v[52:53], v[52:53], v[116:117] op_sel_hi:[1,1,0]
v_pk_fma_f32 v[74:75], v[54:55], v[54:55], v[116:117] op_sel_hi:[1,1,0]
v_pk_fma_f32 v[76:77], v[56:57], v[56:57], v[116:117] op_sel_hi:[1,1,0]
v_pk_fma_f32 v[78:79], v[58:59], v[58:59], v[116:117] op_sel_hi:[1,1,0]
v_pk_mul_f32 v[72:73], v[72:73], v[52:53] neg_lo:[0,1] neg_hi:[0,1]
v_pk_mul_f32 v[74:75], v[74:75], v[54:55] neg_lo:[0,1] neg_hi:[0,1]
v_pk_mul_f32 v[76:77], v[76:77], v[56:57] neg_lo:[0,1] neg_hi:[0,1]
v_pk_mul_f32 v[78:79], v[78:79], v[58:59] neg_lo:[0,1] neg_hi:[0,1]
v_exp_f32 v80, v72
v_exp_f32 v81, v73
v_exp_f32 v82, v74
v_exp_f32 v83, v75
v_exp_f32 v84, v76
v_exp_f32 v85, v77
v_exp_f32 v86, v78
v_exp_f32 v87, v79
v_pk_fma_f32 v[80:81], v[80:81], v[116:117], v[116:117] op_sel:[0,1,1] op_sel_hi:[1,1,1]
v_pk_fma_f32 v[82:83], v[82:83], v[116:117], v[116:117] op_sel:[0,1,1] op_sel_hi:[1,1,1]
v_pk_fma_f32 v[84:85], v[84:85], v[116:117], v[116:117] op_sel:[0,1,1] op_sel_hi:[1,1,1]
v_pk_fma_f32 v[86:87], v[86:87], v[116:117], v[116:117] op_sel:[0,1,1] op_sel_hi:[1,1,1]
s_waitcnt vmcnt(6)
s_barrier
ds_read_b128 v[88:91], v2 offset:49152
ds_read_b128 v[92:95], v2 offset:50176
ds_read_b128 v[96:99], v2 offset:51200
ds_read_b128 v[100:103], v2 offset:52224
v_rcp_f32 v80, v80
v_rcp_f32 v81, v81
v_rcp_f32 v82, v82
v_rcp_f32 v83, v83
v_rcp_f32 v84, v84
v_rcp_f32 v85, v85
v_rcp_f32 v86, v86
v_rcp_f32 v87, v87
s_add_u32 s15, s42, s12
v_pk_mul_f32 v[52:53], v[52:53], v[80:81]
v_pk_mul_f32 v[54:55], v[54:55], v[82:83]
v_pk_mul_f32 v[56:57], v[56:57], v[84:85]
v_pk_mul_f32 v[58:59], v[58:59], v[86:87]
v_cvt_pk_bf16_f32 v52, v52, v53
v_cvt_pk_bf16_f32 v53, v54, v55
v_cvt_pk_bf16_f32 v54, v56, v57
v_cvt_pk_bf16_f32 v55, v58, v59
s_nop 0
v_permlane32_swap_b32 v52, v54
v_permlane32_swap_b32 v53, v55
buffer_store_dwordx4 v[52:55], v3, s[4:7], s15 offen
ds_read_b128 v[72:75], v2 offset:53248
ds_read_b128 v[76:79], v2 offset:54272
s_waitcnt lgkmcnt(4)
v_mfma_f32_16x16x32_bf16 v[36:39], a[96:99], v[88:91], 0
ds_read_b128 v[80:83], v2 offset:55296
ds_read_b128 v[84:87], v2 offset:56320
v_mfma_f32_16x16x32_bf16 v[44:47], a[100:103], v[88:91], 0
v_mfma_f32_16x16x32_bf16 v[52:55], a[104:107], v[88:91], 0
v_mfma_f32_16x16x32_bf16 v[40:43], a[96:99], v[92:95], 0
v_mfma_f32_16x16x32_bf16 v[48:51], a[100:103], v[92:95], 0
v_mfma_f32_16x16x32_bf16 v[56:59], a[104:107], v[92:95], 0
s_waitcnt lgkmcnt(4)
v_mfma_f32_16x16x32_bf16 v[36:39], a[108:111], v[96:99], v[36:39]
ds_read_b128 v[88:91], v2 offset:57344
ds_read_b128 v[92:95], v2 offset:58368
v_mfma_f32_16x16x32_bf16 v[44:47], a[112:115], v[96:99], v[44:47]
s_add_u32 s28, s27, 20480
buffer_load_dwordx4 a[96:99], v1, s[4:7], s28 offen sc1
v_mfma_f32_16x16x32_bf16 v[52:55], a[116:119], v[96:99], v[52:55]
v_add_u32 v15, 8, v15
buffer_load_dwordx4 a[100:103], v1, s[4:7], s28 offen offset:1024 sc1
buffer_load_dwordx4 a[104:107], v1, s[4:7], s28 offen offset:2048 sc1
s_waitcnt vmcnt(3)
v_mfma_f32_16x16x32_bf16 v[40:43], a[108:111], v[100:103], v[40:43]
buffer_store_dword v15, v13, s[4:7], s45 offen
v_mfma_f32_16x16x32_bf16 v[48:51], a[112:115], v[100:103], v[48:51]
v_mfma_f32_16x16x32_bf16 v[56:59], a[116:119], v[100:103], v[56:59]
s_waitcnt lgkmcnt(4)
v_mfma_f32_16x16x32_bf16 v[36:39], a[120:123], v[72:75], v[36:39]
ds_read_b128 v[96:99], v2 offset:59392
ds_read_b128 v[100:103], v2 offset:60416
v_mfma_f32_16x16x32_bf16 v[44:47], a[124:127], v[72:75], v[44:47]
buffer_load_dwordx4 a[108:111], v1, s[4:7], s28 offen offset:3072 sc1
v_mfma_f32_16x16x32_bf16 v[52:55], a[128:131], v[72:75], v[52:55]
v_mfma_f32_16x16x32_bf16 v[40:43], a[120:123], v[76:79], v[40:43]
v_mfma_f32_16x16x32_bf16 v[48:51], a[124:127], v[76:79], v[48:51]
v_mfma_f32_16x16x32_bf16 v[56:59], a[128:131], v[76:79], v[56:59]
s_add_u32 s28, s27, 24576
s_waitcnt lgkmcnt(4)
v_mfma_f32_16x16x32_bf16 v[36:39], a[132:135], v[80:83], v[36:39]
ds_read_b128 v[72:75], v2 offset:61440
ds_read_b128 v[76:79], v2 offset:62464
v_mfma_f32_16x16x32_bf16 v[44:47], a[136:139], v[80:83], v[44:47]
buffer_load_dwordx4 a[112:115], v1, s[4:7], s28 offen sc1
v_mfma_f32_16x16x32_bf16 v[52:55], a[140:143], v[80:83], v[52:55]
v_mfma_f32_16x16x32_bf16 v[40:43], a[132:135], v[84:87], v[40:43]
v_mfma_f32_16x16x32_bf16 v[48:51], a[136:139], v[84:87], v[48:51]
v_mfma_f32_16x16x32_bf16 v[56:59], a[140:143], v[84:87], v[56:59]
buffer_load_dwordx4 a[116:119], v1, s[4:7], s28 offen offset:1024 sc1
s_waitcnt lgkmcnt(4)
v_mfma_f32_16x16x32_bf16 v[36:39], a[144:147], v[88:91], v[36:39]
ds_read_b128 v[80:83], v2 offset:63488
ds_read_b128 v[84:87], v2 offset:64512
v_mfma_f32_16x16x32_bf16 v[44:47], a[148:151], v[88:91], v[44:47]
v_mfma_f32_16x16x32_bf16 v[52:55], a[152:155], v[88:91], v[52:55]
v_mfma_f32_16x16x32_bf16 v[40:43], a[144:147], v[92:95], v[40:43]
buffer_load_dwordx4 a[120:123], v1, s[4:7], s28 offen offset:2048 sc1
v_mfma_f32_16x16x32_bf16 v[48:51], a[148:151], v[92:95], v[48:51]
v_mfma_f32_16x16x32_bf16 v[56:59], a[152:155], v[92:95], v[56:59]
s_waitcnt lgkmcnt(4)
v_mfma_f32_16x16x32_bf16 v[36:39], a[156:159], v[96:99], v[36:39]
ds_read_b128 v[88:91], v2 offset:32768
ds_read_b128 v[92:95], v2 offset:33792
v_mfma_f32_16x16x32_bf16 v[44:47], a[160:163], v[96:99], v[44:47]
buffer_load_dwordx4 a[124:127], v1, s[4:7], s28 offen offset:3072 sc1
v_add_f32 v120, v120, v122
v_mfma_f32_16x16x32_bf16 v[52:55], a[164:167], v[96:99], v[52:55]
v_add_f32 v124, v124, v126
v_add_f32 v121, v121, v123
v_mfma_f32_16x16x32_bf16 v[40:43], a[156:159], v[100:103], v[40:43]
v_add_f32 v125, v125, v127
v_add_f32 v120, v120, v124
v_mfma_f32_16x16x32_bf16 v[48:51], a[160:163], v[100:103], v[48:51]
v_add_f32 v121, v121, v125
v_add_u32 v122, s52, v5
v_mfma_f32_16x16x32_bf16 v[56:59], a[164:167], v[100:103], v[56:59]
s_add_u32 s28, s27, 28672
s_waitcnt lgkmcnt(4)
v_mfma_f32_16x16x32_bf16 v[36:39], a[168:171], v[72:75], v[36:39]
ds_read_b128 v[96:99], v2 offset:34816
ds_read_b128 v[100:103], v2 offset:35840
v_mfma_f32_16x16x32_bf16 v[44:47], a[172:175], v[72:75], v[44:47]
buffer_load_dwordx4 a[128:131], v1, s[4:7], s28 offen sc1
s_nop 0
v_mfma_f32_16x16x32_bf16 v[52:55], a[176:179], v[72:75], v[52:55]
v_permlane32_swap_b32 v120, v121
v_mfma_f32_16x16x32_bf16 v[40:43], a[168:171], v[76:79], v[40:43]
v_add_f32 v120, v120, v121
v_mov_b32 v121, v120
v_mfma_f32_16x16x32_bf16 v[48:51], a[172:175], v[76:79], v[48:51]
buffer_load_dword v17, v4, s[4:7], s92 offen sc1
v_mfma_f32_16x16x32_bf16 v[56:59], a[176:179], v[76:79], v[56:59]
s_waitcnt lgkmcnt(4)
v_mfma_f32_16x16x32_bf16 v[36:39], a[180:183], v[80:83], v[36:39]
ds_read_b128 v[72:75], v2 offset:36864
ds_read_b128 v[76:79], v2 offset:37888
v_mfma_f32_16x16x32_bf16 v[44:47], a[184:187], v[80:83], v[44:47]
v_permlane16_swap_b32 v120, v121
v_mfma_f32_16x16x32_bf16 v[52:55], a[188:191], v[80:83], v[52:55]
buffer_load_dwordx4 a[132:135], v1, s[4:7], s28 offen offset:1024 sc1
v_add_f32 v120, v120, v121
v_mfma_f32_16x16x32_bf16 v[40:43], a[180:183], v[84:87], v[40:43]
v_mov_b32 v121, v120
v_mfma_f32_16x16x32_bf16 v[48:51], a[184:187], v[84:87], v[48:51]
s_nop 0
v_permlane32_swap_b32 v120, v121
v_mfma_f32_16x16x32_bf16 v[56:59], a[188:191], v[84:87], v[56:59]
v_mul_f32 v120, 0x3b000000, v120
s_waitcnt lgkmcnt(4)
v_mfma_f32_16x16x32_bf16 v[36:39], a[208:211], v[88:91], v[36:39]
ds_read_b128 v[80:83], v2 offset:38912
ds_read_b128 v[84:87], v2 offset:39936
v_mfma_f32_16x16x32_bf16 v[44:47], a[212:215], v[88:91], v[44:47]
buffer_load_dwordx4 a[136:139], v1, s[4:7], s28 offen offset:2048 sc1
v_mul_f32 v121, 0x3b000000, v121
v_mfma_f32_16x16x32_bf16 v[52:55], a[216:219], v[88:91], v[52:55]
v_fma_f32 v121, -v120, v120, v121
v_max_f32 v121, 0, v121
v_mfma_f32_16x16x32_bf16 v[40:43], a[208:211], v[92:95], v[40:43]
v_add_f32 v121, 0x3727c5ac, v121
v_mfma_f32_16x16x32_bf16 v[48:51], a[212:215], v[92:95], v[48:51]
v_rsq_f32 v121, v121
v_mfma_f32_16x16x32_bf16 v[56:59], a[216:219], v[92:95], v[56:59]
buffer_load_dwordx4 a[140:143], v1, s[4:7], s28 offen offset:3072 sc1
s_waitcnt lgkmcnt(4)
v_mfma_f32_16x16x32_bf16 v[36:39], a[220:223], v[96:99], v[36:39]
ds_read_b128 v[88:91], v2 offset:40960
ds_read_b128 v[92:95], v2 offset:41984
v_mfma_f32_16x16x32_bf16 v[44:47], a[224:227], v[96:99], v[44:47]
v_sub_f32 v120, 0, v120
v_mul_f32 v120, v120, v121
v_mfma_f32_16x16x32_bf16 v[52:55], a[228:231], v[96:99], v[52:55]
ds_write_b32 v122, v121 offset:64
ds_write_b32 v122, v120 offset:384
v_mfma_f32_16x16x32_bf16 v[40:43], a[220:223], v[100:103], v[40:43]
s_add_u32 s28, s27, 32768
buffer_load_dwordx4 a[144:147], v1, s[4:7], s28 offen sc1
v_mfma_f32_16x16x32_bf16 v[48:51], a[224:227], v[100:103], v[48:51]
s_waitcnt lgkmcnt(0)
s_barrier
v_mfma_f32_16x16x32_bf16 v[56:59], a[228:231], v[100:103], v[56:59]
v_mfma_f32_16x16x32_bf16 v[36:39], a[232:235], v[72:75], v[36:39]
ds_read_b128 v[96:99], v2 offset:43008
ds_read_b128 v[100:103], v2 offset:44032
v_mfma_f32_16x16x32_bf16 v[44:47], a[236:239], v[72:75], v[44:47]
buffer_load_dwordx4 a[148:151], v1, s[4:7], s28 offen offset:1024 sc1
v_mfma_f32_16x16x32_bf16 v[52:55], a[240:243], v[72:75], v[52:55]
v_mfma_f32_16x16x32_bf16 v[40:43], a[232:235], v[76:79], v[40:43]
v_mfma_f32_16x16x32_bf16 v[48:51], a[236:239], v[76:79], v[48:51]
v_mfma_f32_16x16x32_bf16 v[56:59], a[240:243], v[76:79], v[56:59]
buffer_load_dwordx4 a[152:155], v1, s[4:7], s28 offen offset:2048 sc1
v_mfma_f32_16x16x32_bf16 v[36:39], a[244:247], v[80:83], v[36:39]
ds_read_b128 v[72:75], v2 offset:45056
ds_read_b128 v[76:79], v2 offset:46080
v_mfma_f32_16x16x32_bf16 v[44:47], a[248:251], v[80:83], v[44:47]
v_mfma_f32_16x16x32_bf16 v[52:55], a[252:255], v[80:83], v[52:55]
v_mfma_f32_16x16x32_bf16 v[40:43], a[244:247], v[84:87], v[40:43]
buffer_load_dwordx4 a[156:159], v1, s[4:7], s28 offen offset:3072 sc1
v_mfma_f32_16x16x32_bf16 v[48:51], a[248:251], v[84:87], v[48:51]
v_mfma_f32_16x16x32_bf16 v[56:59], a[252:255], v[84:87], v[56:59]
v_mfma_f32_16x16x32_bf16 v[36:39], v[128:131], v[88:91], v[36:39]
ds_read_b128 v[80:83], v2 offset:47104
ds_read_b128 v[84:87], v2 offset:48128
v_mfma_f32_16x16x32_bf16 v[44:47], v[132:135], v[88:91], v[44:47]
s_add_u32 s28, s27, 36864
buffer_load_dwordx4 a[160:163], v1, s[4:7], s28 offen sc1
v_mfma_f32_16x16x32_bf16 v[52:55], v[136:139], v[88:91], v[52:55]
v_mfma_f32_16x16x32_bf16 v[40:43], v[128:131], v[92:95], v[40:43]
v_mfma_f32_16x16x32_bf16 v[48:51], v[132:135], v[92:95], v[48:51]
v_mfma_f32_16x16x32_bf16 v[56:59], v[136:139], v[92:95], v[56:59]
buffer_load_dwordx4 a[164:167], v1, s[4:7], s28 offen offset:1024 sc1
s_waitcnt lgkmcnt(4)
v_mfma_f32_16x16x32_bf16 v[36:39], v[140:143], v[96:99], v[36:39]
v_mfma_f32_16x16x32_bf16 v[44:47], v[144:147], v[96:99], v[44:47]
v_mfma_f32_16x16x32_bf16 v[52:55], v[148:151], v[96:99], v[52:55]
v_mfma_f32_16x16x32_bf16 v[40:43], v[140:143], v[100:103], v[40:43]
buffer_load_dwordx4 a[168:171], v1, s[4:7], s28 offen offset:2048 sc1
v_mfma_f32_16x16x32_bf16 v[48:51], v[144:147], v[100:103], v[48:51]
v_mfma_f32_16x16x32_bf16 v[56:59], v[148:151], v[100:103], v[56:59]
s_waitcnt lgkmcnt(2)
v_mfma_f32_16x16x32_bf16 v[36:39], v[152:155], v[72:75], v[36:39]
v_mov_b32 v116, s36
v_mov_b32 v117, s37
v_mfma_f32_16x16x32_bf16 v[44:47], v[156:159], v[72:75], v[44:47]
buffer_load_dwordx4 a[172:175], v1, s[4:7], s28 offen offset:3072 sc1
ds_read2_b32 v[68:69], v5 offset0:16 offset1:96
v_mfma_f32_16x16x32_bf16 v[52:55], v[160:163], v[72:75], v[52:55]
ds_read2_b32 v[70:71], v5 offset0:32 offset1:112
ds_read_b128 v[104:107], v6 offset:256
v_mfma_f32_16x16x32_bf16 v[40:43], v[152:155], v[76:79], v[40:43]
ds_read_b128 v[88:91], v6 offset:512
ds_read_b128 v[108:111], v6 offset:320
v_mfma_f32_16x16x32_bf16 v[48:51], v[156:159], v[76:79], v[48:51]
ds_read_b128 v[92:95], v6 offset:576
ds_read_b128 v[112:115], v6 offset:384
v_mfma_f32_16x16x32_bf16 v[56:59], v[160:163], v[76:79], v[56:59]
s_add_u32 s28, s27, 40960
s_waitcnt lgkmcnt(7)
v_mfma_f32_16x16x32_bf16 v[36:39], v[164:167], v[80:83], v[36:39]
buffer_load_dwordx4 a[176:179], v1, s[4:7], s28 offen sc1
ds_read_b128 v[96:99], v6 offset:640
v_mfma_f32_16x16x32_bf16 v[44:47], v[168:171], v[80:83], v[44:47]
v_mfma_f32_16x16x32_bf16 v[52:55], v[172:175], v[80:83], v[52:55]
v_mfma_f32_16x16x32_bf16 v[40:43], v[164:167], v[84:87], v[40:43]
v_mfma_f32_16x16x32_bf16 v[48:51], v[168:171], v[84:87], v[48:51]
buffer_load_dwordx4 a[180:183], v1, s[4:7], s28 offen offset:1024 sc1
v_mfma_f32_16x16x32_bf16 v[56:59], v[172:175], v[84:87], v[56:59]
buffer_load_dwordx4 a[184:187], v1, s[4:7], s28 offen offset:2048 sc1
s_waitcnt lgkmcnt(0)
v_pk_mul_f32 v[68:69], v[68:69], v[116:117] op_sel:[0,1] op_sel_hi:[1,1]
v_pk_mul_f32 v[70:71], v[70:71], v[116:117] op_sel:[0,1] op_sel_hi:[1,1]
s_add_u32 s46, s32, 15
buffer_load_dwordx4 a[188:191], v1, s[4:7], s28 offen offset:3072 sc1
s_waitcnt vmcnt(15)
v_lshrrev_b32 v17, 3, v17
v_subrev_u32 v17, s46, v17
v_cmp_lt_u32 vcc, 31, v17
s_cbranch_vccnz L_spin_34
L_ok_33:
s_add_u32 s17, s12, s19
v_pk_fma_f32 v[72:73], v[104:105], v[68:69], v[88:89] op_sel:[0,1,0] op_sel_hi:[1,1,1]
v_pk_fma_f32 v[74:75], v[106:107], v[68:69], v[90:91] op_sel:[0,1,0] op_sel_hi:[1,1,1]
v_pk_fma_f32 v[76:77], v[104:105], v[70:71], v[88:89] op_sel:[0,1,0] op_sel_hi:[1,1,1]
v_pk_fma_f32 v[78:79], v[106:107], v[70:71], v[90:91] op_sel:[0,1,0] op_sel_hi:[1,1,1]
v_pk_fma_f32 v[36:37], v[36:37], v[68:69], v[72:73] op_sel_hi:[1,0,1]
v_pk_fma_f32 v[38:39], v[38:39], v[68:69], v[74:75] op_sel_hi:[1,0,1]
v_pk_fma_f32 v[40:41], v[40:41], v[70:71], v[76:77] op_sel_hi:[1,0,1]
v_pk_fma_f32 v[42:43], v[42:43], v[70:71], v[78:79] op_sel_hi:[1,0,1]
v_pk_fma_f32 v[72:73], v[36:37], v[36:37], v[116:117] op_sel_hi:[1,1,0]
s_add_u32 m0, s2, 0
s_add_u32 s29, s17, 0x0
buffer_load_dwordx4 v1, s[4:7], s29 offen sc1 lds
v_pk_fma_f32 v[74:75], v[38:39], v[38:39], v[116:117] op_sel_hi:[1,1,0]
v_pk_fma_f32 v[76:77], v[40:41], v[40:41], v[116:117] op_sel_hi:[1,1,0]
v_pk_fma_f32 v[78:79], v[42:43], v[42:43], v[116:117] op_sel_hi:[1,1,0]
v_pk_mul_f32 v[72:73], v[72:73], v[36:37] neg_lo:[0,1] neg_hi:[0,1]
v_pk_mul_f32 v[74:75], v[74:75], v[38:39] neg_lo:[0,1] neg_hi:[0,1]
v_pk_mul_f32 v[76:77], v[76:77], v[40:41] neg_lo:[0,1] neg_hi:[0,1]
v_pk_mul_f32 v[78:79], v[78:79], v[42:43] neg_lo:[0,1] neg_hi:[0,1]
v_exp_f32 v80, v72
buffer_load_dwordx4 v1, s[4:7], s29 offen offset:1024 sc1 lds
v_exp_f32 v81, v73
v_exp_f32 v82, v74
v_exp_f32 v83, v75
v_exp_f32 v84, v76
v_exp_f32 v85, v77
s_add_u32 m0, s2, 8192
s_add_u32 s29, s17, 0x1000
buffer_load_dwordx4 v1, s[4:7], s29 offen sc1 lds
v_exp_f32 v86, v78
v_exp_f32 v87, v79
v_pk_fma_f32 v[80:81], v[80:81], v[116:117], v[116:117] op_sel:[0,1,1] op_sel_hi:[1,1,1]
v_pk_fma_f32 v[82:83], v[82:83], v[116:117], v[116:117] op_sel:[0,1,1] op_sel_hi:[1,1,1]
v_pk_fma_f32 v[84:85], v[84:85], v[116:117], v[116:117] op_sel:[0,1,1] op_sel_hi:[1,1,1]
v_pk_fma_f32 v[86:87], v[86:87], v[116:117], v[116:117] op_sel:[0,1,1] op_sel_hi:[1,1,1]
v_rcp_f32 v80, v80
buffer_load_dwordx4 v1, s[4:7], s29 offen offset:1024 sc1 lds
v_rcp_f32 v81, v81
v_rcp_f32 v82, v82
v_rcp_f32 v83, v83
v_rcp_f32 v84, v84
v_rcp_f32 v85, v85
s_add_u32 m0, s2, 16384
s_add_u32 s29, s17, 0x2000
buffer_load_dwordx4 v1, s[4:7], s29 offen sc1 lds
v_rcp_f32 v86, v86
v_rcp_f32 v87, v87
s_add_u32 s15, s40, s12
v_pk_mul_f32 v[36:37], v[36:37], v[80:81]
v_pk_mul_f32 v[38:39], v[38:39], v[82:83]
v_pk_mul_f32 v[40:41], v[40:41], v[84:85]
v_pk_mul_f32 v[42:43], v[42:43], v[86:87]
s_add_u32 s15, s15, 0x16000
v_cvt_pk_bf16_f32 v36, v36, v37
v_cvt_pk_bf16_f32 v37, v38, v39
buffer_load_dwordx4 v1, s[4:7], s29 offen offset:1024 sc1 lds
v_cvt_pk_bf16_f32 v38, v40, v41
v_cvt_pk_bf16_f32 v39, v42, v43
s_nop 0
v_permlane32_swap_b32 v36, v38
v_permlane32_swap_b32 v37, v39
buffer_store_dwordx4 v[36:39], v3, s[4:7], s15 offen
v_pk_fma_f32 v[72:73], v[108:109], v[68:69], v[92:93] op_sel:[0,1,0] op_sel_hi:[1,1,1]
v_pk_fma_f32 v[74:75], v[110:111], v[68:69], v[94:95] op_sel:[0,1,0] op_sel_hi:[1,1,1]
v_pk_fma_f32 v[76:77], v[108:109], v[70:71], v[92:93] op_sel:[0,1,0] op_sel_hi:[1,1,1]
v_pk_fma_f32 v[78:79], v[110:111], v[70:71], v[94:95] op_sel:[0,1,0] op_sel_hi:[1,1,1]
v_pk_fma_f32 v[44:45], v[44:45], v[68:69], v[72:73] op_sel_hi:[1,0,1]
v_pk_fma_f32 v[46:47], v[46:47], v[68:69], v[74:75] op_sel_hi:[1,0,1]
v_pk_fma_f32 v[48:49], v[48:49], v[70:71], v[76:77] op_sel_hi:[1,0,1]
v_pk_fma_f32 v[50:51], v[50:51], v[70:71], v[78:79] op_sel_hi:[1,0,1]
v_pk_fma_f32 v[72:73], v[44:45], v[44:45], v[116:117] op_sel_hi:[1,1,0]
s_add_u32 m0, s2, 24576
s_add_u32 s29, s17, 0x3000
buffer_load_dwordx4 v1, s[4:7], s29 offen sc1 lds
v_pk_fma_f32 v[74:75], v[46:47], v[46:47], v[116:117] op_sel_hi:[1,1,0]
v_pk_fma_f32 v[76:77], v[48:49], v[48:49], v[116:117] op_sel_hi:[1,1,0]
v_pk_fma_f32 v[78:79], v[50:51], v[50:51], v[116:117] op_sel_hi:[1,1,0]
v_pk_mul_f32 v[72:73], v[72:73], v[44:45] neg_lo:[0,1] neg_hi:[0,1]
v_pk_mul_f32 v[74:75], v[74:75], v[46:47] neg_lo:[0,1] neg_hi:[0,1]
v_pk_mul_f32 v[76:77], v[76:77], v[48:49] neg_lo:[0,1] neg_hi:[0,1]
v_pk_mul_f32 v[78:79], v[78:79], v[50:51] neg_lo:[0,1] neg_hi:[0,1]
v_exp_f32 v80, v72
buffer_load_dwordx4 v1, s[4:7], s29 offen offset:1024 sc1 lds
v_exp_f32 v81, v73
v_exp_f32 v82, v74
v_exp_f32 v83, v75
v_exp_f32 v84, v76
v_exp_f32 v85, v77
s_add_u32 m0, s2, 32768
s_add_u32 s29, s17, 0x4000
buffer_load_dwordx4 v1, s[4:7], s29 offen sc1 lds
v_exp_f32 v86, v78
v_exp_f32 v87, v79
v_pk_fma_f32 v[80:81], v[80:81], v[116:117], v[116:117] op_sel:[0,1,1] op_sel_hi:[1,1,1]
v_pk_fma_f32 v[82:83], v[82:83], v[116:117], v[116:117] op_sel:[0,1,1] op_sel_hi:[1,1,1]
v_pk_fma_f32 v[84:85], v[84:85], v[116:117], v[116:117] op_sel:[0,1,1] op_sel_hi:[1,1,1]
v_pk_fma_f32 v[86:87], v[86:87], v[116:117], v[116:117] op_sel:[0,1,1] op_sel_hi:[1,1,1]
v_rcp_f32 v80, v80
buffer_load_dwordx4 v1, s[4:7], s29 offen offset:1024 sc1 lds
v_rcp_f32 v81, v81
v_rcp_f32 v82, v82
v_rcp_f32 v83, v83
v_rcp_f32 v84, v84
v_rcp_f32 v85, v85
s_add_u32 m0, s2, 40960
s_add_u32 s29, s17, 0x5000
buffer_load_dwordx4 v1, s[4:7], s29 offen sc1 lds
v_rcp_f32 v86, v86
v_rcp_f32 v87, v87
s_add_u32 s15, s41, s12
v_pk_mul_f32 v[44:45], v[44:45], v[80:81]
v_pk_mul_f32 v[46:47], v[46:47], v[82:83]
v_pk_mul_f32 v[48:49], v[48:49], v[84:85]
v_pk_mul_f32 v[50:51], v[50:51], v[86:87]
s_add_u32 s15, s15, 0x16000
v_cvt_pk_bf16_f32 v44, v44, v45
v_cvt_pk_bf16_f32 v45, v46, v47
buffer_load_dwordx4 v1, s[4:7], s29 offen offset:1024 sc1 lds
v_cvt_pk_bf16_f32 v46, v48, v49
v_cvt_pk_bf16_f32 v47, v50, v51
s_nop 0
v_permlane32_swap_b32 v44, v46
v_permlane32_swap_b32 v45, v47
buffer_store_dwordx4 v[44:47], v3, s[4:7], s15 offen
v_pk_fma_f32 v[72:73], v[112:113], v[68:69], v[96:97] op_sel:[0,1,0] op_sel_hi:[1,1,1]
v_pk_fma_f32 v[74:75], v[114:115], v[68:69], v[98:99] op_sel:[0,1,0] op_sel_hi:[1,1,1]
v_pk_fma_f32 v[76:77], v[112:113], v[70:71], v[96:97] op_sel:[0,1,0] op_sel_hi:[1,1,1]
v_pk_fma_f32 v[78:79], v[114:115], v[70:71], v[98:99] op_sel:[0,1,0] op_sel_hi:[1,1,1]
v_pk_fma_f32 v[52:53], v[52:53], v[68:69], v[72:73] op_sel_hi:[1,0,1]
v_pk_fma_f32 v[54:55], v[54:55], v[68:69], v[74:75] op_sel_hi:[1,0,1]
v_pk_fma_f32 v[56:57], v[56:57], v[70:71], v[76:77] op_sel_hi:[1,0,1]
v_pk_fma_f32 v[58:59], v[58:59], v[70:71], v[78:79] op_sel_hi:[1,0,1]
v_pk_fma_f32 v[72:73], v[52:53], v[52:53], v[116:117] op_sel_hi:[1,1,0]
s_add_u32 m0, s2, 49152
s_add_u32 s29, s17, 0x6000
buffer_load_dwordx4 v1, s[4:7], s29 offen sc1 lds
v_pk_fma_f32 v[74:75], v[54:55], v[54:55], v[116:117] op_sel_hi:[1,1,0]
v_pk_fma_f32 v[76:77], v[56:57], v[56:57], v[116:117] op_sel_hi:[1,1,0]
v_pk_fma_f32 v[78:79], v[58:59], v[58:59], v[116:117] op_sel_hi:[1,1,0]
v_pk_mul_f32 v[72:73], v[72:73], v[52:53] neg_lo:[0,1] neg_hi:[0,1]
v_pk_mul_f32 v[74:75], v[74:75], v[54:55] neg_lo:[0,1] neg_hi:[0,1]
v_pk_mul_f32 v[76:77], v[76:77], v[56:57] neg_lo:[0,1] neg_hi:[0,1]
v_pk_mul_f32 v[78:79], v[78:79], v[58:59] neg_lo:[0,1] neg_hi:[0,1]
v_exp_f32 v80, v72
buffer_load_dwordx4 v1, s[4:7], s29 offen offset:1024 sc1 lds
v_exp_f32 v81, v73
v_exp_f32 v82, v74
v_exp_f32 v83, v75
v_exp_f32 v84, v76
v_exp_f32 v85, v77
s_add_u32 m0, s2, 57344
s_add_u32 s29, s17, 0x7000
buffer_load_dwordx4 v1, s[4:7], s29 offen sc1 lds
v_exp_f32 v86, v78
v_exp_f32 v87, v79
v_pk_fma_f32 v[80:81], v[80:81], v[116:117], v[116:117] op_sel:[0,1,1] op_sel_hi:[1,1,1]
v_pk_fma_f32 v[82:83], v[82:83], v[116:117], v[116:117] op_sel:[0,1,1] op_sel_hi:[1,1,1]
v_pk_fma_f32 v[84:85], v[84:85], v[116:117], v[116:117] op_sel:[0,1,1] op_sel_hi:[1,1,1]
v_pk_fma_f32 v[86:87], v[86:87], v[116:117], v[116:117] op_sel:[0,1,1] op_sel_hi:[1,1,1]
s_waitcnt vmcnt(8)
s_barrier
ds_read_b128 v[88:91], v7 offset:0
ds_read_b128 v[92:95], v8 offset:0
ds_read_b128 v[96:99], v7 offset:4096
ds_read_b128 v[100:103], v8 offset:4096
v_rcp_f32 v80, v80
buffer_load_dwordx4 v1, s[4:7], s29 offen offset:1024 sc1 lds
v_rcp_f32 v81, v81
v_rcp_f32 v82, v82
v_rcp_f32 v83, v83
v_rcp_f32 v84, v84
v_rcp_f32 v85, v85
s_add_u32 m0, s2, 65536
s_add_u32 s29, s17, 0x8000
buffer_load_dwordx4 v1, s[4:7], s29 offen sc1 lds
v_rcp_f32 v86, v86
v_rcp_f32 v87, v87
s_add_u32 s15, s42, s12
v_pk_mul_f32 v[52:53], v[52:53], v[80:81]
v_pk_mul_f32 v[54:55], v[54:55], v[82:83]
v_pk_mul_f32 v[56:57], v[56:57], v[84:85]
v_pk_mul_f32 v[58:59], v[58:59], v[86:87]
s_add_u32 s15, s15, 0x16000
v_cvt_pk_bf16_f32 v52, v52, v53
v_cvt_pk_bf16_f32 v53, v54, v55
buffer_load_dwordx4 v1, s[4:7], s29 offen offset:1024 sc1 lds
v_cvt_pk_bf16_f32 v54, v56, v57
v_cvt_pk_bf16_f32 v55, v58, v59
s_nop 0
v_permlane32_swap_b32 v52, v54
v_permlane32_swap_b32 v53, v55
buffer_store_dwordx4 v[52:55], v3, s[4:7], s15 offen
ds_read_b128 v[72:75], v7 offset:8192
ds_read_b128 v[76:79], v8 offset:8192
v_lshrrev_b32 v106, 4, v1
v_and_b32 v106, 48, v106
s_waitcnt lgkmcnt(4)
v_mfma_f32_16x16x32_bf16 v[36:39], v[176:179], v[88:91], 0
ds_read_b128 v[80:83], v7 offset:12288
ds_read_b128 v[84:87], v8 offset:12288
v_mfma_f32_16x16x32_bf16 v[40:43], v[180:183], v[88:91], 0
v_mfma_f32_16x16x32_bf16 v[44:47], v[176:179], v[92:95], 0
s_add_u32 m0, s2, 73728
s_add_u32 s29, s17, 0x9000
v_mfma_f32_16x16x32_bf16 v[48:51], v[180:183], v[92:95], 0
buffer_load_dwordx4 v1, s[4:7], s29 offen sc1 lds
s_waitcnt lgkmcnt(4)
v_mfma_f32_16x16x32_bf16 v[36:39], v[184:187], v[96:99], v[36:39]
ds_read_b128 v[88:91], v7 offset:16384
ds_read_b128 v[92:95], v8 offset:16384
v_mfma_f32_16x16x32_bf16 v[40:43], v[188:191], v[96:99], v[40:43]
v_mfma_f32_16x16x32_bf16 v[44:47], v[184:187], v[100:103], v[44:47]
buffer_load_dwordx4 v1, s[4:7], s29 offen offset:1024 sc1 lds
v_mfma_f32_16x16x32_bf16 v[48:51], v[188:191], v[100:103], v[48:51]
s_waitcnt lgkmcnt(4)
v_mfma_f32_16x16x32_bf16 v[36:39], v[192:195], v[72:75], v[36:39]
ds_read_b128 v[96:99], v7 offset:20480
ds_read_b128 v[100:103], v8 offset:20480
v_mfma_f32_16x16x32_bf16 v[40:43], v[196:199], v[72:75], v[40:43]
s_add_u32 m0, s2, 81920
s_add_u32 s29, s17, 0xa000
v_mfma_f32_16x16x32_bf16 v[44:47], v[192:195], v[76:79], v[44:47]
buffer_load_dwordx4 v1, s[4:7], s29 offen sc1 lds
v_mfma_f32_16x16x32_bf16 v[48:51], v[196:199], v[76:79], v[48:51]
s_waitcnt lgkmcnt(4)
v_mfma_f32_16x16x32_bf16 v[36:39], v[200:203], v[80:83], v[36:39]
ds_read_b128 v[72:75], v7 offset:24576
ds_read_b128 v[76:79], v8 offset:24576
v_mfma_f32_16x16x32_bf16 v[40:43], v[204:207], v[80:83], v[40:43]
buffer_load_dwordx4 v1, s[4:7], s29 offen offset:1024 sc1 lds
v_add_u32 v15, 8, v15
v_mfma_f32_16x16x32_bf16 v[44:47], v[200:203], v[84:87], v[44:47]
s_waitcnt vmcnt(4)
buffer_store_dword v15, v13, s[4:7], s45 offen
v_mfma_f32_16x16x32_bf16 v[48:51], v[204:207], v[84:87], v[48:51]
s_waitcnt lgkmcnt(4)
v_mfma_f32_16x16x32_bf16 v[36:39], v[208:211], v[88:91], v[36:39]
ds_read_b128 v[80:83], v7 offset:28672
ds_read_b128 v[84:87], v8 offset:28672
v_mfma_f32_16x16x32_bf16 v[40:43], v[212:215], v[88:91], v[40:43]
buffer_load_dwordx4 v[108:111], v106, s[48:51], s95 offen
v_mfma_f32_16x16x32_bf16 v[44:47], v[208:211], v[92:95], v[44:47]
v_mfma_f32_16x16x32_bf16 v[48:51], v[212:215], v[92:95], v[48:51]
s_waitcnt lgkmcnt(4)
v_mfma_f32_16x16x32_bf16 v[36:39], v[216:219], v[96:99], v[36:39]
s_barrier
ds_read_b128 v[88:91], v7 offset:32768
v_mfma_f32_16x16x32_bf16 v[40:43], v[220:223], v[96:99], v[40:43]
ds_read_b128 v[92:95], v8 offset:32768
v_mfma_f32_16x16x32_bf16 v[44:47], v[216:219], v[100:103], v[44:47]
v_mfma_f32_16x16x32_bf16 v[48:51], v[220:223], v[100:103], v[48:51]
s_waitcnt lgkmcnt(4)
v_mfma_f32_16x16x32_bf16 v[36:39], v[224:227], v[72:75], v[36:39]
ds_read_b128 v[96:99], v7 offset:36864
ds_read_b128 v[100:103], v8 offset:36864
v_mfma_f32_16x16x32_bf16 v[40:43], v[228:231], v[72:75], v[40:43]
v_mfma_f32_16x16x32_bf16 v[44:47], v[224:227], v[76:79], v[44:47]
v_mfma_f32_16x16x32_bf16 v[48:51], v[228:231], v[76:79], v[48:51]
s_waitcnt lgkmcnt(4)
v_mfma_f32_16x16x32_bf16 v[36:39], v[232:235], v[80:83], v[36:39]
ds_read_b128 v[72:75], v7 offset:40960
ds_read_b128 v[76:79], v8 offset:40960
v_mfma_f32_16x16x32_bf16 v[40:43], v[236:239], v[80:83], v[40:43]
v_mfma_f32_16x16x32_bf16 v[44:47], v[232:235], v[84:87], v[44:47]
v_mfma_f32_16x16x32_bf16 v[48:51], v[236:239], v[84:87], v[48:51]
s_waitcnt lgkmcnt(4)
v_mfma_f32_16x16x32_bf16 v[36:39], v[240:243], v[88:91], v[36:39]
ds_read_b128 v[80:83], v7 offset:45056
ds_read_b128 v[84:87], v8 offset:45056
v_mfma_f32_16x16x32_bf16 v[40:43], v[244:247], v[88:91], v[40:43]
v_mfma_f32_16x16x32_bf16 v[44:47], v[240:243], v[92:95], v[44:47]
v_mfma_f32_16x16x32_bf16 v[48:51], v[244:247], v[92:95], v[48:51]
s_waitcnt lgkmcnt(4)
v_mfma_f32_16x16x32_bf16 v[36:39], v[248:251], v[96:99], v[36:39]
ds_read_b128 v[88:91], v7 offset:49152
ds_read_b128 v[92:95], v8 offset:49152
v_mfma_f32_16x16x32_bf16 v[40:43], v[252:255], v[96:99], v[40:43]
v_mfma_f32_16x16x32_bf16 v[44:47], v[248:251], v[100:103], v[44:47]
v_mfma_f32_16x16x32_bf16 v[48:51], v[252:255], v[100:103], v[48:51]
s_waitcnt lgkmcnt(4)
v_mfma_f32_16x16x32_bf16 v[36:39], a[96:99], v[72:75], v[36:39]
ds_read_b128 v[96:99], v7 offset:53248
ds_read_b128 v[100:103], v8 offset:53248
v_mfma_f32_16x16x32_bf16 v[40:43], a[100:103], v[72:75], v[40:43]
buffer_load_dword v17, v4, s[4:7], s92 offen sc1
v_mfma_f32_16x16x32_bf16 v[44:47], a[96:99], v[76:79], v[44:47]
v_mfma_f32_16x16x32_bf16 v[48:51], a[100:103], v[76:79], v[48:51]
s_waitcnt lgkmcnt(4)
v_mfma_f32_16x16x32_bf16 v[36:39], a[104:107], v[80:83], v[36:39]
ds_read_b128 v[72:75], v7 offset:57344
ds_read_b128 v[76:79], v8 offset:57344
v_mfma_f32_16x16x32_bf16 v[40:43], a[108:111], v[80:83], v[40:43]
v_mfma_f32_16x16x32_bf16 v[44:47], a[104:107], v[84:87], v[44:47]
v_mfma_f32_16x16x32_bf16 v[48:51], a[108:111], v[84:87], v[48:51]
s_waitcnt lgkmcnt(4)
v_mfma_f32_16x16x32_bf16 v[36:39], a[112:115], v[88:91], v[36:39]
ds_read_b128 v[80:83], v7 offset:61440
ds_read_b128 v[84:87], v8 offset:61440
v_mfma_f32_16x16x32_bf16 v[40:43], a[116:119], v[88:91], v[40:43]
v_mfma_f32_16x16x32_bf16 v[44:47], a[112:115], v[92:95], v[44:47]
v_mfma_f32_16x16x32_bf16 v[48:51], a[116:119], v[92:95], v[48:51]
s_waitcnt lgkmcnt(4)
v_mfma_f32_16x16x32_bf16 v[36:39], a[120:123], v[96:99], v[36:39]
s_waitcnt vmcnt(3)
s_barrier
v_mfma_f32_16x16x32_bf16 v[40:43], a[124:127], v[96:99], v[40:43]
ds_read_b128 v[88:91], v9 offset:0
ds_read_b128 v[92:95], v10 offset:0
v_mfma_f32_16x16x32_bf16 v[44:47], a[120:123], v[100:103], v[44:47]
s_waitcnt vmcnt(1)
v_lshlrev_b32 v112, 16, v108
v_mfma_f32_16x16x32_bf16 v[48:51], a[124:127], v[100:103], v[48:51]
v_and_b32 v113, 0xffff0000, v108
s_waitcnt lgkmcnt(4)
v_mfma_f32_16x16x32_bf16 v[36:39], a[128:131], v[72:75], v[36:39]
ds_read_b128 v[96:99], v9 offset:4096
ds_read_b128 v[100:103], v10 offset:4096
v_mfma_f32_16x16x32_bf16 v[40:43], a[132:135], v[72:75], v[40:43]
s_add_u32 s44, s32, 16
s_waitcnt vmcnt(0)
v_lshrrev_b32 v17, 3, v17
v_mfma_f32_16x16x32_bf16 v[44:47], a[128:131], v[76:79], v[44:47]
v_subrev_u32 v17, s44, v17
v_cmp_lt_u32 vcc, 31, v17
s_cbranch_vccnz L_spin_36
L_ok_35:
s_add_u32 s18, s12, s19
v_mfma_f32_16x16x32_bf16 v[48:51], a[132:135], v[76:79], v[48:51]
s_add_u32 m0, s2, 90112
s_waitcnt lgkmcnt(4)
v_mfma_f32_16x16x32_bf16 v[36:39], a[136:139], v[80:83], v[36:39]
ds_read_b128 v[72:75], v9 offset:8192
ds_read_b128 v[76:79], v10 offset:8192
v_mfma_f32_16x16x32_bf16 v[40:43], a[140:143], v[80:83], v[40:43]
s_add_u32 s29, s18, 0x1b000
buffer_load_dwordx4 v1, s[4:7], s29 offen sc1 lds
v_mfma_f32_16x16x32_bf16 v[44:47], a[136:139], v[84:87], v[44:47]
v_add_f32 v20, v20, v112
v_add_f32 v21, v21, v113
v_mfma_f32_16x16x32_bf16 v[48:51], a[140:143], v[84:87], v[48:51]
v_add_f32 v28, v28, v112
s_waitcnt lgkmcnt(4)
v_mfma_f32_16x16x32_bf16 v[36:39], a[144:147], v[88:91], v[36:39]
ds_read_b128 v[80:83], v9 offset:12288
ds_read_b128 v[84:87], v10 offset:12288
v_mfma_f32_16x16x32_bf16 v[40:43], a[148:151], v[88:91], v[40:43]
buffer_load_dwordx4 v1, s[4:7], s29 offen offset:1024 sc1 lds
v_add_f32 v29, v29, v113
v_mfma_f32_16x16x32_bf16 v[44:47], a[144:147], v[92:95], v[44:47]
v_lshlrev_b32 v112, 16, v109
v_and_b32 v113, 0xffff0000, v109
v_mfma_f32_16x16x32_bf16 v[48:51], a[148:151], v[92:95], v[48:51]
v_add_f32 v22, v22, v112
s_waitcnt lgkmcnt(4)
v_mfma_f32_16x16x32_bf16 v[36:39], a[152:155], v[96:99], v[36:39]
ds_read_b128 v[88:91], v9 offset:16384
ds_read_b128 v[92:95], v10 offset:16384
v_mfma_f32_16x16x32_bf16 v[40:43], a[156:159], v[96:99], v[40:43]
s_add_u32 m0, s2, 98304
s_add_u32 s29, s18, 0x1c000
v_mfma_f32_16x16x32_bf16 v[44:47], a[152:155], v[100:103], v[44:47]
buffer_load_dwordx4 v1, s[4:7], s29 offen sc1 lds
v_add_f32 v23, v23, v113
v_mfma_f32_16x16x32_bf16 v[48:51], a[156:159], v[100:103], v[48:51]
v_add_f32 v30, v30, v112
s_waitcnt lgkmcnt(4)
v_mfma_f32_16x16x32_bf16 v[36:39], a[160:163], v[72:75], v[36:39]
ds_read_b128 v[96:99], v9 offset:20480
ds_read_b128 v[100:103], v10 offset:20480
v_mfma_f32_16x16x32_bf16 v[40:43], a[164:167], v[72:75], v[40:43]
buffer_load_dwordx4 v1, s[4:7], s29 offen offset:1024 sc1 lds
v_add_f32 v31, v31, v113
v_mfma_f32_16x16x32_bf16 v[44:47], a[160:163], v[76:79], v[44:47]
v_lshlrev_b32 v112, 16, v110
v_and_b32 v113, 0xffff0000, v110
v_mfma_f32_16x16x32_bf16 v[48:51], a[164:167], v[76:79], v[48:51]
v_add_f32 v24, v24, v112
s_waitcnt lgkmcnt(4)
v_mfma_f32_16x16x32_bf16 v[44:47], a[168:171], v[84:87], v[44:47]
s_add_u32 m0, s2, 106496
s_add_u32 s29, s18, 0x1d000
v_mfma_f32_16x16x32_bf16 v[48:51], a[172:175], v[84:87], v[48:51]
buffer_load_dwordx4 v1, s[4:7], s29 offen sc1 lds
v_add_f32 v25, v25, v113
s_waitcnt lgkmcnt(2)
v_mfma_f32_16x16x32_bf16 v[44:47], a[176:179], v[92:95], v[44:47]
v_add_f32 v32, v32, v112
v_add_f32 v33, v33, v113
v_mfma_f32_16x16x32_bf16 v[48:51], a[180:183], v[92:95], v[48:51]
v_lshlrev_b32 v112, 16, v111
v_and_b32 v113, 0xffff0000, v111
s_waitcnt lgkmcnt(0)
v_mfma_f32_16x16x32_bf16 v[44:47], a[184:187], v[100:103], v[44:47]
buffer_load_dwordx4 v1, s[4:7], s29 offen offset:1024 sc1 lds
v_add_f32 v26, v26, v112
v_mfma_f32_16x16x32_bf16 v[48:51], a[188:191], v[100:103], v[48:51]
v_add_f32 v27, v27, v113
v_add_f32 v34, v34, v112
v_add_f32 v35, v35, v113
v_mfma_f32_16x16x32_bf16 v[36:39], a[168:171], v[80:83], v[36:39]
s_lshl_b32 s15, s8, 11
s_add_u32 s15, s15, 0x20000
v_mfma_f32_16x16x32_bf16 v[40:43], a[172:175], v[80:83], v[40:43]
s_add_u32 m0, s2, 114688
s_add_u32 s29, s18, 0x1e000
s_xor_b32 s16, s15, 0x1000
v_add_u32 v104, s15, v1
v_mfma_f32_16x16x32_bf16 v[36:39], a[176:179], v[88:91], v[36:39]
buffer_load_dwordx4 v1, s[4:7], s29 offen sc1 lds
v_add_u32 v105, s16, v1
v_mfma_f32_16x16x32_bf16 v[40:43], a[180:183], v[88:91], v[40:43]
ds_write_b128 v104, v[44:47] offset:0
ds_write_b128 v104, v[48:51] offset:1024
v_mfma_f32_16x16x32_bf16 v[36:39], a[184:187], v[96:99], v[36:39]
v_mfma_f32_16x16x32_bf16 v[40:43], a[188:191], v[96:99], v[40:43]
buffer_load_dwordx4 v1, s[4:7], s29 offen offset:1024 sc1 lds
s_waitcnt lgkmcnt(0)
s_barrier
ds_read_b128 v[68:71], v105 offset:0
ds_read_b128 v[72:75], v105 offset:1024
s_nop 1
v_pk_add_f32 v[20:21], v[20:21], v[36:37]
v_pk_add_f32 v[22:23], v[22:23], v[38:39]
v_pk_add_f32 v[24:25], v[24:25], v[40:41]
v_pk_add_f32 v[26:27], v[26:27], v[42:43]
s_add_u32 m0, s2, 122880
s_add_u32 s29, s18, 0x1f000
buffer_load_dwordx4 v1, s[4:7], s29 offen sc1 lds
buffer_load_dwordx4 v1, s[4:7], s29 offen offset:1024 sc1 lds
s_waitcnt lgkmcnt(1)
v_pk_add_f32 v[20:21], v[20:21], v[68:69]
v_pk_add_f32 v[22:23], v[22:23], v[70:71]
s_waitcnt lgkmcnt(0)
v_pk_add_f32 v[24:25], v[24:25], v[72:73]
v_pk_add_f32 v[26:27], v[26:27], v[74:75]
v_cvt_pk_bf16_f32 v76, v20, v21
v_cvt_pk_bf16_f32 v77, v22, v23
v_cvt_pk_bf16_f32 v78, v24, v25
v_cvt_pk_bf16_f32 v79, v26, v27
buffer_store_dwordx4 v[76:79], v12, s[20:23], s53 offen
s_add_u32 m0, s2, 0
s_add_u32 s29, s18, 0x20000
buffer_load_dwordx4 v1, s[4:7], s29 offen sc1 lds
buffer_load_dwordx4 v1, s[4:7], s29 offen offset:1024 sc1 lds
s_waitcnt vmcnt(9)
s_barrier
ds_read_b128 v[88:91], v9 offset:24576
ds_read_b128 v[92:95], v10 offset:24576
ds_read_b128 v[96:99], v9 offset:28672
ds_read_b128 v[100:103], v10 offset:28672
ds_read_b128 v[72:75], v9 offset:32768
ds_read_b128 v[76:79], v10 offset:32768
s_add_u32 m0, s2, 8192
s_add_u32 s29, s18, 0x16000
buffer_load_dwordx4 v1, s[4:7], s29 offen sc1 lds
buffer_load_dwordx4 v1, s[4:7], s29 offen offset:1024 sc1 lds
s_waitcnt lgkmcnt(4)
v_mfma_f32_16x16x32_bf16 v[36:39], a[96:99], v[88:91], 0
ds_read_b128 v[80:83], v9 offset:36864
ds_read_b128 v[84:87], v10 offset:36864
v_mfma_f32_16x16x32_bf16 v[40:43], a[100:103], v[88:91], 0
v_mfma_f32_16x16x32_bf16 v[44:47], a[96:99], v[92:95], 0
s_add_u32 m0, s2, 16384
s_add_u32 s29, s18, 0x17000
v_mfma_f32_16x16x32_bf16 v[48:51], a[100:103], v[92:95], 0
buffer_load_dwordx4 v1, s[4:7], s29 offen sc1 lds
s_waitcnt lgkmcnt(4)
v_mfma_f32_16x16x32_bf16 v[36:39], a[104:107], v[96:99], v[36:39]
s_waitcnt vmcnt(6)
s_barrier
v_mfma_f32_16x16x32_bf16 v[40:43], a[108:111], v[96:99], v[40:43]
ds_read_b128 v[88:91], v9 offset:40960
ds_read_b128 v[92:95], v10 offset:40960
v_mfma_f32_16x16x32_bf16 v[44:47], a[104:107], v[100:103], v[44:47]
buffer_load_dwordx4 v1, s[4:7], s29 offen offset:1024 sc1 lds
v_mfma_f32_16x16x32_bf16 v[48:51], a[108:111], v[100:103], v[48:51]
s_waitcnt lgkmcnt(4)
v_mfma_f32_16x16x32_bf16 v[36:39], a[112:115], v[72:75], v[36:39]
ds_read_b128 v[96:99], v9 offset:45056
ds_read_b128 v[100:103], v10 offset:45056
v_mfma_f32_16x16x32_bf16 v[40:43], a[116:119], v[72:75], v[40:43]
s_add_u32 m0, s2, 24576
s_add_u32 s29, s18, 0x18000
v_mfma_f32_16x16x32_bf16 v[44:47], a[112:115], v[76:79], v[44:47]
buffer_load_dwordx4 v1, s[4:7], s29 offen sc1 lds
v_mfma_f32_16x16x32_bf16 v[48:51], a[116:119], v[76:79], v[48:51]
s_waitcnt lgkmcnt(4)
v_mfma_f32_16x16x32_bf16 v[36:39], a[120:123], v[80:83], v[36:39]
ds_read_b128 v[72:75], v9 offset:49152
ds_read_b128 v[76:79], v10 offset:49152
v_mfma_f32_16x16x32_bf16 v[40:43], a[124:127], v[80:83], v[40:43]
buffer_load_dwordx4 v1, s[4:7], s29 offen offset:1024 sc1 lds
v_mfma_f32_16x16x32_bf16 v[44:47], a[120:123], v[84:87], v[44:47]
v_mfma_f32_16x16x32_bf16 v[48:51], a[124:127], v[84:87], v[48:51]
s_waitcnt lgkmcnt(4)
v_mfma_f32_16x16x32_bf16 v[36:39], a[128:131], v[88:91], v[36:39]
ds_read_b128 v[80:83], v9 offset:53248
ds_read_b128 v[84:87], v10 offset:53248
v_mfma_f32_16x16x32_bf16 v[40:43], a[132:135], v[88:91], v[40:43]
s_add_u32 m0, s2, 32768
s_add_u32 s29, s18, 0x19000
v_mfma_f32_16x16x32_bf16 v[44:47], a[128:131], v[92:95], v[44:47]
buffer_load_dwordx4 v1, s[4:7], s29 offen sc1 lds
v_mfma_f32_16x16x32_bf16 v[48:51], a[132:135], v[92:95], v[48:51]
s_waitcnt lgkmcnt(4)
v_mfma_f32_16x16x32_bf16 v[36:39], a[136:139], v[96:99], v[36:39]
ds_read_b128 v[88:91], v9 offset:57344
ds_read_b128 v[92:95], v10 offset:57344
v_mfma_f32_16x16x32_bf16 v[40:43], a[140:143], v[96:99], v[40:43]
buffer_load_dwordx4 v1, s[4:7], s29 offen offset:1024 sc1 lds
v_mfma_f32_16x16x32_bf16 v[44:47], a[136:139], v[100:103], v[44:47]
v_mfma_f32_16x16x32_bf16 v[48:51], a[140:143], v[100:103], v[48:51]
s_waitcnt lgkmcnt(4)
v_mfma_f32_16x16x32_bf16 v[36:39], a[144:147], v[72:75], v[36:39]
ds_read_b128 v[96:99], v9 offset:61440
ds_read_b128 v[100:103], v10 offset:61440
v_mfma_f32_16x16x32_bf16 v[40:43], a[148:151], v[72:75], v[40:43]
s_add_u32 m0, s2, 40960
s_add_u32 s29, s18, 0x1a000
v_mfma_f32_16x16x32_bf16 v[44:47], a[144:147], v[76:79], v[44:47]
buffer_load_dwordx4 v1, s[4:7], s29 offen sc1 lds
v_mfma_f32_16x16x32_bf16 v[48:51], a[148:151], v[76:79], v[48:51]
s_waitcnt lgkmcnt(4)
v_mfma_f32_16x16x32_bf16 v[36:39], a[152:155], v[80:83], v[36:39]
s_waitcnt vmcnt(5)
s_barrier
v_mfma_f32_16x16x32_bf16 v[40:43], a[156:159], v[80:83], v[40:43]
ds_read_b128 v[72:75], v7 offset:0
ds_read_b128 v[76:79], v8 offset:0
v_mfma_f32_16x16x32_bf16 v[44:47], a[152:155], v[84:87], v[44:47]
buffer_load_dwordx4 v1, s[4:7], s29 offen offset:1024 sc1 lds
v_mfma_f32_16x16x32_bf16 v[48:51], a[156:159], v[84:87], v[48:51]
s_waitcnt lgkmcnt(4)
v_mfma_f32_16x16x32_bf16 v[36:39], a[160:163], v[88:91], v[36:39]
ds_read_b128 v[80:83], v7 offset:4096
ds_read_b128 v[84:87], v8 offset:4096
v_mfma_f32_16x16x32_bf16 v[40:43], a[164:167], v[88:91], v[40:43]
v_mfma_f32_16x16x32_bf16 v[44:47], a[160:163], v[92:95], v[44:47]
v_mfma_f32_16x16x32_bf16 v[48:51], a[164:167], v[92:95], v[48:51]
s_waitcnt lgkmcnt(4)
v_mfma_f32_16x16x32_bf16 v[36:39], a[168:171], v[96:99], v[36:39]
ds_read_b128 v[88:91], v7 offset:8192
ds_read_b128 v[92:95], v8 offset:8192
v_mfma_f32_16x16x32_bf16 v[40:43], a[172:175], v[96:99], v[40:43]
v_mfma_f32_16x16x32_bf16 v[44:47], a[168:171], v[100:103], v[44:47]
v_mfma_f32_16x16x32_bf16 v[48:51], a[172:175], v[100:103], v[48:51]
s_waitcnt lgkmcnt(4)
v_mfma_f32_16x16x32_bf16 v[36:39], a[176:179], v[72:75], v[36:39]
ds_read_b128 v[96:99], v7 offset:12288
ds_read_b128 v[100:103], v8 offset:12288
v_mfma_f32_16x16x32_bf16 v[40:43], a[180:183], v[72:75], v[40:43]
v_mfma_f32_16x16x32_bf16 v[44:47], a[176:179], v[76:79], v[44:47]
v_mfma_f32_16x16x32_bf16 v[48:51], a[180:183], v[76:79], v[48:51]
s_waitcnt lgkmcnt(4)
v_mfma_f32_16x16x32_bf16 v[36:39], a[184:187], v[80:83], v[36:39]
ds_read_b128 v[72:75], v7 offset:16384
ds_read_b128 v[76:79], v8 offset:16384
v_mfma_f32_16x16x32_bf16 v[40:43], a[188:191], v[80:83], v[40:43]
v_mfma_f32_16x16x32_bf16 v[44:47], a[184:187], v[84:87], v[44:47]
v_mfma_f32_16x16x32_bf16 v[48:51], a[188:191], v[84:87], v[48:51]
s_waitcnt lgkmcnt(4)
v_mfma_f32_16x16x32_bf16 v[36:39], v[176:179], v[88:91], v[36:39]
ds_read_b128 v[80:83], v7 offset:20480
ds_read_b128 v[84:87], v8 offset:20480
v_mfma_f32_16x16x32_bf16 v[40:43], v[180:183], v[88:91], v[40:43]
v_mfma_f32_16x16x32_bf16 v[44:47], v[176:179], v[92:95], v[44:47]
v_mfma_f32_16x16x32_bf16 v[48:51], v[180:183], v[92:95], v[48:51]
s_waitcnt lgkmcnt(4)
v_mfma_f32_16x16x32_bf16 v[36:39], v[184:187], v[96:99], v[36:39]
s_waitcnt vmcnt(0)
s_barrier
v_mfma_f32_16x16x32_bf16 v[40:43], v[188:191], v[96:99], v[40:43]
ds_read_b128 v[88:91], v7 offset:24576
ds_read_b128 v[92:95], v8 offset:24576
v_mfma_f32_16x16x32_bf16 v[44:47], v[184:187], v[100:103], v[44:47]
v_mfma_f32_16x16x32_bf16 v[48:51], v[188:191], v[100:103], v[48:51]
s_and_b32 s14, s10, 3
s_or_b32 s14, s14, s9
s_or_b32 s14, s14, s8
s_cbranch_scc1 L_wb_37
buffer_wbl2 sc1
L_wb_37:
s_waitcnt lgkmcnt(4)
v_mfma_f32_16x16x32_bf16 v[36:39], v[192:195], v[72:75], v[36:39]
ds_read_b128 v[96:99], v7 offset:28672
ds_read_b128 v[100:103], v8 offset:28672
v_mfma_f32_16x16x32_bf16 v[40:43], v[196:199], v[72:75], v[40:43]
v_mfma_f32_16x16x32_bf16 v[44:47], v[192:195], v[76:79], v[44:47]
v_mfma_f32_16x16x32_bf16 v[48:51], v[196:199], v[76:79], v[48:51]
s_waitcnt lgkmcnt(4)
v_mfma_f32_16x16x32_bf16 v[36:39], v[200:203], v[80:83], v[36:39]
ds_read_b128 v[72:75], v7 offset:32768
ds_read_b128 v[76:79], v8 offset:32768
v_mfma_f32_16x16x32_bf16 v[40:43], v[204:207], v[80:83], v[40:43]
v_mfma_f32_16x16x32_bf16 v[44:47], v[200:203], v[84:87], v[44:47]
v_mfma_f32_16x16x32_bf16 v[48:51], v[204:207], v[84:87], v[48:51]
s_waitcnt lgkmcnt(4)
v_mfma_f32_16x16x32_bf16 v[36:39], v[208:211], v[88:91], v[36:39]
ds_read_b128 v[80:83], v7 offset:36864
ds_read_b128 v[84:87], v8 offset:36864
v_mfma_f32_16x16x32_bf16 v[40:43], v[212:215], v[88:91], v[40:43]
v_mfma_f32_16x16x32_bf16 v[44:47], v[208:211], v[92:95], v[44:47]
v_mfma_f32_16x16x32_bf16 v[48:51], v[212:215], v[92:95], v[48:51]
s_waitcnt lgkmcnt(4)
v_mfma_f32_16x16x32_bf16 v[36:39], v[216:219], v[96:99], v[36:39]
ds_read_b128 v[88:91], v7 offset:40960
ds_read_b128 v[92:95], v8 offset:40960
v_mfma_f32_16x16x32_bf16 v[40:43], v[220:223], v[96:99], v[40:43]
v_mfma_f32_16x16x32_bf16 v[44:47], v[216:219], v[100:103], v[44:47]
v_mfma_f32_16x16x32_bf16 v[48:51], v[220:223], v[100:103], v[48:51]
s_waitcnt lgkmcnt(4)
v_mfma_f32_16x16x32_bf16 v[36:39], v[224:227], v[72:75], v[36:39]
ds_read_b128 v[96:99], v7 offset:45056
ds_read_b128 v[100:103], v8 offset:45056
v_mfma_f32_16x16x32_bf16 v[40:43], v[228:231], v[72:75], v[40:43]
v_mfma_f32_16x16x32_bf16 v[44:47], v[224:227], v[76:79], v[44:47]
v_mfma_f32_16x16x32_bf16 v[48:51], v[228:231], v[76:79], v[48:51]
s_waitcnt lgkmcnt(4)
v_mfma_f32_16x16x32_bf16 v[44:47], v[232:235], v[84:87], v[44:47]
v_mfma_f32_16x16x32_bf16 v[48:51], v[236:239], v[84:87], v[48:51]
s_waitcnt lgkmcnt(2)
v_mfma_f32_16x16x32_bf16 v[44:47], v[240:243], v[92:95], v[44:47]
v_mfma_f32_16x16x32_bf16 v[48:51], v[244:247], v[92:95], v[48:51]
s_waitcnt lgkmcnt(0)
v_mfma_f32_16x16x32_bf16 v[44:47], v[248:251], v[100:103], v[44:47]
v_mfma_f32_16x16x32_bf16 v[48:51], v[252:255], v[100:103], v[48:51]
v_mfma_f32_16x16x32_bf16 v[36:39], v[232:235], v[80:83], v[36:39]
s_lshl_b32 s15, s8, 11
s_add_u32 s15, s15, 0x20000
v_mfma_f32_16x16x32_bf16 v[40:43], v[236:239], v[80:83], v[40:43]
s_xor_b32 s16, s15, 0x1000
v_add_u32 v104, s15, v1
v_mfma_f32_16x16x32_bf16 v[36:39], v[240:243], v[88:91], v[36:39]
v_add_u32 v105, s16, v1
v_mfma_f32_16x16x32_bf16 v[40:43], v[244:247], v[88:91], v[40:43]
ds_write_b128 v104, v[44:47] offset:0
ds_write_b128 v104, v[48:51] offset:1024
v_mfma_f32_16x16x32_bf16 v[36:39], v[248:251], v[96:99], v[36:39]
v_mfma_f32_16x16x32_bf16 v[40:43], v[252:255], v[96:99], v[40:43]
s_waitcnt lgkmcnt(0)
s_barrier
ds_read_b128 v[68:71], v105 offset:0
ds_read_b128 v[72:75], v105 offset:1024
s_nop 2
v_pk_add_f32 v[28:29], v[28:29], v[36:37]
v_pk_add_f32 v[30:31], v[30:31], v[38:39]
v_pk_add_f32 v[32:33], v[32:33], v[40:41]
v_pk_add_f32 v[34:35], v[34:35], v[42:43]
s_waitcnt lgkmcnt(1)
v_pk_add_f32 v[28:29], v[28:29], v[68:69]
v_pk_add_f32 v[30:31], v[30:31], v[70:71]
s_waitcnt lgkmcnt(0)
v_pk_add_f32 v[32:33], v[32:33], v[72:73]
v_pk_add_f32 v[34:35], v[34:35], v[74:75]
v_cvt_pk_bf16_f32 v76, v28, v29
v_cvt_pk_bf16_f32 v77, v30, v31
v_cvt_pk_bf16_f32 v78, v32, v33
v_cvt_pk_bf16_f32 v79, v34, v35
buffer_store_dwordx4 v[76:79], v12, s[20:23], s54 offen
s_waitcnt vmcnt(0)
s_endpgm
L_spin_6:
s_mov_b32 s44, 0
L_spin_6_l:
buffer_load_dword v17, v19, s[4:7], 0 offen sc1
s_add_u32 s44, s44, 1
s_cmp_gt_u32 s44, 0x40000
s_cbranch_scc1 L_abort
s_waitcnt vmcnt(0)
v_lshrrev_b32 v17, 3, v17
v_subrev_u32 v17, s46, v17
v_cmp_lt_u32 vcc, 31, v17
s_cbranch_vccnz L_spin_6_l
s_branch L_ok_5
L_spin_8:
s_mov_b32 s44, 0
L_spin_8_l:
buffer_load_dword v17, v4, s[4:7], s92 offen sc1
s_add_u32 s44, s44, 1
s_cmp_gt_u32 s44, 0x40000
s_cbranch_scc1 L_abort
s_waitcnt vmcnt(0)
v_lshrrev_b32 v17, 3, v17
v_subrev_u32 v17, s46, v17
v_cmp_lt_u32 vcc, 31, v17
s_cbranch_vccnz L_spin_8_l
s_branch L_ok_7
L_spin_10:
s_mov_b32 s44, 0
L_spin_10_l:
buffer_load_dword v17, v4, s[4:7], s92 offen sc1
s_add_u32 s44, s44, 1
s_cmp_gt_u32 s44, 0x40000
s_cbranch_scc1 L_abort
s_waitcnt vmcnt(0)
v_lshrrev_b32 v17, 3, v17
v_subrev_u32 v17, s46, v17
v_cmp_lt_u32 vcc, 31, v17
s_cbranch_vccnz L_spin_10_l
s_branch L_ok_9
L_spin_12:
s_mov_b32 s55, 0
L_spin_12_l:
buffer_load_dword v17, v4, s[4:7], s92 offen sc1
s_add_u32 s55, s55, 1
s_cmp_gt_u32 s55, 0x40000
s_cbranch_scc1 L_abort
s_waitcnt vmcnt(0)
v_lshrrev_b32 v17, 3, v17
v_subrev_u32 v17, s44, v17
v_cmp_lt_u32 vcc, 31, v17
s_cbranch_vccnz L_spin_12_l
s_branch L_ok_11
L_spin_14:
s_mov_b32 s55, 0
L_spin_14_l:
buffer_load_dword v17, v4, s[4:7], s92 offen sc1
s_add_u32 s55, s55, 1
s_cmp_gt_u32 s55, 0x40000
s_cbranch_scc1 L_abort
s_waitcnt vmcnt(0)
v_lshrrev_b32 v17, 3, v17
v_subrev_u32 v17, s44, v17
v_cmp_lt_u32 vcc, 31, v17
s_cbranch_vccnz L_spin_14_l
s_branch L_ok_13
L_spin_16:
s_mov_b32 s44, 0
L_spin_16_l:
buffer_load_dword v17, v4, s[4:7], s92 offen sc1
s_add_u32 s44, s44, 1
s_cmp_gt_u32 s44, 0x40000
s_cbranch_scc1 L_abort
s_waitcnt vmcnt(0)
v_lshrrev_b32 v17, 3, v17
v_subrev_u32 v17, s46, v17
v_cmp_lt_u32 vcc, 31, v17
s_cbranch_vccnz L_spin_16_l
s_branch L_ok_15
L_spin_18:
s_mov_b32 s55, 0
L_spin_18_l:
buffer_load_dword v17, v4, s[4:7], s92 offen sc1
s_add_u32 s55, s55, 1
s_cmp_gt_u32 s55, 0x40000
s_cbranch_scc1 L_abort
s_waitcnt vmcnt(0)
v_lshrrev_b32 v17, 3, v17
v_subrev_u32 v17, s44, v17
v_cmp_lt_u32 vcc, 31, v17
s_cbranch_vccnz L_spin_18_l
s_branch L_ok_17
L_spin_20:
s_mov_b32 s55, 0
L_spin_20_l:
buffer_load_dword v17, v4, s[4:7], s92 offen sc1
s_add_u32 s55, s55, 1
s_cmp_gt_u32 s55, 0x40000
s_cbranch_scc1 L_abort
s_waitcnt vmcnt(0)
v_lshrrev_b32 v17, 3, v17
v_subrev_u32 v17, s44, v17
v_cmp_lt_u32 vcc, 31, v17
s_cbranch_vccnz L_spin_20_l
s_branch L_ok_19
L_spin_22:
s_cmp_lg_u32 s33, 0
s_cbranch_scc1 L_ok_21
s_mov_b32 s55, 0
L_spin_22_l:
buffer_load_dword v17, v4, s[4:7], s90 offen sc1
s_add_u32 s55, s55, 1
s_cmp_gt_u32 s55, 0x40000
s_cbranch_scc1 L_abort
s_waitcnt vmcnt(0)
v_lshrrev_b32 v17, 3, v17
v_subrev_u32 v17, s44, v17
v_cmp_lt_u32 vcc, 31, v17
s_cbranch_vccnz L_spin_22_l
s_branch L_ok_21
L_spin_24:
s_mov_b32 s55, 0
L_spin_24_l:
buffer_load_dword v17, v4, s[4:7], s92 offen sc1
s_add_u32 s55, s55, 1
s_cmp_gt_u32 s55, 0x40000
s_cbranch_scc1 L_abort
s_waitcnt vmcnt(0)
v_lshrrev_b32 v17, 3, v17
v_subrev_u32 v17, s44, v17
v_cmp_lt_u32 vcc, 31, v17
s_cbranch_vccnz L_spin_24_l
s_branch L_ok_23
L_spin_26:
s_mov_b32 s44, 0
L_spin_26_l:
buffer_load_dword v17, v4, s[4:7], s92 offen sc1
s_add_u32 s44, s44, 1
s_cmp_gt_u32 s44, 0x40000
s_cbranch_scc1 L_abort
s_waitcnt vmcnt(0)
v_lshrrev_b32 v17, 3, v17
v_subrev_u32 v17, s46, v17
v_cmp_lt_u32 vcc, 31, v17
s_cbranch_vccnz L_spin_26_l
s_branch L_ok_25
L_spin_28:
s_mov_b32 s44, 0
L_spin_28_l:
buffer_load_dword v17, v4, s[4:7], s92 offen sc1
s_add_u32 s44, s44, 1
s_cmp_gt_u32 s44, 0x40000
s_cbranch_scc1 L_abort
s_waitcnt vmcnt(0)
v_lshrrev_b32 v17, 3, v17
v_subrev_u32 v17, s46, v17
v_cmp_lt_u32 vcc, 31, v17
s_cbranch_vccnz L_spin_28_l
s_branch L_ok_27
L_spin_30:
s_mov_b32 s44, 0
L_spin_30_l:
buffer_load_dword v17, v4, s[4:7], s92 offen sc1
s_add_u32 s44, s44, 1
s_cmp_gt_u32 s44, 0x40000
s_cbranch_scc1 L_abort
s_waitcnt vmcnt(0)
v_lshrrev_b32 v17, 3, v17
v_subrev_u32 v17, s46, v17
v_cmp_lt_u32 vcc, 31, v17
s_cbranch_vccnz L_spin_30_l
s_branch L_ok_29
L_spin_32:
s_mov_b32 s55, 0
L_spin_32_l:
buffer_load_dword v17, v4, s[4:7], s92 offen sc1
s_add_u32 s55, s55, 1
s_cmp_gt_u32 s55, 0x40000
s_cbranch_scc1 L_abort
s_waitcnt vmcnt(0)
v_lshrrev_b32 v17, 3, v17
v_subrev_u32 v17, s44, v17
v_cmp_lt_u32 vcc, 31, v17
s_cbranch_vccnz L_spin_32_l
s_branch L_ok_31
L_spin_34:
s_mov_b32 s44, 0
L_spin_34_l:
buffer_load_dword v17, v4, s[4:7], s92 offen sc1
s_add_u32 s44, s44, 1
s_cmp_gt_u32 s44, 0x40000
s_cbranch_scc1 L_abort
s_waitcnt vmcnt(0)
v_lshrrev_b32 v17, 3, v17
v_subrev_u32 v17, s46, v17
v_cmp_lt_u32 vcc, 31, v17
s_cbranch_vccnz L_spin_34_l
s_branch L_ok_33
L_spin_36:
s_mov_b32 s55, 0
L_spin_36_l:
buffer_load_dword v17, v4, s[4:7], s92 offen sc1
s_add_u32 s55, s55, 1
s_cmp_gt_u32 s55, 0x40000
s_cbranch_scc1 L_abort
s_waitcnt vmcnt(0)
v_lshrrev_b32 v17, 3, v17
v_subrev_u32 v17, s44, v17
v_cmp_lt_u32 vcc, 31, v17
s_cbranch_vccnz L_spin_36_l
s_branch L_ok_35
L_spin_2:
s_mov_b32 s44, 0
v_mov_b32 v108, 0
L_spin_2_l:
buffer_load_dword v16, v108, s[48:51], 0 offen sc1
s_add_u32 s44, s44, 1
s_cmp_gt_u32 s44, 0x40000
s_cbranch_scc1 L_abort
s_waitcnt vmcnt(0)
v_cmp_eq_u32 vcc, 0, v16
s_cbranch_vccnz L_spin_2_l
s_branch L_ok_1
L_spin_4:
s_mov_b32 s44, 0
L_spin_4_l:
buffer_load_dword v17, v175, s[4:7], 0 offen sc1
s_add_u32 s44, s44, 1
s_cmp_gt_u32 s44, 0x40000
s_cbranch_scc1 L_abort
s_waitcnt vmcnt(0)
v_lshrrev_b32 v17, 3, v17
v_subrev_u32 v17, s46, v17
v_cmp_lt_u32 vcc, 31, v17
s_cbranch_vccnz L_spin_4_l
s_branch L_ok_3
L_body_slow:
s_mov_b32 s47, s100
ds_read_b128 v[68:71], v6 offset:64
ds_read2_b32 v[88:89], v5 offset0:48 offset1:128
ds_read_b128 v[90:93], v6 offset:0
ds_read2_b32 v[94:95], v5 offset0:64 offset1:144
v_add_u32 v96, s91, v5
v_subrev_u32 v97, s91, v6
ds_read_b32 v96, v96 offset:128
ds_read_b128 v[72:75], v97 offset:192
ds_read_b128 v[76:79], v97 offset:512
ds_read_b128 v[80:83], v97 offset:256
ds_read_b128 v[84:87], v97 offset:576
s_lshl_b32 s29, s14, 6
s_add_u32 s29, s29, 0
s_lshl_b32 s46, s30, 9
s_add_u32 s29, s29, s46
s_and_b32 s29, s29, 0x380
s_add_u32 m0, s17, 114688
s_add_u32 s29, s29, s93
buffer_load_dwordx4 v255, s[68:71], s29 offen lds
s_waitcnt lgkmcnt(4)
v_pk_mul_f32 v[98:99], v[68:69], v[88:89] op_sel:[0,1] op_sel_hi:[1,1]
v_pk_mul_f32 v[100:101], v[70:71], v[88:89] op_sel:[0,1] op_sel_hi:[1,1]
v_pk_fma_f32 v[44:45], v[44:45], v[88:89], v[98:99] op_sel_hi:[1,0,1]
v_pk_fma_f32 v[46:47], v[46:47], v[88:89], v[100:101] op_sel_hi:[1,0,1]
v_cvt_pk_bf16_f32 v106, v44, v45
v_cvt_pk_bf16_f32 v107, v46, v47
v_pk_mul_f32 v[98:99], v[90:91], v[88:89] op_sel:[0,1] op_sel_hi:[1,1]
v_pk_mul_f32 v[100:101], v[92:93], v[88:89] op_sel:[0,1] op_sel_hi:[1,1]
v_pk_fma_f32 v[36:37], v[36:37], v[88:89], v[98:99] op_sel_hi:[1,0,1]
s_lshl_b32 s29, s14, 6
s_add_u32 s29, s29, 128
s_lshl_b32 s46, s30, 9
s_add_u32 s29, s29, s46
s_and_b32 s29, s29, 0x380
s_add_u32 m0, s17, 116736
s_add_u32 s29, s29, s93
buffer_load_dwordx4 v255, s[68:71], s29 offen lds
v_pk_fma_f32 v[38:39], v[38:39], v[88:89], v[100:101] op_sel_hi:[1,0,1]
v_cvt_pk_bf16_f32 v116, v36, v37
v_cvt_pk_bf16_f32 v117, v38, v39
v_pk_mul_f32 v[98:99], v[68:69], v[94:95] op_sel:[0,1] op_sel_hi:[1,1]
v_pk_mul_f32 v[100:101], v[70:71], v[94:95] op_sel:[0,1] op_sel_hi:[1,1]
v_pk_fma_f32 v[48:49], v[48:49], v[94:95], v[98:99] op_sel_hi:[1,0,1]
v_pk_fma_f32 v[50:51], v[50:51], v[94:95], v[100:101] op_sel_hi:[1,0,1]
v_cvt_pk_bf16_f32 v108, v48, v49
v_cvt_pk_bf16_f32 v109, v50, v51
s_lshl_b32 s29, s14, 6
s_add_u32 s29, s29, 256
s_lshl_b32 s46, s30, 9
s_add_u32 s29, s29, s46
s_and_b32 s29, s29, 0x380
s_add_u32 m0, s17, 118784
s_add_u32 s29, s29, s93
buffer_load_dwordx4 v255, s[68:71], s29 offen lds
v_pk_mul_f32 v[98:99], v[90:91], v[94:95] op_sel:[0,1] op_sel_hi:[1,1]
v_pk_mul_f32 v[100:101], v[92:93], v[94:95] op_sel:[0,1] op_sel_hi:[1,1]
v_pk_fma_f32 v[40:41], v[40:41], v[94:95], v[98:99] op_sel_hi:[1,0,1]
v_pk_fma_f32 v[42:43], v[42:43], v[94:95], v[100:101] op_sel_hi:[1,0,1]
v_cvt_pk_bf16_f32 v118, v40, v41
v_cvt_pk_bf16_f32 v119, v42, v43
s_waitcnt lgkmcnt(2)
v_pk_mul_f32 v[76:77], v[76:77], v[96:97] op_sel_hi:[1,0]
v_pk_mul_f32 v[78:79], v[78:79], v[96:97] op_sel_hi:[1,0]
v_pk_fma_f32 v[52:53], v[52:53], v[72:73], v[76:77]
s_lshl_b32 s29, s14, 6
s_add_u32 s29, s29, 384
s_lshl_b32 s46, s30, 9
s_add_u32 s29, s29, s46
s_and_b32 s29, s29, 0x380
s_add_u32 m0, s17, 120832
s_add_u32 s29, s29, s93
buffer_load_dwordx4 v255, s[68:71], s29 offen lds
v_pk_fma_f32 v[54:55], v[54:55], v[74:75], v[78:79]
v_cvt_pk_bf16_f32 v112, v52, v53
v_cvt_pk_bf16_f32 v113, v54, v55
s_waitcnt lgkmcnt(0)
v_pk_mul_f32 v[84:85], v[84:85], v[96:97] op_sel_hi:[1,0]
v_pk_mul_f32 v[86:87], v[86:87], v[96:97] op_sel_hi:[1,0]
v_pk_fma_f32 v[56:57], v[56:57], v[80:81], v[84:85]
v_pk_fma_f32 v[58:59], v[58:59], v[82:83], v[86:87]
v_cvt_pk_bf16_f32 v114, v56, v57
v_cvt_pk_bf16_f32 v115, v58, v59
s_waitcnt vmcnt(4)
v_add_f32 v120, v120, v122
v_add_f32 v124, v124, v126
v_add_f32 v121, v121, v123
v_add_f32 v125, v125, v127
v_add_f32 v120, v120, v124
v_add_f32 v121, v121, v125
v_add_u32 v122, s52, v5
s_nop 0
v_permlane32_swap_b32 v120, v121
v_add_f32 v120, v120, v121
v_mov_b32 v121, v120
s_nop 1
v_permlane16_swap_b32 v120, v121
v_add_f32 v120, v120, v121
v_mov_b32 v121, v120
s_nop 1
v_permlane32_swap_b32 v120, v121
v_mul_f32 v120, 0x3b000000, v120
v_mul_f32 v121, 0x3b000000, v121
v_fma_f32 v121, -v120, v120, v121
v_max_f32 v121, 0, v121
v_add_f32 v121, 0x3727c5ac, v121
v_rsq_f32 v121, v121
v_sub_f32 v120, 0, v120
v_mul_f32 v120, v120, v121
ds_write_b32 v122, v121 offset:64
ds_write_b32 v122, v120 offset:384
s_waitcnt lgkmcnt(0)
s_barrier
ds_read_b128 v[88:91], v250 offset:2048
ds_read_b128 v[92:95], v251 offset:2048
ds_read_b128 v[96:99], v250 offset:6144
s_waitcnt lgkmcnt(2)
v_mfma_f32_16x16x32_bf16 v[52:55], a[4:7], v[88:91], 0
ds_read_b128 v[100:103], v251 offset:6144
v_mfma_f32_16x16x32_bf16 v[56:59], v[88:91], a[8:11], 0
s_waitcnt lgkmcnt(2)
v_mfma_f32_16x16x32_bf16 v[52:55], a[16:19], v[92:95], v[52:55]
ds_read_b128 v[88:91], v250 offset:10240
v_mfma_f32_16x16x32_bf16 v[56:59], v[92:95], a[20:23], v[56:59]
s_waitcnt lgkmcnt(2)
v_mfma_f32_16x16x32_bf16 v[52:55], a[28:31], v[96:99], v[52:55]
ds_read_b128 v[92:95], v251 offset:10240
s_add_u32 s46, s58, 0x0
v_mfma_f32_16x16x32_bf16 v[56:59], v[96:99], a[32:35], v[56:59]
buffer_load_dwordx2 v[120:121], v14, s[4:7], s46 offen sc1
s_waitcnt lgkmcnt(2)
v_mfma_f32_16x16x32_bf16 v[52:55], a[40:43], v[100:103], v[52:55]
ds_read_b128 v[96:99], v250 offset:14336
buffer_load_dwordx2 v[122:123], v14, s[4:7], s46 offen offset:256 sc1
v_mfma_f32_16x16x32_bf16 v[56:59], v[100:103], a[44:47], v[56:59]
s_waitcnt lgkmcnt(2)
v_mfma_f32_16x16x32_bf16 v[52:55], a[52:55], v[88:91], v[52:55]
ds_read_b128 v[100:103], v251 offset:14336
v_mfma_f32_16x16x32_bf16 v[56:59], v[88:91], a[56:59], v[56:59]
s_add_u32 s46, s58, 0x0
s_waitcnt lgkmcnt(2)
v_mfma_f32_16x16x32_bf16 v[52:55], a[64:67], v[92:95], v[52:55]
ds_read_b128 v[88:91], v250 offset:18432
buffer_load_dwordx2 v[124:125], v14, s[4:7], s46 offen offset:512 sc1
v_mfma_f32_16x16x32_bf16 v[56:59], v[92:95], a[68:71], v[56:59]
buffer_load_dwordx2 v[126:127], v14, s[4:7], s46 offen offset:768 sc1
s_waitcnt lgkmcnt(2)
v_mfma_f32_16x16x32_bf16 v[52:55], a[76:79], v[96:99], v[52:55]
ds_read_b128 v[92:95], v251 offset:18432
v_mfma_f32_16x16x32_bf16 v[56:59], v[96:99], a[80:83], v[56:59]
s_waitcnt lgkmcnt(2)
v_mfma_f32_16x16x32_bf16 v[52:55], a[88:91], v[100:103], v[52:55]
ds_read_b128 v[96:99], v250 offset:22528
v_mfma_f32_16x16x32_bf16 v[56:59], v[100:103], a[92:95], v[56:59]
s_waitcnt lgkmcnt(2)
v_mfma_f32_16x16x32_bf16 v[52:55], a[100:103], v[88:91], v[52:55]
ds_read_b128 v[100:103], v251 offset:22528
v_mfma_f32_16x16x32_bf16 v[56:59], v[88:91], a[104:107], v[56:59]
s_waitcnt lgkmcnt(2)
v_mfma_f32_16x16x32_bf16 v[52:55], a[112:115], v[92:95], v[52:55]
ds_read_b128 v[88:91], v250 offset:26624
buffer_load_dword v17, v19, s[4:7], 0 offen sc1
v_mfma_f32_16x16x32_bf16 v[56:59], v[92:95], a[116:119], v[56:59]
s_waitcnt lgkmcnt(2)
v_mfma_f32_16x16x32_bf16 v[52:55], a[124:127], v[96:99], v[52:55]
ds_read_b128 v[92:95], v251 offset:26624
v_mfma_f32_16x16x32_bf16 v[56:59], v[96:99], a[128:131], v[56:59]
s_waitcnt lgkmcnt(2)
v_mfma_f32_16x16x32_bf16 v[52:55], a[136:139], v[100:103], v[52:55]
ds_read_b128 v[96:99], v250 offset:30720
v_mfma_f32_16x16x32_bf16 v[56:59], v[100:103], a[140:143], v[56:59]
s_waitcnt lgkmcnt(2)
v_mfma_f32_16x16x32_bf16 v[52:55], a[148:151], v[88:91], v[52:55]
ds_read_b128 v[100:103], v251 offset:30720
v_mfma_f32_16x16x32_bf16 v[56:59], v[88:91], a[152:155], v[56:59]
s_waitcnt lgkmcnt(2)
v_mfma_f32_16x16x32_bf16 v[52:55], a[160:163], v[92:95], v[52:55]
v_mfma_f32_16x16x32_bf16 v[56:59], v[92:95], a[164:167], v[56:59]
s_waitcnt lgkmcnt(1)
v_mfma_f32_16x16x32_bf16 v[52:55], a[172:175], v[96:99], v[52:55]
ds_read_b128 v[68:71], v6 offset:64
ds_read2_b32 v[72:73], v5 offset0:32 offset1:112
v_mfma_f32_16x16x32_bf16 v[56:59], v[96:99], a[176:179], v[56:59]
v_add_u32 v74, s91, v5
s_waitcnt lgkmcnt(2)
v_mfma_f32_16x16x32_bf16 v[52:55], a[184:187], v[100:103], v[52:55]
v_subrev_u32 v75, s91, v6
ds_read_b32 v74, v74 offset:128
v_mfma_f32_16x16x32_bf16 v[56:59], v[100:103], a[188:191], v[56:59]
ds_read_b128 v[80:83], v75 offset:128
ds_read_b128 v[84:87], v75 offset:448
s_waitcnt lgkmcnt(2)
v_pk_mul_f32 v[76:77], v[68:69], v[72:73] op_sel:[0,1] op_sel_hi:[1,1]
v_pk_mul_f32 v[78:79], v[70:71], v[72:73] op_sel:[0,1] op_sel_hi:[1,1]
v_pk_fma_f32 v[52:53], v[52:53], v[72:73], v[76:77] op_sel_hi:[1,0,1]
v_pk_fma_f32 v[54:55], v[54:55], v[72:73], v[78:79] op_sel_hi:[1,0,1]
v_cvt_pk_bf16_f32 v104, v52, v53
v_cvt_pk_bf16_f32 v105, v54, v55
s_waitcnt lgkmcnt(0)
v_pk_mul_f32 v[84:85], v[84:85], v[74:75] op_sel_hi:[1,0]
v_pk_mul_f32 v[86:87], v[86:87], v[74:75] op_sel_hi:[1,0]
v_pk_fma_f32 v[56:57], v[56:57], v[80:81], v[84:85]
v_pk_fma_f32 v[58:59], v[58:59], v[82:83], v[86:87]
v_cvt_pk_bf16_f32 v110, v56, v57
v_cvt_pk_bf16_f32 v111, v58, v59
v_add_u32 v80, 0x27400, v1
ds_read_b128 v[84:87], v80 offset:1024
ds_read_b128 v[80:83], v80
v_mfma_f32_16x16x16_bf16 v[36:39], v[104:105], v[116:117], 0
v_mfma_f32_16x16x16_bf16 v[40:43], v[106:107], v[116:117], 0
v_mfma_f32_16x16x16_bf16 v[44:47], v[106:107], v[118:119], 0
v_mfma_f32_16x16x16_bf16 v[48:51], v[108:109], v[118:119], 0
v_mov_b32 v52, 0x3f803f80
v_mov_b32 v53, 0x3f803f80
v_mov_b32 v54, 0x3f803f80
v_mov_b32 v55, 0x3f803f80
v_mov_b32 v108, v104
v_mov_b32 v109, v105
s_waitcnt lgkmcnt(0)
v_pk_fma_f32 v[36:37], v[36:37], s[34:35], v[80:81]
v_pk_fma_f32 v[38:39], v[38:39], s[34:35], v[82:83]
v_pk_fma_f32 v[40:41], v[40:41], s[34:35], v[84:85]
v_pk_fma_f32 v[42:43], v[42:43], s[34:35], v[86:87]
v_pk_fma_f32 v[44:45], v[44:45], s[34:35], v[80:81]
v_pk_fma_f32 v[46:47], v[46:47], s[34:35], v[82:83]
v_pk_fma_f32 v[48:49], v[48:49], s[34:35], v[84:85]
v_pk_fma_f32 v[50:51], v[50:51], s[34:35], v[86:87]
v_max3_f32 v56, v36, v37, v38
v_max3_f32 v58, v44, v45, v46
v_max3_f32 v57, v39, v40, v41
v_max3_f32 v59, v47, v48, v49
v_max3_f32 v56, v56, v42, v43
v_max3_f32 v58, v58, v50, v51
v_max_f32 v56, v56, v57
v_max_f32 v58, v58, v59
s_add_u32 s15, s47, s39
s_add_u32 s15, s15, 0x200000
v_permlane32_swap_b32 v56, v58
v_max_f32 v56, v56, v58
v_mov_b32 v58, v56
s_nop 1
v_permlane16_swap_b32 v56, v58
v_max_f32 v56, v56, v58
v_mov_b32 v58, v56
s_nop 1
v_permlane32_swap_b32 v56, v58
v_pk_add_f32 v[36:37], v[36:37], v[56:57] op_sel_hi:[1,0] neg_lo:[0,1] neg_hi:[0,1]
v_pk_add_f32 v[38:39], v[38:39], v[56:57] op_sel_hi:[1,0] neg_lo:[0,1] neg_hi:[0,1]
v_pk_add_f32 v[40:41], v[40:41], v[56:57] op_sel_hi:[1,0] neg_lo:[0,1] neg_hi:[0,1]
v_pk_add_f32 v[42:43], v[42:43], v[56:57] op_sel_hi:[1,0] neg_lo:[0,1] neg_hi:[0,1]
v_exp_f32 v36, v36
v_exp_f32 v37, v37
v_exp_f32 v38, v38
v_exp_f32 v39, v39
v_exp_f32 v40, v40
v_exp_f32 v41, v41
v_exp_f32 v42, v42
v_exp_f32 v43, v43
v_pk_add_f32 v[44:45], v[44:45], v[58:59] op_sel_hi:[1,0] neg_lo:[0,1] neg_hi:[0,1]
v_pk_add_f32 v[46:47], v[46:47], v[58:59] op_sel_hi:[1,0] neg_lo:[0,1] neg_hi:[0,1]
v_pk_add_f32 v[48:49], v[48:49], v[58:59] op_sel_hi:[1,0] neg_lo:[0,1] neg_hi:[0,1]
v_pk_add_f32 v[50:51], v[50:51], v[58:59] op_sel_hi:[1,0] neg_lo:[0,1] neg_hi:[0,1]
v_exp_f32 v44, v44
v_exp_f32 v45, v45
v_exp_f32 v46, v46
v_exp_f32 v47, v47
v_exp_f32 v48, v48
v_exp_f32 v49, v49
v_exp_f32 v50, v50
v_exp_f32 v51, v51
s_add_u32 s46, s32, 1
s_waitcnt vmcnt(0)
v_lshrrev_b32 v17, 3, v17
v_subrev_u32 v17, s46, v17
v_cmp_lt_u32 vcc, 31, v17
s_cbranch_vccnz L_spin_39
L_ok_38:
s_barrier
ds_read_b128 v[92:95], v250 offset:40960
ds_read_b128 v[96:99], v250 offset:16384
ds_read_b128 v[100:103], v250 offset:18432
v_cvt_pk_bf16_f32 v68, v36, v37
v_cvt_pk_bf16_f32 v69, v38, v39
v_cvt_pk_bf16_f32 v70, v40, v41
v_cvt_pk_bf16_f32 v71, v42, v43
v_cvt_pk_bf16_f32 v72, v44, v45
v_cvt_pk_bf16_f32 v73, v46, v47
v_cvt_pk_bf16_f32 v74, v48, v49
v_cvt_pk_bf16_f32 v75, v50, v51
v_mfma_f32_16x16x32_bf16 v[40:43], v[52:55], v[68:71], 0
s_nop 0
v_mfma_f32_16x16x32_bf16 v[48:51], v[52:55], v[72:75], 0
v_mfma_f32_16x16x32_bf16 v[36:39], v[110:113], v[68:71], 0
v_mfma_f32_16x16x32_bf16 v[44:47], v[112:115], v[72:75], 0
v_mov_b32 v114, v110
v_mov_b32 v115, v111
s_nop 1
v_rcp_f32 v40, v40
s_nop 0
v_rcp_f32 v48, v48
v_pk_mul_f32 v[36:37], v[36:37], v[40:41] op_sel_hi:[1,0]
v_pk_mul_f32 v[38:39], v[38:39], v[40:41] op_sel_hi:[1,0]
v_pk_mul_f32 v[44:45], v[44:45], v[48:49] op_sel_hi:[1,0]
v_pk_mul_f32 v[46:47], v[46:47], v[48:49] op_sel_hi:[1,0]
v_cvt_pk_bf16_f32 v76, v36, v37
v_cvt_pk_bf16_f32 v77, v38, v39
v_cvt_pk_bf16_f32 v78, v44, v45
v_cvt_pk_bf16_f32 v79, v46, v47
s_nop 0
v_permlane32_swap_b32 v76, v78
v_permlane32_swap_b32 v77, v79
buffer_store_dwordx4 v[76:79], v3, s[4:7], s15 offen sc1
ds_read_b128 v[80:83], v251 offset:40960
ds_read_b128 v[84:87], v251 offset:16384
ds_read_b128 v[88:91], v251 offset:18432
s_waitcnt lgkmcnt(3)
v_mfma_f32_16x16x32_bf16 v[44:47], a[100:103], v[92:95], 0
ds_read_b128 v[68:71], v250 offset:43008
ds_read_b128 v[72:75], v250 offset:20480
v_mfma_f32_16x16x32_bf16 v[48:51], v[92:95], a[104:107], 0
ds_read_b128 v[76:79], v250 offset:22528
v_mfma_f32_16x16x32_bf16 v[36:39], a[100:103], v[96:99], 0
s_add_u32 s28, s25, 0
buffer_load_dwordx4 a[192:195], v1, s[4:7], s28 offen sc1
v_mfma_f32_16x16x32_bf16 v[40:43], v[96:99], a[104:107], 0
v_mfma_f32_16x16x32_bf16 v[60:63], a[96:99], v[96:99], 0
v_mfma_f32_16x16x32_bf16 v[64:67], a[96:99], v[100:103], 0
buffer_load_dwordx4 a[196:199], v1, s[4:7], s28 offen offset:1024 sc1
s_waitcnt lgkmcnt(3)
v_mfma_f32_16x16x32_bf16 v[44:47], a[112:115], v[80:83], v[44:47]
ds_read_b128 v[92:95], v251 offset:43008
ds_read_b128 v[96:99], v251 offset:20480
v_mfma_f32_16x16x32_bf16 v[48:51], v[80:83], a[116:119], v[48:51]
ds_read_b128 v[100:103], v251 offset:22528
v_mfma_f32_16x16x32_bf16 v[36:39], a[112:115], v[84:87], v[36:39]
s_add_u32 s28, s25, 4096
buffer_load_dwordx4 a[96:99], v1, s[4:7], s28 offen sc1
v_mfma_f32_16x16x32_bf16 v[40:43], v[84:87], a[116:119], v[40:43]
v_mfma_f32_16x16x32_bf16 v[60:63], a[108:111], v[84:87], v[60:63]
v_mfma_f32_16x16x32_bf16 v[64:67], a[108:111], v[88:91], v[64:67]
buffer_load_dwordx4 a[100:103], v1, s[4:7], s28 offen offset:1024 sc1
s_waitcnt lgkmcnt(3)
v_mfma_f32_16x16x32_bf16 v[44:47], a[124:127], v[68:71], v[44:47]
ds_read_b128 v[80:83], v250 offset:45056
ds_read_b128 v[84:87], v250 offset:24576
v_mfma_f32_16x16x32_bf16 v[48:51], v[68:71], a[128:131], v[48:51]
ds_read_b128 v[88:91], v250 offset:26624
v_mfma_f32_16x16x32_bf16 v[36:39], a[124:127], v[72:75], v[36:39]
buffer_load_dwordx4 a[104:107], v1, s[4:7], s28 offen offset:2048 sc1
v_mfma_f32_16x16x32_bf16 v[40:43], v[72:75], a[128:131], v[40:43]
v_mfma_f32_16x16x32_bf16 v[60:63], a[120:123], v[72:75], v[60:63]
v_mfma_f32_16x16x32_bf16 v[64:67], a[120:123], v[76:79], v[64:67]
buffer_load_dwordx4 a[108:111], v1, s[4:7], s28 offen offset:3072 sc1
s_waitcnt lgkmcnt(3)
v_mfma_f32_16x16x32_bf16 v[44:47], a[136:139], v[92:95], v[44:47]
ds_read_b128 v[68:71], v251 offset:45056
ds_read_b128 v[72:75], v251 offset:24576
v_mfma_f32_16x16x32_bf16 v[48:51], v[92:95], a[140:143], v[48:51]
ds_read_b128 v[76:79], v251 offset:26624
s_add_u32 s28, s25, 8192
buffer_load_dwordx4 a[112:115], v1, s[4:7], s28 offen sc1
buffer_load_dwordx4 a[116:119], v1, s[4:7], s28 offen offset:1024 sc1
s_waitcnt vmcnt(8)
v_mfma_f32_16x16x32_bf16 v[36:39], a[136:139], v[96:99], v[36:39]
buffer_store_dword v15, v13, s[4:7], s45 offen sc1
v_mfma_f32_16x16x32_bf16 v[40:43], v[96:99], a[140:143], v[40:43]
v_mfma_f32_16x16x32_bf16 v[60:63], a[132:135], v[96:99], v[60:63]
v_mfma_f32_16x16x32_bf16 v[64:67], a[132:135], v[100:103], v[64:67]
buffer_load_dwordx4 a[120:123], v1, s[4:7], s28 offen offset:2048 sc1
s_waitcnt lgkmcnt(3)
v_mfma_f32_16x16x32_bf16 v[44:47], a[148:151], v[80:83], v[44:47]
ds_read_b128 v[92:95], v250 offset:47104
ds_read_b128 v[96:99], v250 offset:28672
v_mfma_f32_16x16x32_bf16 v[48:51], v[80:83], a[152:155], v[48:51]
ds_read_b128 v[100:103], v250 offset:30720
v_mfma_f32_16x16x32_bf16 v[36:39], a[148:151], v[84:87], v[36:39]
buffer_load_dwordx4 a[124:127], v1, s[4:7], s28 offen offset:3072 sc1
v_mfma_f32_16x16x32_bf16 v[40:43], v[84:87], a[152:155], v[40:43]
v_mfma_f32_16x16x32_bf16 v[60:63], a[144:147], v[84:87], v[60:63]
v_mfma_f32_16x16x32_bf16 v[64:67], a[144:147], v[88:91], v[64:67]
s_add_u32 s28, s25, 12288
s_waitcnt lgkmcnt(3)
v_mfma_f32_16x16x32_bf16 v[44:47], a[160:163], v[68:71], v[44:47]
ds_read_b128 v[80:83], v251 offset:47104
ds_read_b128 v[84:87], v251 offset:28672
v_mfma_f32_16x16x32_bf16 v[48:51], v[68:71], a[164:167], v[48:51]
ds_read_b128 v[88:91], v251 offset:30720
buffer_load_dwordx4 a[128:131], v1, s[4:7], s28 offen sc1
v_mfma_f32_16x16x32_bf16 v[36:39], a[160:163], v[72:75], v[36:39]
v_mfma_f32_16x16x32_bf16 v[40:43], v[72:75], a[164:167], v[40:43]
v_mfma_f32_16x16x32_bf16 v[60:63], a[156:159], v[72:75], v[60:63]
buffer_load_dwordx4 a[132:135], v1, s[4:7], s28 offen offset:1024 sc1
v_mfma_f32_16x16x32_bf16 v[64:67], a[156:159], v[76:79], v[64:67]
s_waitcnt lgkmcnt(3)
v_mfma_f32_16x16x32_bf16 v[44:47], a[172:175], v[92:95], v[44:47]
ds_read_b128 v[68:71], v250 offset:32768
ds_read_b128 v[72:75], v250 offset:0
v_mfma_f32_16x16x32_bf16 v[48:51], v[92:95], a[176:179], v[48:51]
ds_read_b128 v[76:79], v250 offset:2048
buffer_load_dwordx4 a[136:139], v1, s[4:7], s28 offen offset:2048 sc1
v_mfma_f32_16x16x32_bf16 v[36:39], a[172:175], v[96:99], v[36:39]
v_mfma_f32_16x16x32_bf16 v[40:43], v[96:99], a[176:179], v[40:43]
v_mfma_f32_16x16x32_bf16 v[60:63], a[168:171], v[96:99], v[60:63]
buffer_load_dwordx4 a[140:143], v1, s[4:7], s28 offen offset:3072 sc1
v_mfma_f32_16x16x32_bf16 v[64:67], a[168:171], v[100:103], v[64:67]
s_waitcnt lgkmcnt(3)
v_mfma_f32_16x16x32_bf16 v[44:47], a[184:187], v[80:83], v[44:47]
ds_read_b128 v[92:95], v251 offset:32768
ds_read_b128 v[96:99], v251 offset:0
v_mfma_f32_16x16x32_bf16 v[48:51], v[80:83], a[188:191], v[48:51]
ds_read_b128 v[100:103], v251 offset:2048
s_add_u32 s28, s26, 24576
v_mfma_f32_16x16x32_bf16 v[36:39], a[184:187], v[84:87], v[36:39]
buffer_load_dwordx4 a[144:147], v1, s[4:7], s28 offen sc1
v_mfma_f32_16x16x32_bf16 v[40:43], v[84:87], a[188:191], v[40:43]
v_mfma_f32_16x16x32_bf16 v[60:63], a[180:183], v[84:87], v[60:63]
v_mfma_f32_16x16x32_bf16 v[64:67], a[180:183], v[88:91], v[64:67]
s_add_u32 s14, s28, s88
s_waitcnt lgkmcnt(3)
v_mfma_f32_16x16x32_bf16 v[44:47], a[4:7], v[68:71], v[44:47]
ds_read_b128 v[80:83], v250 offset:34816
ds_read_b128 v[84:87], v250 offset:4096
v_mfma_f32_16x16x32_bf16 v[48:51], v[68:71], a[8:11], v[48:51]
ds_read_b128 v[88:91], v250 offset:6144
buffer_load_dwordx4 a[148:151], v1, s[4:7], s14 offen sc1
v_mfma_f32_16x16x32_bf16 v[36:39], a[4:7], v[72:75], v[36:39]
v_mfma_f32_16x16x32_bf16 v[40:43], v[72:75], a[8:11], v[40:43]
v_mfma_f32_16x16x32_bf16 v[60:63], a[0:3], v[72:75], v[60:63]
s_add_u32 s14, s28, s89
buffer_load_dwordx4 a[152:155], v1, s[4:7], s14 offen sc1
v_mfma_f32_16x16x32_bf16 v[64:67], a[0:3], v[76:79], v[64:67]
s_waitcnt lgkmcnt(3)
v_mfma_f32_16x16x32_bf16 v[44:47], a[16:19], v[92:95], v[44:47]
ds_read_b128 v[68:71], v251 offset:34816
ds_read_b128 v[72:75], v251 offset:4096
v_mfma_f32_16x16x32_bf16 v[48:51], v[92:95], a[20:23], v[48:51]
ds_read_b128 v[76:79], v251 offset:6144
s_add_u32 s28, s26, 27648
v_mfma_f32_16x16x32_bf16 v[36:39], a[16:19], v[96:99], v[36:39]
buffer_load_dwordx4 a[156:159], v1, s[4:7], s28 offen sc1
v_mfma_f32_16x16x32_bf16 v[40:43], v[96:99], a[20:23], v[40:43]
v_mfma_f32_16x16x32_bf16 v[60:63], a[12:15], v[96:99], v[60:63]
v_mfma_f32_16x16x32_bf16 v[64:67], a[12:15], v[100:103], v[64:67]
s_add_u32 s14, s28, s88
s_waitcnt lgkmcnt(3)
v_mfma_f32_16x16x32_bf16 v[44:47], a[28:31], v[80:83], v[44:47]
ds_read_b128 v[92:95], v250 offset:36864
ds_read_b128 v[96:99], v250 offset:8192
v_mfma_f32_16x16x32_bf16 v[48:51], v[80:83], a[32:35], v[48:51]
ds_read_b128 v[100:103], v250 offset:10240
buffer_load_dwordx4 a[160:163], v1, s[4:7], s14 offen sc1
v_mfma_f32_16x16x32_bf16 v[36:39], a[28:31], v[84:87], v[36:39]
v_mfma_f32_16x16x32_bf16 v[40:43], v[84:87], a[32:35], v[40:43]
v_mfma_f32_16x16x32_bf16 v[60:63], a[24:27], v[84:87], v[60:63]
v_mfma_f32_16x16x32_bf16 v[64:67], a[24:27], v[88:91], v[64:67]
s_waitcnt lgkmcnt(3)
v_mfma_f32_16x16x32_bf16 v[44:47], a[40:43], v[68:71], v[44:47]
ds_read_b128 v[80:83], v251 offset:36864
ds_read_b128 v[84:87], v251 offset:8192
v_mfma_f32_16x16x32_bf16 v[48:51], v[68:71], a[44:47], v[48:51]
ds_read_b128 v[88:91], v251 offset:10240
buffer_load_dword v17, v4, s[4:7], s92 offen sc1
v_mfma_f32_16x16x32_bf16 v[36:39], a[40:43], v[72:75], v[36:39]
v_add_f32 v120, v120, v122
v_add_f32 v124, v124, v126
v_mfma_f32_16x16x32_bf16 v[40:43], v[72:75], a[44:47], v[40:43]
v_add_f32 v121, v121, v123
v_add_f32 v125, v125, v127
v_mfma_f32_16x16x32_bf16 v[60:63], a[36:39], v[72:75], v[60:63]
s_add_u32 s14, s28, s89
buffer_load_dwordx4 a[164:167], v1, s[4:7], s14 offen sc1
v_mfma_f32_16x16x32_bf16 v[64:67], a[36:39], v[76:79], v[64:67]
v_add_f32 v120, v120, v124
s_waitcnt lgkmcnt(3)
v_mfma_f32_16x16x32_bf16 v[44:47], a[52:55], v[92:95], v[44:47]
ds_read_b128 v[68:71], v250 offset:38912
ds_read_b128 v[72:75], v250 offset:12288
v_mfma_f32_16x16x32_bf16 v[48:51], v[92:95], a[56:59], v[48:51]
ds_read_b128 v[76:79], v250 offset:14336
s_add_u32 s28, s26, 30720
v_mfma_f32_16x16x32_bf16 v[36:39], a[52:55], v[96:99], v[36:39]
buffer_load_dwordx4 a[168:171], v1, s[4:7], s28 offen sc1
v_add_f32 v121, v121, v125
v_mfma_f32_16x16x32_bf16 v[40:43], v[96:99], a[56:59], v[40:43]
v_mov_b32 v122, v5
s_nop 0
v_mfma_f32_16x16x32_bf16 v[60:63], a[48:51], v[96:99], v[60:63]
v_permlane32_swap_b32 v120, v121
v_mfma_f32_16x16x32_bf16 v[64:67], a[48:51], v[100:103], v[64:67]
s_add_u32 s14, s28, s88
s_waitcnt lgkmcnt(3)
v_mfma_f32_16x16x32_bf16 v[44:47], a[64:67], v[80:83], v[44:47]
ds_read_b128 v[92:95], v251 offset:38912
ds_read_b128 v[96:99], v251 offset:12288
v_mfma_f32_16x16x32_bf16 v[48:51], v[80:83], a[68:71], v[48:51]
ds_read_b128 v[100:103], v251 offset:14336
buffer_load_dwordx4 a[172:175], v1, s[4:7], s14 offen sc1
v_mfma_f32_16x16x32_bf16 v[36:39], a[64:67], v[84:87], v[36:39]
v_add_f32 v120, v120, v121
v_mov_b32 v121, v120
v_mfma_f32_16x16x32_bf16 v[40:43], v[84:87], a[68:71], v[40:43]
s_nop 0
v_permlane16_swap_b32 v120, v121
v_mfma_f32_16x16x32_bf16 v[60:63], a[60:63], v[84:87], v[60:63]
s_add_u32 s14, s28, s89
buffer_load_dwordx4 a[176:179], v1, s[4:7], s14 offen sc1
v_mfma_f32_16x16x32_bf16 v[64:67], a[60:63], v[88:91], v[64:67]
v_add_f32 v120, v120, v121
s_waitcnt lgkmcnt(3)
v_mfma_f32_16x16x32_bf16 v[44:47], a[76:79], v[68:71], v[44:47]
v_mov_b32 v121, v120
v_mfma_f32_16x16x32_bf16 v[48:51], v[68:71], a[80:83], v[48:51]
s_add_u32 s28, s26, 33792
buffer_load_dwordx4 a[180:183], v1, s[4:7], s28 offen sc1
v_mfma_f32_16x16x32_bf16 v[36:39], a[76:79], v[72:75], v[36:39]
v_permlane32_swap_b32 v120, v121
v_mfma_f32_16x16x32_bf16 v[40:43], v[72:75], a[80:83], v[40:43]
v_mul_f32 v120, 0x3b000000, v120
v_mul_f32 v121, 0x3b000000, v121
v_mfma_f32_16x16x32_bf16 v[60:63], a[72:75], v[72:75], v[60:63]
s_add_u32 s14, s28, s88
buffer_load_dwordx4 a[184:187], v1, s[4:7], s14 offen sc1
v_mfma_f32_16x16x32_bf16 v[64:67], a[72:75], v[76:79], v[64:67]
v_fma_f32 v121, -v120, v120, v121
s_waitcnt lgkmcnt(0)
v_mfma_f32_16x16x32_bf16 v[44:47], a[88:91], v[92:95], v[44:47]
v_max_f32 v121, 0, v121
v_add_f32 v121, 0x3727c5ac, v121
v_mfma_f32_16x16x32_bf16 v[48:51], v[92:95], a[92:95], v[48:51]
s_add_u32 s14, s28, s89
buffer_load_dwordx4 a[188:191], v1, s[4:7], s14 offen sc1
v_mfma_f32_16x16x32_bf16 v[36:39], a[88:91], v[96:99], v[36:39]
v_rsq_f32 v121, v121
v_mfma_f32_16x16x32_bf16 v[40:43], v[96:99], a[92:95], v[40:43]
v_sub_f32 v120, 0, v120
v_mul_f32 v120, v120, v121
v_mfma_f32_16x16x32_bf16 v[60:63], a[84:87], v[96:99], v[60:63]
s_add_u32 s28, s25, 0
buffer_load_dwordx4 a[200:203], v1, s[4:7], s28 offen offset:2048 sc1
v_mfma_f32_16x16x32_bf16 v[64:67], a[84:87], v[100:103], v[64:67]
ds_write_b32 v122, v121 offset:0
ds_write_b32 v122, v120 offset:320
ds_read_b128 v[68:71], v6 offset:64
ds_read2_b32 v[72:73], v5 offset0:0 offset1:80
ds_read2_b32 v[74:75], v5 offset0:16 offset1:96
ds_read_b128 v[76:79], v6 offset:0
ds_read2_b32 v[80:81], v5 offset0:32 offset1:112
v_add_u32 v82, s91, v5
v_subrev_u32 v83, s91, v6
ds_read_b32 v82, v82 offset:128
ds_read_b128 v[88:91], v83 offset:0
ds_read_b128 v[92:95], v83 offset:320
ds_read_b128 v[96:99], v83 offset:64
ds_read_b128 v[100:103], v83 offset:384
s_waitcnt lgkmcnt(4)
v_pk_mul_f32 v[84:85], v[68:69], v[72:73] op_sel:[0,1] op_sel_hi:[1,1]
v_pk_mul_f32 v[86:87], v[70:71], v[72:73] op_sel:[0,1] op_sel_hi:[1,1]
v_pk_fma_f32 v[44:45], v[44:45], v[72:73], v[84:85] op_sel_hi:[1,0,1]
v_pk_fma_f32 v[46:47], v[46:47], v[72:73], v[86:87] op_sel_hi:[1,0,1]
v_cvt_pk_bf16_f32 v104, v44, v45
v_cvt_pk_bf16_f32 v105, v46, v47
v_pk_mul_f32 v[84:85], v[68:69], v[74:75] op_sel:[0,1] op_sel_hi:[1,1]
v_pk_mul_f32 v[86:87], v[70:71], v[74:75] op_sel:[0,1] op_sel_hi:[1,1]
v_pk_fma_f32 v[36:37], v[36:37], v[74:75], v[84:85] op_sel_hi:[1,0,1]
v_pk_fma_f32 v[38:39], v[38:39], v[74:75], v[86:87] op_sel_hi:[1,0,1]
v_cvt_pk_bf16_f32 v106, v36, v37
v_cvt_pk_bf16_f32 v107, v38, v39
v_pk_mul_f32 v[84:85], v[76:77], v[74:75] op_sel:[0,1] op_sel_hi:[1,1]
v_pk_mul_f32 v[86:87], v[78:79], v[74:75] op_sel:[0,1] op_sel_hi:[1,1]
v_pk_fma_f32 v[60:61], v[60:61], v[74:75], v[84:85] op_sel_hi:[1,0,1]
v_pk_fma_f32 v[62:63], v[62:63], v[74:75], v[86:87] op_sel_hi:[1,0,1]
buffer_load_dwordx4 a[204:207], v1, s[4:7], s28 offen offset:3072 sc1
v_cvt_pk_bf16_f32 v116, v60, v61
v_cvt_pk_bf16_f32 v117, v62, v63
v_pk_mul_f32 v[84:85], v[76:77], v[80:81] op_sel:[0,1] op_sel_hi:[1,1]
v_pk_mul_f32 v[86:87], v[78:79], v[80:81] op_sel:[0,1] op_sel_hi:[1,1]
v_pk_fma_f32 v[64:65], v[64:65], v[80:81], v[84:85] op_sel_hi:[1,0,1]
v_pk_fma_f32 v[66:67], v[66:67], v[80:81], v[86:87] op_sel_hi:[1,0,1]
v_cvt_pk_bf16_f32 v118, v64, v65
v_cvt_pk_bf16_f32 v119, v66, v67
s_waitcnt lgkmcnt(2)
v_pk_mul_f32 v[92:93], v[92:93], v[82:83] op_sel_hi:[1,0]
v_pk_mul_f32 v[94:95], v[94:95], v[82:83] op_sel_hi:[1,0]
v_pk_fma_f32 v[48:49], v[48:49], v[88:89], v[92:93]
v_pk_fma_f32 v[50:51], v[50:51], v[90:91], v[94:95]
v_cvt_pk_bf16_f32 v110, v48, v49
v_cvt_pk_bf16_f32 v111, v50, v51
s_waitcnt lgkmcnt(0)
v_pk_mul_f32 v[100:101], v[100:101], v[82:83] op_sel_hi:[1,0]
v_pk_mul_f32 v[102:103], v[102:103], v[82:83] op_sel_hi:[1,0]
v_pk_fma_f32 v[40:41], v[40:41], v[96:97], v[100:101]
v_pk_fma_f32 v[42:43], v[42:43], v[98:99], v[102:103]
v_cvt_pk_bf16_f32 v112, v40, v41
s_add_u32 s28, s26, 0
buffer_load_dwordx4 a[208:211], v1, s[4:7], s28 offen sc1
v_cvt_pk_bf16_f32 v113, v42, v43
s_add_u32 s46, s32, 3
s_waitcnt vmcnt(10)
v_lshrrev_b32 v17, 3, v17
v_subrev_u32 v17, s46, v17
v_cmp_lt_u32 vcc, 31, v17
s_cbranch_vccnz L_spin_41
L_ok_40:
s_add_u32 s17, s47, s97
v_add_u32 v80, 0x27400, v1
ds_read_b128 v[84:87], v80 offset:1024
ds_read_b128 v[80:83], v80
v_mfma_f32_16x16x16_bf16 v[36:39], v[104:105], v[116:117], 0
v_mfma_f32_16x16x16_bf16 v[40:43], v[106:107], v[116:117], 0
v_mfma_f32_16x16x16_bf16 v[44:47], v[106:107], v[118:119], 0
s_add_u32 m0, s2, 0
s_add_u32 s29, s17, 0x200000
v_mfma_f32_16x16x16_bf16 v[48:51], v[108:109], v[118:119], 0
buffer_load_dwordx4 v1, s[4:7], s29 offen sc1 lds
v_mov_b32 v60, 0x3f803f80
v_mov_b32 v61, 0x3f803f80
v_mov_b32 v62, 0x3f803f80
v_mov_b32 v63, 0x3f803f80
s_waitcnt lgkmcnt(0)
v_min_f32 v52, s38, v80
v_min_f32 v53, s38, v81
v_min_f32 v54, s38, v82
v_min_f32 v55, s38, v83
v_pk_fma_f32 v[36:37], v[36:37], s[34:35], v[52:53]
buffer_load_dwordx4 v1, s[4:7], s29 offen offset:1024 sc1 lds
v_pk_fma_f32 v[38:39], v[38:39], s[34:35], v[54:55]
v_pk_fma_f32 v[40:41], v[40:41], s[34:35], v[84:85]
v_pk_fma_f32 v[42:43], v[42:43], s[34:35], v[86:87]
v_pk_fma_f32 v[44:45], v[44:45], s[34:35], v[80:81]
v_pk_fma_f32 v[46:47], v[46:47], s[34:35], v[82:83]
v_pk_fma_f32 v[48:49], v[48:49], s[34:35], v[84:85]
v_pk_fma_f32 v[50:51], v[50:51], s[34:35], v[86:87]
v_max3_f32 v56, v36, v37, v38
v_max3_f32 v58, v44, v45, v46
s_add_u32 m0, s2, 8192
s_add_u32 s29, s17, 0x201000
buffer_load_dwordx4 v1, s[4:7], s29 offen sc1 lds
v_max3_f32 v57, v39, v40, v41
v_max3_f32 v59, v47, v48, v49
v_max3_f32 v56, v56, v42, v43
v_max3_f32 v58, v58, v50, v51
v_max_f32 v56, v56, v57
v_max_f32 v58, v58, v59
s_add_u32 s15, s47, s39
s_add_u32 s15, s15, 0x208000
v_permlane32_swap_b32 v56, v58
v_max_f32 v56, v56, v58
buffer_load_dwordx4 v1, s[4:7], s29 offen offset:1024 sc1 lds
v_mov_b32 v58, v56
s_nop 1
v_permlane16_swap_b32 v56, v58
v_max_f32 v56, v56, v58
v_mov_b32 v58, v56
s_nop 1
v_permlane32_swap_b32 v56, v58
v_pk_add_f32 v[36:37], v[36:37], v[56:57] op_sel_hi:[1,0] neg_lo:[0,1] neg_hi:[0,1]
v_pk_add_f32 v[38:39], v[38:39], v[56:57] op_sel_hi:[1,0] neg_lo:[0,1] neg_hi:[0,1]
v_pk_add_f32 v[40:41], v[40:41], v[56:57] op_sel_hi:[1,0] neg_lo:[0,1] neg_hi:[0,1]
s_add_u32 m0, s2, 16384
s_add_u32 s29, s17, 0x202000
buffer_load_dwordx4 v1, s[4:7], s29 offen sc1 lds
v_pk_add_f32 v[42:43], v[42:43], v[56:57] op_sel_hi:[1,0] neg_lo:[0,1] neg_hi:[0,1]
v_exp_f32 v36, v36
v_exp_f32 v37, v37
v_exp_f32 v38, v38
v_exp_f32 v39, v39
v_exp_f32 v40, v40
buffer_load_dwordx4 v1, s[4:7], s29 offen offset:1024 sc1 lds
v_exp_f32 v41, v41
v_exp_f32 v42, v42
v_exp_f32 v43, v43
v_pk_add_f32 v[44:45], v[44:45], v[58:59] op_sel_hi:[1,0] neg_lo:[0,1] neg_hi:[0,1]
v_pk_add_f32 v[46:47], v[46:47], v[58:59] op_sel_hi:[1,0] neg_lo:[0,1] neg_hi:[0,1]
v_pk_add_f32 v[48:49], v[48:49], v[58:59] op_sel_hi:[1,0] neg_lo:[0,1] neg_hi:[0,1]
v_pk_add_f32 v[50:51], v[50:51], v[58:59] op_sel_hi:[1,0] neg_lo:[0,1] neg_hi:[0,1]
s_add_u32 m0, s2, 24576
s_add_u32 s29, s17, 0x203000
buffer_load_dwordx4 v1, s[4:7], s29 offen sc1 lds
v_exp_f32 v44, v44
v_exp_f32 v45, v45
v_exp_f32 v46, v46
v_exp_f32 v47, v47
v_exp_f32 v48, v48
buffer_load_dwordx4 v1, s[4:7], s29 offen offset:1024 sc1 lds
v_exp_f32 v49, v49
v_exp_f32 v50, v50
v_exp_f32 v51, v51
v_cvt_pk_bf16_f32 v68, v36, v37
v_cvt_pk_bf16_f32 v69, v38, v39
v_cvt_pk_bf16_f32 v70, v40, v41
v_cvt_pk_bf16_f32 v71, v42, v43
v_cvt_pk_bf16_f32 v72, v44, v45
v_cvt_pk_bf16_f32 v73, v46, v47
v_cvt_pk_bf16_f32 v74, v48, v49
v_cvt_pk_bf16_f32 v75, v50, v51
v_mfma_f32_16x16x32_bf16 v[40:43], v[60:63], v[68:71], 0
s_nop 0
v_mfma_f32_16x16x32_bf16 v[48:51], v[60:63], v[72:75], 0
s_add_u32 s14, s28, s88
buffer_load_dwordx4 a[212:215], v1, s[4:7], s14 offen sc1
v_mfma_f32_16x16x32_bf16 v[36:39], v[110:113], v[68:71], 0
v_mfma_f32_16x16x32_bf16 v[44:47], v[112:115], v[72:75], 0
s_nop 1
v_rcp_f32 v40, v40
s_nop 0
v_rcp_f32 v48, v48
s_nop 1
v_pk_mul_f32 v[36:37], v[36:37], v[40:41] op_sel_hi:[1,0]
v_pk_mul_f32 v[38:39], v[38:39], v[40:41] op_sel_hi:[1,0]
v_pk_mul_f32 v[44:45], v[44:45], v[48:49] op_sel_hi:[1,0]
v_pk_mul_f32 v[46:47], v[46:47], v[48:49] op_sel_hi:[1,0]
v_cvt_pk_bf16_f32 v76, v36, v37
v_cvt_pk_bf16_f32 v77, v38, v39
v_cvt_pk_bf16_f32 v78, v44, v45
v_cvt_pk_bf16_f32 v79, v46, v47
s_nop 0
v_permlane32_swap_b32 v76, v78
v_permlane32_swap_b32 v77, v79
buffer_store_dwordx4 v[76:79], v3, s[4:7], s15 offen sc1
s_add_u32 s14, s28, s89
buffer_load_dwordx4 a[216:219], v1, s[4:7], s14 offen sc1
s_waitcnt vmcnt(3)
s_barrier
ds_read_b128 v[88:91], v7 offset:0
ds_read_b128 v[92:95], v8 offset:0
ds_read_b128 v[96:99], v7 offset:4096
ds_read_b128 v[100:103], v8 offset:4096
ds_read_b128 v[72:75], v7 offset:8192
ds_read_b128 v[76:79], v8 offset:8192
s_add_u32 s28, s26, 3072
buffer_load_dwordx4 a[220:223], v1, s[4:7], s28 offen sc1
s_add_u32 s14, s28, s88
buffer_load_dwordx4 a[224:227], v1, s[4:7], s14 offen sc1
s_waitcnt lgkmcnt(4)
v_mfma_f32_16x16x32_bf16 v[36:39], a[192:195], v[88:91], 0
ds_read_b128 v[80:83], v7 offset:12288
ds_read_b128 v[84:87], v8 offset:12288
v_mfma_f32_16x16x32_bf16 v[40:43], a[196:199], v[88:91], 0
v_mfma_f32_16x16x32_bf16 v[44:47], a[192:195], v[92:95], 0
v_mfma_f32_16x16x32_bf16 v[48:51], a[196:199], v[92:95], 0
s_add_u32 s14, s28, s89
s_waitcnt lgkmcnt(4)
v_mfma_f32_16x16x32_bf16 v[36:39], a[200:203], v[96:99], v[36:39]
ds_read_b128 v[88:91], v7 offset:16384
ds_read_b128 v[92:95], v8 offset:16384
v_mfma_f32_16x16x32_bf16 v[40:43], a[204:207], v[96:99], v[40:43]
buffer_load_dwordx4 a[228:231], v1, s[4:7], s14 offen sc1
v_mfma_f32_16x16x32_bf16 v[44:47], a[200:203], v[100:103], v[44:47]
v_mfma_f32_16x16x32_bf16 v[48:51], a[204:207], v[100:103], v[48:51]
s_waitcnt lgkmcnt(4)
v_mfma_f32_16x16x32_bf16 v[36:39], a[96:99], v[72:75], v[36:39]
ds_read_b128 v[96:99], v7 offset:20480
ds_read_b128 v[100:103], v8 offset:20480
v_mfma_f32_16x16x32_bf16 v[40:43], a[100:103], v[72:75], v[40:43]
s_add_u32 s28, s26, 6144
buffer_load_dwordx4 a[232:235], v1, s[4:7], s28 offen sc1
v_mfma_f32_16x16x32_bf16 v[44:47], a[96:99], v[76:79], v[44:47]
v_mfma_f32_16x16x32_bf16 v[48:51], a[100:103], v[76:79], v[48:51]
s_waitcnt lgkmcnt(4)
v_mfma_f32_16x16x32_bf16 v[36:39], a[104:107], v[80:83], v[36:39]
ds_read_b128 v[72:75], v7 offset:24576
ds_read_b128 v[76:79], v8 offset:24576
v_mfma_f32_16x16x32_bf16 v[40:43], a[108:111], v[80:83], v[40:43]
s_add_u32 s14, s28, s88
buffer_load_dwordx4 a[236:239], v1, s[4:7], s14 offen sc1
v_mfma_f32_16x16x32_bf16 v[44:47], a[104:107], v[84:87], v[44:47]
v_mfma_f32_16x16x32_bf16 v[48:51], a[108:111], v[84:87], v[48:51]
s_waitcnt lgkmcnt(4)
v_mfma_f32_16x16x32_bf16 v[36:39], a[112:115], v[88:91], v[36:39]
ds_read_b128 v[80:83], v7 offset:28672
ds_read_b128 v[84:87], v8 offset:28672
v_mfma_f32_16x16x32_bf16 v[40:43], a[116:119], v[88:91], v[40:43]
s_add_u32 s14, s28, s89
buffer_load_dwordx4 a[240:243], v1, s[4:7], s14 offen sc1
v_mfma_f32_16x16x32_bf16 v[44:47], a[112:115], v[92:95], v[44:47]
v_add_u32 v15, 8, v15
s_add_u32 s28, s26, 9216
buffer_load_dwordx4 a[244:247], v1, s[4:7], s28 offen sc1
s_add_u32 s14, s28, s88
buffer_load_dwordx4 a[248:251], v1, s[4:7], s14 offen sc1
s_waitcnt vmcnt(9)
v_mfma_f32_16x16x32_bf16 v[48:51], a[116:119], v[92:95], v[48:51]
buffer_store_dword v15, v13, s[4:7], s45 offen sc1
s_waitcnt lgkmcnt(4)
v_mfma_f32_16x16x32_bf16 v[44:47], a[120:123], v[100:103], v[44:47]
v_mfma_f32_16x16x32_bf16 v[48:51], a[124:127], v[100:103], v[48:51]
s_waitcnt lgkmcnt(2)
v_mfma_f32_16x16x32_bf16 v[44:47], a[128:131], v[76:79], v[44:47]
v_mfma_f32_16x16x32_bf16 v[48:51], a[132:135], v[76:79], v[48:51]
s_add_u32 s14, s28, s89
buffer_load_dwordx4 a[252:255], v1, s[4:7], s14 offen sc1
s_waitcnt lgkmcnt(0)
v_mfma_f32_16x16x32_bf16 v[44:47], a[136:139], v[84:87], v[44:47]
v_mfma_f32_16x16x32_bf16 v[48:51], a[140:143], v[84:87], v[48:51]
v_mfma_f32_16x16x32_bf16 v[36:39], a[120:123], v[96:99], v[36:39]
s_lshl_b32 s15, s8, 11
s_add_u32 s15, s15, 0x20000
v_mfma_f32_16x16x32_bf16 v[40:43], a[124:127], v[96:99], v[40:43]
s_add_u32 s28, s26, 12288
buffer_load_dwordx4 v[128:131], v1, s[4:7], s28 offen sc1
s_xor_b32 s16, s15, 0x1000
v_add_u32 v104, s15, v1
v_mfma_f32_16x16x32_bf16 v[36:39], a[128:131], v[72:75], v[36:39]
v_add_u32 v105, s16, v1
v_mfma_f32_16x16x32_bf16 v[40:43], a[132:135], v[72:75], v[40:43]
ds_write_b128 v104, v[44:47] offset:0
ds_write_b128 v104, v[48:51] offset:1024
v_mfma_f32_16x16x32_bf16 v[36:39], a[136:139], v[80:83], v[36:39]
v_mfma_f32_16x16x32_bf16 v[40:43], a[140:143], v[80:83], v[40:43]
s_add_u32 s14, s28, s88
buffer_load_dwordx4 v[132:135], v1, s[4:7], s14 offen sc1
s_waitcnt lgkmcnt(0)
s_barrier
ds_read_b128 v[68:71], v105 offset:0
ds_read_b128 v[72:75], v105 offset:1024
s_add_u32 s14, s28, s89
buffer_load_dwordx4 v[136:139], v1, s[4:7], s14 offen sc1
s_add_u32 s28, s26, 15360
buffer_load_dwordx4 v[140:143], v1, s[4:7], s28 offen sc1
v_pk_add_f32 v[20:21], v[20:21], v[36:37]
v_pk_add_f32 v[22:23], v[22:23], v[38:39]
v_pk_add_f32 v[24:25], v[24:25], v[40:41]
v_pk_add_f32 v[26:27], v[26:27], v[42:43]
s_add_u32 s14, s28, s88
buffer_load_dwordx4 v[144:147], v1, s[4:7], s14 offen sc1
s_add_u32 s14, s28, s89
buffer_load_dwordx4 v[148:151], v1, s[4:7], s14 offen sc1
s_waitcnt lgkmcnt(1)
v_pk_add_f32 v[20:21], v[20:21], v[68:69]
v_pk_add_f32 v[22:23], v[22:23], v[70:71]
s_waitcnt lgkmcnt(0)
v_pk_add_f32 v[24:25], v[24:25], v[72:73]
v_pk_add_f32 v[26:27], v[26:27], v[74:75]
buffer_load_dword v17, v4, s[4:7], s92 offen sc1
s_add_u32 s15, s47, s62
s_add_u32 s15, s15, 0x400000
v_cvt_pk_bf16_f32 v76, v20, v21
v_cvt_pk_bf16_f32 v77, v22, v23
v_cvt_pk_bf16_f32 v78, v24, v25
v_cvt_pk_bf16_f32 v79, v26, v27
buffer_store_dwordx4 v[76:79], v1, s[4:7], s15 offen sc1
v_pk_add_f32 v[68:69], v[20:21], v[22:23]
v_pk_add_f32 v[70:71], v[24:25], v[26:27]
v_pk_mul_f32 v[72:73], v[20:21], v[20:21]
v_pk_add_f32 v[68:69], v[68:69], v[70:71]
v_pk_fma_f32 v[72:73], v[22:23], v[22:23], v[72:73]
v_pk_fma_f32 v[72:73], v[24:25], v[24:25], v[72:73]
v_pk_fma_f32 v[72:73], v[26:27], v[26:27], v[72:73]
v_add_f32 v68, v68, v69
v_add_f32 v72, v72, v73
s_add_u32 s16, s13, s63
s_add_u32 s16, s16, 0xd40000
v_permlane32_swap_b32 v68, v72
v_add_f32 v68, v68, v72
v_mov_b32 v72, v68
s_nop 1
v_permlane16_swap_b32 v68, v72
v_add_f32 v68, v68, v72
buffer_store_dword v68, v11, s[4:7], s16 offen sc1
s_add_u32 s46, s32, 4
s_add_u32 s28, s26, 18432
buffer_load_dwordx4 v[152:155], v1, s[4:7], s28 offen sc1
s_add_u32 s14, s28, s88
buffer_load_dwordx4 v[156:159], v1, s[4:7], s14 offen sc1
s_add_u32 s14, s28, s89
buffer_load_dwordx4 v[160:163], v1, s[4:7], s14 offen sc1
s_add_u32 s28, s26, 21504
buffer_load_dwordx4 v[164:167], v1, s[4:7], s28 offen sc1
s_add_u32 s14, s28, s88
buffer_load_dwordx4 v[168:171], v1, s[4:7], s14 offen sc1
s_add_u32 s14, s28, s89
buffer_load_dwordx4 v[172:175], v1, s[4:7], s14 offen sc1
s_waitcnt vmcnt(8)
v_lshrrev_b32 v17, 3, v17
v_subrev_u32 v17, s46, v17
v_cmp_lt_u32 vcc, 31, v17
s_cbranch_vccnz L_spin_43
L_ok_42:
s_add_u32 s17, s47, s97
s_add_u32 m0, s2, 32768
s_add_u32 s29, s17, 0x209000
buffer_load_dwordx4 v1, s[4:7], s29 offen sc1 lds
buffer_load_dwordx4 v1, s[4:7], s29 offen offset:1024 sc1 lds
s_add_u32 m0, s2, 40960
s_add_u32 s29, s17, 0x20a000
buffer_load_dwordx4 v1, s[4:7], s29 offen sc1 lds
buffer_load_dwordx4 v1, s[4:7], s29 offen offset:1024 sc1 lds
v_add_u32 v15, 8, v15
s_waitcnt vmcnt(10)
buffer_store_dword v15, v13, s[4:7], s45 offen sc1
s_add_u32 m0, s2, 49152
s_add_u32 s29, s17, 0x20b000
buffer_load_dwordx4 v1, s[4:7], s29 offen sc1 lds
buffer_load_dwordx4 v1, s[4:7], s29 offen offset:1024 sc1 lds
s_add_u32 m0, s2, 57344
s_add_u32 s29, s17, 0x208000
buffer_load_dwordx4 v1, s[4:7], s29 offen sc1 lds
buffer_load_dwordx4 v1, s[4:7], s29 offen offset:1024 sc1 lds
s_waitcnt vmcnt(7)
s_barrier
ds_read_b128 v[88:91], v7 offset:32768
ds_read_b128 v[92:95], v8 offset:32768
ds_read_b128 v[96:99], v7 offset:36864
ds_read_b128 v[100:103], v8 offset:36864
s_add_u32 s28, s27, 0
buffer_load_dwordx4 v[176:179], v1, s[4:7], s28 offen sc1
buffer_load_dwordx4 v[180:183], v1, s[4:7], s28 offen offset:1024 sc1
buffer_load_dwordx4 v[184:187], v1, s[4:7], s28 offen offset:2048 sc1
s_waitcnt vmcnt(8)
s_barrier
ds_read_b128 v[72:75], v7 offset:40960
ds_read_b128 v[76:79], v8 offset:40960
buffer_load_dwordx4 v[188:191], v1, s[4:7], s28 offen offset:3072 sc1
s_add_u32 s28, s27, 4096
buffer_load_dwordx4 v[192:195], v1, s[4:7], s28 offen sc1
s_waitcnt lgkmcnt(4)
v_mfma_f32_16x16x32_bf16 v[36:39], a[96:99], v[88:91], 0
ds_read_b128 v[80:83], v7 offset:45056
ds_read_b128 v[84:87], v8 offset:45056
v_mfma_f32_16x16x32_bf16 v[40:43], a[100:103], v[88:91], 0
v_mfma_f32_16x16x32_bf16 v[44:47], a[96:99], v[92:95], 0
buffer_load_dword v17, v4, s[4:7], s92 offen sc1
v_mfma_f32_16x16x32_bf16 v[48:51], a[100:103], v[92:95], 0
s_waitcnt lgkmcnt(4)
v_mfma_f32_16x16x32_bf16 v[36:39], a[104:107], v[96:99], v[36:39]
s_add_u32 s28, s26, 36864
buffer_load_dwordx4 a[96:99], v1, s[4:7], s28 offen sc1
s_add_u32 s14, s28, s88
buffer_load_dwordx4 a[100:103], v1, s[4:7], s14 offen sc1
s_waitcnt vmcnt(8)
s_barrier
v_mfma_f32_16x16x32_bf16 v[40:43], a[108:111], v[96:99], v[40:43]
ds_read_b128 v[88:91], v7 offset:49152
ds_read_b128 v[92:95], v8 offset:49152
v_mfma_f32_16x16x32_bf16 v[44:47], a[104:107], v[100:103], v[44:47]
v_mfma_f32_16x16x32_bf16 v[48:51], a[108:111], v[100:103], v[48:51]
s_waitcnt lgkmcnt(4)
v_mfma_f32_16x16x32_bf16 v[36:39], a[112:115], v[72:75], v[36:39]
ds_read_b128 v[96:99], v7 offset:53248
ds_read_b128 v[100:103], v8 offset:53248
v_mfma_f32_16x16x32_bf16 v[40:43], a[116:119], v[72:75], v[40:43]
s_add_u32 s14, s28, s89
buffer_load_dwordx4 a[104:107], v1, s[4:7], s14 offen sc1
v_mfma_f32_16x16x32_bf16 v[44:47], a[112:115], v[76:79], v[44:47]
v_mfma_f32_16x16x32_bf16 v[48:51], a[116:119], v[76:79], v[48:51]
s_waitcnt lgkmcnt(4)
v_mfma_f32_16x16x32_bf16 v[36:39], a[120:123], v[80:83], v[36:39]
ds_read_b128 v[72:75], v7 offset:57344
ds_read_b128 v[76:79], v8 offset:57344
v_mfma_f32_16x16x32_bf16 v[40:43], a[124:127], v[80:83], v[40:43]
s_add_u32 s28, s26, 39936
buffer_load_dwordx4 a[108:111], v1, s[4:7], s28 offen sc1
v_mfma_f32_16x16x32_bf16 v[44:47], a[120:123], v[84:87], v[44:47]
v_mfma_f32_16x16x32_bf16 v[48:51], a[124:127], v[84:87], v[48:51]
s_waitcnt lgkmcnt(4)
v_mfma_f32_16x16x32_bf16 v[36:39], a[128:131], v[88:91], v[36:39]
ds_read_b128 v[80:83], v7 offset:61440
ds_read_b128 v[84:87], v8 offset:61440
v_mfma_f32_16x16x32_bf16 v[40:43], a[132:135], v[88:91], v[40:43]
s_add_u32 s14, s28, s88
buffer_load_dwordx4 a[112:115], v1, s[4:7], s14 offen sc1
v_mfma_f32_16x16x32_bf16 v[44:47], a[128:131], v[92:95], v[44:47]
s_add_u32 s44, s32, 5
s_add_u32 s14, s28, s89
buffer_load_dwordx4 a[116:119], v1, s[4:7], s14 offen sc1
s_add_u32 s28, s26, 43008
buffer_load_dwordx4 a[120:123], v1, s[4:7], s28 offen sc1
s_waitcnt vmcnt(7)
v_lshrrev_b32 v17, 3, v17
v_mfma_f32_16x16x32_bf16 v[48:51], a[132:135], v[92:95], v[48:51]
v_subrev_u32 v17, s44, v17
s_waitcnt lgkmcnt(4)
v_mfma_f32_16x16x32_bf16 v[44:47], a[136:139], v[100:103], v[44:47]
v_cmp_lt_u32 vcc, 31, v17
s_cbranch_vccnz L_spin_45
L_ok_44:
s_add_u32 s17, s47, s96
s_add_u32 m0, s3, 65536
s_add_u32 s29, s17, 0x400000
buffer_load_dwordx4 v1, s[4:7], s29 offen sc1 lds
buffer_load_dwordx4 v1, s[4:7], s29 offen offset:1024 sc1 lds
v_mfma_f32_16x16x32_bf16 v[48:51], a[140:143], v[100:103], v[48:51]
s_waitcnt lgkmcnt(2)
v_mfma_f32_16x16x32_bf16 v[44:47], a[192:195], v[76:79], v[44:47]
v_mfma_f32_16x16x32_bf16 v[48:51], a[196:199], v[76:79], v[48:51]
s_add_u32 s46, s13, 0xd40000
buffer_load_dwordx2 v[120:121], v14, s[4:7], s46 offen sc1
s_waitcnt lgkmcnt(0)
v_mfma_f32_16x16x32_bf16 v[44:47], a[200:203], v[84:87], v[44:47]
buffer_load_dwordx2 v[122:123], v14, s[4:7], s46 offen offset:256 sc1
v_mfma_f32_16x16x32_bf16 v[48:51], a[204:207], v[84:87], v[48:51]
v_mfma_f32_16x16x32_bf16 v[36:39], a[136:139], v[96:99], v[36:39]
s_lshl_b32 s15, s8, 11
s_add_u32 s15, s15, 0x20000
v_mfma_f32_16x16x32_bf16 v[40:43], a[140:143], v[96:99], v[40:43]
s_add_u32 m0, s3, 73728
s_add_u32 s29, s17, 0x402000
s_xor_b32 s16, s15, 0x1000
v_add_u32 v104, s15, v1
v_mfma_f32_16x16x32_bf16 v[36:39], a[192:195], v[72:75], v[36:39]
buffer_load_dwordx4 v1, s[4:7], s29 offen sc1 lds
v_add_u32 v105, s16, v1
v_mfma_f32_16x16x32_bf16 v[40:43], a[196:199], v[72:75], v[40:43]
ds_write_b128 v104, v[44:47] offset:0
ds_write_b128 v104, v[48:51] offset:1024
v_mfma_f32_16x16x32_bf16 v[36:39], a[200:203], v[80:83], v[36:39]
v_mfma_f32_16x16x32_bf16 v[40:43], a[204:207], v[80:83], v[40:43]
buffer_load_dwordx4 v1, s[4:7], s29 offen offset:1024 sc1 lds
s_waitcnt lgkmcnt(0)
s_barrier
ds_read_b128 v[68:71], v105 offset:0
ds_read_b128 v[72:75], v105 offset:1024
s_nop 1
v_pk_add_f32 v[28:29], v[28:29], v[36:37]
v_pk_add_f32 v[30:31], v[30:31], v[38:39]
v_pk_add_f32 v[32:33], v[32:33], v[40:41]
v_pk_add_f32 v[34:35], v[34:35], v[42:43]
s_add_u32 s46, s13, 0xd40000
buffer_load_dwordx2 v[124:125], v14, s[4:7], s46 offen offset:512 sc1
buffer_load_dwordx2 v[126:127], v14, s[4:7], s46 offen offset:768 sc1
s_add_u32 m0, s3, 81920
s_add_u32 s29, s17, 0x404000
buffer_load_dwordx4 v1, s[4:7], s29 offen sc1 lds
s_waitcnt lgkmcnt(1)
v_pk_add_f32 v[28:29], v[28:29], v[68:69]
v_pk_add_f32 v[30:31], v[30:31], v[70:71]
s_waitcnt lgkmcnt(0)
v_pk_add_f32 v[32:33], v[32:33], v[72:73]
v_pk_add_f32 v[34:35], v[34:35], v[74:75]
s_add_u32 s15, s47, s62
s_add_u32 s15, s15, 0x408000
v_cvt_pk_bf16_f32 v76, v28, v29
v_cvt_pk_bf16_f32 v77, v30, v31
v_cvt_pk_bf16_f32 v78, v32, v33
v_cvt_pk_bf16_f32 v79, v34, v35
buffer_store_dwordx4 v[76:79], v1, s[4:7], s15 offen sc1
v_pk_add_f32 v[68:69], v[28:29], v[30:31]
v_pk_add_f32 v[70:71], v[32:33], v[34:35]
v_pk_mul_f32 v[72:73], v[28:29], v[28:29]
v_pk_add_f32 v[68:69], v[68:69], v[70:71]
v_pk_fma_f32 v[72:73], v[30:31], v[30:31], v[72:73]
v_pk_fma_f32 v[72:73], v[32:33], v[32:33], v[72:73]
v_pk_fma_f32 v[72:73], v[34:35], v[34:35], v[72:73]
v_add_f32 v68, v68, v69
v_add_f32 v72, v72, v73
s_add_u32 s16, s13, s63
s_add_u32 s16, s16, 0xd41000
v_permlane32_swap_b32 v68, v72
v_add_f32 v68, v68, v72
v_mov_b32 v72, v68
s_nop 1
v_permlane16_swap_b32 v68, v72
v_add_f32 v68, v68, v72
buffer_store_dword v68, v11, s[4:7], s16 offen sc1
buffer_load_dwordx4 v1, s[4:7], s29 offen offset:1024 sc1 lds
s_add_u32 m0, s3, 90112
s_add_u32 s29, s17, 0x406000
buffer_load_dwordx4 v1, s[4:7], s29 offen sc1 lds
s_waitcnt vmcnt(11)
s_barrier
ds_read_b128 v[88:91], v2 offset:0
ds_read_b128 v[92:95], v2 offset:1024
ds_read_b128 v[96:99], v2 offset:2048
ds_read_b128 v[100:103], v2 offset:3072
ds_read_b128 v[72:75], v2 offset:4096
ds_read_b128 v[76:79], v2 offset:5120
buffer_load_dwordx4 v1, s[4:7], s29 offen offset:1024 sc1 lds
s_add_u32 s14, s28, s88
buffer_load_dwordx4 a[124:127], v1, s[4:7], s14 offen sc1
s_waitcnt lgkmcnt(4)
v_mfma_f32_16x16x32_bf16 v[36:39], a[208:211], v[88:91], 0
ds_read_b128 v[80:83], v2 offset:6144
ds_read_b128 v[84:87], v2 offset:7168
v_mfma_f32_16x16x32_bf16 v[44:47], a[212:215], v[88:91], 0
v_mfma_f32_16x16x32_bf16 v[52:55], a[216:219], v[88:91], 0
s_add_u32 s14, s28, s89
buffer_load_dwordx4 a[128:131], v1, s[4:7], s14 offen sc1
v_mfma_f32_16x16x32_bf16 v[40:43], a[208:211], v[92:95], 0
v_mfma_f32_16x16x32_bf16 v[48:51], a[212:215], v[92:95], 0
v_mfma_f32_16x16x32_bf16 v[56:59], a[216:219], v[92:95], 0
s_add_u32 s28, s26, 46080
s_waitcnt lgkmcnt(4)
v_mfma_f32_16x16x32_bf16 v[36:39], a[220:223], v[96:99], v[36:39]
buffer_load_dwordx4 a[132:135], v1, s[4:7], s28 offen sc1
s_add_u32 s14, s28, s88
buffer_load_dwordx4 a[136:139], v1, s[4:7], s14 offen sc1
s_waitcnt vmcnt(12)
s_barrier
v_mfma_f32_16x16x32_bf16 v[44:47], a[224:227], v[96:99], v[44:47]
ds_read_b128 v[88:91], v2 offset:8192
ds_read_b128 v[92:95], v2 offset:9216
v_mfma_f32_16x16x32_bf16 v[52:55], a[228:231], v[96:99], v[52:55]
v_mfma_f32_16x16x32_bf16 v[40:43], a[220:223], v[100:103], v[40:43]
s_add_u32 s14, s28, s89
buffer_load_dwordx4 a[140:143], v1, s[4:7], s14 offen sc1
v_mfma_f32_16x16x32_bf16 v[48:51], a[224:227], v[100:103], v[48:51]
v_mfma_f32_16x16x32_bf16 v[56:59], a[228:231], v[100:103], v[56:59]
s_waitcnt lgkmcnt(4)
v_mfma_f32_16x16x32_bf16 v[36:39], a[232:235], v[72:75], v[36:39]
ds_read_b128 v[96:99], v2 offset:10240
ds_read_b128 v[100:103], v2 offset:11264
v_mfma_f32_16x16x32_bf16 v[44:47], a[236:239], v[72:75], v[44:47]
s_add_u32 s28, s27, 4096
buffer_load_dwordx4 v[196:199], v1, s[4:7], s28 offen offset:1024 sc1
v_mfma_f32_16x16x32_bf16 v[52:55], a[240:243], v[72:75], v[52:55]
v_mfma_f32_16x16x32_bf16 v[40:43], a[232:235], v[76:79], v[40:43]
v_mfma_f32_16x16x32_bf16 v[48:51], a[236:239], v[76:79], v[48:51]
buffer_load_dwordx4 v[200:203], v1, s[4:7], s28 offen offset:2048 sc1
v_mfma_f32_16x16x32_bf16 v[56:59], a[240:243], v[76:79], v[56:59]
s_waitcnt lgkmcnt(4)
v_mfma_f32_16x16x32_bf16 v[36:39], a[244:247], v[80:83], v[36:39]
ds_read_b128 v[72:75], v2 offset:12288
ds_read_b128 v[76:79], v2 offset:13312
v_mfma_f32_16x16x32_bf16 v[44:47], a[248:251], v[80:83], v[44:47]
buffer_load_dwordx4 v[204:207], v1, s[4:7], s28 offen offset:3072 sc1
s_waitcnt vmcnt(14)
v_mfma_f32_16x16x32_bf16 v[52:55], a[252:255], v[80:83], v[52:55]
v_add_f32 v120, v120, v122
v_add_f32 v124, v124, v126
v_mfma_f32_16x16x32_bf16 v[40:43], a[244:247], v[84:87], v[40:43]
v_add_f32 v121, v121, v123
v_add_f32 v125, v125, v127
v_mfma_f32_16x16x32_bf16 v[48:51], a[248:251], v[84:87], v[48:51]
s_add_u32 s28, s27, 8192
buffer_load_dwordx4 v[208:211], v1, s[4:7], s28 offen sc1
v_mfma_f32_16x16x32_bf16 v[56:59], a[252:255], v[84:87], v[56:59]
v_add_f32 v120, v120, v124
s_waitcnt lgkmcnt(4)
v_mfma_f32_16x16x32_bf16 v[36:39], v[128:131], v[88:91], v[36:39]
ds_read_b128 v[80:83], v2 offset:14336
ds_read_b128 v[84:87], v2 offset:15360
v_mfma_f32_16x16x32_bf16 v[44:47], v[132:135], v[88:91], v[44:47]
buffer_load_dwordx4 v[212:215], v1, s[4:7], s28 offen offset:1024 sc1
v_add_f32 v121, v121, v125
v_mfma_f32_16x16x32_bf16 v[52:55], v[136:139], v[88:91], v[52:55]
v_add_u32 v122, s52, v5
s_nop 0
v_mfma_f32_16x16x32_bf16 v[40:43], v[128:131], v[92:95], v[40:43]
v_permlane32_swap_b32 v120, v121
v_mfma_f32_16x16x32_bf16 v[48:51], v[132:135], v[92:95], v[48:51]
buffer_load_dwordx4 v[216:219], v1, s[4:7], s28 offen offset:2048 sc1
v_add_f32 v120, v120, v121
v_mfma_f32_16x16x32_bf16 v[56:59], v[136:139], v[92:95], v[56:59]
v_mov_b32 v121, v120
s_waitcnt lgkmcnt(4)
v_mfma_f32_16x16x32_bf16 v[36:39], v[140:143], v[96:99], v[36:39]
v_permlane16_swap_b32 v120, v121
v_add_f32 v120, v120, v121
v_mov_b32 v121, v120
s_add_u32 s46, s43, 0x610000
buffer_load_dwordx4 v[104:107], v1, s[4:7], s46 offen sc1
v_permlane32_swap_b32 v120, v121
v_mul_f32 v120, 0x3b000000, v120
v_mul_f32 v121, 0x3b000000, v121
v_fma_f32 v121, -v120, v120, v121
v_max_f32 v121, 0, v121
v_add_f32 v121, 0x3727c5ac, v121
v_rsq_f32 v121, v121
v_sub_f32 v120, 0, v120
v_mul_f32 v120, v120, v121
buffer_load_dwordx4 v[220:223], v1, s[4:7], s28 offen offset:3072 sc1
ds_write_b32 v122, v121 offset:192
ds_write_b32 v122, v120 offset:512
s_add_u32 s28, s27, 12288
buffer_load_dwordx4 v[224:227], v1, s[4:7], s28 offen sc1
buffer_load_dwordx4 v[228:231], v1, s[4:7], s28 offen offset:1024 sc1
buffer_load_dwordx4 v[232:235], v1, s[4:7], s28 offen offset:2048 sc1
buffer_load_dwordx4 v[236:239], v1, s[4:7], s28 offen offset:3072 sc1
s_add_u32 s28, s27, 16384
buffer_load_dwordx4 v[240:243], v1, s[4:7], s28 offen sc1
buffer_load_dwordx4 v[244:247], v1, s[4:7], s28 offen offset:1024 sc1
s_waitcnt vmcnt(19) lgkmcnt(0)
s_barrier
v_mfma_f32_16x16x32_bf16 v[44:47], v[144:147], v[96:99], v[44:47]
ds_read_b128 v[88:91], v2 offset:16384
ds_read_b128 v[92:95], v2 offset:17408
v_mfma_f32_16x16x32_bf16 v[52:55], v[148:151], v[96:99], v[52:55]
v_mfma_f32_16x16x32_bf16 v[40:43], v[140:143], v[100:103], v[40:43]
buffer_load_dwordx4 v[248:251], v1, s[4:7], s28 offen offset:2048 sc1
v_mfma_f32_16x16x32_bf16 v[48:51], v[144:147], v[100:103], v[48:51]
v_mfma_f32_16x16x32_bf16 v[56:59], v[148:151], v[100:103], v[56:59]
v_mfma_f32_16x16x32_bf16 v[36:39], v[152:155], v[72:75], v[36:39]
ds_read_b128 v[96:99], v2 offset:18432
ds_read_b128 v[100:103], v2 offset:19456
v_mfma_f32_16x16x32_bf16 v[44:47], v[156:159], v[72:75], v[44:47]
buffer_load_dwordx4 v[252:255], v1, s[4:7], s28 offen offset:3072 sc1
v_add_u32 v15, 8, v15
v_mfma_f32_16x16x32_bf16 v[52:55], v[160:163], v[72:75], v[52:55]
buffer_store_dword v15, v13, s[4:7], s45 offen sc1
v_mfma_f32_16x16x32_bf16 v[40:43], v[152:155], v[76:79], v[40:43]
v_mfma_f32_16x16x32_bf16 v[48:51], v[156:159], v[76:79], v[48:51]
v_mfma_f32_16x16x32_bf16 v[56:59], v[160:163], v[76:79], v[56:59]
v_mfma_f32_16x16x32_bf16 v[36:39], v[164:167], v[80:83], v[36:39]
ds_read_b128 v[72:75], v2 offset:20480
ds_read_b128 v[76:79], v2 offset:21504
v_mfma_f32_16x16x32_bf16 v[44:47], v[168:171], v[80:83], v[44:47]
v_mfma_f32_16x16x32_bf16 v[52:55], v[172:175], v[80:83], v[52:55]
v_mfma_f32_16x16x32_bf16 v[40:43], v[164:167], v[84:87], v[40:43]
v_mfma_f32_16x16x32_bf16 v[48:51], v[168:171], v[84:87], v[48:51]
v_mfma_f32_16x16x32_bf16 v[56:59], v[172:175], v[84:87], v[56:59]
s_waitcnt lgkmcnt(4)
v_mfma_f32_16x16x32_bf16 v[36:39], a[144:147], v[88:91], v[36:39]
ds_read_b128 v[80:83], v2 offset:22528
ds_read_b128 v[84:87], v2 offset:23552
v_mfma_f32_16x16x32_bf16 v[44:47], a[148:151], v[88:91], v[44:47]
v_mfma_f32_16x16x32_bf16 v[52:55], a[152:155], v[88:91], v[52:55]
v_mfma_f32_16x16x32_bf16 v[40:43], a[144:147], v[92:95], v[40:43]
v_mfma_f32_16x16x32_bf16 v[48:51], a[148:151], v[92:95], v[48:51]
v_mfma_f32_16x16x32_bf16 v[56:59], a[152:155], v[92:95], v[56:59]
s_waitcnt lgkmcnt(4)
v_mfma_f32_16x16x32_bf16 v[36:39], a[156:159], v[96:99], v[36:39]
ds_read_b128 v[88:91], v2 offset:24576
ds_read_b128 v[92:95], v2 offset:25600
v_mfma_f32_16x16x32_bf16 v[44:47], a[160:163], v[96:99], v[44:47]
v_mfma_f32_16x16x32_bf16 v[52:55], a[164:167], v[96:99], v[52:55]
v_mfma_f32_16x16x32_bf16 v[40:43], a[156:159], v[100:103], v[40:43]
v_mfma_f32_16x16x32_bf16 v[48:51], a[160:163], v[100:103], v[48:51]
v_mfma_f32_16x16x32_bf16 v[56:59], a[164:167], v[100:103], v[56:59]
s_waitcnt lgkmcnt(4)
v_mfma_f32_16x16x32_bf16 v[36:39], a[168:171], v[72:75], v[36:39]
ds_read_b128 v[96:99], v2 offset:26624
ds_read_b128 v[100:103], v2 offset:27648
v_mfma_f32_16x16x32_bf16 v[44:47], a[172:175], v[72:75], v[44:47]
v_mfma_f32_16x16x32_bf16 v[52:55], a[176:179], v[72:75], v[52:55]
v_mfma_f32_16x16x32_bf16 v[40:43], a[168:171], v[76:79], v[40:43]
v_mfma_f32_16x16x32_bf16 v[48:51], a[172:175], v[76:79], v[48:51]
v_mfma_f32_16x16x32_bf16 v[56:59], a[176:179], v[76:79], v[56:59]
s_waitcnt lgkmcnt(4)
v_mfma_f32_16x16x32_bf16 v[36:39], a[180:183], v[80:83], v[36:39]
ds_read_b128 v[72:75], v2 offset:28672
ds_read_b128 v[76:79], v2 offset:29696
v_mfma_f32_16x16x32_bf16 v[44:47], a[184:187], v[80:83], v[44:47]
buffer_load_dword v17, v4, s[4:7], s92 offen sc1
s_waitcnt vmcnt(11)
v_mfma_f32_16x16x32_bf16 v[52:55], a[188:191], v[80:83], v[52:55]
v_add_f32_dpp v104, v104, v104 row_ror:4 row_mask:0xf bank_mask:0xf
v_add_f32_dpp v105, v105, v105 row_ror:4 row_mask:0xf bank_mask:0xf
v_mfma_f32_16x16x32_bf16 v[40:43], a[180:183], v[84:87], v[40:43]
v_add_f32_dpp v106, v106, v106 row_ror:4 row_mask:0xf bank_mask:0xf
v_add_f32_dpp v107, v107, v107 row_ror:4 row_mask:0xf bank_mask:0xf
v_mfma_f32_16x16x32_bf16 v[48:51], a[184:187], v[84:87], v[48:51]
v_add_f32_dpp v104, v104, v104 row_ror:8 row_mask:0xf bank_mask:0xf
v_add_f32_dpp v105, v105, v105 row_ror:8 row_mask:0xf bank_mask:0xf
v_mfma_f32_16x16x32_bf16 v[56:59], a[188:191], v[84:87], v[56:59]
v_add_f32_dpp v106, v106, v106 row_ror:8 row_mask:0xf bank_mask:0xf
s_waitcnt lgkmcnt(4)
v_mfma_f32_16x16x32_bf16 v[36:39], a[96:99], v[88:91], v[36:39]
ds_read_b128 v[80:83], v2 offset:30720
ds_read_b128 v[84:87], v2 offset:31744
v_mfma_f32_16x16x32_bf16 v[44:47], a[100:103], v[88:91], v[44:47]
v_add_f32_dpp v107, v107, v107 row_ror:8 row_mask:0xf bank_mask:0xf
v_and_b32 v108, 48, v1
v_mfma_f32_16x16x32_bf16 v[52:55], a[104:107], v[88:91], v[52:55]
v_lshrrev_b32 v109, 4, v1
v_and_b32 v109, 48, v109
v_mfma_f32_16x16x32_bf16 v[40:43], a[96:99], v[92:95], v[40:43]
v_lshl_add_u32 v108, v109, 2, v108
v_sub_u32 v109, v6, v109
v_mfma_f32_16x16x32_bf16 v[48:51], a[100:103], v[92:95], v[48:51]
v_add_u32 v108, v108, v109
ds_write_b128 v108, v[104:107] offset:256
v_mfma_f32_16x16x32_bf16 v[56:59], a[104:107], v[92:95], v[56:59]
s_waitcnt lgkmcnt(5)
v_mfma_f32_16x16x32_bf16 v[36:39], a[108:111], v[96:99], v[36:39]
v_mfma_f32_16x16x32_bf16 v[44:47], a[112:115], v[96:99], v[44:47]
v_mfma_f32_16x16x32_bf16 v[52:55], a[116:119], v[96:99], v[52:55]
v_mfma_f32_16x16x32_bf16 v[40:43], a[108:111], v[100:103], v[40:43]
v_mfma_f32_16x16x32_bf16 v[48:51], a[112:115], v[100:103], v[48:51]
v_mfma_f32_16x16x32_bf16 v[56:59], a[116:119], v[100:103], v[56:59]
s_waitcnt lgkmcnt(3)
v_mfma_f32_16x16x32_bf16 v[36:39], a[120:123], v[72:75], v[36:39]
v_mov_b32 v116, s36
v_mov_b32 v117, s37
v_mfma_f32_16x16x32_bf16 v[44:47], a[124:127], v[72:75], v[44:47]
ds_read2_b32 v[68:69], v5 offset0:48 offset1:128
ds_read2_b32 v[70:71], v5 offset0:64 offset1:144
v_mfma_f32_16x16x32_bf16 v[52:55], a[128:131], v[72:75], v[52:55]
ds_read_b128 v[104:107], v6 offset:256
ds_read_b128 v[88:91], v6 offset:512
v_mfma_f32_16x16x32_bf16 v[40:43], a[120:123], v[76:79], v[40:43]
ds_read_b128 v[108:111], v6 offset:320
ds_read_b128 v[92:95], v6 offset:576
v_mfma_f32_16x16x32_bf16 v[48:51], a[124:127], v[76:79], v[48:51]
ds_read_b128 v[112:115], v6 offset:384
ds_read_b128 v[96:99], v6 offset:640
v_mfma_f32_16x16x32_bf16 v[56:59], a[128:131], v[76:79], v[56:59]
s_waitcnt lgkmcnt(9)
v_mfma_f32_16x16x32_bf16 v[36:39], a[132:135], v[80:83], v[36:39]
s_add_u32 s44, s32, 6
s_waitcnt vmcnt(0)
v_lshrrev_b32 v17, 3, v17
v_mfma_f32_16x16x32_bf16 v[44:47], a[136:139], v[80:83], v[44:47]
v_subrev_u32 v17, s44, v17
v_cmp_lt_u32 vcc, 31, v17
s_cbranch_vccnz L_spin_47
L_ok_46:
s_add_u32 s17, s47, s96
v_mfma_f32_16x16x32_bf16 v[52:55], a[140:143], v[80:83], v[52:55]
s_add_u32 m0, s3, 98304
s_add_u32 s29, s17, 0x408000
v_mfma_f32_16x16x32_bf16 v[40:43], a[132:135], v[84:87], v[40:43]
buffer_load_dwordx4 v1, s[4:7], s29 offen sc1 lds
v_mfma_f32_16x16x32_bf16 v[48:51], a[136:139], v[84:87], v[48:51]
v_mfma_f32_16x16x32_bf16 v[56:59], a[140:143], v[84:87], v[56:59]
s_waitcnt lgkmcnt(0)
v_pk_mul_f32 v[68:69], v[68:69], v[116:117] op_sel:[0,1] op_sel_hi:[1,1]
v_pk_mul_f32 v[70:71], v[70:71], v[116:117] op_sel:[0,1] op_sel_hi:[1,1]
v_pk_fma_f32 v[72:73], v[104:105], v[68:69], v[88:89] op_sel:[0,1,0] op_sel_hi:[1,1,1]
buffer_load_dwordx4 v1, s[4:7], s29 offen offset:1024 sc1 lds
v_pk_fma_f32 v[74:75], v[106:107], v[68:69], v[90:91] op_sel:[0,1,0] op_sel_hi:[1,1,1]
v_pk_fma_f32 v[76:77], v[104:105], v[70:71], v[88:89] op_sel:[0,1,0] op_sel_hi:[1,1,1]
v_pk_fma_f32 v[78:79], v[106:107], v[70:71], v[90:91] op_sel:[0,1,0] op_sel_hi:[1,1,1]
v_pk_fma_f32 v[36:37], v[36:37], v[68:69], v[72:73] op_sel_hi:[1,0,1]
v_pk_fma_f32 v[38:39], v[38:39], v[68:69], v[74:75] op_sel_hi:[1,0,1]
v_pk_fma_f32 v[40:41], v[40:41], v[70:71], v[76:77] op_sel_hi:[1,0,1]
v_pk_fma_f32 v[42:43], v[42:43], v[70:71], v[78:79] op_sel_hi:[1,0,1]
v_pk_fma_f32 v[72:73], v[36:37], v[36:37], v[116:117] op_sel_hi:[1,1,0]
v_pk_fma_f32 v[74:75], v[38:39], v[38:39], v[116:117] op_sel_hi:[1,1,0]
s_add_u32 m0, s3, 106496
s_add_u32 s29, s17, 0x40a000
buffer_load_dwordx4 v1, s[4:7], s29 offen sc1 lds
v_pk_fma_f32 v[76:77], v[40:41], v[40:41], v[116:117] op_sel_hi:[1,1,0]
v_pk_fma_f32 v[78:79], v[42:43], v[42:43], v[116:117] op_sel_hi:[1,1,0]
v_pk_mul_f32 v[72:73], v[72:73], v[36:37] neg_lo:[0,1] neg_hi:[0,1]
v_pk_mul_f32 v[74:75], v[74:75], v[38:39] neg_lo:[0,1] neg_hi:[0,1]
v_pk_mul_f32 v[76:77], v[76:77], v[40:41] neg_lo:[0,1] neg_hi:[0,1]
v_pk_mul_f32 v[78:79], v[78:79], v[42:43] neg_lo:[0,1] neg_hi:[0,1]
v_exp_f32 v80, v72
v_exp_f32 v81, v73
buffer_load_dwordx4 v1, s[4:7], s29 offen offset:1024 sc1 lds
v_exp_f32 v82, v74
v_exp_f32 v83, v75
v_exp_f32 v84, v76
v_exp_f32 v85, v77
v_exp_f32 v86, v78
s_add_u32 m0, s3, 114688
s_add_u32 s29, s17, 0x40c000
buffer_load_dwordx4 v1, s[4:7], s29 offen sc1 lds
v_exp_f32 v87, v79
v_pk_fma_f32 v[80:81], v[80:81], v[116:117], v[116:117] op_sel:[0,1,1] op_sel_hi:[1,1,1]
v_pk_fma_f32 v[82:83], v[82:83], v[116:117], v[116:117] op_sel:[0,1,1] op_sel_hi:[1,1,1]
v_pk_fma_f32 v[84:85], v[84:85], v[116:117], v[116:117] op_sel:[0,1,1] op_sel_hi:[1,1,1]
v_pk_fma_f32 v[86:87], v[86:87], v[116:117], v[116:117] op_sel:[0,1,1] op_sel_hi:[1,1,1]
v_rcp_f32 v80, v80
v_rcp_f32 v81, v81
buffer_load_dwordx4 v1, s[4:7], s29 offen offset:1024 sc1 lds
v_rcp_f32 v82, v82
v_rcp_f32 v83, v83
v_rcp_f32 v84, v84
v_rcp_f32 v85, v85
v_rcp_f32 v86, v86
s_add_u32 m0, s3, 122880
s_add_u32 s29, s17, 0x40e000
buffer_load_dwordx4 v1, s[4:7], s29 offen sc1 lds
v_rcp_f32 v87, v87
s_add_u32 s15, s40, s12
v_pk_mul_f32 v[36:37], v[36:37], v[80:81]
v_pk_mul_f32 v[38:39], v[38:39], v[82:83]
v_pk_mul_f32 v[40:41], v[40:41], v[84:85]
v_pk_mul_f32 v[42:43], v[42:43], v[86:87]
v_cvt_pk_bf16_f32 v36, v36, v37
v_cvt_pk_bf16_f32 v37, v38, v39
v_cvt_pk_bf16_f32 v38, v40, v41
buffer_load_dwordx4 v1, s[4:7], s29 offen offset:1024 sc1 lds
v_cvt_pk_bf16_f32 v39, v42, v43
v_permlane32_swap_b32 v36, v38
s_nop 0
v_permlane32_swap_b32 v37, v39
buffer_store_dwordx4 v[36:39], v3, s[4:7], s15 offen sc1
v_pk_fma_f32 v[72:73], v[108:109], v[68:69], v[92:93] op_sel:[0,1,0] op_sel_hi:[1,1,1]
v_pk_fma_f32 v[74:75], v[110:111], v[68:69], v[94:95] op_sel:[0,1,0] op_sel_hi:[1,1,1]
v_pk_fma_f32 v[76:77], v[108:109], v[70:71], v[92:93] op_sel:[0,1,0] op_sel_hi:[1,1,1]
v_pk_fma_f32 v[78:79], v[110:111], v[70:71], v[94:95] op_sel:[0,1,0] op_sel_hi:[1,1,1]
v_pk_fma_f32 v[44:45], v[44:45], v[68:69], v[72:73] op_sel_hi:[1,0,1]
v_pk_fma_f32 v[46:47], v[46:47], v[68:69], v[74:75] op_sel_hi:[1,0,1]
v_pk_fma_f32 v[48:49], v[48:49], v[70:71], v[76:77] op_sel_hi:[1,0,1]
v_pk_fma_f32 v[50:51], v[50:51], v[70:71], v[78:79] op_sel_hi:[1,0,1]
v_pk_fma_f32 v[72:73], v[44:45], v[44:45], v[116:117] op_sel_hi:[1,1,0]
s_add_u32 s46, s13, 0xd41000
buffer_load_dwordx2 v[120:121], v14, s[4:7], s46 offen sc1
buffer_load_dwordx2 v[122:123], v14, s[4:7], s46 offen offset:256 sc1
v_pk_fma_f32 v[74:75], v[46:47], v[46:47], v[116:117] op_sel_hi:[1,1,0]
v_pk_fma_f32 v[76:77], v[48:49], v[48:49], v[116:117] op_sel_hi:[1,1,0]
v_pk_fma_f32 v[78:79], v[50:51], v[50:51], v[116:117] op_sel_hi:[1,1,0]
v_pk_mul_f32 v[72:73], v[72:73], v[44:45] neg_lo:[0,1] neg_hi:[0,1]
v_pk_mul_f32 v[74:75], v[74:75], v[46:47] neg_lo:[0,1] neg_hi:[0,1]
v_pk_mul_f32 v[76:77], v[76:77], v[48:49] neg_lo:[0,1] neg_hi:[0,1]
v_pk_mul_f32 v[78:79], v[78:79], v[50:51] neg_lo:[0,1] neg_hi:[0,1]
v_exp_f32 v80, v72
s_add_u32 s46, s13, 0xd41000
buffer_load_dwordx2 v[124:125], v14, s[4:7], s46 offen offset:512 sc1
buffer_load_dwordx2 v[126:127], v14, s[4:7], s46 offen offset:768 sc1
v_exp_f32 v81, v73
v_exp_f32 v82, v74
v_exp_f32 v83, v75
v_exp_f32 v84, v76
v_exp_f32 v85, v77
v_exp_f32 v86, v78
v_exp_f32 v87, v79
v_pk_fma_f32 v[80:81], v[80:81], v[116:117], v[116:117] op_sel:[0,1,1] op_sel_hi:[1,1,1]
v_pk_fma_f32 v[82:83], v[82:83], v[116:117], v[116:117] op_sel:[0,1,1] op_sel_hi:[1,1,1]
v_pk_fma_f32 v[84:85], v[84:85], v[116:117], v[116:117] op_sel:[0,1,1] op_sel_hi:[1,1,1]
v_pk_fma_f32 v[86:87], v[86:87], v[116:117], v[116:117] op_sel:[0,1,1] op_sel_hi:[1,1,1]
v_rcp_f32 v80, v80
v_rcp_f32 v81, v81
v_rcp_f32 v82, v82
v_rcp_f32 v83, v83
v_rcp_f32 v84, v84
v_rcp_f32 v85, v85
v_rcp_f32 v86, v86
v_rcp_f32 v87, v87
s_add_u32 s15, s41, s12
v_pk_mul_f32 v[44:45], v[44:45], v[80:81]
v_pk_mul_f32 v[46:47], v[46:47], v[82:83]
v_pk_mul_f32 v[48:49], v[48:49], v[84:85]
v_pk_mul_f32 v[50:51], v[50:51], v[86:87]
v_cvt_pk_bf16_f32 v44, v44, v45
v_cvt_pk_bf16_f32 v45, v46, v47
v_cvt_pk_bf16_f32 v46, v48, v49
v_cvt_pk_bf16_f32 v47, v50, v51
s_nop 0
v_permlane32_swap_b32 v44, v46
v_permlane32_swap_b32 v45, v47
buffer_store_dwordx4 v[44:47], v3, s[4:7], s15 offen sc1
v_pk_fma_f32 v[72:73], v[112:113], v[68:69], v[96:97] op_sel:[0,1,0] op_sel_hi:[1,1,1]
v_pk_fma_f32 v[74:75], v[114:115], v[68:69], v[98:99] op_sel:[0,1,0] op_sel_hi:[1,1,1]
v_pk_fma_f32 v[76:77], v[112:113], v[70:71], v[96:97] op_sel:[0,1,0] op_sel_hi:[1,1,1]
v_pk_fma_f32 v[78:79], v[114:115], v[70:71], v[98:99] op_sel:[0,1,0] op_sel_hi:[1,1,1]
v_pk_fma_f32 v[52:53], v[52:53], v[68:69], v[72:73] op_sel_hi:[1,0,1]
v_pk_fma_f32 v[54:55], v[54:55], v[68:69], v[74:75] op_sel_hi:[1,0,1]
v_pk_fma_f32 v[56:57], v[56:57], v[70:71], v[76:77] op_sel_hi:[1,0,1]
v_pk_fma_f32 v[58:59], v[58:59], v[70:71], v[78:79] op_sel_hi:[1,0,1]
v_pk_fma_f32 v[72:73], v[52:53], v[52:53], v[116:117] op_sel_hi:[1,1,0]
v_pk_fma_f32 v[74:75], v[54:55], v[54:55], v[116:117] op_sel_hi:[1,1,0]
v_pk_fma_f32 v[76:77], v[56:57], v[56:57], v[116:117] op_sel_hi:[1,1,0]
v_pk_fma_f32 v[78:79], v[58:59], v[58:59], v[116:117] op_sel_hi:[1,1,0]
v_pk_mul_f32 v[72:73], v[72:73], v[52:53] neg_lo:[0,1] neg_hi:[0,1]
v_pk_mul_f32 v[74:75], v[74:75], v[54:55] neg_lo:[0,1] neg_hi:[0,1]
v_pk_mul_f32 v[76:77], v[76:77], v[56:57] neg_lo:[0,1] neg_hi:[0,1]
v_pk_mul_f32 v[78:79], v[78:79], v[58:59] neg_lo:[0,1] neg_hi:[0,1]
v_exp_f32 v80, v72
v_exp_f32 v81, v73
v_exp_f32 v82, v74
v_exp_f32 v83, v75
v_exp_f32 v84, v76
v_exp_f32 v85, v77
v_exp_f32 v86, v78
v_exp_f32 v87, v79
v_pk_fma_f32 v[80:81], v[80:81], v[116:117], v[116:117] op_sel:[0,1,1] op_sel_hi:[1,1,1]
v_pk_fma_f32 v[82:83], v[82:83], v[116:117], v[116:117] op_sel:[0,1,1] op_sel_hi:[1,1,1]
v_pk_fma_f32 v[84:85], v[84:85], v[116:117], v[116:117] op_sel:[0,1,1] op_sel_hi:[1,1,1]
v_pk_fma_f32 v[86:87], v[86:87], v[116:117], v[116:117] op_sel:[0,1,1] op_sel_hi:[1,1,1]
s_waitcnt vmcnt(6)
s_barrier
ds_read_b128 v[88:91], v2 offset:49152
ds_read_b128 v[92:95], v2 offset:50176
ds_read_b128 v[96:99], v2 offset:51200
ds_read_b128 v[100:103], v2 offset:52224
v_rcp_f32 v80, v80
v_rcp_f32 v81, v81
v_rcp_f32 v82, v82
v_rcp_f32 v83, v83
v_rcp_f32 v84, v84
v_rcp_f32 v85, v85
v_rcp_f32 v86, v86
v_rcp_f32 v87, v87
s_add_u32 s15, s42, s12
v_pk_mul_f32 v[52:53], v[52:53], v[80:81]
v_pk_mul_f32 v[54:55], v[54:55], v[82:83]
v_pk_mul_f32 v[56:57], v[56:57], v[84:85]
v_pk_mul_f32 v[58:59], v[58:59], v[86:87]
v_cvt_pk_bf16_f32 v52, v52, v53
v_cvt_pk_bf16_f32 v53, v54, v55
v_cvt_pk_bf16_f32 v54, v56, v57
v_cvt_pk_bf16_f32 v55, v58, v59
s_nop 0
v_permlane32_swap_b32 v52, v54
v_permlane32_swap_b32 v53, v55
buffer_store_dwordx4 v[52:55], v3, s[4:7], s15 offen sc1
ds_read_b128 v[72:75], v2 offset:53248
ds_read_b128 v[76:79], v2 offset:54272
s_waitcnt lgkmcnt(4)
v_mfma_f32_16x16x32_bf16 v[36:39], a[144:147], v[88:91], 0
ds_read_b128 v[80:83], v2 offset:55296
ds_read_b128 v[84:87], v2 offset:56320
v_mfma_f32_16x16x32_bf16 v[44:47], a[148:151], v[88:91], 0
v_mfma_f32_16x16x32_bf16 v[52:55], a[152:155], v[88:91], 0
v_mfma_f32_16x16x32_bf16 v[40:43], a[144:147], v[92:95], 0
v_mfma_f32_16x16x32_bf16 v[48:51], a[148:151], v[92:95], 0
v_mfma_f32_16x16x32_bf16 v[56:59], a[152:155], v[92:95], 0
s_waitcnt lgkmcnt(4)
v_mfma_f32_16x16x32_bf16 v[36:39], a[156:159], v[96:99], v[36:39]
ds_read_b128 v[88:91], v2 offset:57344
ds_read_b128 v[92:95], v2 offset:58368
v_mfma_f32_16x16x32_bf16 v[44:47], a[160:163], v[96:99], v[44:47]
s_add_u32 s28, s27, 20480
buffer_load_dwordx4 a[144:147], v1, s[4:7], s28 offen sc1
v_mfma_f32_16x16x32_bf16 v[52:55], a[164:167], v[96:99], v[52:55]
v_mfma_f32_16x16x32_bf16 v[40:43], a[156:159], v[100:103], v[40:43]
v_mfma_f32_16x16x32_bf16 v[48:51], a[160:163], v[100:103], v[48:51]
v_mfma_f32_16x16x32_bf16 v[56:59], a[164:167], v[100:103], v[56:59]
buffer_load_dwordx4 a[148:151], v1, s[4:7], s28 offen offset:1024 sc1
s_waitcnt lgkmcnt(4)
v_mfma_f32_16x16x32_bf16 v[36:39], a[168:171], v[72:75], v[36:39]
ds_read_b128 v[96:99], v2 offset:59392
ds_read_b128 v[100:103], v2 offset:60416
v_mfma_f32_16x16x32_bf16 v[44:47], a[172:175], v[72:75], v[44:47]
s_waitcnt vmcnt(4)
v_add_f32 v120, v120, v122
v_mfma_f32_16x16x32_bf16 v[52:55], a[176:179], v[72:75], v[52:55]
v_add_f32 v124, v124, v126
v_add_f32 v121, v121, v123
v_mfma_f32_16x16x32_bf16 v[40:43], a[168:171], v[76:79], v[40:43]
buffer_load_dwordx4 a[152:155], v1, s[4:7], s28 offen offset:2048 sc1
v_add_f32 v125, v125, v127
v_mfma_f32_16x16x32_bf16 v[48:51], a[172:175], v[76:79], v[48:51]
v_add_f32 v120, v120, v124
v_add_f32 v121, v121, v125
v_mfma_f32_16x16x32_bf16 v[56:59], a[176:179], v[76:79], v[56:59]
v_add_u32 v122, s52, v5
s_waitcnt lgkmcnt(4)
v_mfma_f32_16x16x32_bf16 v[36:39], a[180:183], v[80:83], v[36:39]
ds_read_b128 v[72:75], v2 offset:61440
ds_read_b128 v[76:79], v2 offset:62464
v_mfma_f32_16x16x32_bf16 v[44:47], a[184:187], v[80:83], v[44:47]
buffer_load_dwordx4 a[156:159], v1, s[4:7], s28 offen offset:3072 sc1
s_nop 0
v_mfma_f32_16x16x32_bf16 v[52:55], a[188:191], v[80:83], v[52:55]
v_permlane32_swap_b32 v120, v121
v_mfma_f32_16x16x32_bf16 v[40:43], a[180:183], v[84:87], v[40:43]
v_add_f32 v120, v120, v121
v_mov_b32 v121, v120
v_mfma_f32_16x16x32_bf16 v[48:51], a[184:187], v[84:87], v[48:51]
s_nop 0
v_permlane16_swap_b32 v120, v121
v_mfma_f32_16x16x32_bf16 v[56:59], a[188:191], v[84:87], v[56:59]
s_add_u32 s28, s27, 24576
s_waitcnt lgkmcnt(4)
v_mfma_f32_16x16x32_bf16 v[36:39], a[96:99], v[88:91], v[36:39]
ds_read_b128 v[80:83], v2 offset:63488
ds_read_b128 v[84:87], v2 offset:64512
v_mfma_f32_16x16x32_bf16 v[44:47], a[100:103], v[88:91], v[44:47]
buffer_load_dwordx4 a[160:163], v1, s[4:7], s28 offen sc1
v_add_u32 v15, 8, v15
v_mfma_f32_16x16x32_bf16 v[52:55], a[104:107], v[88:91], v[52:55]
buffer_load_dwordx4 a[164:167], v1, s[4:7], s28 offen offset:1024 sc1
s_waitcnt vmcnt(6)
v_mfma_f32_16x16x32_bf16 v[40:43], a[96:99], v[92:95], v[40:43]
buffer_store_dword v15, v13, s[4:7], s45 offen sc1
v_add_f32 v120, v120, v121
v_mfma_f32_16x16x32_bf16 v[48:51], a[100:103], v[92:95], v[48:51]
v_mov_b32 v121, v120
v_mfma_f32_16x16x32_bf16 v[56:59], a[104:107], v[92:95], v[56:59]
s_waitcnt lgkmcnt(4)
v_mfma_f32_16x16x32_bf16 v[36:39], a[108:111], v[96:99], v[36:39]
ds_read_b128 v[88:91], v2 offset:32768
ds_read_b128 v[92:95], v2 offset:33792
v_mfma_f32_16x16x32_bf16 v[44:47], a[112:115], v[96:99], v[44:47]
buffer_load_dwordx4 a[168:171], v1, s[4:7], s28 offen offset:2048 sc1
v_mfma_f32_16x16x32_bf16 v[52:55], a[116:119], v[96:99], v[52:55]
v_permlane32_swap_b32 v120, v121
v_mfma_f32_16x16x32_bf16 v[40:43], a[108:111], v[100:103], v[40:43]
v_mul_f32 v120, 0x3b000000, v120
v_mul_f32 v121, 0x3b000000, v121
v_mfma_f32_16x16x32_bf16 v[48:51], a[112:115], v[100:103], v[48:51]
v_fma_f32 v121, -v120, v120, v121
v_max_f32 v121, 0, v121
v_mfma_f32_16x16x32_bf16 v[56:59], a[116:119], v[100:103], v[56:59]
buffer_load_dwordx4 a[172:175], v1, s[4:7], s28 offen offset:3072 sc1
s_waitcnt lgkmcnt(4)
v_mfma_f32_16x16x32_bf16 v[36:39], a[120:123], v[72:75], v[36:39]
ds_read_b128 v[96:99], v2 offset:34816
ds_read_b128 v[100:103], v2 offset:35840
v_mfma_f32_16x16x32_bf16 v[44:47], a[124:127], v[72:75], v[44:47]
v_add_f32 v121, 0x3727c5ac, v121
v_mfma_f32_16x16x32_bf16 v[52:55], a[128:131], v[72:75], v[52:55]
v_rsq_f32 v121, v121
v_mfma_f32_16x16x32_bf16 v[40:43], a[120:123], v[76:79], v[40:43]
s_add_u32 s28, s27, 28672
buffer_load_dwordx4 a[176:179], v1, s[4:7], s28 offen sc1
v_mfma_f32_16x16x32_bf16 v[48:51], a[124:127], v[76:79], v[48:51]
v_sub_f32 v120, 0, v120
v_mul_f32 v120, v120, v121
v_mfma_f32_16x16x32_bf16 v[56:59], a[128:131], v[76:79], v[56:59]
ds_write_b32 v122, v121 offset:64
s_waitcnt lgkmcnt(5)
v_mfma_f32_16x16x32_bf16 v[36:39], a[132:135], v[80:83], v[36:39]
ds_read_b128 v[72:75], v2 offset:36864
ds_read_b128 v[76:79], v2 offset:37888
v_mfma_f32_16x16x32_bf16 v[44:47], a[136:139], v[80:83], v[44:47]
buffer_load_dwordx4 a[180:183], v1, s[4:7], s28 offen offset:1024 sc1
ds_write_b32 v122, v120 offset:384
v_mfma_f32_16x16x32_bf16 v[52:55], a[140:143], v[80:83], v[52:55]
s_waitcnt lgkmcnt(0)
s_barrier
v_mfma_f32_16x16x32_bf16 v[40:43], a[132:135], v[84:87], v[40:43]
v_mfma_f32_16x16x32_bf16 v[48:51], a[136:139], v[84:87], v[48:51]
v_mfma_f32_16x16x32_bf16 v[56:59], a[140:143], v[84:87], v[56:59]
buffer_load_dwordx4 a[184:187], v1, s[4:7], s28 offen offset:2048 sc1
v_mfma_f32_16x16x32_bf16 v[36:39], a[208:211], v[88:91], v[36:39]
ds_read_b128 v[80:83], v2 offset:38912
ds_read_b128 v[84:87], v2 offset:39936
v_mfma_f32_16x16x32_bf16 v[44:47], a[212:215], v[88:91], v[44:47]
v_mfma_f32_16x16x32_bf16 v[52:55], a[216:219], v[88:91], v[52:55]
v_mfma_f32_16x16x32_bf16 v[40:43], a[208:211], v[92:95], v[40:43]
buffer_load_dwordx4 a[188:191], v1, s[4:7], s28 offen offset:3072 sc1
v_mfma_f32_16x16x32_bf16 v[48:51], a[212:215], v[92:95], v[48:51]
v_mfma_f32_16x16x32_bf16 v[56:59], a[216:219], v[92:95], v[56:59]
v_mfma_f32_16x16x32_bf16 v[36:39], a[220:223], v[96:99], v[36:39]
ds_read_b128 v[88:91], v2 offset:40960
ds_read_b128 v[92:95], v2 offset:41984
v_mfma_f32_16x16x32_bf16 v[44:47], a[224:227], v[96:99], v[44:47]
buffer_load_dword v17, v4, s[4:7], s92 offen sc1
v_mfma_f32_16x16x32_bf16 v[52:55], a[228:231], v[96:99], v[52:55]
v_mfma_f32_16x16x32_bf16 v[40:43], a[220:223], v[100:103], v[40:43]
v_mfma_f32_16x16x32_bf16 v[48:51], a[224:227], v[100:103], v[48:51]
v_mfma_f32_16x16x32_bf16 v[56:59], a[228:231], v[100:103], v[56:59]
s_add_u32 s28, s27, 32768
v_mfma_f32_16x16x32_bf16 v[36:39], a[232:235], v[72:75], v[36:39]
ds_read_b128 v[96:99], v2 offset:43008
ds_read_b128 v[100:103], v2 offset:44032
v_mfma_f32_16x16x32_bf16 v[44:47], a[236:239], v[72:75], v[44:47]
buffer_load_dwordx4 a[96:99], v1, s[4:7], s28 offen sc1
v_mfma_f32_16x16x32_bf16 v[52:55], a[240:243], v[72:75], v[52:55]
v_mfma_f32_16x16x32_bf16 v[40:43], a[232:235], v[76:79], v[40:43]
v_mfma_f32_16x16x32_bf16 v[48:51], a[236:239], v[76:79], v[48:51]
v_mfma_f32_16x16x32_bf16 v[56:59], a[240:243], v[76:79], v[56:59]
buffer_load_dwordx4 a[100:103], v1, s[4:7], s28 offen offset:1024 sc1
s_waitcnt lgkmcnt(4)
v_mfma_f32_16x16x32_bf16 v[36:39], a[244:247], v[80:83], v[36:39]
ds_read_b128 v[72:75], v2 offset:45056
ds_read_b128 v[76:79], v2 offset:46080
v_mfma_f32_16x16x32_bf16 v[44:47], a[248:251], v[80:83], v[44:47]
v_mfma_f32_16x16x32_bf16 v[52:55], a[252:255], v[80:83], v[52:55]
v_mfma_f32_16x16x32_bf16 v[40:43], a[244:247], v[84:87], v[40:43]
buffer_load_dwordx4 a[104:107], v1, s[4:7], s28 offen offset:2048 sc1
v_mfma_f32_16x16x32_bf16 v[48:51], a[248:251], v[84:87], v[48:51]
v_mfma_f32_16x16x32_bf16 v[56:59], a[252:255], v[84:87], v[56:59]
s_waitcnt lgkmcnt(4)
v_mfma_f32_16x16x32_bf16 v[36:39], v[128:131], v[88:91], v[36:39]
ds_read_b128 v[80:83], v2 offset:47104
ds_read_b128 v[84:87], v2 offset:48128
v_mfma_f32_16x16x32_bf16 v[44:47], v[132:135], v[88:91], v[44:47]
buffer_load_dwordx4 a[108:111], v1, s[4:7], s28 offen offset:3072 sc1
v_mfma_f32_16x16x32_bf16 v[52:55], v[136:139], v[88:91], v[52:55]
v_mfma_f32_16x16x32_bf16 v[40:43], v[128:131], v[92:95], v[40:43]
v_mfma_f32_16x16x32_bf16 v[48:51], v[132:135], v[92:95], v[48:51]
v_mfma_f32_16x16x32_bf16 v[56:59], v[136:139], v[92:95], v[56:59]
s_add_u32 s28, s27, 36864
s_waitcnt lgkmcnt(4)
v_mfma_f32_16x16x32_bf16 v[36:39], v[140:143], v[96:99], v[36:39]
buffer_load_dwordx4 a[112:115], v1, s[4:7], s28 offen sc1
v_mfma_f32_16x16x32_bf16 v[44:47], v[144:147], v[96:99], v[44:47]
v_mfma_f32_16x16x32_bf16 v[52:55], v[148:151], v[96:99], v[52:55]
v_mfma_f32_16x16x32_bf16 v[40:43], v[140:143], v[100:103], v[40:43]
v_mfma_f32_16x16x32_bf16 v[48:51], v[144:147], v[100:103], v[48:51]
buffer_load_dwordx4 a[116:119], v1, s[4:7], s28 offen offset:1024 sc1
v_mfma_f32_16x16x32_bf16 v[56:59], v[148:151], v[100:103], v[56:59]
s_waitcnt lgkmcnt(2)
v_mfma_f32_16x16x32_bf16 v[36:39], v[152:155], v[72:75], v[36:39]
v_mov_b32 v116, s36
v_mov_b32 v117, s37
v_mfma_f32_16x16x32_bf16 v[44:47], v[156:159], v[72:75], v[44:47]
ds_read2_b32 v[68:69], v5 offset0:16 offset1:96
ds_read2_b32 v[70:71], v5 offset0:32 offset1:112
v_mfma_f32_16x16x32_bf16 v[52:55], v[160:163], v[72:75], v[52:55]
buffer_load_dwordx4 a[120:123], v1, s[4:7], s28 offen offset:2048 sc1
ds_read_b128 v[104:107], v6 offset:256
v_mfma_f32_16x16x32_bf16 v[40:43], v[152:155], v[76:79], v[40:43]
ds_read_b128 v[88:91], v6 offset:512
ds_read_b128 v[108:111], v6 offset:320
v_mfma_f32_16x16x32_bf16 v[48:51], v[156:159], v[76:79], v[48:51]
ds_read_b128 v[92:95], v6 offset:576
ds_read_b128 v[112:115], v6 offset:384
v_mfma_f32_16x16x32_bf16 v[56:59], v[160:163], v[76:79], v[56:59]
ds_read_b128 v[96:99], v6 offset:640
s_waitcnt lgkmcnt(8)
v_mfma_f32_16x16x32_bf16 v[36:39], v[164:167], v[80:83], v[36:39]
buffer_load_dwordx4 a[124:127], v1, s[4:7], s28 offen offset:3072 sc1
v_mfma_f32_16x16x32_bf16 v[44:47], v[168:171], v[80:83], v[44:47]
v_mfma_f32_16x16x32_bf16 v[52:55], v[172:175], v[80:83], v[52:55]
v_mfma_f32_16x16x32_bf16 v[40:43], v[164:167], v[84:87], v[40:43]
v_mfma_f32_16x16x32_bf16 v[48:51], v[168:171], v[84:87], v[48:51]
s_add_u32 s28, s27, 40960
buffer_load_dwordx4 a[128:131], v1, s[4:7], s28 offen sc1
v_mfma_f32_16x16x32_bf16 v[56:59], v[172:175], v[84:87], v[56:59]
s_add_u32 s46, s32, 7
buffer_load_dwordx4 a[132:135], v1, s[4:7], s28 offen offset:1024 sc1
s_waitcnt vmcnt(10)
v_lshrrev_b32 v17, 3, v17
v_subrev_u32 v17, s46, v17
v_cmp_lt_u32 vcc, 31, v17
s_cbranch_vccnz L_spin_49
L_ok_48:
s_add_u32 s17, s12, s19
s_waitcnt lgkmcnt(0)
v_pk_mul_f32 v[68:69], v[68:69], v[116:117] op_sel:[0,1] op_sel_hi:[1,1]
v_pk_mul_f32 v[70:71], v[70:71], v[116:117] op_sel:[0,1] op_sel_hi:[1,1]
v_pk_fma_f32 v[72:73], v[104:105], v[68:69], v[88:89] op_sel:[0,1,0] op_sel_hi:[1,1,1]
v_pk_fma_f32 v[74:75], v[106:107], v[68:69], v[90:91] op_sel:[0,1,0] op_sel_hi:[1,1,1]
v_pk_fma_f32 v[76:77], v[104:105], v[70:71], v[88:89] op_sel:[0,1,0] op_sel_hi:[1,1,1]
v_pk_fma_f32 v[78:79], v[106:107], v[70:71], v[90:91] op_sel:[0,1,0] op_sel_hi:[1,1,1]
v_pk_fma_f32 v[36:37], v[36:37], v[68:69], v[72:73] op_sel_hi:[1,0,1]
v_pk_fma_f32 v[38:39], v[38:39], v[68:69], v[74:75] op_sel_hi:[1,0,1]
v_pk_fma_f32 v[40:41], v[40:41], v[70:71], v[76:77] op_sel_hi:[1,0,1]
s_add_u32 m0, s2, 0
s_add_u32 s29, s17, 0x0
buffer_load_dwordx4 v1, s[4:7], s29 offen sc1 lds
v_pk_fma_f32 v[42:43], v[42:43], v[70:71], v[78:79] op_sel_hi:[1,0,1]
v_pk_fma_f32 v[72:73], v[36:37], v[36:37], v[116:117] op_sel_hi:[1,1,0]
v_pk_fma_f32 v[74:75], v[38:39], v[38:39], v[116:117] op_sel_hi:[1,1,0]
v_pk_fma_f32 v[76:77], v[40:41], v[40:41], v[116:117] op_sel_hi:[1,1,0]
v_pk_fma_f32 v[78:79], v[42:43], v[42:43], v[116:117] op_sel_hi:[1,1,0]
v_pk_mul_f32 v[72:73], v[72:73], v[36:37] neg_lo:[0,1] neg_hi:[0,1]
v_pk_mul_f32 v[74:75], v[74:75], v[38:39] neg_lo:[0,1] neg_hi:[0,1]
v_pk_mul_f32 v[76:77], v[76:77], v[40:41] neg_lo:[0,1] neg_hi:[0,1]
v_pk_mul_f32 v[78:79], v[78:79], v[42:43] neg_lo:[0,1] neg_hi:[0,1]
buffer_load_dwordx4 v1, s[4:7], s29 offen offset:1024 sc1 lds
v_exp_f32 v80, v72
v_exp_f32 v81, v73
v_exp_f32 v82, v74
v_exp_f32 v83, v75
v_exp_f32 v84, v76
s_add_u32 m0, s2, 8192
s_add_u32 s29, s17, 0x1000
buffer_load_dwordx4 v1, s[4:7], s29 offen sc1 lds
v_exp_f32 v85, v77
v_exp_f32 v86, v78
v_exp_f32 v87, v79
v_pk_fma_f32 v[80:81], v[80:81], v[116:117], v[116:117] op_sel:[0,1,1] op_sel_hi:[1,1,1]
v_pk_fma_f32 v[82:83], v[82:83], v[116:117], v[116:117] op_sel:[0,1,1] op_sel_hi:[1,1,1]
v_pk_fma_f32 v[84:85], v[84:85], v[116:117], v[116:117] op_sel:[0,1,1] op_sel_hi:[1,1,1]
v_pk_fma_f32 v[86:87], v[86:87], v[116:117], v[116:117] op_sel:[0,1,1] op_sel_hi:[1,1,1]
buffer_load_dwordx4 v1, s[4:7], s29 offen offset:1024 sc1 lds
v_rcp_f32 v80, v80
v_rcp_f32 v81, v81
v_rcp_f32 v82, v82
v_rcp_f32 v83, v83
v_rcp_f32 v84, v84
s_add_u32 m0, s2, 16384
s_add_u32 s29, s17, 0x2000
buffer_load_dwordx4 v1, s[4:7], s29 offen sc1 lds
v_rcp_f32 v85, v85
v_rcp_f32 v86, v86
v_rcp_f32 v87, v87
s_add_u32 s15, s40, s12
v_pk_mul_f32 v[36:37], v[36:37], v[80:81]
v_pk_mul_f32 v[38:39], v[38:39], v[82:83]
v_pk_mul_f32 v[40:41], v[40:41], v[84:85]
v_pk_mul_f32 v[42:43], v[42:43], v[86:87]
buffer_load_dwordx4 v1, s[4:7], s29 offen offset:1024 sc1 lds
s_add_u32 s15, s15, 0x16000
v_cvt_pk_bf16_f32 v36, v36, v37
v_cvt_pk_bf16_f32 v37, v38, v39
v_cvt_pk_bf16_f32 v38, v40, v41
v_cvt_pk_bf16_f32 v39, v42, v43
s_nop 0
v_permlane32_swap_b32 v36, v38
v_permlane32_swap_b32 v37, v39
buffer_store_dwordx4 v[36:39], v3, s[4:7], s15 offen sc1
v_pk_fma_f32 v[72:73], v[108:109], v[68:69], v[92:93] op_sel:[0,1,0] op_sel_hi:[1,1,1]
v_pk_fma_f32 v[74:75], v[110:111], v[68:69], v[94:95] op_sel:[0,1,0] op_sel_hi:[1,1,1]
v_pk_fma_f32 v[76:77], v[108:109], v[70:71], v[92:93] op_sel:[0,1,0] op_sel_hi:[1,1,1]
v_pk_fma_f32 v[78:79], v[110:111], v[70:71], v[94:95] op_sel:[0,1,0] op_sel_hi:[1,1,1]
v_pk_fma_f32 v[44:45], v[44:45], v[68:69], v[72:73] op_sel_hi:[1,0,1]
v_pk_fma_f32 v[46:47], v[46:47], v[68:69], v[74:75] op_sel_hi:[1,0,1]
v_pk_fma_f32 v[48:49], v[48:49], v[70:71], v[76:77] op_sel_hi:[1,0,1]
v_pk_fma_f32 v[50:51], v[50:51], v[70:71], v[78:79] op_sel_hi:[1,0,1]
v_pk_fma_f32 v[72:73], v[44:45], v[44:45], v[116:117] op_sel_hi:[1,1,0]
s_add_u32 m0, s2, 24576
s_add_u32 s29, s17, 0x3000
buffer_load_dwordx4 v1, s[4:7], s29 offen sc1 lds
v_pk_fma_f32 v[74:75], v[46:47], v[46:47], v[116:117] op_sel_hi:[1,1,0]
v_pk_fma_f32 v[76:77], v[48:49], v[48:49], v[116:117] op_sel_hi:[1,1,0]
v_pk_fma_f32 v[78:79], v[50:51], v[50:51], v[116:117] op_sel_hi:[1,1,0]
v_pk_mul_f32 v[72:73], v[72:73], v[44:45] neg_lo:[0,1] neg_hi:[0,1]
v_pk_mul_f32 v[74:75], v[74:75], v[46:47] neg_lo:[0,1] neg_hi:[0,1]
v_pk_mul_f32 v[76:77], v[76:77], v[48:49] neg_lo:[0,1] neg_hi:[0,1]
v_pk_mul_f32 v[78:79], v[78:79], v[50:51] neg_lo:[0,1] neg_hi:[0,1]
v_exp_f32 v80, v72
buffer_load_dwordx4 v1, s[4:7], s29 offen offset:1024 sc1 lds
v_exp_f32 v81, v73
v_exp_f32 v82, v74
v_exp_f32 v83, v75
v_exp_f32 v84, v76
v_exp_f32 v85, v77
s_add_u32 m0, s2, 32768
s_add_u32 s29, s17, 0x4000
buffer_load_dwordx4 v1, s[4:7], s29 offen sc1 lds
v_exp_f32 v86, v78
v_exp_f32 v87, v79
v_pk_fma_f32 v[80:81], v[80:81], v[116:117], v[116:117] op_sel:[0,1,1] op_sel_hi:[1,1,1]
v_pk_fma_f32 v[82:83], v[82:83], v[116:117], v[116:117] op_sel:[0,1,1] op_sel_hi:[1,1,1]
v_pk_fma_f32 v[84:85], v[84:85], v[116:117], v[116:117] op_sel:[0,1,1] op_sel_hi:[1,1,1]
v_pk_fma_f32 v[86:87], v[86:87], v[116:117], v[116:117] op_sel:[0,1,1] op_sel_hi:[1,1,1]
v_rcp_f32 v80, v80
buffer_load_dwordx4 v1, s[4:7], s29 offen offset:1024 sc1 lds
v_rcp_f32 v81, v81
v_rcp_f32 v82, v82
v_rcp_f32 v83, v83
v_rcp_f32 v84, v84
v_rcp_f32 v85, v85
s_add_u32 m0, s2, 40960
s_add_u32 s29, s17, 0x5000
buffer_load_dwordx4 v1, s[4:7], s29 offen sc1 lds
v_rcp_f32 v86, v86
v_rcp_f32 v87, v87
s_add_u32 s15, s41, s12
v_pk_mul_f32 v[44:45], v[44:45], v[80:81]
v_pk_mul_f32 v[46:47], v[46:47], v[82:83]
v_pk_mul_f32 v[48:49], v[48:49], v[84:85]
v_pk_mul_f32 v[50:51], v[50:51], v[86:87]
s_add_u32 s15, s15, 0x16000
v_cvt_pk_bf16_f32 v44, v44, v45
v_cvt_pk_bf16_f32 v45, v46, v47
buffer_load_dwordx4 v1, s[4:7], s29 offen offset:1024 sc1 lds
v_cvt_pk_bf16_f32 v46, v48, v49
v_cvt_pk_bf16_f32 v47, v50, v51
s_nop 0
v_permlane32_swap_b32 v44, v46
v_permlane32_swap_b32 v45, v47
buffer_store_dwordx4 v[44:47], v3, s[4:7], s15 offen sc1
v_pk_fma_f32 v[72:73], v[112:113], v[68:69], v[96:97] op_sel:[0,1,0] op_sel_hi:[1,1,1]
v_pk_fma_f32 v[74:75], v[114:115], v[68:69], v[98:99] op_sel:[0,1,0] op_sel_hi:[1,1,1]
v_pk_fma_f32 v[76:77], v[112:113], v[70:71], v[96:97] op_sel:[0,1,0] op_sel_hi:[1,1,1]
v_pk_fma_f32 v[78:79], v[114:115], v[70:71], v[98:99] op_sel:[0,1,0] op_sel_hi:[1,1,1]
v_pk_fma_f32 v[52:53], v[52:53], v[68:69], v[72:73] op_sel_hi:[1,0,1]
v_pk_fma_f32 v[54:55], v[54:55], v[68:69], v[74:75] op_sel_hi:[1,0,1]
v_pk_fma_f32 v[56:57], v[56:57], v[70:71], v[76:77] op_sel_hi:[1,0,1]
v_pk_fma_f32 v[58:59], v[58:59], v[70:71], v[78:79] op_sel_hi:[1,0,1]
v_pk_fma_f32 v[72:73], v[52:53], v[52:53], v[116:117] op_sel_hi:[1,1,0]
s_add_u32 m0, s2, 49152
s_add_u32 s29, s17, 0x6000
buffer_load_dwordx4 v1, s[4:7], s29 offen sc1 lds
v_pk_fma_f32 v[74:75], v[54:55], v[54:55], v[116:117] op_sel_hi:[1,1,0]
v_pk_fma_f32 v[76:77], v[56:57], v[56:57], v[116:117] op_sel_hi:[1,1,0]
v_pk_fma_f32 v[78:79], v[58:59], v[58:59], v[116:117] op_sel_hi:[1,1,0]
v_pk_mul_f32 v[72:73], v[72:73], v[52:53] neg_lo:[0,1] neg_hi:[0,1]
v_pk_mul_f32 v[74:75], v[74:75], v[54:55] neg_lo:[0,1] neg_hi:[0,1]
v_pk_mul_f32 v[76:77], v[76:77], v[56:57] neg_lo:[0,1] neg_hi:[0,1]
v_pk_mul_f32 v[78:79], v[78:79], v[58:59] neg_lo:[0,1] neg_hi:[0,1]
v_exp_f32 v80, v72
buffer_load_dwordx4 v1, s[4:7], s29 offen offset:1024 sc1 lds
v_exp_f32 v81, v73
v_exp_f32 v82, v74
v_exp_f32 v83, v75
v_exp_f32 v84, v76
v_exp_f32 v85, v77
s_add_u32 m0, s2, 57344
s_add_u32 s29, s17, 0x7000
buffer_load_dwordx4 v1, s[4:7], s29 offen sc1 lds
v_exp_f32 v86, v78
v_exp_f32 v87, v79
v_pk_fma_f32 v[80:81], v[80:81], v[116:117], v[116:117] op_sel:[0,1,1] op_sel_hi:[1,1,1]
v_pk_fma_f32 v[82:83], v[82:83], v[116:117], v[116:117] op_sel:[0,1,1] op_sel_hi:[1,1,1]
v_pk_fma_f32 v[84:85], v[84:85], v[116:117], v[116:117] op_sel:[0,1,1] op_sel_hi:[1,1,1]
v_pk_fma_f32 v[86:87], v[86:87], v[116:117], v[116:117] op_sel:[0,1,1] op_sel_hi:[1,1,1]
buffer_load_dwordx4 a[136:139], v1, s[4:7], s28 offen offset:2048 sc1
s_waitcnt vmcnt(9)
s_barrier
ds_read_b128 v[88:91], v7 offset:0
ds_read_b128 v[92:95], v8 offset:0
ds_read_b128 v[96:99], v7 offset:4096
ds_read_b128 v[100:103], v8 offset:4096
v_rcp_f32 v80, v80
v_rcp_f32 v81, v81
v_rcp_f32 v82, v82
v_rcp_f32 v83, v83
v_rcp_f32 v84, v84
buffer_load_dwordx4 v1, s[4:7], s29 offen offset:1024 sc1 lds
v_rcp_f32 v85, v85
v_rcp_f32 v86, v86
v_rcp_f32 v87, v87
s_add_u32 s15, s42, s12
v_pk_mul_f32 v[52:53], v[52:53], v[80:81]
v_pk_mul_f32 v[54:55], v[54:55], v[82:83]
v_pk_mul_f32 v[56:57], v[56:57], v[84:85]
v_pk_mul_f32 v[58:59], v[58:59], v[86:87]
s_add_u32 m0, s2, 65536
s_add_u32 s29, s17, 0x8000
buffer_load_dwordx4 v1, s[4:7], s29 offen sc1 lds
s_add_u32 s15, s15, 0x16000
v_cvt_pk_bf16_f32 v52, v52, v53
v_cvt_pk_bf16_f32 v53, v54, v55
v_cvt_pk_bf16_f32 v54, v56, v57
v_cvt_pk_bf16_f32 v55, v58, v59
s_nop 0
v_permlane32_swap_b32 v52, v54
v_permlane32_swap_b32 v53, v55
buffer_store_dwordx4 v[52:55], v3, s[4:7], s15 offen sc1
ds_read_b128 v[72:75], v7 offset:8192
ds_read_b128 v[76:79], v8 offset:8192
s_waitcnt lgkmcnt(4)
v_mfma_f32_16x16x32_bf16 v[36:39], v[176:179], v[88:91], 0
ds_read_b128 v[80:83], v7 offset:12288
ds_read_b128 v[84:87], v8 offset:12288
v_mfma_f32_16x16x32_bf16 v[40:43], v[180:183], v[88:91], 0
v_mfma_f32_16x16x32_bf16 v[44:47], v[176:179], v[92:95], 0
buffer_load_dwordx4 v1, s[4:7], s29 offen offset:1024 sc1 lds
v_mfma_f32_16x16x32_bf16 v[48:51], v[180:183], v[92:95], 0
v_lshrrev_b32 v106, 4, v1
v_and_b32 v106, 48, v106
s_waitcnt lgkmcnt(4)
v_mfma_f32_16x16x32_bf16 v[36:39], v[184:187], v[96:99], v[36:39]
ds_read_b128 v[88:91], v7 offset:16384
ds_read_b128 v[92:95], v8 offset:16384
v_mfma_f32_16x16x32_bf16 v[40:43], v[188:191], v[96:99], v[40:43]
s_add_u32 m0, s2, 73728
s_add_u32 s29, s17, 0x9000
v_mfma_f32_16x16x32_bf16 v[44:47], v[184:187], v[100:103], v[44:47]
buffer_load_dwordx4 v1, s[4:7], s29 offen sc1 lds
v_mfma_f32_16x16x32_bf16 v[48:51], v[188:191], v[100:103], v[48:51]
s_waitcnt lgkmcnt(4)
v_mfma_f32_16x16x32_bf16 v[36:39], v[192:195], v[72:75], v[36:39]
ds_read_b128 v[96:99], v7 offset:20480
ds_read_b128 v[100:103], v8 offset:20480
v_mfma_f32_16x16x32_bf16 v[40:43], v[196:199], v[72:75], v[40:43]
buffer_load_dwordx4 v1, s[4:7], s29 offen offset:1024 sc1 lds
v_mfma_f32_16x16x32_bf16 v[44:47], v[192:195], v[76:79], v[44:47]
v_mfma_f32_16x16x32_bf16 v[48:51], v[196:199], v[76:79], v[48:51]
s_waitcnt lgkmcnt(4)
v_mfma_f32_16x16x32_bf16 v[36:39], v[200:203], v[80:83], v[36:39]
ds_read_b128 v[72:75], v7 offset:24576
ds_read_b128 v[76:79], v8 offset:24576
v_mfma_f32_16x16x32_bf16 v[40:43], v[204:207], v[80:83], v[40:43]
s_add_u32 m0, s2, 81920
s_add_u32 s29, s17, 0xa000
v_mfma_f32_16x16x32_bf16 v[44:47], v[200:203], v[84:87], v[44:47]
buffer_load_dwordx4 v1, s[4:7], s29 offen sc1 lds
v_mfma_f32_16x16x32_bf16 v[48:51], v[204:207], v[84:87], v[48:51]
s_waitcnt lgkmcnt(4)
v_mfma_f32_16x16x32_bf16 v[36:39], v[208:211], v[88:91], v[36:39]
ds_read_b128 v[80:83], v7 offset:28672
ds_read_b128 v[84:87], v8 offset:28672
v_mfma_f32_16x16x32_bf16 v[40:43], v[212:215], v[88:91], v[40:43]
buffer_load_dwordx4 v1, s[4:7], s29 offen offset:1024 sc1 lds
v_mfma_f32_16x16x32_bf16 v[44:47], v[208:211], v[92:95], v[44:47]
v_mfma_f32_16x16x32_bf16 v[48:51], v[212:215], v[92:95], v[48:51]
s_waitcnt lgkmcnt(4)
v_mfma_f32_16x16x32_bf16 v[36:39], v[216:219], v[96:99], v[36:39]
buffer_load_dwordx4 a[140:143], v1, s[4:7], s28 offen offset:3072 sc1
s_waitcnt vmcnt(8)
s_barrier
v_mfma_f32_16x16x32_bf16 v[40:43], v[220:223], v[96:99], v[40:43]
ds_read_b128 v[88:91], v7 offset:32768
ds_read_b128 v[92:95], v8 offset:32768
v_mfma_f32_16x16x32_bf16 v[44:47], v[216:219], v[100:103], v[44:47]
v_mfma_f32_16x16x32_bf16 v[48:51], v[220:223], v[100:103], v[48:51]
buffer_load_dwordx4 v[108:111], v106, s[48:51], s95 offen
s_waitcnt lgkmcnt(4)
v_mfma_f32_16x16x32_bf16 v[36:39], v[224:227], v[72:75], v[36:39]
ds_read_b128 v[96:99], v7 offset:36864
ds_read_b128 v[100:103], v8 offset:36864
v_mfma_f32_16x16x32_bf16 v[40:43], v[228:231], v[72:75], v[40:43]
v_add_u32 v15, 8, v15
s_waitcnt vmcnt(7)
v_mfma_f32_16x16x32_bf16 v[44:47], v[224:227], v[76:79], v[44:47]
buffer_store_dword v15, v13, s[4:7], s45 offen sc1
v_mfma_f32_16x16x32_bf16 v[48:51], v[228:231], v[76:79], v[48:51]
s_waitcnt lgkmcnt(4)
v_mfma_f32_16x16x32_bf16 v[36:39], v[232:235], v[80:83], v[36:39]
ds_read_b128 v[72:75], v7 offset:40960
ds_read_b128 v[76:79], v8 offset:40960
v_mfma_f32_16x16x32_bf16 v[40:43], v[236:239], v[80:83], v[40:43]
buffer_load_dword v17, v4, s[4:7], s92 offen sc1
v_mfma_f32_16x16x32_bf16 v[44:47], v[232:235], v[84:87], v[44:47]
v_mfma_f32_16x16x32_bf16 v[48:51], v[236:239], v[84:87], v[48:51]
s_waitcnt lgkmcnt(4)
v_mfma_f32_16x16x32_bf16 v[36:39], v[240:243], v[88:91], v[36:39]
ds_read_b128 v[80:83], v7 offset:45056
ds_read_b128 v[84:87], v8 offset:45056
v_mfma_f32_16x16x32_bf16 v[40:43], v[244:247], v[88:91], v[40:43]
v_mfma_f32_16x16x32_bf16 v[44:47], v[240:243], v[92:95], v[44:47]
v_mfma_f32_16x16x32_bf16 v[48:51], v[244:247], v[92:95], v[48:51]
s_waitcnt lgkmcnt(4)
v_mfma_f32_16x16x32_bf16 v[36:39], v[248:251], v[96:99], v[36:39]
ds_read_b128 v[88:91], v7 offset:49152
ds_read_b128 v[92:95], v8 offset:49152
v_mfma_f32_16x16x32_bf16 v[40:43], v[252:255], v[96:99], v[40:43]
v_mfma_f32_16x16x32_bf16 v[44:47], v[248:251], v[100:103], v[44:47]
v_mfma_f32_16x16x32_bf16 v[48:51], v[252:255], v[100:103], v[48:51]
s_waitcnt lgkmcnt(4)
v_mfma_f32_16x16x32_bf16 v[36:39], a[144:147], v[72:75], v[36:39]
ds_read_b128 v[96:99], v7 offset:53248
ds_read_b128 v[100:103], v8 offset:53248
v_mfma_f32_16x16x32_bf16 v[40:43], a[148:151], v[72:75], v[40:43]
v_mfma_f32_16x16x32_bf16 v[44:47], a[144:147], v[76:79], v[44:47]
v_mfma_f32_16x16x32_bf16 v[48:51], a[148:151], v[76:79], v[48:51]
s_waitcnt lgkmcnt(4)
v_mfma_f32_16x16x32_bf16 v[36:39], a[152:155], v[80:83], v[36:39]
ds_read_b128 v[72:75], v7 offset:57344
ds_read_b128 v[76:79], v8 offset:57344
v_mfma_f32_16x16x32_bf16 v[40:43], a[156:159], v[80:83], v[40:43]
v_mfma_f32_16x16x32_bf16 v[44:47], a[152:155], v[84:87], v[44:47]
v_mfma_f32_16x16x32_bf16 v[48:51], a[156:159], v[84:87], v[48:51]
s_waitcnt lgkmcnt(4)
v_mfma_f32_16x16x32_bf16 v[36:39], a[160:163], v[88:91], v[36:39]
ds_read_b128 v[80:83], v7 offset:61440
ds_read_b128 v[84:87], v8 offset:61440
v_mfma_f32_16x16x32_bf16 v[40:43], a[164:167], v[88:91], v[40:43]
s_add_u32 s44, s32, 8
s_waitcnt vmcnt(0)
v_lshrrev_b32 v17, 3, v17
v_mfma_f32_16x16x32_bf16 v[44:47], a[160:163], v[92:95], v[44:47]
v_subrev_u32 v17, s44, v17
v_cmp_lt_u32 vcc, 31, v17
s_cbranch_vccnz L_spin_51
L_ok_50:
s_add_u32 s18, s12, s19
v_mfma_f32_16x16x32_bf16 v[48:51], a[164:167], v[92:95], v[48:51]
s_add_u32 m0, s2, 90112
s_waitcnt lgkmcnt(4)
v_mfma_f32_16x16x32_bf16 v[36:39], a[168:171], v[96:99], v[36:39]
s_add_u32 s29, s18, 0x1b000
buffer_load_dwordx4 v1, s[4:7], s29 offen sc1 lds
s_barrier
v_mfma_f32_16x16x32_bf16 v[40:43], a[172:175], v[96:99], v[40:43]
ds_read_b128 v[88:91], v9 offset:0
ds_read_b128 v[92:95], v10 offset:0
v_mfma_f32_16x16x32_bf16 v[44:47], a[168:171], v[100:103], v[44:47]
v_lshlrev_b32 v112, 16, v108
v_and_b32 v113, 0xffff0000, v108
v_mfma_f32_16x16x32_bf16 v[48:51], a[172:175], v[100:103], v[48:51]
buffer_load_dwordx4 v1, s[4:7], s29 offen offset:1024 sc1 lds
s_waitcnt lgkmcnt(4)
v_mfma_f32_16x16x32_bf16 v[36:39], a[176:179], v[72:75], v[36:39]
ds_read_b128 v[96:99], v9 offset:4096
ds_read_b128 v[100:103], v10 offset:4096
v_mfma_f32_16x16x32_bf16 v[40:43], a[180:183], v[72:75], v[40:43]
v_add_f32 v20, v20, v112
v_add_f32 v21, v21, v113
v_mfma_f32_16x16x32_bf16 v[44:47], a[176:179], v[76:79], v[44:47]
s_add_u32 m0, s2, 98304
s_add_u32 s29, s18, 0x1c000
v_mfma_f32_16x16x32_bf16 v[48:51], a[180:183], v[76:79], v[48:51]
buffer_load_dwordx4 v1, s[4:7], s29 offen sc1 lds
s_waitcnt lgkmcnt(4)
v_mfma_f32_16x16x32_bf16 v[36:39], a[184:187], v[80:83], v[36:39]
ds_read_b128 v[72:75], v9 offset:8192
ds_read_b128 v[76:79], v10 offset:8192
v_mfma_f32_16x16x32_bf16 v[40:43], a[188:191], v[80:83], v[40:43]
v_add_f32 v28, v28, v112
v_add_f32 v29, v29, v113
v_mfma_f32_16x16x32_bf16 v[44:47], a[184:187], v[84:87], v[44:47]
buffer_load_dwordx4 v1, s[4:7], s29 offen offset:1024 sc1 lds
v_lshlrev_b32 v112, 16, v109
v_mfma_f32_16x16x32_bf16 v[48:51], a[188:191], v[84:87], v[48:51]
v_and_b32 v113, 0xffff0000, v109
s_waitcnt lgkmcnt(4)
v_mfma_f32_16x16x32_bf16 v[36:39], a[96:99], v[88:91], v[36:39]
ds_read_b128 v[80:83], v9 offset:12288
ds_read_b128 v[84:87], v10 offset:12288
v_mfma_f32_16x16x32_bf16 v[40:43], a[100:103], v[88:91], v[40:43]
s_add_u32 m0, s2, 106496
s_add_u32 s29, s18, 0x1d000
v_mfma_f32_16x16x32_bf16 v[44:47], a[96:99], v[92:95], v[44:47]
buffer_load_dwordx4 v1, s[4:7], s29 offen sc1 lds
v_add_f32 v22, v22, v112
v_mfma_f32_16x16x32_bf16 v[48:51], a[100:103], v[92:95], v[48:51]
v_add_f32 v23, v23, v113
s_waitcnt lgkmcnt(4)
v_mfma_f32_16x16x32_bf16 v[36:39], a[104:107], v[96:99], v[36:39]
ds_read_b128 v[88:91], v9 offset:16384
ds_read_b128 v[92:95], v10 offset:16384
v_mfma_f32_16x16x32_bf16 v[40:43], a[108:111], v[96:99], v[40:43]
buffer_load_dwordx4 v1, s[4:7], s29 offen offset:1024 sc1 lds
v_add_f32 v30, v30, v112
v_mfma_f32_16x16x32_bf16 v[44:47], a[104:107], v[100:103], v[44:47]
v_add_f32 v31, v31, v113
v_lshlrev_b32 v112, 16, v110
v_mfma_f32_16x16x32_bf16 v[48:51], a[108:111], v[100:103], v[48:51]
v_and_b32 v113, 0xffff0000, v110
s_waitcnt lgkmcnt(4)
v_mfma_f32_16x16x32_bf16 v[36:39], a[112:115], v[72:75], v[36:39]
ds_read_b128 v[96:99], v9 offset:20480
ds_read_b128 v[100:103], v10 offset:20480
v_mfma_f32_16x16x32_bf16 v[40:43], a[116:119], v[72:75], v[40:43]
s_add_u32 m0, s2, 114688
s_add_u32 s29, s18, 0x1e000
v_mfma_f32_16x16x32_bf16 v[44:47], a[112:115], v[76:79], v[44:47]
buffer_load_dwordx4 v1, s[4:7], s29 offen sc1 lds
v_add_f32 v24, v24, v112
v_mfma_f32_16x16x32_bf16 v[48:51], a[116:119], v[76:79], v[48:51]
v_add_f32 v25, v25, v113
s_waitcnt lgkmcnt(4)
v_mfma_f32_16x16x32_bf16 v[44:47], a[120:123], v[84:87], v[44:47]
v_add_f32 v32, v32, v112
v_add_f32 v33, v33, v113
v_mfma_f32_16x16x32_bf16 v[48:51], a[124:127], v[84:87], v[48:51]
buffer_load_dwordx4 v1, s[4:7], s29 offen offset:1024 sc1 lds
v_lshlrev_b32 v112, 16, v111
s_waitcnt lgkmcnt(2)
v_mfma_f32_16x16x32_bf16 v[44:47], a[128:131], v[92:95], v[44:47]
v_and_b32 v113, 0xffff0000, v111
v_add_f32 v26, v26, v112
v_mfma_f32_16x16x32_bf16 v[48:51], a[132:135], v[92:95], v[48:51]
v_add_f32 v27, v27, v113
v_add_f32 v34, v34, v112
s_waitcnt lgkmcnt(0)
v_mfma_f32_16x16x32_bf16 v[44:47], a[136:139], v[100:103], v[44:47]
s_add_u32 m0, s2, 122880
s_add_u32 s29, s18, 0x1f000
v_mfma_f32_16x16x32_bf16 v[48:51], a[140:143], v[100:103], v[48:51]
buffer_load_dwordx4 v1, s[4:7], s29 offen sc1 lds
v_add_f32 v35, v35, v113
v_mfma_f32_16x16x32_bf16 v[36:39], a[120:123], v[80:83], v[36:39]
s_lshl_b32 s15, s8, 11
s_add_u32 s15, s15, 0x20000
v_mfma_f32_16x16x32_bf16 v[40:43], a[124:127], v[80:83], v[40:43]
s_xor_b32 s16, s15, 0x1000
v_add_u32 v104, s15, v1
v_mfma_f32_16x16x32_bf16 v[36:39], a[128:131], v[88:91], v[36:39]
buffer_load_dwordx4 v1, s[4:7], s29 offen offset:1024 sc1 lds
v_add_u32 v105, s16, v1
v_mfma_f32_16x16x32_bf16 v[40:43], a[132:135], v[88:91], v[40:43]
ds_write_b128 v104, v[44:47] offset:0
ds_write_b128 v104, v[48:51] offset:1024
v_mfma_f32_16x16x32_bf16 v[36:39], a[136:139], v[96:99], v[36:39]
v_mfma_f32_16x16x32_bf16 v[40:43], a[140:143], v[96:99], v[40:43]
s_add_u32 m0, s2, 0
s_add_u32 s29, s18, 0x20000
buffer_load_dwordx4 v1, s[4:7], s29 offen sc1 lds
s_waitcnt lgkmcnt(0)
s_barrier
ds_read_b128 v[68:71], v105 offset:0
ds_read_b128 v[72:75], v105 offset:1024
v_pk_add_f32 v[20:21], v[20:21], v[36:37]
v_pk_add_f32 v[22:23], v[22:23], v[38:39]
v_pk_add_f32 v[24:25], v[24:25], v[40:41]
v_pk_add_f32 v[26:27], v[26:27], v[42:43]
buffer_load_dwordx4 v1, s[4:7], s29 offen offset:1024 sc1 lds
s_add_u32 m0, s2, 8192
s_add_u32 s29, s18, 0x16000
buffer_load_dwordx4 v1, s[4:7], s29 offen sc1 lds
s_waitcnt lgkmcnt(1)
v_pk_add_f32 v[20:21], v[20:21], v[68:69]
v_pk_add_f32 v[22:23], v[22:23], v[70:71]
s_waitcnt lgkmcnt(0)
v_pk_add_f32 v[24:25], v[24:25], v[72:73]
v_pk_add_f32 v[26:27], v[26:27], v[74:75]
s_add_u32 s15, s47, s62
s_add_u32 s15, s15, 0x1000000
v_cvt_pk_bf16_f32 v76, v20, v21
v_cvt_pk_bf16_f32 v77, v22, v23
v_cvt_pk_bf16_f32 v78, v24, v25
v_cvt_pk_bf16_f32 v79, v26, v27
buffer_store_dwordx4 v[76:79], v1, s[4:7], s15 offen sc1
v_pk_add_f32 v[68:69], v[20:21], v[22:23]
v_pk_add_f32 v[70:71], v[24:25], v[26:27]
v_pk_mul_f32 v[72:73], v[20:21], v[20:21]
v_pk_add_f32 v[68:69], v[68:69], v[70:71]
v_pk_fma_f32 v[72:73], v[22:23], v[22:23], v[72:73]
v_pk_fma_f32 v[72:73], v[24:25], v[24:25], v[72:73]
v_pk_fma_f32 v[72:73], v[26:27], v[26:27], v[72:73]
v_add_f32 v68, v68, v69
v_add_f32 v72, v72, v73
s_add_u32 s16, s13, s63
s_add_u32 s16, s16, 0x1d00000
v_permlane32_swap_b32 v68, v72
v_add_f32 v68, v68, v72
v_mov_b32 v72, v68
s_add_u32 s15, s59, 0x1000000
s_add_u32 s46, s60, 0x1000000
v_permlane16_swap_b32 v68, v72
v_add_f32 v68, v68, v72
buffer_store_dword v68, v11, s[4:7], s16 offen sc1
buffer_store_dwordx4 v[76:79], v1, s[4:7], s15 offen sc1
buffer_store_dword v68, v11, s[4:7], s46 offen sc1
buffer_load_dwordx4 v1, s[4:7], s29 offen offset:1024 sc1 lds
s_add_u32 m0, s2, 16384
s_add_u32 s29, s18, 0x17000
buffer_load_dwordx4 v1, s[4:7], s29 offen sc1 lds
s_waitcnt vmcnt(15)
s_barrier
ds_read_b128 v[88:91], v9 offset:24576
ds_read_b128 v[92:95], v10 offset:24576
ds_read_b128 v[96:99], v9 offset:28672
ds_read_b128 v[100:103], v10 offset:28672
ds_read_b128 v[72:75], v9 offset:32768
ds_read_b128 v[76:79], v10 offset:32768
buffer_load_dwordx4 v1, s[4:7], s29 offen offset:1024 sc1 lds
s_add_u32 m0, s2, 24576
s_add_u32 s29, s18, 0x18000
buffer_load_dwordx4 v1, s[4:7], s29 offen sc1 lds
s_waitcnt lgkmcnt(4)
v_mfma_f32_16x16x32_bf16 v[36:39], a[144:147], v[88:91], 0
ds_read_b128 v[80:83], v9 offset:36864
ds_read_b128 v[84:87], v10 offset:36864
v_mfma_f32_16x16x32_bf16 v[40:43], a[148:151], v[88:91], 0
v_add_u32 v15, 8, v15
s_waitcnt vmcnt(6)
v_mfma_f32_16x16x32_bf16 v[44:47], a[144:147], v[92:95], 0
buffer_load_dwordx4 v1, s[4:7], s29 offen offset:1024 sc1 lds
buffer_store_dword v15, v13, s[4:7], s45 offen sc1
v_mfma_f32_16x16x32_bf16 v[48:51], a[148:151], v[92:95], 0
s_waitcnt lgkmcnt(4)
v_mfma_f32_16x16x32_bf16 v[36:39], a[152:155], v[96:99], v[36:39]
s_add_u32 s28, s24, 24576
buffer_load_dwordx4 a[144:147], v1, s[4:7], s28 offen sc1
buffer_load_dwordx4 a[148:151], v1, s[4:7], s28 offen offset:1024 sc1
s_barrier
v_mfma_f32_16x16x32_bf16 v[40:43], a[156:159], v[96:99], v[40:43]
ds_read_b128 v[88:91], v9 offset:40960
ds_read_b128 v[92:95], v10 offset:40960
v_mfma_f32_16x16x32_bf16 v[44:47], a[152:155], v[100:103], v[44:47]
v_mfma_f32_16x16x32_bf16 v[48:51], a[156:159], v[100:103], v[48:51]
s_add_u32 m0, s2, 32768
s_waitcnt lgkmcnt(4)
v_mfma_f32_16x16x32_bf16 v[36:39], a[160:163], v[72:75], v[36:39]
ds_read_b128 v[96:99], v9 offset:45056
ds_read_b128 v[100:103], v10 offset:45056
v_mfma_f32_16x16x32_bf16 v[40:43], a[164:167], v[72:75], v[40:43]
s_add_u32 s29, s18, 0x19000
buffer_load_dwordx4 v1, s[4:7], s29 offen sc1 lds
v_mfma_f32_16x16x32_bf16 v[44:47], a[160:163], v[76:79], v[44:47]
v_mfma_f32_16x16x32_bf16 v[48:51], a[164:167], v[76:79], v[48:51]
s_waitcnt lgkmcnt(4)
v_mfma_f32_16x16x32_bf16 v[36:39], a[168:171], v[80:83], v[36:39]
ds_read_b128 v[72:75], v9 offset:49152
ds_read_b128 v[76:79], v10 offset:49152
v_mfma_f32_16x16x32_bf16 v[40:43], a[172:175], v[80:83], v[40:43]
buffer_load_dwordx4 v1, s[4:7], s29 offen offset:1024 sc1 lds
v_mfma_f32_16x16x32_bf16 v[44:47], a[168:171], v[84:87], v[44:47]
v_mfma_f32_16x16x32_bf16 v[48:51], a[172:175], v[84:87], v[48:51]
s_waitcnt lgkmcnt(4)
v_mfma_f32_16x16x32_bf16 v[36:39], a[176:179], v[88:91], v[36:39]
ds_read_b128 v[80:83], v9 offset:53248
ds_read_b128 v[84:87], v10 offset:53248
v_mfma_f32_16x16x32_bf16 v[40:43], a[180:183], v[88:91], v[40:43]
s_add_u32 m0, s2, 40960
s_add_u32 s29, s18, 0x1a000
v_mfma_f32_16x16x32_bf16 v[44:47], a[176:179], v[92:95], v[44:47]
buffer_load_dwordx4 v1, s[4:7], s29 offen sc1 lds
v_mfma_f32_16x16x32_bf16 v[48:51], a[180:183], v[92:95], v[48:51]
s_waitcnt lgkmcnt(4)
v_mfma_f32_16x16x32_bf16 v[36:39], a[184:187], v[96:99], v[36:39]
ds_read_b128 v[88:91], v9 offset:57344
ds_read_b128 v[92:95], v10 offset:57344
v_mfma_f32_16x16x32_bf16 v[40:43], a[188:191], v[96:99], v[40:43]
buffer_load_dwordx4 v1, s[4:7], s29 offen offset:1024 sc1 lds
v_mfma_f32_16x16x32_bf16 v[44:47], a[184:187], v[100:103], v[44:47]
v_mfma_f32_16x16x32_bf16 v[48:51], a[188:191], v[100:103], v[48:51]
s_waitcnt lgkmcnt(4)
v_mfma_f32_16x16x32_bf16 v[36:39], a[96:99], v[72:75], v[36:39]
ds_read_b128 v[96:99], v9 offset:61440
ds_read_b128 v[100:103], v10 offset:61440
v_mfma_f32_16x16x32_bf16 v[40:43], a[100:103], v[72:75], v[40:43]
v_mfma_f32_16x16x32_bf16 v[44:47], a[96:99], v[76:79], v[44:47]
v_mfma_f32_16x16x32_bf16 v[48:51], a[100:103], v[76:79], v[48:51]
buffer_load_dwordx4 a[152:155], v1, s[4:7], s28 offen offset:2048 sc1
s_waitcnt lgkmcnt(4)
v_mfma_f32_16x16x32_bf16 v[36:39], a[104:107], v[80:83], v[36:39]
s_add_u32 s28, s24, 27648
buffer_load_dwordx4 a[156:159], v1, s[4:7], s28 offen sc1
buffer_load_dwordx4 a[160:163], v1, s[4:7], s28 offen offset:1024 sc1
s_waitcnt vmcnt(12)
s_barrier
v_mfma_f32_16x16x32_bf16 v[40:43], a[108:111], v[80:83], v[40:43]
ds_read_b128 v[72:75], v7 offset:0
ds_read_b128 v[76:79], v8 offset:0
v_mfma_f32_16x16x32_bf16 v[44:47], a[104:107], v[84:87], v[44:47]
v_mfma_f32_16x16x32_bf16 v[48:51], a[108:111], v[84:87], v[48:51]
s_waitcnt lgkmcnt(4)
v_mfma_f32_16x16x32_bf16 v[36:39], a[112:115], v[88:91], v[36:39]
ds_read_b128 v[80:83], v7 offset:4096
ds_read_b128 v[84:87], v8 offset:4096
v_mfma_f32_16x16x32_bf16 v[40:43], a[116:119], v[88:91], v[40:43]
buffer_store_dword v15, v13, s[4:7], s45 offen offset:2176 sc1
v_mfma_f32_16x16x32_bf16 v[44:47], a[112:115], v[92:95], v[44:47]
v_mfma_f32_16x16x32_bf16 v[48:51], a[116:119], v[92:95], v[48:51]
s_waitcnt lgkmcnt(4)
v_mfma_f32_16x16x32_bf16 v[36:39], a[120:123], v[96:99], v[36:39]
ds_read_b128 v[88:91], v7 offset:8192
ds_read_b128 v[92:95], v8 offset:8192
v_mfma_f32_16x16x32_bf16 v[40:43], a[124:127], v[96:99], v[40:43]
v_mfma_f32_16x16x32_bf16 v[44:47], a[120:123], v[100:103], v[44:47]
v_mfma_f32_16x16x32_bf16 v[48:51], a[124:127], v[100:103], v[48:51]
buffer_load_dwordx4 a[164:167], v1, s[4:7], s28 offen offset:2048 sc1
s_waitcnt lgkmcnt(4)
v_mfma_f32_16x16x32_bf16 v[36:39], a[128:131], v[72:75], v[36:39]
ds_read_b128 v[96:99], v7 offset:12288
ds_read_b128 v[100:103], v8 offset:12288
v_mfma_f32_16x16x32_bf16 v[40:43], a[132:135], v[72:75], v[40:43]
v_mfma_f32_16x16x32_bf16 v[44:47], a[128:131], v[76:79], v[44:47]
v_mfma_f32_16x16x32_bf16 v[48:51], a[132:135], v[76:79], v[48:51]
s_waitcnt lgkmcnt(4)
v_mfma_f32_16x16x32_bf16 v[36:39], a[136:139], v[80:83], v[36:39]
ds_read_b128 v[72:75], v7 offset:16384
ds_read_b128 v[76:79], v8 offset:16384
v_mfma_f32_16x16x32_bf16 v[40:43], a[140:143], v[80:83], v[40:43]
s_add_u32 s28, s24, 30720
buffer_load_dwordx4 a[168:171], v1, s[4:7], s28 offen sc1
v_mfma_f32_16x16x32_bf16 v[44:47], a[136:139], v[84:87], v[44:47]
v_mfma_f32_16x16x32_bf16 v[48:51], a[140:143], v[84:87], v[48:51]
s_waitcnt lgkmcnt(4)
v_mfma_f32_16x16x32_bf16 v[36:39], v[176:179], v[88:91], v[36:39]
ds_read_b128 v[80:83], v7 offset:20480
ds_read_b128 v[84:87], v8 offset:20480
v_mfma_f32_16x16x32_bf16 v[40:43], v[180:183], v[88:91], v[40:43]
buffer_load_dword v17, v4, s[4:7], s92 offen sc1
v_mfma_f32_16x16x32_bf16 v[44:47], v[176:179], v[92:95], v[44:47]
v_mfma_f32_16x16x32_bf16 v[48:51], v[180:183], v[92:95], v[48:51]
s_waitcnt lgkmcnt(4)
v_mfma_f32_16x16x32_bf16 v[36:39], v[184:187], v[96:99], v[36:39]
buffer_load_dwordx4 a[172:175], v1, s[4:7], s28 offen offset:1024 sc1
buffer_load_dwordx4 a[176:179], v1, s[4:7], s28 offen offset:2048 sc1
s_add_u32 s28, s24, 33792
buffer_load_dwordx4 a[180:183], v1, s[4:7], s28 offen sc1
buffer_load_dwordx4 a[184:187], v1, s[4:7], s28 offen offset:1024 sc1
s_waitcnt vmcnt(11)
s_barrier
v_mfma_f32_16x16x32_bf16 v[40:43], v[188:191], v[96:99], v[40:43]
ds_read_b128 v[88:91], v7 offset:24576
ds_read_b128 v[92:95], v8 offset:24576
v_mfma_f32_16x16x32_bf16 v[44:47], v[184:187], v[100:103], v[44:47]
v_mfma_f32_16x16x32_bf16 v[48:51], v[188:191], v[100:103], v[48:51]
s_waitcnt lgkmcnt(4)
v_mfma_f32_16x16x32_bf16 v[36:39], v[192:195], v[72:75], v[36:39]
ds_read_b128 v[96:99], v7 offset:28672
ds_read_b128 v[100:103], v8 offset:28672
v_mfma_f32_16x16x32_bf16 v[40:43], v[196:199], v[72:75], v[40:43]
v_mfma_f32_16x16x32_bf16 v[44:47], v[192:195], v[76:79], v[44:47]
buffer_load_dwordx4 a[188:191], v1, s[4:7], s28 offen offset:2048 sc1
v_mfma_f32_16x16x32_bf16 v[48:51], v[196:199], v[76:79], v[48:51]
s_waitcnt lgkmcnt(4)
v_mfma_f32_16x16x32_bf16 v[36:39], v[200:203], v[80:83], v[36:39]
ds_read_b128 v[72:75], v7 offset:32768
ds_read_b128 v[76:79], v8 offset:32768
v_mfma_f32_16x16x32_bf16 v[40:43], v[204:207], v[80:83], v[40:43]
v_mfma_f32_16x16x32_bf16 v[44:47], v[200:203], v[84:87], v[44:47]
v_mfma_f32_16x16x32_bf16 v[48:51], v[204:207], v[84:87], v[48:51]
s_waitcnt lgkmcnt(4)
v_mfma_f32_16x16x32_bf16 v[36:39], v[208:211], v[88:91], v[36:39]
ds_read_b128 v[80:83], v7 offset:36864
ds_read_b128 v[84:87], v8 offset:36864
v_mfma_f32_16x16x32_bf16 v[40:43], v[212:215], v[88:91], v[40:43]
s_add_u32 s28, s24, 36864
buffer_load_dwordx4 a[96:99], v1, s[4:7], s28 offen sc1
v_mfma_f32_16x16x32_bf16 v[44:47], v[208:211], v[92:95], v[44:47]
s_add_u32 s44, s32, 9
buffer_load_dwordx4 a[100:103], v1, s[4:7], s28 offen offset:1024 sc1
buffer_load_dwordx4 a[104:107], v1, s[4:7], s28 offen offset:2048 sc1
s_add_u32 s28, s24, 39936
buffer_load_dwordx4 a[108:111], v1, s[4:7], s28 offen sc1
buffer_load_dwordx4 a[112:115], v1, s[4:7], s28 offen offset:1024 sc1
s_waitcnt vmcnt(10)
v_lshrrev_b32 v17, 3, v17
v_mfma_f32_16x16x32_bf16 v[48:51], v[212:215], v[92:95], v[48:51]
v_subrev_u32 v17, s44, v17
s_waitcnt lgkmcnt(4)
v_mfma_f32_16x16x32_bf16 v[36:39], v[216:219], v[96:99], v[36:39]
ds_read_b128 v[88:91], v7 offset:40960
ds_read_b128 v[92:95], v8 offset:40960
v_mfma_f32_16x16x32_bf16 v[40:43], v[220:223], v[96:99], v[40:43]
v_cmp_lt_u32 vcc, 31, v17
s_cbranch_vccnz L_spin_53
L_ok_52:
s_add_u32 s17, s47, s96
v_mfma_f32_16x16x32_bf16 v[44:47], v[216:219], v[100:103], v[44:47]
s_add_u32 m0, s3, 49152
s_add_u32 s29, s17, 0x1000000
v_mfma_f32_16x16x32_bf16 v[48:51], v[220:223], v[100:103], v[48:51]
buffer_load_dwordx4 v1, s[4:7], s29 offen sc1 lds
s_waitcnt lgkmcnt(4)
v_mfma_f32_16x16x32_bf16 v[36:39], v[224:227], v[72:75], v[36:39]
ds_read_b128 v[96:99], v7 offset:45056
ds_read_b128 v[100:103], v8 offset:45056
v_mfma_f32_16x16x32_bf16 v[40:43], v[228:231], v[72:75], v[40:43]
v_mfma_f32_16x16x32_bf16 v[44:47], v[224:227], v[76:79], v[44:47]
buffer_load_dwordx4 v1, s[4:7], s29 offen offset:1024 sc1 lds
v_mfma_f32_16x16x32_bf16 v[48:51], v[228:231], v[76:79], v[48:51]
s_waitcnt lgkmcnt(4)
v_mfma_f32_16x16x32_bf16 v[44:47], v[232:235], v[84:87], v[44:47]
v_mfma_f32_16x16x32_bf16 v[48:51], v[236:239], v[84:87], v[48:51]
s_add_u32 s46, s13, 0x1d00000
buffer_load_dwordx2 v[120:121], v14, s[4:7], s46 offen sc1
s_waitcnt lgkmcnt(2)
v_mfma_f32_16x16x32_bf16 v[44:47], v[240:243], v[92:95], v[44:47]
buffer_load_dwordx2 v[122:123], v14, s[4:7], s46 offen offset:256 sc1
v_mfma_f32_16x16x32_bf16 v[48:51], v[244:247], v[92:95], v[48:51]
s_waitcnt lgkmcnt(0)
v_mfma_f32_16x16x32_bf16 v[44:47], v[248:251], v[100:103], v[44:47]
v_mfma_f32_16x16x32_bf16 v[48:51], v[252:255], v[100:103], v[48:51]
s_add_u32 m0, s3, 57344
s_add_u32 s29, s17, 0x1002000
buffer_load_dwordx4 v1, s[4:7], s29 offen sc1 lds
v_mfma_f32_16x16x32_bf16 v[36:39], v[232:235], v[80:83], v[36:39]
s_lshl_b32 s15, s8, 11
s_add_u32 s15, s15, 0x20000
v_mfma_f32_16x16x32_bf16 v[40:43], v[236:239], v[80:83], v[40:43]
s_xor_b32 s16, s15, 0x1000
v_add_u32 v104, s15, v1
v_mfma_f32_16x16x32_bf16 v[36:39], v[240:243], v[88:91], v[36:39]
buffer_load_dwordx4 v1, s[4:7], s29 offen offset:1024 sc1 lds
v_add_u32 v105, s16, v1
v_mfma_f32_16x16x32_bf16 v[40:43], v[244:247], v[88:91], v[40:43]
ds_write_b128 v104, v[44:47] offset:0
ds_write_b128 v104, v[48:51] offset:1024
v_mfma_f32_16x16x32_bf16 v[36:39], v[248:251], v[96:99], v[36:39]
v_mfma_f32_16x16x32_bf16 v[40:43], v[252:255], v[96:99], v[40:43]
s_add_u32 s46, s13, 0x1d00000
buffer_load_dwordx2 v[124:125], v14, s[4:7], s46 offen offset:512 sc1
buffer_load_dwordx2 v[126:127], v14, s[4:7], s46 offen offset:768 sc1
s_waitcnt lgkmcnt(0)
s_barrier
ds_read_b128 v[68:71], v105 offset:0
ds_read_b128 v[72:75], v105 offset:1024
buffer_load_dwordx4 a[116:119], v1, s[4:7], s28 offen offset:2048 sc1
s_add_u32 s28, s24, 43008
buffer_load_dwordx4 a[120:123], v1, s[4:7], s28 offen sc1
buffer_load_dwordx4 a[124:127], v1, s[4:7], s28 offen offset:1024 sc1
buffer_load_dwordx4 a[128:131], v1, s[4:7], s28 offen offset:2048 sc1
v_pk_add_f32 v[28:29], v[28:29], v[36:37]
v_pk_add_f32 v[30:31], v[30:31], v[38:39]
v_pk_add_f32 v[32:33], v[32:33], v[40:41]
v_pk_add_f32 v[34:35], v[34:35], v[42:43]
s_add_u32 m0, s3, 65536
s_add_u32 s29, s17, 0x1004000
buffer_load_dwordx4 v1, s[4:7], s29 offen sc1 lds
buffer_load_dwordx4 v1, s[4:7], s29 offen offset:1024 sc1 lds
s_waitcnt lgkmcnt(1)
v_pk_add_f32 v[28:29], v[28:29], v[68:69]
v_pk_add_f32 v[30:31], v[30:31], v[70:71]
s_waitcnt lgkmcnt(0)
v_pk_add_f32 v[32:33], v[32:33], v[72:73]
v_pk_add_f32 v[34:35], v[34:35], v[74:75]
s_add_u32 s15, s47, s62
s_add_u32 s15, s15, 0x1008000
v_cvt_pk_bf16_f32 v76, v28, v29
v_cvt_pk_bf16_f32 v77, v30, v31
v_cvt_pk_bf16_f32 v78, v32, v33
v_cvt_pk_bf16_f32 v79, v34, v35
buffer_store_dwordx4 v[76:79], v1, s[4:7], s15 offen sc1
v_pk_add_f32 v[68:69], v[28:29], v[30:31]
v_pk_add_f32 v[70:71], v[32:33], v[34:35]
v_pk_mul_f32 v[72:73], v[28:29], v[28:29]
v_pk_add_f32 v[68:69], v[68:69], v[70:71]
v_pk_fma_f32 v[72:73], v[30:31], v[30:31], v[72:73]
v_pk_fma_f32 v[72:73], v[32:33], v[32:33], v[72:73]
v_pk_fma_f32 v[72:73], v[34:35], v[34:35], v[72:73]
v_add_f32 v68, v68, v69
v_add_f32 v72, v72, v73
s_add_u32 s16, s13, s63
s_add_u32 s16, s16, 0x1d01000
v_permlane32_swap_b32 v68, v72
v_add_f32 v68, v68, v72
v_mov_b32 v72, v68
s_nop 1
v_permlane16_swap_b32 v68, v72
v_add_f32 v68, v68, v72
buffer_store_dword v68, v11, s[4:7], s16 offen sc1
s_add_u32 m0, s3, 73728
s_add_u32 s29, s17, 0x1006000
buffer_load_dwordx4 v1, s[4:7], s29 offen sc1 lds
buffer_load_dwordx4 v1, s[4:7], s29 offen offset:1024 sc1 lds
s_add_u32 s28, s24, 46080
buffer_load_dwordx4 a[132:135], v1, s[4:7], s28 offen sc1
buffer_load_dwordx4 a[136:139], v1, s[4:7], s28 offen offset:1024 sc1
s_waitcnt vmcnt(18)
s_barrier
ds_read_b128 v[88:91], v1 offset:49152
ds_read_b128 v[92:95], v1 offset:50176
ds_read_b128 v[96:99], v1 offset:51200
ds_read_b128 v[100:103], v1 offset:52224
ds_read_b128 v[72:75], v1 offset:53248
ds_read_b128 v[76:79], v1 offset:54272
s_waitcnt lgkmcnt(4)
v_mfma_f32_16x16x32_bf16 v[44:47], a[4:7], v[88:91], 0
ds_read_b128 v[80:83], v1 offset:55296
ds_read_b128 v[84:87], v1 offset:56320
v_mfma_f32_16x16x32_bf16 v[52:55], v[88:91], a[8:11], 0
buffer_load_dword v17, v4, s[4:7], s90 offen sc1
v_mfma_f32_16x16x32_bf16 v[36:39], a[0:3], v[88:91], 0
v_mfma_f32_16x16x32_bf16 v[48:51], a[4:7], v[92:95], 0
v_mfma_f32_16x16x32_bf16 v[56:59], v[92:95], a[8:11], 0
v_mfma_f32_16x16x32_bf16 v[40:43], a[0:3], v[92:95], 0
s_waitcnt lgkmcnt(4)
v_mfma_f32_16x16x32_bf16 v[44:47], a[16:19], v[96:99], v[44:47]
s_waitcnt vmcnt(13)
v_add_f32 v120, v120, v122
v_add_f32 v124, v124, v126
v_add_f32 v121, v121, v123
v_add_f32 v125, v125, v127
v_add_f32 v120, v120, v124
v_add_f32 v121, v121, v125
v_add_u32 v122, s52, v5
s_nop 0
v_permlane32_swap_b32 v120, v121
v_add_f32 v120, v120, v121
v_mov_b32 v121, v120
s_nop 1
v_permlane16_swap_b32 v120, v121
v_add_f32 v120, v120, v121
v_mov_b32 v121, v120
s_nop 1
v_permlane32_swap_b32 v120, v121
v_mul_f32 v120, 0x3b000000, v120
v_mul_f32 v121, 0x3b000000, v121
v_fma_f32 v121, -v120, v120, v121
v_max_f32 v121, 0, v121
v_add_f32 v121, 0x3727c5ac, v121
v_rsq_f32 v121, v121
v_sub_f32 v120, 0, v120
v_mul_f32 v120, v120, v121
ds_write_b32 v122, v121 offset:192
ds_write_b32 v122, v120 offset:512
buffer_load_dwordx4 a[140:143], v1, s[4:7], s28 offen offset:2048 sc1
s_waitcnt vmcnt(4) lgkmcnt(0)
s_barrier
v_mfma_f32_16x16x32_bf16 v[52:55], v[96:99], a[20:23], v[52:55]
ds_read_b128 v[88:91], v1 offset:57344
ds_read_b128 v[92:95], v1 offset:58368
v_mfma_f32_16x16x32_bf16 v[36:39], a[12:15], v[96:99], v[36:39]
v_mfma_f32_16x16x32_bf16 v[48:51], a[16:19], v[100:103], v[48:51]
v_mfma_f32_16x16x32_bf16 v[56:59], v[100:103], a[20:23], v[56:59]
v_mfma_f32_16x16x32_bf16 v[40:43], a[12:15], v[100:103], v[40:43]
v_mfma_f32_16x16x32_bf16 v[44:47], a[28:31], v[72:75], v[44:47]
ds_read_b128 v[96:99], v1 offset:59392
ds_read_b128 v[100:103], v1 offset:60416
v_mfma_f32_16x16x32_bf16 v[52:55], v[72:75], a[32:35], v[52:55]
v_add_u32 v15, 8, v15
buffer_store_dword v15, v13, s[4:7], s45 offen sc1
v_mfma_f32_16x16x32_bf16 v[36:39], a[24:27], v[72:75], v[36:39]
v_mfma_f32_16x16x32_bf16 v[48:51], a[28:31], v[76:79], v[48:51]
v_mfma_f32_16x16x32_bf16 v[56:59], v[76:79], a[32:35], v[56:59]
v_mfma_f32_16x16x32_bf16 v[40:43], a[24:27], v[76:79], v[40:43]
v_mfma_f32_16x16x32_bf16 v[44:47], a[40:43], v[80:83], v[44:47]
ds_read_b128 v[72:75], v1 offset:61440
ds_read_b128 v[76:79], v1 offset:62464
v_mfma_f32_16x16x32_bf16 v[52:55], v[80:83], a[44:47], v[52:55]
s_add_u32 s44, s32, 9
s_waitcnt vmcnt(2)
v_lshrrev_b32 v17, 3, v17
v_mfma_f32_16x16x32_bf16 v[36:39], a[36:39], v[80:83], v[36:39]
v_subrev_u32 v17, s44, v17
v_cmp_lt_u32 vcc, 31, v17
s_cbranch_vccnz L_spin_55
L_ok_54:
v_mfma_f32_16x16x32_bf16 v[48:51], a[40:43], v[84:87], v[48:51]
v_mfma_f32_16x16x32_bf16 v[56:59], v[84:87], a[44:47], v[56:59]
v_mfma_f32_16x16x32_bf16 v[40:43], a[36:39], v[84:87], v[40:43]
s_waitcnt lgkmcnt(4)
v_mfma_f32_16x16x32_bf16 v[44:47], a[52:55], v[88:91], v[44:47]
ds_read_b128 v[80:83], v1 offset:63488
ds_read_b128 v[84:87], v1 offset:64512
v_mfma_f32_16x16x32_bf16 v[52:55], v[88:91], a[56:59], v[52:55]
v_mfma_f32_16x16x32_bf16 v[36:39], a[48:51], v[88:91], v[36:39]
v_mfma_f32_16x16x32_bf16 v[48:51], a[52:55], v[92:95], v[48:51]
v_mfma_f32_16x16x32_bf16 v[56:59], v[92:95], a[56:59], v[56:59]
v_mfma_f32_16x16x32_bf16 v[40:43], a[48:51], v[92:95], v[40:43]
s_waitcnt lgkmcnt(4)
v_mfma_f32_16x16x32_bf16 v[44:47], a[64:67], v[96:99], v[44:47]
ds_read_b128 v[88:91], v2 offset:0
ds_read_b128 v[92:95], v2 offset:1024
v_mfma_f32_16x16x32_bf16 v[52:55], v[96:99], a[68:71], v[52:55]
buffer_load_dword v17, v4, s[4:7], s92 offen sc1
v_mfma_f32_16x16x32_bf16 v[36:39], a[60:63], v[96:99], v[36:39]
v_mfma_f32_16x16x32_bf16 v[48:51], a[64:67], v[100:103], v[48:51]
v_mfma_f32_16x16x32_bf16 v[56:59], v[100:103], a[68:71], v[56:59]
v_mfma_f32_16x16x32_bf16 v[40:43], a[60:63], v[100:103], v[40:43]
s_waitcnt lgkmcnt(4)
v_mfma_f32_16x16x32_bf16 v[44:47], a[76:79], v[72:75], v[44:47]
ds_read_b128 v[96:99], v2 offset:2048
ds_read_b128 v[100:103], v2 offset:3072
v_mfma_f32_16x16x32_bf16 v[52:55], v[72:75], a[80:83], v[52:55]
v_mfma_f32_16x16x32_bf16 v[36:39], a[72:75], v[72:75], v[36:39]
v_mfma_f32_16x16x32_bf16 v[48:51], a[76:79], v[76:79], v[48:51]
v_mfma_f32_16x16x32_bf16 v[56:59], v[76:79], a[80:83], v[56:59]
v_mfma_f32_16x16x32_bf16 v[40:43], a[72:75], v[76:79], v[40:43]
s_waitcnt lgkmcnt(4)
v_mfma_f32_16x16x32_bf16 v[44:47], a[88:91], v[80:83], v[44:47]
ds_read_b128 v[72:75], v2 offset:4096
ds_read_b128 v[76:79], v2 offset:5120
v_mfma_f32_16x16x32_bf16 v[52:55], v[80:83], a[92:95], v[52:55]
v_mfma_f32_16x16x32_bf16 v[36:39], a[84:87], v[80:83], v[36:39]
v_mfma_f32_16x16x32_bf16 v[48:51], a[88:91], v[84:87], v[48:51]
v_mfma_f32_16x16x32_bf16 v[56:59], v[84:87], a[92:95], v[56:59]
v_mfma_f32_16x16x32_bf16 v[40:43], a[84:87], v[84:87], v[40:43]
s_waitcnt lgkmcnt(4)
v_mfma_f32_16x16x32_bf16 v[44:47], a[148:151], v[88:91], v[44:47]
ds_read_b128 v[80:83], v2 offset:6144
ds_read_b128 v[84:87], v2 offset:7168
v_mfma_f32_16x16x32_bf16 v[52:55], v[88:91], a[152:155], v[52:55]
s_add_u32 s44, s32, 10
s_waitcnt vmcnt(0)
v_lshrrev_b32 v17, 3, v17
v_mfma_f32_16x16x32_bf16 v[36:39], a[144:147], v[88:91], v[36:39]
v_subrev_u32 v17, s44, v17
v_cmp_lt_u32 vcc, 31, v17
s_cbranch_vccnz L_spin_57
L_ok_56:
s_add_u32 s17, s47, s96
v_mfma_f32_16x16x32_bf16 v[48:51], a[148:151], v[92:95], v[48:51]
s_add_u32 m0, s3, 81920
s_add_u32 s29, s17, 0x1008000
v_mfma_f32_16x16x32_bf16 v[56:59], v[92:95], a[152:155], v[56:59]
buffer_load_dwordx4 v1, s[4:7], s29 offen offset:1024 sc1 lds
v_mfma_f32_16x16x32_bf16 v[40:43], a[144:147], v[92:95], v[40:43]
s_waitcnt lgkmcnt(4)
v_mfma_f32_16x16x32_bf16 v[44:47], a[160:163], v[96:99], v[44:47]
ds_read_b128 v[88:91], v2 offset:8192
ds_read_b128 v[92:95], v2 offset:9216
v_mfma_f32_16x16x32_bf16 v[52:55], v[96:99], a[164:167], v[52:55]
s_add_u32 m0, s3, 90112
s_add_u32 s29, s17, 0x100a000
v_mfma_f32_16x16x32_bf16 v[36:39], a[156:159], v[96:99], v[36:39]
buffer_load_dwordx4 v1, s[4:7], s29 offen offset:1024 sc1 lds
v_mfma_f32_16x16x32_bf16 v[48:51], a[160:163], v[100:103], v[48:51]
v_mfma_f32_16x16x32_bf16 v[56:59], v[100:103], a[164:167], v[56:59]
v_mfma_f32_16x16x32_bf16 v[40:43], a[156:159], v[100:103], v[40:43]
s_add_u32 m0, s3, 98304
s_waitcnt lgkmcnt(4)
v_mfma_f32_16x16x32_bf16 v[44:47], a[172:175], v[72:75], v[44:47]
ds_read_b128 v[96:99], v2 offset:10240
ds_read_b128 v[100:103], v2 offset:11264
v_mfma_f32_16x16x32_bf16 v[52:55], v[72:75], a[176:179], v[52:55]
s_add_u32 s29, s17, 0x100c000
buffer_load_dwordx4 v1, s[4:7], s29 offen offset:1024 sc1 lds
v_mfma_f32_16x16x32_bf16 v[36:39], a[168:171], v[72:75], v[36:39]
v_mfma_f32_16x16x32_bf16 v[48:51], a[172:175], v[76:79], v[48:51]
v_mfma_f32_16x16x32_bf16 v[56:59], v[76:79], a[176:179], v[56:59]
s_add_u32 m0, s3, 106496
s_add_u32 s29, s17, 0x100e000
v_mfma_f32_16x16x32_bf16 v[40:43], a[168:171], v[76:79], v[40:43]
buffer_load_dwordx4 v1, s[4:7], s29 offen offset:1024 sc1 lds
s_waitcnt lgkmcnt(4)
v_mfma_f32_16x16x32_bf16 v[44:47], a[184:187], v[80:83], v[44:47]
ds_read_b128 v[72:75], v2 offset:12288
ds_read_b128 v[76:79], v2 offset:13312
v_mfma_f32_16x16x32_bf16 v[52:55], v[80:83], a[188:191], v[52:55]
v_mfma_f32_16x16x32_bf16 v[36:39], a[180:183], v[80:83], v[36:39]
s_add_u32 s46, s13, 0x1d01000
buffer_load_dwordx2 v[120:121], v14, s[4:7], s46 offen sc1
v_mfma_f32_16x16x32_bf16 v[48:51], a[184:187], v[84:87], v[48:51]
buffer_load_dwordx2 v[122:123], v14, s[4:7], s46 offen offset:256 sc1
v_mfma_f32_16x16x32_bf16 v[56:59], v[84:87], a[188:191], v[56:59]
v_mfma_f32_16x16x32_bf16 v[40:43], a[180:183], v[84:87], v[40:43]
s_waitcnt lgkmcnt(4)
v_mfma_f32_16x16x32_bf16 v[44:47], a[100:103], v[88:91], v[44:47]
ds_read_b128 v[80:83], v2 offset:14336
ds_read_b128 v[84:87], v2 offset:15360
v_mfma_f32_16x16x32_bf16 v[52:55], v[88:91], a[104:107], v[52:55]
s_add_u32 s46, s13, 0x1d01000
buffer_load_dwordx2 v[124:125], v14, s[4:7], s46 offen offset:512 sc1
v_mfma_f32_16x16x32_bf16 v[36:39], a[96:99], v[88:91], v[36:39]
buffer_load_dwordx2 v[126:127], v14, s[4:7], s46 offen offset:768 sc1
v_mfma_f32_16x16x32_bf16 v[48:51], a[100:103], v[92:95], v[48:51]
v_mfma_f32_16x16x32_bf16 v[56:59], v[92:95], a[104:107], v[56:59]
v_mfma_f32_16x16x32_bf16 v[40:43], a[96:99], v[92:95], v[40:43]
s_add_u32 m0, s3, 81920
s_waitcnt lgkmcnt(4)
v_mfma_f32_16x16x32_bf16 v[44:47], a[112:115], v[96:99], v[44:47]
s_add_u32 s29, s17, 0x1008000
buffer_load_dwordx4 v1, s[4:7], s29 offen sc1 lds
v_mfma_f32_16x16x32_bf16 v[52:55], v[96:99], a[116:119], v[52:55]
v_mfma_f32_16x16x32_bf16 v[36:39], a[108:111], v[96:99], v[36:39]
v_mfma_f32_16x16x32_bf16 v[48:51], a[112:115], v[100:103], v[48:51]
s_add_u32 m0, s3, 90112
s_add_u32 s29, s17, 0x100a000
v_mfma_f32_16x16x32_bf16 v[56:59], v[100:103], a[116:119], v[56:59]
buffer_load_dwordx4 v1, s[4:7], s29 offen sc1 lds
v_mfma_f32_16x16x32_bf16 v[40:43], a[108:111], v[100:103], v[40:43]
s_waitcnt lgkmcnt(2)
v_mfma_f32_16x16x32_bf16 v[44:47], a[124:127], v[72:75], v[44:47]
ds_read_b128 v[68:71], v6 offset:64
ds_read2_b32 v[88:89], v5 offset0:48 offset1:128
v_mfma_f32_16x16x32_bf16 v[52:55], v[72:75], a[128:131], v[52:55]
s_add_u32 m0, s3, 98304
s_add_u32 s29, s17, 0x100c000
v_mfma_f32_16x16x32_bf16 v[36:39], a[120:123], v[72:75], v[36:39]
buffer_load_dwordx4 v1, s[4:7], s29 offen sc1 lds
ds_read_b128 v[90:93], v6 offset:0
v_mfma_f32_16x16x32_bf16 v[48:51], a[124:127], v[76:79], v[48:51]
ds_read2_b32 v[94:95], v5 offset0:64 offset1:144
v_add_u32 v96, s91, v5
v_mfma_f32_16x16x32_bf16 v[56:59], v[76:79], a[128:131], v[56:59]
v_subrev_u32 v97, s91, v6
ds_read_b32 v96, v96 offset:128
v_mfma_f32_16x16x32_bf16 v[40:43], a[120:123], v[76:79], v[40:43]
s_add_u32 m0, s3, 106496
s_waitcnt lgkmcnt(5)
v_mfma_f32_16x16x32_bf16 v[44:47], a[136:139], v[80:83], v[44:47]
s_add_u32 s29, s17, 0x100e000
buffer_load_dwordx4 v1, s[4:7], s29 offen sc1 lds
v_mfma_f32_16x16x32_bf16 v[52:55], v[80:83], a[140:143], v[52:55]
s_waitcnt vmcnt(4)
v_add_f32 v120, v120, v122
v_mfma_f32_16x16x32_bf16 v[36:39], a[132:135], v[80:83], v[36:39]
v_add_f32 v124, v124, v126
v_add_f32 v121, v121, v123
v_mfma_f32_16x16x32_bf16 v[48:51], a[136:139], v[84:87], v[48:51]
s_add_u32 m0, s94, 114688
s_add_u32 s29, s57, 0x1000000
v_mfma_f32_16x16x32_bf16 v[56:59], v[84:87], a[140:143], v[56:59]
buffer_load_dwordx4 v1, s[4:7], s29 offen sc1 lds
v_add_f32 v125, v125, v127
v_mfma_f32_16x16x32_bf16 v[40:43], a[132:135], v[84:87], v[40:43]
v_add_f32 v120, v120, v124
v_add_f32 v121, v121, v125
v_add_u32 v122, s52, v5
s_nop 0
v_permlane32_swap_b32 v120, v121
v_add_f32 v120, v120, v121
v_mov_b32 v121, v120
buffer_load_dwordx4 v1, s[4:7], s29 offen offset:1024 sc1 lds
s_nop 0
v_permlane16_swap_b32 v120, v121
v_add_f32 v120, v120, v121
v_mov_b32 v121, v120
s_nop 1
v_permlane32_swap_b32 v120, v121
v_mul_f32 v120, 0x3b000000, v120
v_mul_f32 v121, 0x3b000000, v121
v_fma_f32 v121, -v120, v120, v121
v_max_f32 v121, 0, v121
v_add_f32 v121, 0x3727c5ac, v121
buffer_load_dwordx4 v1, s[4:7], s29 offen offset:2048 sc1 lds
v_rsq_f32 v121, v121
v_sub_f32 v120, 0, v120
v_mul_f32 v120, v120, v121
ds_write_b32 v122, v121 offset:64
ds_write_b32 v122, v120 offset:384
ds_read_b128 v[72:75], v97 offset:192
ds_read_b128 v[76:79], v97 offset:512
ds_read_b128 v[80:83], v97 offset:256
ds_read_b128 v[84:87], v97 offset:576
s_waitcnt lgkmcnt(6)
v_pk_mul_f32 v[98:99], v[68:69], v[88:89] op_sel:[0,1] op_sel_hi:[1,1]
v_pk_mul_f32 v[100:101], v[70:71], v[88:89] op_sel:[0,1] op_sel_hi:[1,1]
v_pk_fma_f32 v[44:45], v[44:45], v[88:89], v[98:99] op_sel_hi:[1,0,1]
v_pk_fma_f32 v[46:47], v[46:47], v[88:89], v[100:101] op_sel_hi:[1,0,1]
v_cvt_pk_bf16_f32 v106, v44, v45
v_cvt_pk_bf16_f32 v107, v46, v47
buffer_load_dwordx4 v1, s[4:7], s29 offen offset:3072 sc1 lds
v_pk_mul_f32 v[98:99], v[90:91], v[88:89] op_sel:[0,1] op_sel_hi:[1,1]
v_pk_mul_f32 v[100:101], v[92:93], v[88:89] op_sel:[0,1] op_sel_hi:[1,1]
v_pk_fma_f32 v[36:37], v[36:37], v[88:89], v[98:99] op_sel_hi:[1,0,1]
v_pk_fma_f32 v[38:39], v[38:39], v[88:89], v[100:101] op_sel_hi:[1,0,1]
v_cvt_pk_bf16_f32 v116, v36, v37
v_cvt_pk_bf16_f32 v117, v38, v39
v_pk_mul_f32 v[98:99], v[68:69], v[94:95] op_sel:[0,1] op_sel_hi:[1,1]
v_pk_mul_f32 v[100:101], v[70:71], v[94:95] op_sel:[0,1] op_sel_hi:[1,1]
v_pk_fma_f32 v[48:49], v[48:49], v[94:95], v[98:99] op_sel_hi:[1,0,1]
v_pk_fma_f32 v[50:51], v[50:51], v[94:95], v[100:101] op_sel_hi:[1,0,1]
v_cvt_pk_bf16_f32 v108, v48, v49
v_cvt_pk_bf16_f32 v109, v50, v51
v_pk_mul_f32 v[98:99], v[90:91], v[94:95] op_sel:[0,1] op_sel_hi:[1,1]
v_pk_mul_f32 v[100:101], v[92:93], v[94:95] op_sel:[0,1] op_sel_hi:[1,1]
v_pk_fma_f32 v[40:41], v[40:41], v[94:95], v[98:99] op_sel_hi:[1,0,1]
v_pk_fma_f32 v[42:43], v[42:43], v[94:95], v[100:101] op_sel_hi:[1,0,1]
v_cvt_pk_bf16_f32 v118, v40, v41
v_cvt_pk_bf16_f32 v119, v42, v43
s_waitcnt lgkmcnt(2)
v_pk_mul_f32 v[76:77], v[76:77], v[96:97] op_sel_hi:[1,0]
v_pk_mul_f32 v[78:79], v[78:79], v[96:97] op_sel_hi:[1,0]
v_pk_fma_f32 v[52:53], v[52:53], v[72:73], v[76:77]
v_pk_fma_f32 v[54:55], v[54:55], v[74:75], v[78:79]
v_cvt_pk_bf16_f32 v112, v52, v53
v_cvt_pk_bf16_f32 v113, v54, v55
s_waitcnt lgkmcnt(0)
v_pk_mul_f32 v[84:85], v[84:85], v[96:97] op_sel_hi:[1,0]
v_pk_mul_f32 v[86:87], v[86:87], v[96:97] op_sel_hi:[1,0]
v_pk_fma_f32 v[56:57], v[56:57], v[80:81], v[84:85]
v_pk_fma_f32 v[58:59], v[58:59], v[82:83], v[86:87]
v_cvt_pk_bf16_f32 v114, v56, v57
v_cvt_pk_bf16_f32 v115, v58, v59
s_barrier
ds_read_b128 v[88:91], v2 offset:17408
ds_read_b128 v[92:95], v2 offset:19456
ds_read_b128 v[96:99], v2 offset:21504
s_waitcnt lgkmcnt(2)
v_mfma_f32_16x16x32_bf16 v[52:55], a[4:7], v[88:91], 0
ds_read_b128 v[100:103], v2 offset:23552
v_mfma_f32_16x16x32_bf16 v[56:59], v[88:91], a[8:11], 0
s_waitcnt lgkmcnt(2)
v_mfma_f32_16x16x32_bf16 v[52:55], a[16:19], v[92:95], v[52:55]
ds_read_b128 v[88:91], v2 offset:25600
v_mfma_f32_16x16x32_bf16 v[56:59], v[92:95], a[20:23], v[56:59]
s_waitcnt lgkmcnt(2)
v_mfma_f32_16x16x32_bf16 v[52:55], a[28:31], v[96:99], v[52:55]
ds_read_b128 v[92:95], v2 offset:27648
s_add_u32 s46, s58, 0x1000000
v_mfma_f32_16x16x32_bf16 v[56:59], v[96:99], a[32:35], v[56:59]
buffer_load_dwordx2 v[120:121], v14, s[4:7], s46 offen sc1
s_waitcnt lgkmcnt(2)
v_mfma_f32_16x16x32_bf16 v[52:55], a[40:43], v[100:103], v[52:55]
ds_read_b128 v[96:99], v2 offset:29696
buffer_load_dwordx2 v[122:123], v14, s[4:7], s46 offen offset:256 sc1
v_mfma_f32_16x16x32_bf16 v[56:59], v[100:103], a[44:47], v[56:59]
s_waitcnt lgkmcnt(2)
v_mfma_f32_16x16x32_bf16 v[52:55], a[52:55], v[88:91], v[52:55]
ds_read_b128 v[100:103], v2 offset:31744
v_mfma_f32_16x16x32_bf16 v[56:59], v[88:91], a[56:59], v[56:59]
s_add_u32 s46, s58, 0x1000000
s_waitcnt lgkmcnt(2)
v_mfma_f32_16x16x32_bf16 v[52:55], a[64:67], v[92:95], v[52:55]
ds_read_b128 v[88:91], v2 offset:33792
buffer_load_dwordx2 v[124:125], v14, s[4:7], s46 offen offset:512 sc1
v_mfma_f32_16x16x32_bf16 v[56:59], v[92:95], a[68:71], v[56:59]
buffer_load_dwordx2 v[126:127], v14, s[4:7], s46 offen offset:768 sc1
s_waitcnt lgkmcnt(2)
v_mfma_f32_16x16x32_bf16 v[52:55], a[76:79], v[96:99], v[52:55]
ds_read_b128 v[92:95], v2 offset:35840
v_mfma_f32_16x16x32_bf16 v[56:59], v[96:99], a[80:83], v[56:59]
s_waitcnt lgkmcnt(2)
v_mfma_f32_16x16x32_bf16 v[52:55], a[88:91], v[100:103], v[52:55]
ds_read_b128 v[96:99], v2 offset:37888
v_mfma_f32_16x16x32_bf16 v[56:59], v[100:103], a[92:95], v[56:59]
s_waitcnt lgkmcnt(2)
v_mfma_f32_16x16x32_bf16 v[52:55], a[148:151], v[88:91], v[52:55]
ds_read_b128 v[100:103], v2 offset:39936
v_mfma_f32_16x16x32_bf16 v[56:59], v[88:91], a[152:155], v[56:59]
s_waitcnt lgkmcnt(2)
v_mfma_f32_16x16x32_bf16 v[52:55], a[160:163], v[92:95], v[52:55]
ds_read_b128 v[88:91], v2 offset:41984
v_mfma_f32_16x16x32_bf16 v[56:59], v[92:95], a[164:167], v[56:59]
s_waitcnt lgkmcnt(2)
v_mfma_f32_16x16x32_bf16 v[52:55], a[172:175], v[96:99], v[52:55]
ds_read_b128 v[92:95], v2 offset:44032
v_mfma_f32_16x16x32_bf16 v[56:59], v[96:99], a[176:179], v[56:59]
s_waitcnt lgkmcnt(2)
v_mfma_f32_16x16x32_bf16 v[52:55], a[184:187], v[100:103], v[52:55]
ds_read_b128 v[96:99], v2 offset:46080
v_mfma_f32_16x16x32_bf16 v[56:59], v[100:103], a[188:191], v[56:59]
s_waitcnt lgkmcnt(2)
v_mfma_f32_16x16x32_bf16 v[52:55], a[100:103], v[88:91], v[52:55]
ds_read_b128 v[100:103], v2 offset:48128
v_mfma_f32_16x16x32_bf16 v[56:59], v[88:91], a[104:107], v[56:59]
s_waitcnt lgkmcnt(2)
v_mfma_f32_16x16x32_bf16 v[52:55], a[112:115], v[92:95], v[52:55]
v_mfma_f32_16x16x32_bf16 v[56:59], v[92:95], a[116:119], v[56:59]
s_waitcnt lgkmcnt(1)
v_mfma_f32_16x16x32_bf16 v[52:55], a[124:127], v[96:99], v[52:55]
ds_read_b128 v[68:71], v6 offset:64
ds_read2_b32 v[72:73], v5 offset0:32 offset1:112
v_mfma_f32_16x16x32_bf16 v[56:59], v[96:99], a[128:131], v[56:59]
v_add_u32 v74, s91, v5
s_waitcnt lgkmcnt(2)
v_mfma_f32_16x16x32_bf16 v[52:55], a[136:139], v[100:103], v[52:55]
v_subrev_u32 v75, s91, v6
ds_read_b32 v74, v74 offset:128
v_mfma_f32_16x16x32_bf16 v[56:59], v[100:103], a[140:143], v[56:59]
ds_read_b128 v[80:83], v75 offset:128
ds_read_b128 v[84:87], v75 offset:448
s_waitcnt lgkmcnt(2)
v_pk_mul_f32 v[76:77], v[68:69], v[72:73] op_sel:[0,1] op_sel_hi:[1,1]
v_pk_mul_f32 v[78:79], v[70:71], v[72:73] op_sel:[0,1] op_sel_hi:[1,1]
v_pk_fma_f32 v[52:53], v[52:53], v[72:73], v[76:77] op_sel_hi:[1,0,1]
v_pk_fma_f32 v[54:55], v[54:55], v[72:73], v[78:79] op_sel_hi:[1,0,1]
v_cvt_pk_bf16_f32 v104, v52, v53
v_cvt_pk_bf16_f32 v105, v54, v55
s_waitcnt lgkmcnt(0)
v_pk_mul_f32 v[84:85], v[84:85], v[74:75] op_sel_hi:[1,0]
v_pk_mul_f32 v[86:87], v[86:87], v[74:75] op_sel_hi:[1,0]
v_pk_fma_f32 v[56:57], v[56:57], v[80:81], v[84:85]
v_pk_fma_f32 v[58:59], v[58:59], v[82:83], v[86:87]
v_cvt_pk_bf16_f32 v110, v56, v57
v_cvt_pk_bf16_f32 v111, v58, v59
v_add_u32 v80, 0x27400, v1
ds_read_b128 v[84:87], v80 offset:1024
ds_read_b128 v[80:83], v80
v_mfma_f32_16x16x16_bf16 v[36:39], v[104:105], v[116:117], 0
v_mfma_f32_16x16x16_bf16 v[40:43], v[106:107], v[116:117], 0
v_mfma_f32_16x16x16_bf16 v[44:47], v[106:107], v[118:119], 0
v_mfma_f32_16x16x16_bf16 v[48:51], v[108:109], v[118:119], 0
v_mov_b32 v52, 0x3f803f80
v_mov_b32 v53, 0x3f803f80
v_mov_b32 v54, 0x3f803f80
v_mov_b32 v55, 0x3f803f80
v_mov_b32 v108, v104
v_mov_b32 v109, v105
s_waitcnt lgkmcnt(0)
v_pk_fma_f32 v[36:37], v[36:37], s[34:35], v[80:81]
v_pk_fma_f32 v[38:39], v[38:39], s[34:35], v[82:83]
v_pk_fma_f32 v[40:41], v[40:41], s[34:35], v[84:85]
v_pk_fma_f32 v[42:43], v[42:43], s[34:35], v[86:87]
v_pk_fma_f32 v[44:45], v[44:45], s[34:35], v[80:81]
v_pk_fma_f32 v[46:47], v[46:47], s[34:35], v[82:83]
v_pk_fma_f32 v[48:49], v[48:49], s[34:35], v[84:85]
v_pk_fma_f32 v[50:51], v[50:51], s[34:35], v[86:87]
v_max3_f32 v56, v36, v37, v38
v_max3_f32 v58, v44, v45, v46
v_max3_f32 v57, v39, v40, v41
v_max3_f32 v59, v47, v48, v49
v_max3_f32 v56, v56, v42, v43
v_max3_f32 v58, v58, v50, v51
v_max_f32 v56, v56, v57
v_max_f32 v58, v58, v59
s_add_u32 s15, s47, s39
s_add_u32 s15, s15, 0x1200000
v_permlane32_swap_b32 v56, v58
v_max_f32 v56, v56, v58
v_mov_b32 v58, v56
s_nop 1
v_permlane16_swap_b32 v56, v58
v_max_f32 v56, v56, v58
v_mov_b32 v58, v56
s_nop 1
v_permlane32_swap_b32 v56, v58
v_pk_add_f32 v[36:37], v[36:37], v[56:57] op_sel_hi:[1,0] neg_lo:[0,1] neg_hi:[0,1]
v_pk_add_f32 v[38:39], v[38:39], v[56:57] op_sel_hi:[1,0] neg_lo:[0,1] neg_hi:[0,1]
v_pk_add_f32 v[40:41], v[40:41], v[56:57] op_sel_hi:[1,0] neg_lo:[0,1] neg_hi:[0,1]
v_pk_add_f32 v[42:43], v[42:43], v[56:57] op_sel_hi:[1,0] neg_lo:[0,1] neg_hi:[0,1]
v_exp_f32 v36, v36
v_exp_f32 v37, v37
v_exp_f32 v38, v38
v_exp_f32 v39, v39
v_exp_f32 v40, v40
v_exp_f32 v41, v41
v_exp_f32 v42, v42
v_exp_f32 v43, v43
v_pk_add_f32 v[44:45], v[44:45], v[58:59] op_sel_hi:[1,0] neg_lo:[0,1] neg_hi:[0,1]
v_pk_add_f32 v[46:47], v[46:47], v[58:59] op_sel_hi:[1,0] neg_lo:[0,1] neg_hi:[0,1]
v_pk_add_f32 v[48:49], v[48:49], v[58:59] op_sel_hi:[1,0] neg_lo:[0,1] neg_hi:[0,1]
v_pk_add_f32 v[50:51], v[50:51], v[58:59] op_sel_hi:[1,0] neg_lo:[0,1] neg_hi:[0,1]
v_exp_f32 v44, v44
v_exp_f32 v45, v45
v_exp_f32 v46, v46
v_exp_f32 v47, v47
v_exp_f32 v48, v48
v_exp_f32 v49, v49
v_exp_f32 v50, v50
v_exp_f32 v51, v51
s_waitcnt vmcnt(4)
s_barrier
ds_read_b128 v[92:95], v2 offset:57344
ds_read_b128 v[96:99], v2 offset:32768
ds_read_b128 v[100:103], v2 offset:33792
v_cvt_pk_bf16_f32 v68, v36, v37
v_cvt_pk_bf16_f32 v69, v38, v39
v_cvt_pk_bf16_f32 v70, v40, v41
v_cvt_pk_bf16_f32 v71, v42, v43
v_cvt_pk_bf16_f32 v72, v44, v45
v_cvt_pk_bf16_f32 v73, v46, v47
v_cvt_pk_bf16_f32 v74, v48, v49
v_cvt_pk_bf16_f32 v75, v50, v51
v_mfma_f32_16x16x32_bf16 v[40:43], v[52:55], v[68:71], 0
s_nop 0
v_mfma_f32_16x16x32_bf16 v[48:51], v[52:55], v[72:75], 0
v_mfma_f32_16x16x32_bf16 v[36:39], v[110:113], v[68:71], 0
v_mfma_f32_16x16x32_bf16 v[44:47], v[112:115], v[72:75], 0
v_mov_b32 v114, v110
v_mov_b32 v115, v111
s_nop 1
v_rcp_f32 v40, v40
s_nop 0
v_rcp_f32 v48, v48
v_pk_mul_f32 v[36:37], v[36:37], v[40:41] op_sel_hi:[1,0]
v_pk_mul_f32 v[38:39], v[38:39], v[40:41] op_sel_hi:[1,0]
v_pk_mul_f32 v[44:45], v[44:45], v[48:49] op_sel_hi:[1,0]
v_pk_mul_f32 v[46:47], v[46:47], v[48:49] op_sel_hi:[1,0]
v_cvt_pk_bf16_f32 v76, v36, v37
v_cvt_pk_bf16_f32 v77, v38, v39
v_cvt_pk_bf16_f32 v78, v44, v45
v_cvt_pk_bf16_f32 v79, v46, v47
s_nop 0
v_permlane32_swap_b32 v76, v78
v_permlane32_swap_b32 v77, v79
buffer_store_dwordx4 v[76:79], v3, s[4:7], s15 offen sc1
ds_read_b128 v[80:83], v2 offset:58368
ds_read_b128 v[84:87], v2 offset:34816
ds_read_b128 v[88:91], v2 offset:35840
s_waitcnt lgkmcnt(3)
v_mfma_f32_16x16x32_bf16 v[44:47], a[148:151], v[92:95], 0
ds_read_b128 v[68:71], v2 offset:59392
ds_read_b128 v[72:75], v2 offset:36864
v_mfma_f32_16x16x32_bf16 v[48:51], v[92:95], a[152:155], 0
ds_read_b128 v[76:79], v2 offset:37888
v_mfma_f32_16x16x32_bf16 v[36:39], a[148:151], v[96:99], 0
v_mfma_f32_16x16x32_bf16 v[40:43], v[96:99], a[152:155], 0
v_mfma_f32_16x16x32_bf16 v[60:63], a[144:147], v[96:99], 0
v_mfma_f32_16x16x32_bf16 v[64:67], a[144:147], v[100:103], 0
s_waitcnt lgkmcnt(3)
v_mfma_f32_16x16x32_bf16 v[44:47], a[160:163], v[80:83], v[44:47]
ds_read_b128 v[92:95], v2 offset:60416
ds_read_b128 v[96:99], v2 offset:38912
v_mfma_f32_16x16x32_bf16 v[48:51], v[80:83], a[164:167], v[48:51]
ds_read_b128 v[100:103], v2 offset:39936
s_add_u32 s28, s25, 4096
v_mfma_f32_16x16x32_bf16 v[36:39], a[160:163], v[84:87], v[36:39]
buffer_load_dwordx4 a[144:147], v1, s[4:7], s28 offen sc1
v_mfma_f32_16x16x32_bf16 v[40:43], v[84:87], a[164:167], v[40:43]
v_mfma_f32_16x16x32_bf16 v[60:63], a[156:159], v[84:87], v[60:63]
buffer_load_dwordx4 a[148:151], v1, s[4:7], s28 offen offset:1024 sc1
v_mfma_f32_16x16x32_bf16 v[64:67], a[156:159], v[88:91], v[64:67]
s_waitcnt lgkmcnt(3)
v_mfma_f32_16x16x32_bf16 v[44:47], a[172:175], v[68:71], v[44:47]
ds_read_b128 v[80:83], v2 offset:61440
ds_read_b128 v[84:87], v2 offset:40960
v_mfma_f32_16x16x32_bf16 v[48:51], v[68:71], a[176:179], v[48:51]
ds_read_b128 v[88:91], v2 offset:41984
buffer_load_dwordx4 a[152:155], v1, s[4:7], s28 offen offset:2048 sc1
v_mfma_f32_16x16x32_bf16 v[36:39], a[172:175], v[72:75], v[36:39]
v_mfma_f32_16x16x32_bf16 v[40:43], v[72:75], a[176:179], v[40:43]
buffer_load_dwordx4 a[156:159], v1, s[4:7], s28 offen offset:3072 sc1
v_mfma_f32_16x16x32_bf16 v[60:63], a[168:171], v[72:75], v[60:63]
v_mfma_f32_16x16x32_bf16 v[64:67], a[168:171], v[76:79], v[64:67]
s_add_u32 s28, s25, 8192
s_waitcnt lgkmcnt(3)
v_mfma_f32_16x16x32_bf16 v[44:47], a[184:187], v[92:95], v[44:47]
ds_read_b128 v[68:71], v2 offset:62464
ds_read_b128 v[72:75], v2 offset:43008
v_mfma_f32_16x16x32_bf16 v[48:51], v[92:95], a[188:191], v[48:51]
ds_read_b128 v[76:79], v2 offset:44032
buffer_load_dwordx4 a[160:163], v1, s[4:7], s28 offen sc1
v_mfma_f32_16x16x32_bf16 v[36:39], a[184:187], v[96:99], v[36:39]
v_add_u32 v15, 8, v15
s_waitcnt vmcnt(5)
v_mfma_f32_16x16x32_bf16 v[40:43], v[96:99], a[188:191], v[40:43]
buffer_load_dwordx4 a[164:167], v1, s[4:7], s28 offen offset:1024 sc1
buffer_store_dword v15, v13, s[4:7], s45 offen sc1
v_mfma_f32_16x16x32_bf16 v[60:63], a[180:183], v[96:99], v[60:63]
v_mfma_f32_16x16x32_bf16 v[64:67], a[180:183], v[100:103], v[64:67]
buffer_load_dwordx4 a[168:171], v1, s[4:7], s28 offen offset:2048 sc1
s_waitcnt lgkmcnt(3)
v_mfma_f32_16x16x32_bf16 v[44:47], a[100:103], v[80:83], v[44:47]
ds_read_b128 v[92:95], v2 offset:63488
ds_read_b128 v[96:99], v2 offset:45056
v_mfma_f32_16x16x32_bf16 v[48:51], v[80:83], a[104:107], v[48:51]
ds_read_b128 v[100:103], v2 offset:46080
buffer_load_dwordx4 a[172:175], v1, s[4:7], s28 offen offset:3072 sc1
v_mfma_f32_16x16x32_bf16 v[36:39], a[100:103], v[84:87], v[36:39]
v_mfma_f32_16x16x32_bf16 v[40:43], v[84:87], a[104:107], v[40:43]
s_add_u32 s28, s25, 12288
buffer_load_dwordx4 a[176:179], v1, s[4:7], s28 offen sc1
v_mfma_f32_16x16x32_bf16 v[60:63], a[96:99], v[84:87], v[60:63]
v_mfma_f32_16x16x32_bf16 v[64:67], a[96:99], v[88:91], v[64:67]
buffer_load_dwordx4 a[180:183], v1, s[4:7], s28 offen offset:1024 sc1
s_waitcnt lgkmcnt(3)
v_mfma_f32_16x16x32_bf16 v[44:47], a[112:115], v[68:71], v[44:47]
ds_read_b128 v[80:83], v2 offset:64512
ds_read_b128 v[84:87], v2 offset:47104
v_mfma_f32_16x16x32_bf16 v[48:51], v[68:71], a[116:119], v[48:51]
ds_read_b128 v[88:91], v2 offset:48128
buffer_load_dwordx4 a[184:187], v1, s[4:7], s28 offen offset:2048 sc1
v_mfma_f32_16x16x32_bf16 v[36:39], a[112:115], v[72:75], v[36:39]
v_add_f32 v120, v120, v122
v_add_f32 v124, v124, v126
v_mfma_f32_16x16x32_bf16 v[40:43], v[72:75], a[116:119], v[40:43]
buffer_load_dwordx4 a[188:191], v1, s[4:7], s28 offen offset:3072 sc1
v_add_f32 v121, v121, v123
v_mfma_f32_16x16x32_bf16 v[60:63], a[108:111], v[72:75], v[60:63]
v_add_f32 v125, v125, v127
v_add_f32 v120, v120, v124
v_mfma_f32_16x16x32_bf16 v[64:67], a[108:111], v[76:79], v[64:67]
s_add_u32 s28, s26, 24576
s_waitcnt lgkmcnt(3)
v_mfma_f32_16x16x32_bf16 v[44:47], a[124:127], v[92:95], v[44:47]
ds_read_b128 v[68:71], v2 offset:49152
ds_read_b128 v[72:75], v2 offset:16384
v_mfma_f32_16x16x32_bf16 v[48:51], v[92:95], a[128:131], v[48:51]
ds_read_b128 v[76:79], v2 offset:17408
buffer_load_dwordx4 a[96:99], v1, s[4:7], s28 offen sc1
v_mfma_f32_16x16x32_bf16 v[36:39], a[124:127], v[96:99], v[36:39]
v_add_f32 v121, v121, v125
v_mov_b32 v122, v5
v_mfma_f32_16x16x32_bf16 v[40:43], v[96:99], a[128:131], v[40:43]
s_add_u32 s14, s28, s88
buffer_load_dwordx4 a[100:103], v1, s[4:7], s14 offen sc1
v_mfma_f32_16x16x32_bf16 v[60:63], a[120:123], v[96:99], v[60:63]
s_nop 0
v_permlane32_swap_b32 v120, v121
v_mfma_f32_16x16x32_bf16 v[64:67], a[120:123], v[100:103], v[64:67]
s_add_u32 s14, s28, s89
s_waitcnt lgkmcnt(3)
v_mfma_f32_16x16x32_bf16 v[44:47], a[136:139], v[80:83], v[44:47]
ds_read_b128 v[92:95], v2 offset:50176
ds_read_b128 v[96:99], v2 offset:18432
v_mfma_f32_16x16x32_bf16 v[48:51], v[80:83], a[140:143], v[48:51]
ds_read_b128 v[100:103], v2 offset:19456
buffer_load_dwordx4 a[104:107], v1, s[4:7], s14 offen sc1
v_mfma_f32_16x16x32_bf16 v[36:39], a[136:139], v[84:87], v[36:39]
v_add_f32 v120, v120, v121
v_mov_b32 v121, v120
v_mfma_f32_16x16x32_bf16 v[40:43], v[84:87], a[140:143], v[40:43]
s_add_u32 s28, s26, 27648
buffer_load_dwordx4 a[108:111], v1, s[4:7], s28 offen sc1
v_mfma_f32_16x16x32_bf16 v[60:63], a[132:135], v[84:87], v[60:63]
v_permlane16_swap_b32 v120, v121
v_mfma_f32_16x16x32_bf16 v[64:67], a[132:135], v[88:91], v[64:67]
s_add_u32 s14, s28, s88
s_waitcnt lgkmcnt(3)
v_mfma_f32_16x16x32_bf16 v[44:47], a[4:7], v[68:71], v[44:47]
ds_read_b128 v[80:83], v2 offset:51200
ds_read_b128 v[84:87], v2 offset:20480
v_mfma_f32_16x16x32_bf16 v[48:51], v[68:71], a[8:11], v[48:51]
ds_read_b128 v[88:91], v2 offset:21504
buffer_load_dwordx4 a[112:115], v1, s[4:7], s14 offen sc1
v_mfma_f32_16x16x32_bf16 v[36:39], a[4:7], v[72:75], v[36:39]
v_add_f32 v120, v120, v121
v_mov_b32 v121, v120
v_mfma_f32_16x16x32_bf16 v[40:43], v[72:75], a[8:11], v[40:43]
s_add_u32 s14, s28, s89
buffer_load_dwordx4 a[116:119], v1, s[4:7], s14 offen sc1
v_mfma_f32_16x16x32_bf16 v[60:63], a[0:3], v[72:75], v[60:63]
v_permlane32_swap_b32 v120, v121
v_mfma_f32_16x16x32_bf16 v[64:67], a[0:3], v[76:79], v[64:67]
s_add_u32 s28, s26, 30720
s_waitcnt lgkmcnt(3)
v_mfma_f32_16x16x32_bf16 v[44:47], a[16:19], v[92:95], v[44:47]
ds_read_b128 v[68:71], v2 offset:52224
ds_read_b128 v[72:75], v2 offset:22528
v_mfma_f32_16x16x32_bf16 v[48:51], v[92:95], a[20:23], v[48:51]
ds_read_b128 v[76:79], v2 offset:23552
buffer_load_dwordx4 a[120:123], v1, s[4:7], s28 offen sc1
v_mfma_f32_16x16x32_bf16 v[36:39], a[16:19], v[96:99], v[36:39]
v_mul_f32 v120, 0x3b000000, v120
v_mul_f32 v121, 0x3b000000, v121
v_mfma_f32_16x16x32_bf16 v[40:43], v[96:99], a[20:23], v[40:43]
v_fma_f32 v121, -v120, v120, v121
v_max_f32 v121, 0, v121
v_mfma_f32_16x16x32_bf16 v[60:63], a[12:15], v[96:99], v[60:63]
buffer_load_dword v17, v4, s[4:7], s92 offen sc1
v_add_f32 v121, 0x3727c5ac, v121
v_mfma_f32_16x16x32_bf16 v[64:67], a[12:15], v[100:103], v[64:67]
s_waitcnt lgkmcnt(3)
v_mfma_f32_16x16x32_bf16 v[44:47], a[28:31], v[80:83], v[44:47]
ds_read_b128 v[92:95], v2 offset:53248
ds_read_b128 v[96:99], v2 offset:24576
v_mfma_f32_16x16x32_bf16 v[48:51], v[80:83], a[32:35], v[48:51]
ds_read_b128 v[100:103], v2 offset:25600
s_add_u32 s14, s28, s88
v_mfma_f32_16x16x32_bf16 v[36:39], a[28:31], v[84:87], v[36:39]
buffer_load_dwordx4 a[124:127], v1, s[4:7], s14 offen sc1
v_mfma_f32_16x16x32_bf16 v[40:43], v[84:87], a[32:35], v[40:43]
v_rsq_f32 v121, v121
v_mfma_f32_16x16x32_bf16 v[60:63], a[24:27], v[84:87], v[60:63]
s_add_u32 s14, s28, s89
buffer_load_dwordx4 a[128:131], v1, s[4:7], s14 offen sc1
v_mfma_f32_16x16x32_bf16 v[64:67], a[24:27], v[88:91], v[64:67]
v_sub_f32 v120, 0, v120
s_waitcnt lgkmcnt(3)
v_mfma_f32_16x16x32_bf16 v[44:47], a[40:43], v[68:71], v[44:47]
ds_read_b128 v[80:83], v2 offset:54272
ds_read_b128 v[84:87], v2 offset:26624
v_mfma_f32_16x16x32_bf16 v[48:51], v[68:71], a[44:47], v[48:51]
ds_read_b128 v[88:91], v2 offset:27648
s_add_u32 s28, s26, 33792
v_mfma_f32_16x16x32_bf16 v[36:39], a[40:43], v[72:75], v[36:39]
buffer_load_dwordx4 a[132:135], v1, s[4:7], s28 offen sc1
v_mul_f32 v120, v120, v121
v_mfma_f32_16x16x32_bf16 v[40:43], v[72:75], a[44:47], v[40:43]
ds_write_b32 v122, v121 offset:0
ds_write_b32 v122, v120 offset:320
v_mfma_f32_16x16x32_bf16 v[60:63], a[36:39], v[72:75], v[60:63]
s_add_u32 s14, s28, s88
buffer_load_dwordx4 a[136:139], v1, s[4:7], s14 offen sc1
v_mfma_f32_16x16x32_bf16 v[64:67], a[36:39], v[76:79], v[64:67]
s_waitcnt lgkmcnt(5)
v_mfma_f32_16x16x32_bf16 v[44:47], a[52:55], v[92:95], v[44:47]
ds_read_b128 v[68:71], v2 offset:55296
ds_read_b128 v[72:75], v2 offset:28672
v_mfma_f32_16x16x32_bf16 v[48:51], v[92:95], a[56:59], v[48:51]
ds_read_b128 v[76:79], v2 offset:29696
s_add_u32 s14, s28, s89
v_mfma_f32_16x16x32_bf16 v[36:39], a[52:55], v[96:99], v[36:39]
buffer_load_dwordx4 a[140:143], v1, s[4:7], s14 offen sc1
v_mfma_f32_16x16x32_bf16 v[40:43], v[96:99], a[56:59], v[40:43]
v_mfma_f32_16x16x32_bf16 v[60:63], a[48:51], v[96:99], v[60:63]
v_mfma_f32_16x16x32_bf16 v[64:67], a[48:51], v[100:103], v[64:67]
s_waitcnt lgkmcnt(5)
v_mfma_f32_16x16x32_bf16 v[44:47], a[64:67], v[80:83], v[44:47]
ds_read_b128 v[92:95], v2 offset:56320
ds_read_b128 v[96:99], v2 offset:30720
v_mfma_f32_16x16x32_bf16 v[48:51], v[80:83], a[68:71], v[48:51]
ds_read_b128 v[100:103], v2 offset:31744
v_mfma_f32_16x16x32_bf16 v[36:39], a[64:67], v[84:87], v[36:39]
v_mfma_f32_16x16x32_bf16 v[40:43], v[84:87], a[68:71], v[40:43]
v_mfma_f32_16x16x32_bf16 v[60:63], a[60:63], v[84:87], v[60:63]
v_mfma_f32_16x16x32_bf16 v[64:67], a[60:63], v[88:91], v[64:67]
s_waitcnt lgkmcnt(3)
v_mfma_f32_16x16x32_bf16 v[44:47], a[76:79], v[68:71], v[44:47]
v_mfma_f32_16x16x32_bf16 v[48:51], v[68:71], a[80:83], v[48:51]
v_mfma_f32_16x16x32_bf16 v[36:39], a[76:79], v[72:75], v[36:39]
v_mfma_f32_16x16x32_bf16 v[40:43], v[72:75], a[80:83], v[40:43]
v_mfma_f32_16x16x32_bf16 v[60:63], a[72:75], v[72:75], v[60:63]
v_mfma_f32_16x16x32_bf16 v[64:67], a[72:75], v[76:79], v[64:67]
s_waitcnt lgkmcnt(0)
v_mfma_f32_16x16x32_bf16 v[44:47], a[88:91], v[92:95], v[44:47]
ds_read_b128 v[68:71], v6 offset:64
ds_read2_b32 v[72:73], v5 offset0:0 offset1:80
v_mfma_f32_16x16x32_bf16 v[48:51], v[92:95], a[92:95], v[48:51]
ds_read2_b32 v[74:75], v5 offset0:16 offset1:96
ds_read_b128 v[76:79], v6 offset:0
v_mfma_f32_16x16x32_bf16 v[36:39], a[88:91], v[96:99], v[36:39]
ds_read2_b32 v[80:81], v5 offset0:32 offset1:112
v_add_u32 v82, s91, v5
v_mfma_f32_16x16x32_bf16 v[40:43], v[96:99], a[92:95], v[40:43]
v_subrev_u32 v83, s91, v6
ds_read_b32 v82, v82 offset:128
v_mfma_f32_16x16x32_bf16 v[60:63], a[84:87], v[96:99], v[60:63]
v_mfma_f32_16x16x32_bf16 v[64:67], a[84:87], v[100:103], v[64:67]
ds_read_b128 v[88:91], v83 offset:0
ds_read_b128 v[92:95], v83 offset:320
ds_read_b128 v[96:99], v83 offset:64
ds_read_b128 v[100:103], v83 offset:384
s_waitcnt lgkmcnt(4)
v_pk_mul_f32 v[84:85], v[68:69], v[72:73] op_sel:[0,1] op_sel_hi:[1,1]
v_pk_mul_f32 v[86:87], v[70:71], v[72:73] op_sel:[0,1] op_sel_hi:[1,1]
v_pk_fma_f32 v[44:45], v[44:45], v[72:73], v[84:85] op_sel_hi:[1,0,1]
v_pk_fma_f32 v[46:47], v[46:47], v[72:73], v[86:87] op_sel_hi:[1,0,1]
v_cvt_pk_bf16_f32 v104, v44, v45
v_cvt_pk_bf16_f32 v105, v46, v47
v_pk_mul_f32 v[84:85], v[68:69], v[74:75] op_sel:[0,1] op_sel_hi:[1,1]
v_pk_mul_f32 v[86:87], v[70:71], v[74:75] op_sel:[0,1] op_sel_hi:[1,1]
v_pk_fma_f32 v[36:37], v[36:37], v[74:75], v[84:85] op_sel_hi:[1,0,1]
v_pk_fma_f32 v[38:39], v[38:39], v[74:75], v[86:87] op_sel_hi:[1,0,1]
v_cvt_pk_bf16_f32 v106, v36, v37
v_cvt_pk_bf16_f32 v107, v38, v39
v_pk_mul_f32 v[84:85], v[76:77], v[74:75] op_sel:[0,1] op_sel_hi:[1,1]
v_pk_mul_f32 v[86:87], v[78:79], v[74:75] op_sel:[0,1] op_sel_hi:[1,1]
v_pk_fma_f32 v[60:61], v[60:61], v[74:75], v[84:85] op_sel_hi:[1,0,1]
v_pk_fma_f32 v[62:63], v[62:63], v[74:75], v[86:87] op_sel_hi:[1,0,1]
v_cvt_pk_bf16_f32 v116, v60, v61
v_cvt_pk_bf16_f32 v117, v62, v63
v_pk_mul_f32 v[84:85], v[76:77], v[80:81] op_sel:[0,1] op_sel_hi:[1,1]
v_pk_mul_f32 v[86:87], v[78:79], v[80:81] op_sel:[0,1] op_sel_hi:[1,1]
v_pk_fma_f32 v[64:65], v[64:65], v[80:81], v[84:85] op_sel_hi:[1,0,1]
v_pk_fma_f32 v[66:67], v[66:67], v[80:81], v[86:87] op_sel_hi:[1,0,1]
v_cvt_pk_bf16_f32 v118, v64, v65
v_cvt_pk_bf16_f32 v119, v66, v67
s_waitcnt lgkmcnt(2)
v_pk_mul_f32 v[92:93], v[92:93], v[82:83] op_sel_hi:[1,0]
v_pk_mul_f32 v[94:95], v[94:95], v[82:83] op_sel_hi:[1,0]
v_pk_fma_f32 v[48:49], v[48:49], v[88:89], v[92:93]
v_pk_fma_f32 v[50:51], v[50:51], v[90:91], v[94:95]
v_cvt_pk_bf16_f32 v110, v48, v49
v_cvt_pk_bf16_f32 v111, v50, v51
s_waitcnt lgkmcnt(0)
v_pk_mul_f32 v[100:101], v[100:101], v[82:83] op_sel_hi:[1,0]
v_pk_mul_f32 v[102:103], v[102:103], v[82:83] op_sel_hi:[1,0]
v_pk_fma_f32 v[40:41], v[40:41], v[96:97], v[100:101]
v_pk_fma_f32 v[42:43], v[42:43], v[98:99], v[102:103]
v_cvt_pk_bf16_f32 v112, v40, v41
v_cvt_pk_bf16_f32 v113, v42, v43
s_add_u32 s46, s32, 11
s_waitcnt vmcnt(5)
v_lshrrev_b32 v17, 3, v17
v_subrev_u32 v17, s46, v17
v_cmp_lt_u32 vcc, 31, v17
s_cbranch_vccnz L_spin_59
L_ok_58:
s_add_u32 s17, s47, s97
v_add_u32 v80, 0x27400, v1
ds_read_b128 v[84:87], v80 offset:1024
ds_read_b128 v[80:83], v80
v_mfma_f32_16x16x16_bf16 v[36:39], v[104:105], v[116:117], 0
s_add_u32 m0, s2, 0
s_add_u32 s29, s17, 0x1200000
v_mfma_f32_16x16x16_bf16 v[40:43], v[106:107], v[116:117], 0
buffer_load_dwordx4 v1, s[4:7], s29 offen sc1 lds
v_mfma_f32_16x16x16_bf16 v[44:47], v[106:107], v[118:119], 0
v_mfma_f32_16x16x16_bf16 v[48:51], v[108:109], v[118:119], 0
v_mov_b32 v60, 0x3f803f80
v_mov_b32 v61, 0x3f803f80
v_mov_b32 v62, 0x3f803f80
buffer_load_dwordx4 v1, s[4:7], s29 offen offset:1024 sc1 lds
v_mov_b32 v63, 0x3f803f80
s_waitcnt lgkmcnt(0)
v_min_f32 v52, s38, v80
v_min_f32 v53, s38, v81
v_min_f32 v54, s38, v82
v_min_f32 v55, s38, v83
v_pk_fma_f32 v[36:37], v[36:37], s[34:35], v[52:53]
v_pk_fma_f32 v[38:39], v[38:39], s[34:35], v[54:55]
v_pk_fma_f32 v[40:41], v[40:41], s[34:35], v[84:85]
v_pk_fma_f32 v[42:43], v[42:43], s[34:35], v[86:87]
s_add_u32 m0, s2, 8192
s_add_u32 s29, s17, 0x1201000
buffer_load_dwordx4 v1, s[4:7], s29 offen sc1 lds
v_pk_fma_f32 v[44:45], v[44:45], s[34:35], v[80:81]
v_pk_fma_f32 v[46:47], v[46:47], s[34:35], v[82:83]
v_pk_fma_f32 v[48:49], v[48:49], s[34:35], v[84:85]
v_pk_fma_f32 v[50:51], v[50:51], s[34:35], v[86:87]
v_max3_f32 v56, v36, v37, v38
v_max3_f32 v58, v44, v45, v46
v_max3_f32 v57, v39, v40, v41
v_max3_f32 v59, v47, v48, v49
v_max3_f32 v56, v56, v42, v43
buffer_load_dwordx4 v1, s[4:7], s29 offen offset:1024 sc1 lds
v_max3_f32 v58, v58, v50, v51
v_max_f32 v56, v56, v57
v_max_f32 v58, v58, v59
s_add_u32 s15, s47, s39
s_add_u32 s15, s15, 0x1208000
v_permlane32_swap_b32 v56, v58
v_max_f32 v56, v56, v58
v_mov_b32 v58, v56
s_nop 1
v_permlane16_swap_b32 v56, v58
v_max_f32 v56, v56, v58
s_add_u32 m0, s2, 16384
s_add_u32 s29, s17, 0x1202000
buffer_load_dwordx4 v1, s[4:7], s29 offen sc1 lds
v_mov_b32 v58, v56
s_nop 1
v_permlane32_swap_b32 v56, v58
v_pk_add_f32 v[36:37], v[36:37], v[56:57] op_sel_hi:[1,0] neg_lo:[0,1] neg_hi:[0,1]
v_pk_add_f32 v[38:39], v[38:39], v[56:57] op_sel_hi:[1,0] neg_lo:[0,1] neg_hi:[0,1]
v_pk_add_f32 v[40:41], v[40:41], v[56:57] op_sel_hi:[1,0] neg_lo:[0,1] neg_hi:[0,1]
v_pk_add_f32 v[42:43], v[42:43], v[56:57] op_sel_hi:[1,0] neg_lo:[0,1] neg_hi:[0,1]
v_exp_f32 v36, v36
v_exp_f32 v37, v37
buffer_load_dwordx4 v1, s[4:7], s29 offen offset:1024 sc1 lds
v_exp_f32 v38, v38
v_exp_f32 v39, v39
v_exp_f32 v40, v40
v_exp_f32 v41, v41
v_exp_f32 v42, v42
s_add_u32 m0, s2, 24576
s_add_u32 s29, s17, 0x1203000
buffer_load_dwordx4 v1, s[4:7], s29 offen sc1 lds
v_exp_f32 v43, v43
v_pk_add_f32 v[44:45], v[44:45], v[58:59] op_sel_hi:[1,0] neg_lo:[0,1] neg_hi:[0,1]
v_pk_add_f32 v[46:47], v[46:47], v[58:59] op_sel_hi:[1,0] neg_lo:[0,1] neg_hi:[0,1]
v_pk_add_f32 v[48:49], v[48:49], v[58:59] op_sel_hi:[1,0] neg_lo:[0,1] neg_hi:[0,1]
v_pk_add_f32 v[50:51], v[50:51], v[58:59] op_sel_hi:[1,0] neg_lo:[0,1] neg_hi:[0,1]
v_exp_f32 v44, v44
v_exp_f32 v45, v45
buffer_load_dwordx4 v1, s[4:7], s29 offen offset:1024 sc1 lds
v_exp_f32 v46, v46
v_exp_f32 v47, v47
v_exp_f32 v48, v48
v_exp_f32 v49, v49
v_exp_f32 v50, v50
v_exp_f32 v51, v51
v_cvt_pk_bf16_f32 v68, v36, v37
v_cvt_pk_bf16_f32 v69, v38, v39
v_cvt_pk_bf16_f32 v70, v40, v41
v_cvt_pk_bf16_f32 v71, v42, v43
v_cvt_pk_bf16_f32 v72, v44, v45
v_cvt_pk_bf16_f32 v73, v46, v47
v_cvt_pk_bf16_f32 v74, v48, v49
v_cvt_pk_bf16_f32 v75, v50, v51
v_mfma_f32_16x16x32_bf16 v[40:43], v[60:63], v[68:71], 0
s_nop 0
v_mfma_f32_16x16x32_bf16 v[48:51], v[60:63], v[72:75], 0
v_mfma_f32_16x16x32_bf16 v[36:39], v[110:113], v[68:71], 0
v_mfma_f32_16x16x32_bf16 v[44:47], v[112:115], v[72:75], 0
s_nop 3
v_rcp_f32 v40, v40
s_nop 0
v_rcp_f32 v48, v48
v_pk_mul_f32 v[36:37], v[36:37], v[40:41] op_sel_hi:[1,0]
v_pk_mul_f32 v[38:39], v[38:39], v[40:41] op_sel_hi:[1,0]
v_pk_mul_f32 v[44:45], v[44:45], v[48:49] op_sel_hi:[1,0]
v_pk_mul_f32 v[46:47], v[46:47], v[48:49] op_sel_hi:[1,0]
v_cvt_pk_bf16_f32 v76, v36, v37
v_cvt_pk_bf16_f32 v77, v38, v39
v_cvt_pk_bf16_f32 v78, v44, v45
v_cvt_pk_bf16_f32 v79, v46, v47
s_nop 0
v_permlane32_swap_b32 v76, v78
v_permlane32_swap_b32 v77, v79
buffer_store_dwordx4 v[76:79], v3, s[4:7], s15 offen sc1
s_waitcnt vmcnt(1)
s_barrier
ds_read_b128 v[88:91], v7 offset:0
ds_read_b128 v[92:95], v8 offset:0
ds_read_b128 v[96:99], v7 offset:4096
ds_read_b128 v[100:103], v8 offset:4096
ds_read_b128 v[72:75], v7 offset:8192
ds_read_b128 v[76:79], v8 offset:8192
s_waitcnt lgkmcnt(4)
v_mfma_f32_16x16x32_bf16 v[36:39], a[192:195], v[88:91], 0
ds_read_b128 v[80:83], v7 offset:12288
ds_read_b128 v[84:87], v8 offset:12288
v_mfma_f32_16x16x32_bf16 v[40:43], a[196:199], v[88:91], 0
v_mfma_f32_16x16x32_bf16 v[44:47], a[192:195], v[92:95], 0
v_mfma_f32_16x16x32_bf16 v[48:51], a[196:199], v[92:95], 0
s_waitcnt lgkmcnt(4)
v_mfma_f32_16x16x32_bf16 v[36:39], a[200:203], v[96:99], v[36:39]
ds_read_b128 v[88:91], v7 offset:16384
ds_read_b128 v[92:95], v8 offset:16384
v_mfma_f32_16x16x32_bf16 v[40:43], a[204:207], v[96:99], v[40:43]
v_add_u32 v15, 8, v15
s_waitcnt vmcnt(0)
v_mfma_f32_16x16x32_bf16 v[44:47], a[200:203], v[100:103], v[44:47]
buffer_store_dword v15, v13, s[4:7], s45 offen sc1
v_mfma_f32_16x16x32_bf16 v[48:51], a[204:207], v[100:103], v[48:51]
s_waitcnt lgkmcnt(4)
v_mfma_f32_16x16x32_bf16 v[36:39], a[144:147], v[72:75], v[36:39]
ds_read_b128 v[96:99], v7 offset:20480
ds_read_b128 v[100:103], v8 offset:20480
v_mfma_f32_16x16x32_bf16 v[40:43], a[148:151], v[72:75], v[40:43]
v_mfma_f32_16x16x32_bf16 v[44:47], a[144:147], v[76:79], v[44:47]
v_mfma_f32_16x16x32_bf16 v[48:51], a[148:151], v[76:79], v[48:51]
s_waitcnt lgkmcnt(4)
v_mfma_f32_16x16x32_bf16 v[36:39], a[152:155], v[80:83], v[36:39]
ds_read_b128 v[72:75], v7 offset:24576
ds_read_b128 v[76:79], v8 offset:24576
v_mfma_f32_16x16x32_bf16 v[40:43], a[156:159], v[80:83], v[40:43]
v_mfma_f32_16x16x32_bf16 v[44:47], a[152:155], v[84:87], v[44:47]
v_mfma_f32_16x16x32_bf16 v[48:51], a[156:159], v[84:87], v[48:51]
s_waitcnt lgkmcnt(4)
v_mfma_f32_16x16x32_bf16 v[36:39], a[160:163], v[88:91], v[36:39]
ds_read_b128 v[80:83], v7 offset:28672
ds_read_b128 v[84:87], v8 offset:28672
v_mfma_f32_16x16x32_bf16 v[40:43], a[164:167], v[88:91], v[40:43]
v_mfma_f32_16x16x32_bf16 v[44:47], a[160:163], v[92:95], v[44:47]
v_mfma_f32_16x16x32_bf16 v[48:51], a[164:167], v[92:95], v[48:51]
s_waitcnt lgkmcnt(4)
v_mfma_f32_16x16x32_bf16 v[44:47], a[168:171], v[100:103], v[44:47]
v_mfma_f32_16x16x32_bf16 v[48:51], a[172:175], v[100:103], v[48:51]
s_waitcnt lgkmcnt(2)
v_mfma_f32_16x16x32_bf16 v[44:47], a[176:179], v[76:79], v[44:47]
v_mfma_f32_16x16x32_bf16 v[48:51], a[180:183], v[76:79], v[48:51]
s_waitcnt lgkmcnt(0)
v_mfma_f32_16x16x32_bf16 v[44:47], a[184:187], v[84:87], v[44:47]
v_mfma_f32_16x16x32_bf16 v[48:51], a[188:191], v[84:87], v[48:51]
v_mfma_f32_16x16x32_bf16 v[36:39], a[168:171], v[96:99], v[36:39]
s_lshl_b32 s15, s8, 11
s_add_u32 s15, s15, 0x20000
v_mfma_f32_16x16x32_bf16 v[40:43], a[172:175], v[96:99], v[40:43]
s_xor_b32 s16, s15, 0x1000
v_add_u32 v104, s15, v1
v_mfma_f32_16x16x32_bf16 v[36:39], a[176:179], v[72:75], v[36:39]
v_add_u32 v105, s16, v1
v_mfma_f32_16x16x32_bf16 v[40:43], a[180:183], v[72:75], v[40:43]
ds_write_b128 v104, v[44:47] offset:0
ds_write_b128 v104, v[48:51] offset:1024
v_mfma_f32_16x16x32_bf16 v[36:39], a[184:187], v[80:83], v[36:39]
v_mfma_f32_16x16x32_bf16 v[40:43], a[188:191], v[80:83], v[40:43]
s_waitcnt lgkmcnt(0)
s_barrier
ds_read_b128 v[68:71], v105 offset:0
ds_read_b128 v[72:75], v105 offset:1024
buffer_load_dword v17, v4, s[4:7], s92 offen sc1
s_nop 1
v_pk_add_f32 v[20:21], v[20:21], v[36:37]
v_pk_add_f32 v[22:23], v[22:23], v[38:39]
v_pk_add_f32 v[24:25], v[24:25], v[40:41]
v_pk_add_f32 v[26:27], v[26:27], v[42:43]
s_waitcnt lgkmcnt(1)
v_pk_add_f32 v[20:21], v[20:21], v[68:69]
v_pk_add_f32 v[22:23], v[22:23], v[70:71]
s_waitcnt lgkmcnt(0)
v_pk_add_f32 v[24:25], v[24:25], v[72:73]
v_pk_add_f32 v[26:27], v[26:27], v[74:75]
s_add_u32 s15, s47, s62
s_add_u32 s15, s15, 0x1400000
v_cvt_pk_bf16_f32 v76, v20, v21
v_cvt_pk_bf16_f32 v77, v22, v23
v_cvt_pk_bf16_f32 v78, v24, v25
v_cvt_pk_bf16_f32 v79, v26, v27
buffer_store_dwordx4 v[76:79], v1, s[4:7], s15 offen sc1
v_pk_add_f32 v[68:69], v[20:21], v[22:23]
v_pk_add_f32 v[70:71], v[24:25], v[26:27]
v_pk_mul_f32 v[72:73], v[20:21], v[20:21]
v_pk_add_f32 v[68:69], v[68:69], v[70:71]
v_pk_fma_f32 v[72:73], v[22:23], v[22:23], v[72:73]
v_pk_fma_f32 v[72:73], v[24:25], v[24:25], v[72:73]
v_pk_fma_f32 v[72:73], v[26:27], v[26:27], v[72:73]
v_add_f32 v68, v68, v69
v_add_f32 v72, v72, v73
s_add_u32 s16, s13, s63
s_add_u32 s16, s16, 0x1d40000
v_permlane32_swap_b32 v68, v72
v_add_f32 v68, v68, v72
v_mov_b32 v72, v68
s_nop 1
v_permlane16_swap_b32 v68, v72
v_add_f32 v68, v68, v72
buffer_store_dword v68, v11, s[4:7], s16 offen sc1
s_add_u32 s46, s32, 12
s_waitcnt vmcnt(2)
v_lshrrev_b32 v17, 3, v17
v_subrev_u32 v17, s46, v17
v_cmp_lt_u32 vcc, 31, v17
s_cbranch_vccnz L_spin_61
L_ok_60:
s_add_u32 s17, s47, s97
s_add_u32 m0, s2, 32768
s_add_u32 s29, s17, 0x1209000
buffer_load_dwordx4 v1, s[4:7], s29 offen sc1 lds
buffer_load_dwordx4 v1, s[4:7], s29 offen offset:1024 sc1 lds
s_add_u32 m0, s2, 40960
s_add_u32 s29, s17, 0x120a000
buffer_load_dwordx4 v1, s[4:7], s29 offen sc1 lds
buffer_load_dwordx4 v1, s[4:7], s29 offen offset:1024 sc1 lds
v_add_u32 v15, 8, v15
s_waitcnt vmcnt(4)
buffer_store_dword v15, v13, s[4:7], s45 offen sc1
s_add_u32 m0, s2, 49152
s_add_u32 s29, s17, 0x120b000
buffer_load_dwordx4 v1, s[4:7], s29 offen sc1 lds
buffer_load_dwordx4 v1, s[4:7], s29 offen offset:1024 sc1 lds
s_add_u32 m0, s2, 57344
s_add_u32 s29, s17, 0x1208000
buffer_load_dwordx4 v1, s[4:7], s29 offen sc1 lds
buffer_load_dwordx4 v1, s[4:7], s29 offen offset:1024 sc1 lds
s_waitcnt vmcnt(7)
s_barrier
ds_read_b128 v[88:91], v7 offset:32768
ds_read_b128 v[92:95], v8 offset:32768
ds_read_b128 v[96:99], v7 offset:36864
ds_read_b128 v[100:103], v8 offset:36864
s_waitcnt vmcnt(5)
s_barrier
ds_read_b128 v[72:75], v7 offset:40960
ds_read_b128 v[76:79], v8 offset:40960
s_waitcnt lgkmcnt(4)
v_mfma_f32_16x16x32_bf16 v[36:39], a[144:147], v[88:91], 0
ds_read_b128 v[80:83], v7 offset:45056
ds_read_b128 v[84:87], v8 offset:45056
v_mfma_f32_16x16x32_bf16 v[40:43], a[148:151], v[88:91], 0
v_mfma_f32_16x16x32_bf16 v[44:47], a[144:147], v[92:95], 0
v_mfma_f32_16x16x32_bf16 v[48:51], a[148:151], v[92:95], 0
s_waitcnt lgkmcnt(4)
v_mfma_f32_16x16x32_bf16 v[36:39], a[152:155], v[96:99], v[36:39]
s_add_u32 s28, s26, 36864
buffer_load_dwordx4 a[144:147], v1, s[4:7], s28 offen sc1
s_waitcnt vmcnt(1)
s_barrier
v_mfma_f32_16x16x32_bf16 v[40:43], a[156:159], v[96:99], v[40:43]
ds_read_b128 v[88:91], v7 offset:49152
ds_read_b128 v[92:95], v8 offset:49152
v_mfma_f32_16x16x32_bf16 v[44:47], a[152:155], v[100:103], v[44:47]
v_mfma_f32_16x16x32_bf16 v[48:51], a[156:159], v[100:103], v[48:51]
buffer_load_dword v17, v4, s[4:7], s92 offen sc1
s_waitcnt lgkmcnt(4)
v_mfma_f32_16x16x32_bf16 v[36:39], a[160:163], v[72:75], v[36:39]
ds_read_b128 v[96:99], v7 offset:53248
ds_read_b128 v[100:103], v8 offset:53248
v_mfma_f32_16x16x32_bf16 v[40:43], a[164:167], v[72:75], v[40:43]
v_mfma_f32_16x16x32_bf16 v[44:47], a[160:163], v[76:79], v[44:47]
v_mfma_f32_16x16x32_bf16 v[48:51], a[164:167], v[76:79], v[48:51]
s_waitcnt lgkmcnt(4)
v_mfma_f32_16x16x32_bf16 v[36:39], a[168:171], v[80:83], v[36:39]
ds_read_b128 v[72:75], v7 offset:57344
ds_read_b128 v[76:79], v8 offset:57344
v_mfma_f32_16x16x32_bf16 v[40:43], a[172:175], v[80:83], v[40:43]
s_add_u32 s14, s28, s88
buffer_load_dwordx4 a[148:151], v1, s[4:7], s14 offen sc1
v_mfma_f32_16x16x32_bf16 v[44:47], a[168:171], v[84:87], v[44:47]
v_mfma_f32_16x16x32_bf16 v[48:51], a[172:175], v[84:87], v[48:51]
s_waitcnt lgkmcnt(4)
v_mfma_f32_16x16x32_bf16 v[36:39], a[176:179], v[88:91], v[36:39]
ds_read_b128 v[80:83], v7 offset:61440
ds_read_b128 v[84:87], v8 offset:61440
v_mfma_f32_16x16x32_bf16 v[40:43], a[180:183], v[88:91], v[40:43]
v_mfma_f32_16x16x32_bf16 v[44:47], a[176:179], v[92:95], v[44:47]
v_mfma_f32_16x16x32_bf16 v[48:51], a[180:183], v[92:95], v[48:51]
s_add_u32 s14, s28, s89
s_waitcnt lgkmcnt(4)
v_mfma_f32_16x16x32_bf16 v[44:47], a[184:187], v[100:103], v[44:47]
buffer_load_dwordx4 a[152:155], v1, s[4:7], s14 offen sc1
v_mfma_f32_16x16x32_bf16 v[48:51], a[188:191], v[100:103], v[48:51]
s_waitcnt lgkmcnt(2)
v_mfma_f32_16x16x32_bf16 v[44:47], a[192:195], v[76:79], v[44:47]
v_mfma_f32_16x16x32_bf16 v[48:51], a[196:199], v[76:79], v[48:51]
s_waitcnt lgkmcnt(0)
v_mfma_f32_16x16x32_bf16 v[44:47], a[200:203], v[84:87], v[44:47]
v_mfma_f32_16x16x32_bf16 v[48:51], a[204:207], v[84:87], v[48:51]
v_mfma_f32_16x16x32_bf16 v[36:39], a[184:187], v[96:99], v[36:39]
s_lshl_b32 s15, s8, 11
s_add_u32 s15, s15, 0x20000
v_mfma_f32_16x16x32_bf16 v[40:43], a[188:191], v[96:99], v[40:43]
s_xor_b32 s16, s15, 0x1000
v_add_u32 v104, s15, v1
v_mfma_f32_16x16x32_bf16 v[36:39], a[192:195], v[72:75], v[36:39]
v_add_u32 v105, s16, v1
v_mfma_f32_16x16x32_bf16 v[40:43], a[196:199], v[72:75], v[40:43]
ds_write_b128 v104, v[44:47] offset:0
ds_write_b128 v104, v[48:51] offset:1024
v_mfma_f32_16x16x32_bf16 v[36:39], a[200:203], v[80:83], v[36:39]
v_mfma_f32_16x16x32_bf16 v[40:43], a[204:207], v[80:83], v[40:43]
s_add_u32 s46, s32, 13
s_waitcnt vmcnt(2)
v_lshrrev_b32 v17, 3, v17
v_subrev_u32 v17, s46, v17
v_cmp_lt_u32 vcc, 31, v17
s_cbranch_vccnz L_spin_63
L_ok_62:
s_add_u32 s17, s47, s96
s_add_u32 m0, s3, 65536
s_add_u32 s29, s17, 0x1400000
buffer_load_dwordx4 v1, s[4:7], s29 offen sc1 lds
buffer_load_dwordx4 v1, s[4:7], s29 offen offset:1024 sc1 lds
s_waitcnt lgkmcnt(0)
s_barrier
ds_read_b128 v[68:71], v105 offset:0
ds_read_b128 v[72:75], v105 offset:1024
v_pk_add_f32 v[28:29], v[28:29], v[36:37]
v_pk_add_f32 v[30:31], v[30:31], v[38:39]
v_pk_add_f32 v[32:33], v[32:33], v[40:41]
v_pk_add_f32 v[34:35], v[34:35], v[42:43]
s_add_u32 s46, s13, 0x1d40000
buffer_load_dwordx2 v[120:121], v14, s[4:7], s46 offen sc1
buffer_load_dwordx2 v[122:123], v14, s[4:7], s46 offen offset:256 sc1
s_add_u32 m0, s3, 73728
s_add_u32 s29, s17, 0x1402000
buffer_load_dwordx4 v1, s[4:7], s29 offen sc1 lds
s_waitcnt lgkmcnt(1)
v_pk_add_f32 v[28:29], v[28:29], v[68:69]
v_pk_add_f32 v[30:31], v[30:31], v[70:71]
s_waitcnt lgkmcnt(0)
v_pk_add_f32 v[32:33], v[32:33], v[72:73]
v_pk_add_f32 v[34:35], v[34:35], v[74:75]
s_add_u32 s15, s47, s62
s_add_u32 s15, s15, 0x1408000
v_cvt_pk_bf16_f32 v76, v28, v29
v_cvt_pk_bf16_f32 v77, v30, v31
v_cvt_pk_bf16_f32 v78, v32, v33
v_cvt_pk_bf16_f32 v79, v34, v35
buffer_store_dwordx4 v[76:79], v1, s[4:7], s15 offen sc1
v_pk_add_f32 v[68:69], v[28:29], v[30:31]
v_pk_add_f32 v[70:71], v[32:33], v[34:35]
v_pk_mul_f32 v[72:73], v[28:29], v[28:29]
v_pk_add_f32 v[68:69], v[68:69], v[70:71]
v_pk_fma_f32 v[72:73], v[30:31], v[30:31], v[72:73]
v_pk_fma_f32 v[72:73], v[32:33], v[32:33], v[72:73]
v_pk_fma_f32 v[72:73], v[34:35], v[34:35], v[72:73]
v_add_f32 v68, v68, v69
v_add_f32 v72, v72, v73
s_add_u32 s16, s13, s63
s_add_u32 s16, s16, 0x1d41000
v_permlane32_swap_b32 v68, v72
v_add_f32 v68, v68, v72
v_mov_b32 v72, v68
s_nop 1
v_permlane16_swap_b32 v68, v72
v_add_f32 v68, v68, v72
buffer_store_dword v68, v11, s[4:7], s16 offen sc1
buffer_load_dwordx4 v1, s[4:7], s29 offen offset:1024 sc1 lds
s_add_u32 s46, s13, 0x1d40000
buffer_load_dwordx2 v[124:125], v14, s[4:7], s46 offen offset:512 sc1
buffer_load_dwordx2 v[126:127], v14, s[4:7], s46 offen offset:768 sc1
s_waitcnt vmcnt(8)
s_barrier
ds_read_b128 v[88:91], v2 offset:0
ds_read_b128 v[92:95], v2 offset:1024
ds_read_b128 v[96:99], v2 offset:2048
ds_read_b128 v[100:103], v2 offset:3072
ds_read_b128 v[72:75], v2 offset:4096
ds_read_b128 v[76:79], v2 offset:5120
s_add_u32 m0, s3, 81920
s_add_u32 s29, s17, 0x1404000
buffer_load_dwordx4 v1, s[4:7], s29 offen sc1 lds
buffer_load_dwordx4 v1, s[4:7], s29 offen offset:1024 sc1 lds
s_waitcnt lgkmcnt(4)
v_mfma_f32_16x16x32_bf16 v[36:39], a[208:211], v[88:91], 0
ds_read_b128 v[80:83], v2 offset:6144
ds_read_b128 v[84:87], v2 offset:7168
v_mfma_f32_16x16x32_bf16 v[44:47], a[212:215], v[88:91], 0
v_mfma_f32_16x16x32_bf16 v[52:55], a[216:219], v[88:91], 0
s_add_u32 m0, s3, 90112
s_add_u32 s29, s17, 0x1406000
v_mfma_f32_16x16x32_bf16 v[40:43], a[208:211], v[92:95], 0
buffer_load_dwordx4 v1, s[4:7], s29 offen sc1 lds
v_mfma_f32_16x16x32_bf16 v[48:51], a[212:215], v[92:95], 0
v_mfma_f32_16x16x32_bf16 v[56:59], a[216:219], v[92:95], 0
s_waitcnt lgkmcnt(4)
v_mfma_f32_16x16x32_bf16 v[36:39], a[220:223], v[96:99], v[36:39]
s_waitcnt vmcnt(5)
s_barrier
v_mfma_f32_16x16x32_bf16 v[44:47], a[224:227], v[96:99], v[44:47]
ds_read_b128 v[88:91], v2 offset:8192
ds_read_b128 v[92:95], v2 offset:9216
v_mfma_f32_16x16x32_bf16 v[52:55], a[228:231], v[96:99], v[52:55]
buffer_load_dwordx4 v1, s[4:7], s29 offen offset:1024 sc1 lds
v_mfma_f32_16x16x32_bf16 v[40:43], a[220:223], v[100:103], v[40:43]
v_mfma_f32_16x16x32_bf16 v[48:51], a[224:227], v[100:103], v[48:51]
v_mfma_f32_16x16x32_bf16 v[56:59], a[228:231], v[100:103], v[56:59]
s_waitcnt lgkmcnt(4)
v_mfma_f32_16x16x32_bf16 v[36:39], a[232:235], v[72:75], v[36:39]
ds_read_b128 v[96:99], v2 offset:10240
ds_read_b128 v[100:103], v2 offset:11264
v_mfma_f32_16x16x32_bf16 v[44:47], a[236:239], v[72:75], v[44:47]
s_add_u32 s28, s26, 39936
buffer_load_dwordx4 a[156:159], v1, s[4:7], s28 offen sc1
v_mfma_f32_16x16x32_bf16 v[52:55], a[240:243], v[72:75], v[52:55]
v_mfma_f32_16x16x32_bf16 v[40:43], a[232:235], v[76:79], v[40:43]
s_add_u32 s14, s28, s88
buffer_load_dwordx4 a[160:163], v1, s[4:7], s14 offen sc1
v_mfma_f32_16x16x32_bf16 v[48:51], a[236:239], v[76:79], v[48:51]
v_mfma_f32_16x16x32_bf16 v[56:59], a[240:243], v[76:79], v[56:59]
s_add_u32 s14, s28, s89
s_waitcnt lgkmcnt(4)
v_mfma_f32_16x16x32_bf16 v[36:39], a[244:247], v[80:83], v[36:39]
ds_read_b128 v[72:75], v2 offset:12288
ds_read_b128 v[76:79], v2 offset:13312
v_mfma_f32_16x16x32_bf16 v[44:47], a[248:251], v[80:83], v[44:47]
buffer_load_dwordx4 a[164:167], v1, s[4:7], s14 offen sc1
v_mfma_f32_16x16x32_bf16 v[52:55], a[252:255], v[80:83], v[52:55]
v_mfma_f32_16x16x32_bf16 v[40:43], a[244:247], v[84:87], v[40:43]
s_add_u32 s28, s26, 43008
buffer_load_dwordx4 a[168:171], v1, s[4:7], s28 offen sc1
v_mfma_f32_16x16x32_bf16 v[48:51], a[248:251], v[84:87], v[48:51]
v_mfma_f32_16x16x32_bf16 v[56:59], a[252:255], v[84:87], v[56:59]
s_add_u32 s14, s28, s88
s_waitcnt lgkmcnt(4)
v_mfma_f32_16x16x32_bf16 v[36:39], v[128:131], v[88:91], v[36:39]
ds_read_b128 v[80:83], v2 offset:14336
ds_read_b128 v[84:87], v2 offset:15360
v_mfma_f32_16x16x32_bf16 v[44:47], v[132:135], v[88:91], v[44:47]
buffer_load_dwordx4 a[172:175], v1, s[4:7], s14 offen sc1
s_waitcnt vmcnt(9)
v_mfma_f32_16x16x32_bf16 v[52:55], v[136:139], v[88:91], v[52:55]
v_add_f32 v120, v120, v122
v_add_f32 v124, v124, v126
v_mfma_f32_16x16x32_bf16 v[40:43], v[128:131], v[92:95], v[40:43]
s_add_u32 s14, s28, s89
buffer_load_dwordx4 a[176:179], v1, s[4:7], s14 offen sc1
v_mfma_f32_16x16x32_bf16 v[48:51], v[132:135], v[92:95], v[48:51]
v_add_f32 v121, v121, v123
v_add_f32 v125, v125, v127
v_mfma_f32_16x16x32_bf16 v[56:59], v[136:139], v[92:95], v[56:59]
s_add_u32 s28, s26, 46080
s_waitcnt lgkmcnt(4)
v_mfma_f32_16x16x32_bf16 v[36:39], v[140:143], v[96:99], v[36:39]
buffer_load_dwordx4 a[180:183], v1, s[4:7], s28 offen sc1
v_add_f32 v120, v120, v124
v_add_f32 v121, v121, v125
v_add_u32 v122, s52, v5
s_nop 0
v_permlane32_swap_b32 v120, v121
v_add_f32 v120, v120, v121
s_add_u32 s14, s28, s88
buffer_load_dwordx4 a[184:187], v1, s[4:7], s14 offen sc1
v_mov_b32 v121, v120
s_nop 1
v_permlane16_swap_b32 v120, v121
v_add_f32 v120, v120, v121
v_mov_b32 v121, v120
s_nop 1
v_permlane32_swap_b32 v120, v121
v_mul_f32 v120, 0x3b000000, v120
s_add_u32 s14, s28, s89
buffer_load_dwordx4 a[188:191], v1, s[4:7], s14 offen sc1
v_mul_f32 v121, 0x3b000000, v121
v_fma_f32 v121, -v120, v120, v121
v_max_f32 v121, 0, v121
v_add_f32 v121, 0x3727c5ac, v121
v_rsq_f32 v121, v121
v_sub_f32 v120, 0, v120
v_mul_f32 v120, v120, v121
ds_write_b32 v122, v121 offset:192
ds_write_b32 v122, v120 offset:512
s_waitcnt vmcnt(9) lgkmcnt(0)
s_barrier
v_mfma_f32_16x16x32_bf16 v[44:47], v[144:147], v[96:99], v[44:47]
ds_read_b128 v[88:91], v2 offset:16384
ds_read_b128 v[92:95], v2 offset:17408
v_mfma_f32_16x16x32_bf16 v[52:55], v[148:151], v[96:99], v[52:55]
v_mfma_f32_16x16x32_bf16 v[40:43], v[140:143], v[100:103], v[40:43]
v_mfma_f32_16x16x32_bf16 v[48:51], v[144:147], v[100:103], v[48:51]
v_mfma_f32_16x16x32_bf16 v[56:59], v[148:151], v[100:103], v[56:59]
v_mfma_f32_16x16x32_bf16 v[36:39], v[152:155], v[72:75], v[36:39]
ds_read_b128 v[96:99], v2 offset:18432
ds_read_b128 v[100:103], v2 offset:19456
v_mfma_f32_16x16x32_bf16 v[44:47], v[156:159], v[72:75], v[44:47]
v_add_u32 v15, 8, v15
buffer_store_dword v15, v13, s[4:7], s45 offen sc1
v_mfma_f32_16x16x32_bf16 v[52:55], v[160:163], v[72:75], v[52:55]
v_mfma_f32_16x16x32_bf16 v[40:43], v[152:155], v[76:79], v[40:43]
v_mfma_f32_16x16x32_bf16 v[48:51], v[156:159], v[76:79], v[48:51]
v_mfma_f32_16x16x32_bf16 v[56:59], v[160:163], v[76:79], v[56:59]
v_mfma_f32_16x16x32_bf16 v[36:39], v[164:167], v[80:83], v[36:39]
ds_read_b128 v[72:75], v2 offset:20480
ds_read_b128 v[76:79], v2 offset:21504
v_mfma_f32_16x16x32_bf16 v[44:47], v[168:171], v[80:83], v[44:47]
v_mfma_f32_16x16x32_bf16 v[52:55], v[172:175], v[80:83], v[52:55]
v_mfma_f32_16x16x32_bf16 v[40:43], v[164:167], v[84:87], v[40:43]
v_mfma_f32_16x16x32_bf16 v[48:51], v[168:171], v[84:87], v[48:51]
v_mfma_f32_16x16x32_bf16 v[56:59], v[172:175], v[84:87], v[56:59]
s_waitcnt lgkmcnt(4)
v_mfma_f32_16x16x32_bf16 v[36:39], a[96:99], v[88:91], v[36:39]
ds_read_b128 v[80:83], v2 offset:22528
ds_read_b128 v[84:87], v2 offset:23552
v_mfma_f32_16x16x32_bf16 v[44:47], a[100:103], v[88:91], v[44:47]
v_mfma_f32_16x16x32_bf16 v[52:55], a[104:107], v[88:91], v[52:55]
v_mfma_f32_16x16x32_bf16 v[40:43], a[96:99], v[92:95], v[40:43]
v_mfma_f32_16x16x32_bf16 v[48:51], a[100:103], v[92:95], v[48:51]
v_mfma_f32_16x16x32_bf16 v[56:59], a[104:107], v[92:95], v[56:59]
s_waitcnt lgkmcnt(4)
v_mfma_f32_16x16x32_bf16 v[36:39], a[108:111], v[96:99], v[36:39]
ds_read_b128 v[88:91], v2 offset:24576
ds_read_b128 v[92:95], v2 offset:25600
v_mfma_f32_16x16x32_bf16 v[44:47], a[112:115], v[96:99], v[44:47]
v_mfma_f32_16x16x32_bf16 v[52:55], a[116:119], v[96:99], v[52:55]
v_mfma_f32_16x16x32_bf16 v[40:43], a[108:111], v[100:103], v[40:43]
v_mfma_f32_16x16x32_bf16 v[48:51], a[112:115], v[100:103], v[48:51]
v_mfma_f32_16x16x32_bf16 v[56:59], a[116:119], v[100:103], v[56:59]
s_waitcnt lgkmcnt(4)
v_mfma_f32_16x16x32_bf16 v[36:39], a[120:123], v[72:75], v[36:39]
ds_read_b128 v[96:99], v2 offset:26624
ds_read_b128 v[100:103], v2 offset:27648
v_mfma_f32_16x16x32_bf16 v[44:47], a[124:127], v[72:75], v[44:47]
v_mfma_f32_16x16x32_bf16 v[52:55], a[128:131], v[72:75], v[52:55]
v_mfma_f32_16x16x32_bf16 v[40:43], a[120:123], v[76:79], v[40:43]
v_mfma_f32_16x16x32_bf16 v[48:51], a[124:127], v[76:79], v[48:51]
v_mfma_f32_16x16x32_bf16 v[56:59], a[128:131], v[76:79], v[56:59]
s_waitcnt lgkmcnt(4)
v_mfma_f32_16x16x32_bf16 v[36:39], a[132:135], v[80:83], v[36:39]
ds_read_b128 v[72:75], v2 offset:28672
ds_read_b128 v[76:79], v2 offset:29696
v_mfma_f32_16x16x32_bf16 v[44:47], a[136:139], v[80:83], v[44:47]
buffer_load_dword v17, v4, s[4:7], s92 offen sc1
v_mfma_f32_16x16x32_bf16 v[52:55], a[140:143], v[80:83], v[52:55]
v_mfma_f32_16x16x32_bf16 v[40:43], a[132:135], v[84:87], v[40:43]
v_mfma_f32_16x16x32_bf16 v[48:51], a[136:139], v[84:87], v[48:51]
v_mfma_f32_16x16x32_bf16 v[56:59], a[140:143], v[84:87], v[56:59]
s_waitcnt lgkmcnt(4)
v_mfma_f32_16x16x32_bf16 v[36:39], a[144:147], v[88:91], v[36:39]
ds_read_b128 v[80:83], v2 offset:30720
ds_read_b128 v[84:87], v2 offset:31744
v_mfma_f32_16x16x32_bf16 v[44:47], a[148:151], v[88:91], v[44:47]
v_mfma_f32_16x16x32_bf16 v[52:55], a[152:155], v[88:91], v[52:55]
v_mfma_f32_16x16x32_bf16 v[40:43], a[144:147], v[92:95], v[40:43]
v_mfma_f32_16x16x32_bf16 v[48:51], a[148:151], v[92:95], v[48:51]
v_mfma_f32_16x16x32_bf16 v[56:59], a[152:155], v[92:95], v[56:59]
s_waitcnt vmcnt(8) lgkmcnt(4)
v_mfma_f32_16x16x32_bf16 v[36:39], a[156:159], v[96:99], v[36:39]
v_mfma_f32_16x16x32_bf16 v[44:47], a[160:163], v[96:99], v[44:47]
v_mfma_f32_16x16x32_bf16 v[52:55], a[164:167], v[96:99], v[52:55]
v_mfma_f32_16x16x32_bf16 v[40:43], a[156:159], v[100:103], v[40:43]
v_mfma_f32_16x16x32_bf16 v[48:51], a[160:163], v[100:103], v[48:51]
v_mfma_f32_16x16x32_bf16 v[56:59], a[164:167], v[100:103], v[56:59]
s_waitcnt vmcnt(5) lgkmcnt(2)
v_mfma_f32_16x16x32_bf16 v[36:39], a[168:171], v[72:75], v[36:39]
v_mov_b32 v116, s36
v_mov_b32 v117, s37
v_mfma_f32_16x16x32_bf16 v[44:47], a[172:175], v[72:75], v[44:47]
ds_read2_b32 v[68:69], v5 offset0:48 offset1:128
ds_read2_b32 v[70:71], v5 offset0:64 offset1:144
v_mfma_f32_16x16x32_bf16 v[52:55], a[176:179], v[72:75], v[52:55]
ds_read_b128 v[104:107], v6 offset:256
ds_read_b128 v[88:91], v6 offset:512
v_mfma_f32_16x16x32_bf16 v[40:43], a[168:171], v[76:79], v[40:43]
ds_read_b128 v[108:111], v6 offset:320
ds_read_b128 v[92:95], v6 offset:576
v_mfma_f32_16x16x32_bf16 v[48:51], a[172:175], v[76:79], v[48:51]
ds_read_b128 v[112:115], v6 offset:384
ds_read_b128 v[96:99], v6 offset:640
v_mfma_f32_16x16x32_bf16 v[56:59], a[176:179], v[76:79], v[56:59]
s_waitcnt vmcnt(2) lgkmcnt(8)
v_mfma_f32_16x16x32_bf16 v[36:39], a[180:183], v[80:83], v[36:39]
s_add_u32 s44, s32, 14
s_waitcnt vmcnt(0)
v_lshrrev_b32 v17, 3, v17
v_mfma_f32_16x16x32_bf16 v[44:47], a[184:187], v[80:83], v[44:47]
v_subrev_u32 v17, s44, v17
v_cmp_lt_u32 vcc, 31, v17
s_cbranch_vccnz L_spin_65
L_ok_64:
s_add_u32 s17, s47, s96
v_mfma_f32_16x16x32_bf16 v[52:55], a[188:191], v[80:83], v[52:55]
s_add_u32 m0, s3, 98304
s_add_u32 s29, s17, 0x1408000
v_mfma_f32_16x16x32_bf16 v[40:43], a[180:183], v[84:87], v[40:43]
buffer_load_dwordx4 v1, s[4:7], s29 offen sc1 lds
v_mfma_f32_16x16x32_bf16 v[48:51], a[184:187], v[84:87], v[48:51]
v_mfma_f32_16x16x32_bf16 v[56:59], a[188:191], v[84:87], v[56:59]
s_waitcnt lgkmcnt(0)
v_pk_mul_f32 v[68:69], v[68:69], v[116:117] op_sel:[0,1] op_sel_hi:[1,1]
v_pk_mul_f32 v[70:71], v[70:71], v[116:117] op_sel:[0,1] op_sel_hi:[1,1]
v_pk_fma_f32 v[72:73], v[104:105], v[68:69], v[88:89] op_sel:[0,1,0] op_sel_hi:[1,1,1]
buffer_load_dwordx4 v1, s[4:7], s29 offen offset:1024 sc1 lds
v_pk_fma_f32 v[74:75], v[106:107], v[68:69], v[90:91] op_sel:[0,1,0] op_sel_hi:[1,1,1]
v_pk_fma_f32 v[76:77], v[104:105], v[70:71], v[88:89] op_sel:[0,1,0] op_sel_hi:[1,1,1]
v_pk_fma_f32 v[78:79], v[106:107], v[70:71], v[90:91] op_sel:[0,1,0] op_sel_hi:[1,1,1]
v_pk_fma_f32 v[36:37], v[36:37], v[68:69], v[72:73] op_sel_hi:[1,0,1]
v_pk_fma_f32 v[38:39], v[38:39], v[68:69], v[74:75] op_sel_hi:[1,0,1]
v_pk_fma_f32 v[40:41], v[40:41], v[70:71], v[76:77] op_sel_hi:[1,0,1]
v_pk_fma_f32 v[42:43], v[42:43], v[70:71], v[78:79] op_sel_hi:[1,0,1]
v_pk_fma_f32 v[72:73], v[36:37], v[36:37], v[116:117] op_sel_hi:[1,1,0]
v_pk_fma_f32 v[74:75], v[38:39], v[38:39], v[116:117] op_sel_hi:[1,1,0]
s_add_u32 m0, s3, 106496
s_add_u32 s29, s17, 0x140a000
buffer_load_dwordx4 v1, s[4:7], s29 offen sc1 lds
v_pk_fma_f32 v[76:77], v[40:41], v[40:41], v[116:117] op_sel_hi:[1,1,0]
v_pk_fma_f32 v[78:79], v[42:43], v[42:43], v[116:117] op_sel_hi:[1,1,0]
v_pk_mul_f32 v[72:73], v[72:73], v[36:37] neg_lo:[0,1] neg_hi:[0,1]
v_pk_mul_f32 v[74:75], v[74:75], v[38:39] neg_lo:[0,1] neg_hi:[0,1]
v_pk_mul_f32 v[76:77], v[76:77], v[40:41] neg_lo:[0,1] neg_hi:[0,1]
v_pk_mul_f32 v[78:79], v[78:79], v[42:43] neg_lo:[0,1] neg_hi:[0,1]
v_exp_f32 v80, v72
v_exp_f32 v81, v73
buffer_load_dwordx4 v1, s[4:7], s29 offen offset:1024 sc1 lds
v_exp_f32 v82, v74
v_exp_f32 v83, v75
v_exp_f32 v84, v76
v_exp_f32 v85, v77
v_exp_f32 v86, v78
s_add_u32 m0, s3, 114688
s_add_u32 s29, s17, 0x140c000
buffer_load_dwordx4 v1, s[4:7], s29 offen sc1 lds
v_exp_f32 v87, v79
v_pk_fma_f32 v[80:81], v[80:81], v[116:117], v[116:117] op_sel:[0,1,1] op_sel_hi:[1,1,1]
v_pk_fma_f32 v[82:83], v[82:83], v[116:117], v[116:117] op_sel:[0,1,1] op_sel_hi:[1,1,1]
v_pk_fma_f32 v[84:85], v[84:85], v[116:117], v[116:117] op_sel:[0,1,1] op_sel_hi:[1,1,1]
v_pk_fma_f32 v[86:87], v[86:87], v[116:117], v[116:117] op_sel:[0,1,1] op_sel_hi:[1,1,1]
v_rcp_f32 v80, v80
v_rcp_f32 v81, v81
buffer_load_dwordx4 v1, s[4:7], s29 offen offset:1024 sc1 lds
v_rcp_f32 v82, v82
v_rcp_f32 v83, v83
v_rcp_f32 v84, v84
v_rcp_f32 v85, v85
v_rcp_f32 v86, v86
s_add_u32 m0, s3, 122880
s_add_u32 s29, s17, 0x140e000
buffer_load_dwordx4 v1, s[4:7], s29 offen sc1 lds
v_rcp_f32 v87, v87
s_add_u32 s15, s40, s12
v_pk_mul_f32 v[36:37], v[36:37], v[80:81]
v_pk_mul_f32 v[38:39], v[38:39], v[82:83]
v_pk_mul_f32 v[40:41], v[40:41], v[84:85]
v_pk_mul_f32 v[42:43], v[42:43], v[86:87]
s_add_u32 s15, s15, 0x1000000
v_cvt_pk_bf16_f32 v36, v36, v37
v_cvt_pk_bf16_f32 v37, v38, v39
v_cvt_pk_bf16_f32 v38, v40, v41
buffer_load_dwordx4 v1, s[4:7], s29 offen offset:1024 sc1 lds
v_cvt_pk_bf16_f32 v39, v42, v43
v_permlane32_swap_b32 v36, v38
s_nop 0
v_permlane32_swap_b32 v37, v39
buffer_store_dwordx4 v[36:39], v3, s[4:7], s15 offen sc1
v_pk_fma_f32 v[72:73], v[108:109], v[68:69], v[92:93] op_sel:[0,1,0] op_sel_hi:[1,1,1]
v_pk_fma_f32 v[74:75], v[110:111], v[68:69], v[94:95] op_sel:[0,1,0] op_sel_hi:[1,1,1]
v_pk_fma_f32 v[76:77], v[108:109], v[70:71], v[92:93] op_sel:[0,1,0] op_sel_hi:[1,1,1]
v_pk_fma_f32 v[78:79], v[110:111], v[70:71], v[94:95] op_sel:[0,1,0] op_sel_hi:[1,1,1]
v_pk_fma_f32 v[44:45], v[44:45], v[68:69], v[72:73] op_sel_hi:[1,0,1]
v_pk_fma_f32 v[46:47], v[46:47], v[68:69], v[74:75] op_sel_hi:[1,0,1]
v_pk_fma_f32 v[48:49], v[48:49], v[70:71], v[76:77] op_sel_hi:[1,0,1]
v_pk_fma_f32 v[50:51], v[50:51], v[70:71], v[78:79] op_sel_hi:[1,0,1]
v_pk_fma_f32 v[72:73], v[44:45], v[44:45], v[116:117] op_sel_hi:[1,1,0]
s_add_u32 s46, s13, 0x1d41000
buffer_load_dwordx2 v[120:121], v14, s[4:7], s46 offen sc1
buffer_load_dwordx2 v[122:123], v14, s[4:7], s46 offen offset:256 sc1
v_pk_fma_f32 v[74:75], v[46:47], v[46:47], v[116:117] op_sel_hi:[1,1,0]
v_pk_fma_f32 v[76:77], v[48:49], v[48:49], v[116:117] op_sel_hi:[1,1,0]
v_pk_fma_f32 v[78:79], v[50:51], v[50:51], v[116:117] op_sel_hi:[1,1,0]
v_pk_mul_f32 v[72:73], v[72:73], v[44:45] neg_lo:[0,1] neg_hi:[0,1]
v_pk_mul_f32 v[74:75], v[74:75], v[46:47] neg_lo:[0,1] neg_hi:[0,1]
v_pk_mul_f32 v[76:77], v[76:77], v[48:49] neg_lo:[0,1] neg_hi:[0,1]
v_pk_mul_f32 v[78:79], v[78:79], v[50:51] neg_lo:[0,1] neg_hi:[0,1]
v_exp_f32 v80, v72
s_add_u32 s46, s13, 0x1d41000
buffer_load_dwordx2 v[124:125], v14, s[4:7], s46 offen offset:512 sc1
buffer_load_dwordx2 v[126:127], v14, s[4:7], s46 offen offset:768 sc1
v_exp_f32 v81, v73
v_exp_f32 v82, v74
v_exp_f32 v83, v75
v_exp_f32 v84, v76
v_exp_f32 v85, v77
v_exp_f32 v86, v78
v_exp_f32 v87, v79
v_pk_fma_f32 v[80:81], v[80:81], v[116:117], v[116:117] op_sel:[0,1,1] op_sel_hi:[1,1,1]
v_pk_fma_f32 v[82:83], v[82:83], v[116:117], v[116:117] op_sel:[0,1,1] op_sel_hi:[1,1,1]
v_pk_fma_f32 v[84:85], v[84:85], v[116:117], v[116:117] op_sel:[0,1,1] op_sel_hi:[1,1,1]
v_pk_fma_f32 v[86:87], v[86:87], v[116:117], v[116:117] op_sel:[0,1,1] op_sel_hi:[1,1,1]
v_rcp_f32 v80, v80
v_rcp_f32 v81, v81
v_rcp_f32 v82, v82
v_rcp_f32 v83, v83
v_rcp_f32 v84, v84
v_rcp_f32 v85, v85
v_rcp_f32 v86, v86
v_rcp_f32 v87, v87
s_add_u32 s15, s41, s12
v_pk_mul_f32 v[44:45], v[44:45], v[80:81]
v_pk_mul_f32 v[46:47], v[46:47], v[82:83]
v_pk_mul_f32 v[48:49], v[48:49], v[84:85]
v_pk_mul_f32 v[50:51], v[50:51], v[86:87]
s_add_u32 s15, s15, 0x1000000
v_cvt_pk_bf16_f32 v44, v44, v45
v_cvt_pk_bf16_f32 v45, v46, v47
v_cvt_pk_bf16_f32 v46, v48, v49
v_cvt_pk_bf16_f32 v47, v50, v51
s_nop 0
v_permlane32_swap_b32 v44, v46
v_permlane32_swap_b32 v45, v47
buffer_store_dwordx4 v[44:47], v3, s[4:7], s15 offen sc1
v_pk_fma_f32 v[72:73], v[112:113], v[68:69], v[96:97] op_sel:[0,1,0] op_sel_hi:[1,1,1]
v_pk_fma_f32 v[74:75], v[114:115], v[68:69], v[98:99] op_sel:[0,1,0] op_sel_hi:[1,1,1]
v_pk_fma_f32 v[76:77], v[112:113], v[70:71], v[96:97] op_sel:[0,1,0] op_sel_hi:[1,1,1]
v_pk_fma_f32 v[78:79], v[114:115], v[70:71], v[98:99] op_sel:[0,1,0] op_sel_hi:[1,1,1]
v_pk_fma_f32 v[52:53], v[52:53], v[68:69], v[72:73] op_sel_hi:[1,0,1]
v_pk_fma_f32 v[54:55], v[54:55], v[68:69], v[74:75] op_sel_hi:[1,0,1]
v_pk_fma_f32 v[56:57], v[56:57], v[70:71], v[76:77] op_sel_hi:[1,0,1]
v_pk_fma_f32 v[58:59], v[58:59], v[70:71], v[78:79] op_sel_hi:[1,0,1]
v_pk_fma_f32 v[72:73], v[52:53], v[52:53], v[116:117] op_sel_hi:[1,1,0]
v_pk_fma_f32 v[74:75], v[54:55], v[54:55], v[116:117] op_sel_hi:[1,1,0]
v_pk_fma_f32 v[76:77], v[56:57], v[56:57], v[116:117] op_sel_hi:[1,1,0]
v_pk_fma_f32 v[78:79], v[58:59], v[58:59], v[116:117] op_sel_hi:[1,1,0]
v_pk_mul_f32 v[72:73], v[72:73], v[52:53] neg_lo:[0,1] neg_hi:[0,1]
v_pk_mul_f32 v[74:75], v[74:75], v[54:55] neg_lo:[0,1] neg_hi:[0,1]
v_pk_mul_f32 v[76:77], v[76:77], v[56:57] neg_lo:[0,1] neg_hi:[0,1]
v_pk_mul_f32 v[78:79], v[78:79], v[58:59] neg_lo:[0,1] neg_hi:[0,1]
v_exp_f32 v80, v72
v_exp_f32 v81, v73
v_exp_f32 v82, v74
v_exp_f32 v83, v75
v_exp_f32 v84, v76
v_exp_f32 v85, v77
v_exp_f32 v86, v78
v_exp_f32 v87, v79
v_pk_fma_f32 v[80:81], v[80:81], v[116:117], v[116:117] op_sel:[0,1,1] op_sel_hi:[1,1,1]
v_pk_fma_f32 v[82:83], v[82:83], v[116:117], v[116:117] op_sel:[0,1,1] op_sel_hi:[1,1,1]
v_pk_fma_f32 v[84:85], v[84:85], v[116:117], v[116:117] op_sel:[0,1,1] op_sel_hi:[1,1,1]
v_pk_fma_f32 v[86:87], v[86:87], v[116:117], v[116:117] op_sel:[0,1,1] op_sel_hi:[1,1,1]
s_waitcnt vmcnt(6)
s_barrier
ds_read_b128 v[88:91], v2 offset:49152
ds_read_b128 v[92:95], v2 offset:50176
ds_read_b128 v[96:99], v2 offset:51200
ds_read_b128 v[100:103], v2 offset:52224
v_rcp_f32 v80, v80
v_rcp_f32 v81, v81
v_rcp_f32 v82, v82
v_rcp_f32 v83, v83
v_rcp_f32 v84, v84
v_rcp_f32 v85, v85
v_rcp_f32 v86, v86
v_rcp_f32 v87, v87
s_add_u32 s15, s42, s12
v_pk_mul_f32 v[52:53], v[52:53], v[80:81]
v_pk_mul_f32 v[54:55], v[54:55], v[82:83]
v_pk_mul_f32 v[56:57], v[56:57], v[84:85]
v_pk_mul_f32 v[58:59], v[58:59], v[86:87]
s_add_u32 s15, s15, 0x1000000
v_cvt_pk_bf16_f32 v52, v52, v53
v_cvt_pk_bf16_f32 v53, v54, v55
v_cvt_pk_bf16_f32 v54, v56, v57
v_cvt_pk_bf16_f32 v55, v58, v59
s_nop 0
v_permlane32_swap_b32 v52, v54
v_permlane32_swap_b32 v53, v55
buffer_store_dwordx4 v[52:55], v3, s[4:7], s15 offen sc1
ds_read_b128 v[72:75], v2 offset:53248
ds_read_b128 v[76:79], v2 offset:54272
s_waitcnt lgkmcnt(4)
v_mfma_f32_16x16x32_bf16 v[36:39], a[96:99], v[88:91], 0
ds_read_b128 v[80:83], v2 offset:55296
ds_read_b128 v[84:87], v2 offset:56320
v_mfma_f32_16x16x32_bf16 v[44:47], a[100:103], v[88:91], 0
v_mfma_f32_16x16x32_bf16 v[52:55], a[104:107], v[88:91], 0
v_mfma_f32_16x16x32_bf16 v[40:43], a[96:99], v[92:95], 0
v_mfma_f32_16x16x32_bf16 v[48:51], a[100:103], v[92:95], 0
v_mfma_f32_16x16x32_bf16 v[56:59], a[104:107], v[92:95], 0
s_waitcnt lgkmcnt(4)
v_mfma_f32_16x16x32_bf16 v[36:39], a[108:111], v[96:99], v[36:39]
ds_read_b128 v[88:91], v2 offset:57344
ds_read_b128 v[92:95], v2 offset:58368
v_mfma_f32_16x16x32_bf16 v[44:47], a[112:115], v[96:99], v[44:47]
s_add_u32 s28, s27, 20480
buffer_load_dwordx4 a[96:99], v1, s[4:7], s28 offen sc1
v_mfma_f32_16x16x32_bf16 v[52:55], a[116:119], v[96:99], v[52:55]
v_add_u32 v15, 8, v15
buffer_load_dwordx4 a[100:103], v1, s[4:7], s28 offen offset:1024 sc1
buffer_load_dwordx4 a[104:107], v1, s[4:7], s28 offen offset:2048 sc1
s_waitcnt vmcnt(3)
v_mfma_f32_16x16x32_bf16 v[40:43], a[108:111], v[100:103], v[40:43]
buffer_store_dword v15, v13, s[4:7], s45 offen sc1
v_mfma_f32_16x16x32_bf16 v[48:51], a[112:115], v[100:103], v[48:51]
v_mfma_f32_16x16x32_bf16 v[56:59], a[116:119], v[100:103], v[56:59]
s_waitcnt lgkmcnt(4)
v_mfma_f32_16x16x32_bf16 v[36:39], a[120:123], v[72:75], v[36:39]
ds_read_b128 v[96:99], v2 offset:59392
ds_read_b128 v[100:103], v2 offset:60416
v_mfma_f32_16x16x32_bf16 v[44:47], a[124:127], v[72:75], v[44:47]
buffer_load_dwordx4 a[108:111], v1, s[4:7], s28 offen offset:3072 sc1
v_mfma_f32_16x16x32_bf16 v[52:55], a[128:131], v[72:75], v[52:55]
v_mfma_f32_16x16x32_bf16 v[40:43], a[120:123], v[76:79], v[40:43]
v_mfma_f32_16x16x32_bf16 v[48:51], a[124:127], v[76:79], v[48:51]
v_mfma_f32_16x16x32_bf16 v[56:59], a[128:131], v[76:79], v[56:59]
s_add_u32 s28, s27, 24576
s_waitcnt lgkmcnt(4)
v_mfma_f32_16x16x32_bf16 v[36:39], a[132:135], v[80:83], v[36:39]
ds_read_b128 v[72:75], v2 offset:61440
ds_read_b128 v[76:79], v2 offset:62464
v_mfma_f32_16x16x32_bf16 v[44:47], a[136:139], v[80:83], v[44:47]
buffer_load_dwordx4 a[112:115], v1, s[4:7], s28 offen sc1
v_mfma_f32_16x16x32_bf16 v[52:55], a[140:143], v[80:83], v[52:55]
v_mfma_f32_16x16x32_bf16 v[40:43], a[132:135], v[84:87], v[40:43]
v_mfma_f32_16x16x32_bf16 v[48:51], a[136:139], v[84:87], v[48:51]
v_mfma_f32_16x16x32_bf16 v[56:59], a[140:143], v[84:87], v[56:59]
buffer_load_dwordx4 a[116:119], v1, s[4:7], s28 offen offset:1024 sc1
s_waitcnt lgkmcnt(4)
v_mfma_f32_16x16x32_bf16 v[36:39], a[144:147], v[88:91], v[36:39]
ds_read_b128 v[80:83], v2 offset:63488
ds_read_b128 v[84:87], v2 offset:64512
v_mfma_f32_16x16x32_bf16 v[44:47], a[148:151], v[88:91], v[44:47]
v_mfma_f32_16x16x32_bf16 v[52:55], a[152:155], v[88:91], v[52:55]
v_mfma_f32_16x16x32_bf16 v[40:43], a[144:147], v[92:95], v[40:43]
buffer_load_dwordx4 a[120:123], v1, s[4:7], s28 offen offset:2048 sc1
v_mfma_f32_16x16x32_bf16 v[48:51], a[148:151], v[92:95], v[48:51]
v_mfma_f32_16x16x32_bf16 v[56:59], a[152:155], v[92:95], v[56:59]
s_waitcnt lgkmcnt(4)
v_mfma_f32_16x16x32_bf16 v[36:39], a[156:159], v[96:99], v[36:39]
ds_read_b128 v[88:91], v2 offset:32768
ds_read_b128 v[92:95], v2 offset:33792
v_mfma_f32_16x16x32_bf16 v[44:47], a[160:163], v[96:99], v[44:47]
buffer_load_dwordx4 a[124:127], v1, s[4:7], s28 offen offset:3072 sc1
v_add_f32 v120, v120, v122
v_mfma_f32_16x16x32_bf16 v[52:55], a[164:167], v[96:99], v[52:55]
v_add_f32 v124, v124, v126
v_add_f32 v121, v121, v123
v_mfma_f32_16x16x32_bf16 v[40:43], a[156:159], v[100:103], v[40:43]
v_add_f32 v125, v125, v127
v_add_f32 v120, v120, v124
v_mfma_f32_16x16x32_bf16 v[48:51], a[160:163], v[100:103], v[48:51]
v_add_f32 v121, v121, v125
v_add_u32 v122, s52, v5
v_mfma_f32_16x16x32_bf16 v[56:59], a[164:167], v[100:103], v[56:59]
s_add_u32 s28, s27, 28672
s_waitcnt lgkmcnt(4)
v_mfma_f32_16x16x32_bf16 v[36:39], a[168:171], v[72:75], v[36:39]
ds_read_b128 v[96:99], v2 offset:34816
ds_read_b128 v[100:103], v2 offset:35840
v_mfma_f32_16x16x32_bf16 v[44:47], a[172:175], v[72:75], v[44:47]
buffer_load_dwordx4 a[128:131], v1, s[4:7], s28 offen sc1
s_nop 0
v_mfma_f32_16x16x32_bf16 v[52:55], a[176:179], v[72:75], v[52:55]
v_permlane32_swap_b32 v120, v121
v_mfma_f32_16x16x32_bf16 v[40:43], a[168:171], v[76:79], v[40:43]
v_add_f32 v120, v120, v121
v_mov_b32 v121, v120
v_mfma_f32_16x16x32_bf16 v[48:51], a[172:175], v[76:79], v[48:51]
buffer_load_dword v17, v4, s[4:7], s92 offen sc1
v_mfma_f32_16x16x32_bf16 v[56:59], a[176:179], v[76:79], v[56:59]
s_waitcnt lgkmcnt(4)
v_mfma_f32_16x16x32_bf16 v[36:39], a[180:183], v[80:83], v[36:39]
ds_read_b128 v[72:75], v2 offset:36864
ds_read_b128 v[76:79], v2 offset:37888
v_mfma_f32_16x16x32_bf16 v[44:47], a[184:187], v[80:83], v[44:47]
v_permlane16_swap_b32 v120, v121
v_mfma_f32_16x16x32_bf16 v[52:55], a[188:191], v[80:83], v[52:55]
buffer_load_dwordx4 a[132:135], v1, s[4:7], s28 offen offset:1024 sc1
v_add_f32 v120, v120, v121
v_mfma_f32_16x16x32_bf16 v[40:43], a[180:183], v[84:87], v[40:43]
v_mov_b32 v121, v120
v_mfma_f32_16x16x32_bf16 v[48:51], a[184:187], v[84:87], v[48:51]
s_nop 0
v_permlane32_swap_b32 v120, v121
v_mfma_f32_16x16x32_bf16 v[56:59], a[188:191], v[84:87], v[56:59]
v_mul_f32 v120, 0x3b000000, v120
s_waitcnt lgkmcnt(4)
v_mfma_f32_16x16x32_bf16 v[36:39], a[208:211], v[88:91], v[36:39]
ds_read_b128 v[80:83], v2 offset:38912
ds_read_b128 v[84:87], v2 offset:39936
v_mfma_f32_16x16x32_bf16 v[44:47], a[212:215], v[88:91], v[44:47]
buffer_load_dwordx4 a[136:139], v1, s[4:7], s28 offen offset:2048 sc1
v_mul_f32 v121, 0x3b000000, v121
v_mfma_f32_16x16x32_bf16 v[52:55], a[216:219], v[88:91], v[52:55]
v_fma_f32 v121, -v120, v120, v121
v_max_f32 v121, 0, v121
v_mfma_f32_16x16x32_bf16 v[40:43], a[208:211], v[92:95], v[40:43]
v_add_f32 v121, 0x3727c5ac, v121
v_mfma_f32_16x16x32_bf16 v[48:51], a[212:215], v[92:95], v[48:51]
v_rsq_f32 v121, v121
v_mfma_f32_16x16x32_bf16 v[56:59], a[216:219], v[92:95], v[56:59]
buffer_load_dwordx4 a[140:143], v1, s[4:7], s28 offen offset:3072 sc1
s_waitcnt lgkmcnt(4)
v_mfma_f32_16x16x32_bf16 v[36:39], a[220:223], v[96:99], v[36:39]
ds_read_b128 v[88:91], v2 offset:40960
ds_read_b128 v[92:95], v2 offset:41984
v_mfma_f32_16x16x32_bf16 v[44:47], a[224:227], v[96:99], v[44:47]
v_sub_f32 v120, 0, v120
v_mul_f32 v120, v120, v121
v_mfma_f32_16x16x32_bf16 v[52:55], a[228:231], v[96:99], v[52:55]
ds_write_b32 v122, v121 offset:64
ds_write_b32 v122, v120 offset:384
v_mfma_f32_16x16x32_bf16 v[40:43], a[220:223], v[100:103], v[40:43]
s_add_u32 s28, s27, 32768
buffer_load_dwordx4 a[144:147], v1, s[4:7], s28 offen sc1
v_mfma_f32_16x16x32_bf16 v[48:51], a[224:227], v[100:103], v[48:51]
s_waitcnt lgkmcnt(0)
s_barrier
v_mfma_f32_16x16x32_bf16 v[56:59], a[228:231], v[100:103], v[56:59]
v_mfma_f32_16x16x32_bf16 v[36:39], a[232:235], v[72:75], v[36:39]
ds_read_b128 v[96:99], v2 offset:43008
ds_read_b128 v[100:103], v2 offset:44032
v_mfma_f32_16x16x32_bf16 v[44:47], a[236:239], v[72:75], v[44:47]
buffer_load_dwordx4 a[148:151], v1, s[4:7], s28 offen offset:1024 sc1
v_mfma_f32_16x16x32_bf16 v[52:55], a[240:243], v[72:75], v[52:55]
v_mfma_f32_16x16x32_bf16 v[40:43], a[232:235], v[76:79], v[40:43]
v_mfma_f32_16x16x32_bf16 v[48:51], a[236:239], v[76:79], v[48:51]
v_mfma_f32_16x16x32_bf16 v[56:59], a[240:243], v[76:79], v[56:59]
buffer_load_dwordx4 a[152:155], v1, s[4:7], s28 offen offset:2048 sc1
v_mfma_f32_16x16x32_bf16 v[36:39], a[244:247], v[80:83], v[36:39]
ds_read_b128 v[72:75], v2 offset:45056
ds_read_b128 v[76:79], v2 offset:46080
v_mfma_f32_16x16x32_bf16 v[44:47], a[248:251], v[80:83], v[44:47]
v_mfma_f32_16x16x32_bf16 v[52:55], a[252:255], v[80:83], v[52:55]
v_mfma_f32_16x16x32_bf16 v[40:43], a[244:247], v[84:87], v[40:43]
buffer_load_dwordx4 a[156:159], v1, s[4:7], s28 offen offset:3072 sc1
v_mfma_f32_16x16x32_bf16 v[48:51], a[248:251], v[84:87], v[48:51]
v_mfma_f32_16x16x32_bf16 v[56:59], a[252:255], v[84:87], v[56:59]
v_mfma_f32_16x16x32_bf16 v[36:39], v[128:131], v[88:91], v[36:39]
ds_read_b128 v[80:83], v2 offset:47104
ds_read_b128 v[84:87], v2 offset:48128
v_mfma_f32_16x16x32_bf16 v[44:47], v[132:135], v[88:91], v[44:47]
s_add_u32 s28, s27, 36864
buffer_load_dwordx4 a[160:163], v1, s[4:7], s28 offen sc1
v_mfma_f32_16x16x32_bf16 v[52:55], v[136:139], v[88:91], v[52:55]
v_mfma_f32_16x16x32_bf16 v[40:43], v[128:131], v[92:95], v[40:43]
v_mfma_f32_16x16x32_bf16 v[48:51], v[132:135], v[92:95], v[48:51]
v_mfma_f32_16x16x32_bf16 v[56:59], v[136:139], v[92:95], v[56:59]
buffer_load_dwordx4 a[164:167], v1, s[4:7], s28 offen offset:1024 sc1
s_waitcnt lgkmcnt(4)
v_mfma_f32_16x16x32_bf16 v[36:39], v[140:143], v[96:99], v[36:39]
v_mfma_f32_16x16x32_bf16 v[44:47], v[144:147], v[96:99], v[44:47]
v_mfma_f32_16x16x32_bf16 v[52:55], v[148:151], v[96:99], v[52:55]
v_mfma_f32_16x16x32_bf16 v[40:43], v[140:143], v[100:103], v[40:43]
buffer_load_dwordx4 a[168:171], v1, s[4:7], s28 offen offset:2048 sc1
v_mfma_f32_16x16x32_bf16 v[48:51], v[144:147], v[100:103], v[48:51]
v_mfma_f32_16x16x32_bf16 v[56:59], v[148:151], v[100:103], v[56:59]
s_waitcnt lgkmcnt(2)
v_mfma_f32_16x16x32_bf16 v[36:39], v[152:155], v[72:75], v[36:39]
v_mov_b32 v116, s36
v_mov_b32 v117, s37
v_mfma_f32_16x16x32_bf16 v[44:47], v[156:159], v[72:75], v[44:47]
buffer_load_dwordx4 a[172:175], v1, s[4:7], s28 offen offset:3072 sc1
ds_read2_b32 v[68:69], v5 offset0:16 offset1:96
v_mfma_f32_16x16x32_bf16 v[52:55], v[160:163], v[72:75], v[52:55]
ds_read2_b32 v[70:71], v5 offset0:32 offset1:112
ds_read_b128 v[104:107], v6 offset:256
v_mfma_f32_16x16x32_bf16 v[40:43], v[152:155], v[76:79], v[40:43]
ds_read_b128 v[88:91], v6 offset:512
ds_read_b128 v[108:111], v6 offset:320
v_mfma_f32_16x16x32_bf16 v[48:51], v[156:159], v[76:79], v[48:51]
ds_read_b128 v[92:95], v6 offset:576
ds_read_b128 v[112:115], v6 offset:384
v_mfma_f32_16x16x32_bf16 v[56:59], v[160:163], v[76:79], v[56:59]
s_add_u32 s28, s27, 40960
s_waitcnt lgkmcnt(7)
v_mfma_f32_16x16x32_bf16 v[36:39], v[164:167], v[80:83], v[36:39]
buffer_load_dwordx4 a[176:179], v1, s[4:7], s28 offen sc1
ds_read_b128 v[96:99], v6 offset:640
v_mfma_f32_16x16x32_bf16 v[44:47], v[168:171], v[80:83], v[44:47]
v_mfma_f32_16x16x32_bf16 v[52:55], v[172:175], v[80:83], v[52:55]
v_mfma_f32_16x16x32_bf16 v[40:43], v[164:167], v[84:87], v[40:43]
v_mfma_f32_16x16x32_bf16 v[48:51], v[168:171], v[84:87], v[48:51]
buffer_load_dwordx4 a[180:183], v1, s[4:7], s28 offen offset:1024 sc1
v_mfma_f32_16x16x32_bf16 v[56:59], v[172:175], v[84:87], v[56:59]
buffer_load_dwordx4 a[184:187], v1, s[4:7], s28 offen offset:2048 sc1
s_waitcnt lgkmcnt(0)
v_pk_mul_f32 v[68:69], v[68:69], v[116:117] op_sel:[0,1] op_sel_hi:[1,1]
v_pk_mul_f32 v[70:71], v[70:71], v[116:117] op_sel:[0,1] op_sel_hi:[1,1]
s_add_u32 s46, s32, 15
buffer_load_dwordx4 a[188:191], v1, s[4:7], s28 offen offset:3072 sc1
s_waitcnt vmcnt(15)
v_lshrrev_b32 v17, 3, v17
v_subrev_u32 v17, s46, v17
v_cmp_lt_u32 vcc, 31, v17
s_cbranch_vccnz L_spin_67
L_ok_66:
s_add_u32 s17, s12, s19
v_pk_fma_f32 v[72:73], v[104:105], v[68:69], v[88:89] op_sel:[0,1,0] op_sel_hi:[1,1,1]
v_pk_fma_f32 v[74:75], v[106:107], v[68:69], v[90:91] op_sel:[0,1,0] op_sel_hi:[1,1,1]
v_pk_fma_f32 v[76:77], v[104:105], v[70:71], v[88:89] op_sel:[0,1,0] op_sel_hi:[1,1,1]
v_pk_fma_f32 v[78:79], v[106:107], v[70:71], v[90:91] op_sel:[0,1,0] op_sel_hi:[1,1,1]
v_pk_fma_f32 v[36:37], v[36:37], v[68:69], v[72:73] op_sel_hi:[1,0,1]
v_pk_fma_f32 v[38:39], v[38:39], v[68:69], v[74:75] op_sel_hi:[1,0,1]
v_pk_fma_f32 v[40:41], v[40:41], v[70:71], v[76:77] op_sel_hi:[1,0,1]
v_pk_fma_f32 v[42:43], v[42:43], v[70:71], v[78:79] op_sel_hi:[1,0,1]
v_pk_fma_f32 v[72:73], v[36:37], v[36:37], v[116:117] op_sel_hi:[1,1,0]
s_add_u32 m0, s2, 0
s_add_u32 s29, s17, 0x1000000
buffer_load_dwordx4 v1, s[4:7], s29 offen sc1 lds
v_pk_fma_f32 v[74:75], v[38:39], v[38:39], v[116:117] op_sel_hi:[1,1,0]
v_pk_fma_f32 v[76:77], v[40:41], v[40:41], v[116:117] op_sel_hi:[1,1,0]
v_pk_fma_f32 v[78:79], v[42:43], v[42:43], v[116:117] op_sel_hi:[1,1,0]
v_pk_mul_f32 v[72:73], v[72:73], v[36:37] neg_lo:[0,1] neg_hi:[0,1]
v_pk_mul_f32 v[74:75], v[74:75], v[38:39] neg_lo:[0,1] neg_hi:[0,1]
v_pk_mul_f32 v[76:77], v[76:77], v[40:41] neg_lo:[0,1] neg_hi:[0,1]
v_pk_mul_f32 v[78:79], v[78:79], v[42:43] neg_lo:[0,1] neg_hi:[0,1]
v_exp_f32 v80, v72
buffer_load_dwordx4 v1, s[4:7], s29 offen offset:1024 sc1 lds
v_exp_f32 v81, v73
v_exp_f32 v82, v74
v_exp_f32 v83, v75
v_exp_f32 v84, v76
v_exp_f32 v85, v77
s_add_u32 m0, s2, 8192
s_add_u32 s29, s17, 0x1001000
buffer_load_dwordx4 v1, s[4:7], s29 offen sc1 lds
v_exp_f32 v86, v78
v_exp_f32 v87, v79
v_pk_fma_f32 v[80:81], v[80:81], v[116:117], v[116:117] op_sel:[0,1,1] op_sel_hi:[1,1,1]
v_pk_fma_f32 v[82:83], v[82:83], v[116:117], v[116:117] op_sel:[0,1,1] op_sel_hi:[1,1,1]
v_pk_fma_f32 v[84:85], v[84:85], v[116:117], v[116:117] op_sel:[0,1,1] op_sel_hi:[1,1,1]
v_pk_fma_f32 v[86:87], v[86:87], v[116:117], v[116:117] op_sel:[0,1,1] op_sel_hi:[1,1,1]
v_rcp_f32 v80, v80
buffer_load_dwordx4 v1, s[4:7], s29 offen offset:1024 sc1 lds
v_rcp_f32 v81, v81
v_rcp_f32 v82, v82
v_rcp_f32 v83, v83
v_rcp_f32 v84, v84
v_rcp_f32 v85, v85
s_add_u32 m0, s2, 16384
s_add_u32 s29, s17, 0x1002000
buffer_load_dwordx4 v1, s[4:7], s29 offen sc1 lds
v_rcp_f32 v86, v86
v_rcp_f32 v87, v87
s_add_u32 s15, s40, s12
v_pk_mul_f32 v[36:37], v[36:37], v[80:81]
v_pk_mul_f32 v[38:39], v[38:39], v[82:83]
v_pk_mul_f32 v[40:41], v[40:41], v[84:85]
v_pk_mul_f32 v[42:43], v[42:43], v[86:87]
s_add_u32 s15, s15, 0x1016000
v_cvt_pk_bf16_f32 v36, v36, v37
v_cvt_pk_bf16_f32 v37, v38, v39
buffer_load_dwordx4 v1, s[4:7], s29 offen offset:1024 sc1 lds
v_cvt_pk_bf16_f32 v38, v40, v41
v_cvt_pk_bf16_f32 v39, v42, v43
s_nop 0
v_permlane32_swap_b32 v36, v38
v_permlane32_swap_b32 v37, v39
buffer_store_dwordx4 v[36:39], v3, s[4:7], s15 offen sc1
v_pk_fma_f32 v[72:73], v[108:109], v[68:69], v[92:93] op_sel:[0,1,0] op_sel_hi:[1,1,1]
v_pk_fma_f32 v[74:75], v[110:111], v[68:69], v[94:95] op_sel:[0,1,0] op_sel_hi:[1,1,1]
v_pk_fma_f32 v[76:77], v[108:109], v[70:71], v[92:93] op_sel:[0,1,0] op_sel_hi:[1,1,1]
v_pk_fma_f32 v[78:79], v[110:111], v[70:71], v[94:95] op_sel:[0,1,0] op_sel_hi:[1,1,1]
v_pk_fma_f32 v[44:45], v[44:45], v[68:69], v[72:73] op_sel_hi:[1,0,1]
v_pk_fma_f32 v[46:47], v[46:47], v[68:69], v[74:75] op_sel_hi:[1,0,1]
v_pk_fma_f32 v[48:49], v[48:49], v[70:71], v[76:77] op_sel_hi:[1,0,1]
v_pk_fma_f32 v[50:51], v[50:51], v[70:71], v[78:79] op_sel_hi:[1,0,1]
v_pk_fma_f32 v[72:73], v[44:45], v[44:45], v[116:117] op_sel_hi:[1,1,0]
s_add_u32 m0, s2, 24576
s_add_u32 s29, s17, 0x1003000
buffer_load_dwordx4 v1, s[4:7], s29 offen sc1 lds
v_pk_fma_f32 v[74:75], v[46:47], v[46:47], v[116:117] op_sel_hi:[1,1,0]
v_pk_fma_f32 v[76:77], v[48:49], v[48:49], v[116:117] op_sel_hi:[1,1,0]
v_pk_fma_f32 v[78:79], v[50:51], v[50:51], v[116:117] op_sel_hi:[1,1,0]
v_pk_mul_f32 v[72:73], v[72:73], v[44:45] neg_lo:[0,1] neg_hi:[0,1]
v_pk_mul_f32 v[74:75], v[74:75], v[46:47] neg_lo:[0,1] neg_hi:[0,1]
v_pk_mul_f32 v[76:77], v[76:77], v[48:49] neg_lo:[0,1] neg_hi:[0,1]
v_pk_mul_f32 v[78:79], v[78:79], v[50:51] neg_lo:[0,1] neg_hi:[0,1]
v_exp_f32 v80, v72
buffer_load_dwordx4 v1, s[4:7], s29 offen offset:1024 sc1 lds
v_exp_f32 v81, v73
v_exp_f32 v82, v74
v_exp_f32 v83, v75
v_exp_f32 v84, v76
v_exp_f32 v85, v77
s_add_u32 m0, s2, 32768
s_add_u32 s29, s17, 0x1004000
buffer_load_dwordx4 v1, s[4:7], s29 offen sc1 lds
v_exp_f32 v86, v78
v_exp_f32 v87, v79
v_pk_fma_f32 v[80:81], v[80:81], v[116:117], v[116:117] op_sel:[0,1,1] op_sel_hi:[1,1,1]
v_pk_fma_f32 v[82:83], v[82:83], v[116:117], v[116:117] op_sel:[0,1,1] op_sel_hi:[1,1,1]
v_pk_fma_f32 v[84:85], v[84:85], v[116:117], v[116:117] op_sel:[0,1,1] op_sel_hi:[1,1,1]
v_pk_fma_f32 v[86:87], v[86:87], v[116:117], v[116:117] op_sel:[0,1,1] op_sel_hi:[1,1,1]
v_rcp_f32 v80, v80
buffer_load_dwordx4 v1, s[4:7], s29 offen offset:1024 sc1 lds
v_rcp_f32 v81, v81
v_rcp_f32 v82, v82
v_rcp_f32 v83, v83
v_rcp_f32 v84, v84
v_rcp_f32 v85, v85
s_add_u32 m0, s2, 40960
s_add_u32 s29, s17, 0x1005000
buffer_load_dwordx4 v1, s[4:7], s29 offen sc1 lds
v_rcp_f32 v86, v86
v_rcp_f32 v87, v87
s_add_u32 s15, s41, s12
v_pk_mul_f32 v[44:45], v[44:45], v[80:81]
v_pk_mul_f32 v[46:47], v[46:47], v[82:83]
v_pk_mul_f32 v[48:49], v[48:49], v[84:85]
v_pk_mul_f32 v[50:51], v[50:51], v[86:87]
s_add_u32 s15, s15, 0x1016000
v_cvt_pk_bf16_f32 v44, v44, v45
v_cvt_pk_bf16_f32 v45, v46, v47
buffer_load_dwordx4 v1, s[4:7], s29 offen offset:1024 sc1 lds
v_cvt_pk_bf16_f32 v46, v48, v49
v_cvt_pk_bf16_f32 v47, v50, v51
s_nop 0
v_permlane32_swap_b32 v44, v46
v_permlane32_swap_b32 v45, v47
buffer_store_dwordx4 v[44:47], v3, s[4:7], s15 offen sc1
v_pk_fma_f32 v[72:73], v[112:113], v[68:69], v[96:97] op_sel:[0,1,0] op_sel_hi:[1,1,1]
v_pk_fma_f32 v[74:75], v[114:115], v[68:69], v[98:99] op_sel:[0,1,0] op_sel_hi:[1,1,1]
v_pk_fma_f32 v[76:77], v[112:113], v[70:71], v[96:97] op_sel:[0,1,0] op_sel_hi:[1,1,1]
v_pk_fma_f32 v[78:79], v[114:115], v[70:71], v[98:99] op_sel:[0,1,0] op_sel_hi:[1,1,1]
v_pk_fma_f32 v[52:53], v[52:53], v[68:69], v[72:73] op_sel_hi:[1,0,1]
v_pk_fma_f32 v[54:55], v[54:55], v[68:69], v[74:75] op_sel_hi:[1,0,1]
v_pk_fma_f32 v[56:57], v[56:57], v[70:71], v[76:77] op_sel_hi:[1,0,1]
v_pk_fma_f32 v[58:59], v[58:59], v[70:71], v[78:79] op_sel_hi:[1,0,1]
v_pk_fma_f32 v[72:73], v[52:53], v[52:53], v[116:117] op_sel_hi:[1,1,0]
s_add_u32 m0, s2, 49152
s_add_u32 s29, s17, 0x1006000
buffer_load_dwordx4 v1, s[4:7], s29 offen sc1 lds
v_pk_fma_f32 v[74:75], v[54:55], v[54:55], v[116:117] op_sel_hi:[1,1,0]
v_pk_fma_f32 v[76:77], v[56:57], v[56:57], v[116:117] op_sel_hi:[1,1,0]
v_pk_fma_f32 v[78:79], v[58:59], v[58:59], v[116:117] op_sel_hi:[1,1,0]
v_pk_mul_f32 v[72:73], v[72:73], v[52:53] neg_lo:[0,1] neg_hi:[0,1]
v_pk_mul_f32 v[74:75], v[74:75], v[54:55] neg_lo:[0,1] neg_hi:[0,1]
v_pk_mul_f32 v[76:77], v[76:77], v[56:57] neg_lo:[0,1] neg_hi:[0,1]
v_pk_mul_f32 v[78:79], v[78:79], v[58:59] neg_lo:[0,1] neg_hi:[0,1]
v_exp_f32 v80, v72
buffer_load_dwordx4 v1, s[4:7], s29 offen offset:1024 sc1 lds
v_exp_f32 v81, v73
v_exp_f32 v82, v74
v_exp_f32 v83, v75
v_exp_f32 v84, v76
v_exp_f32 v85, v77
s_add_u32 m0, s2, 57344
s_add_u32 s29, s17, 0x1007000
buffer_load_dwordx4 v1, s[4:7], s29 offen sc1 lds
v_exp_f32 v86, v78
v_exp_f32 v87, v79
v_pk_fma_f32 v[80:81], v[80:81], v[116:117], v[116:117] op_sel:[0,1,1] op_sel_hi:[1,1,1]
v_pk_fma_f32 v[82:83], v[82:83], v[116:117], v[116:117] op_sel:[0,1,1] op_sel_hi:[1,1,1]
v_pk_fma_f32 v[84:85], v[84:85], v[116:117], v[116:117] op_sel:[0,1,1] op_sel_hi:[1,1,1]
v_pk_fma_f32 v[86:87], v[86:87], v[116:117], v[116:117] op_sel:[0,1,1] op_sel_hi:[1,1,1]
s_waitcnt vmcnt(8)
s_barrier
ds_read_b128 v[88:91], v7 offset:0
ds_read_b128 v[92:95], v8 offset:0
ds_read_b128 v[96:99], v7 offset:4096
ds_read_b128 v[100:103], v8 offset:4096
v_rcp_f32 v80, v80
buffer_load_dwordx4 v1, s[4:7], s29 offen offset:1024 sc1 lds
v_rcp_f32 v81, v81
v_rcp_f32 v82, v82
v_rcp_f32 v83, v83
v_rcp_f32 v84, v84
v_rcp_f32 v85, v85
s_add_u32 m0, s2, 65536
s_add_u32 s29, s17, 0x1008000
buffer_load_dwordx4 v1, s[4:7], s29 offen sc1 lds
v_rcp_f32 v86, v86
v_rcp_f32 v87, v87
s_add_u32 s15, s42, s12
v_pk_mul_f32 v[52:53], v[52:53], v[80:81]
v_pk_mul_f32 v[54:55], v[54:55], v[82:83]
v_pk_mul_f32 v[56:57], v[56:57], v[84:85]
v_pk_mul_f32 v[58:59], v[58:59], v[86:87]
s_add_u32 s15, s15, 0x1016000
v_cvt_pk_bf16_f32 v52, v52, v53
v_cvt_pk_bf16_f32 v53, v54, v55
buffer_load_dwordx4 v1, s[4:7], s29 offen offset:1024 sc1 lds
v_cvt_pk_bf16_f32 v54, v56, v57
v_cvt_pk_bf16_f32 v55, v58, v59
s_nop 0
v_permlane32_swap_b32 v52, v54
v_permlane32_swap_b32 v53, v55
buffer_store_dwordx4 v[52:55], v3, s[4:7], s15 offen sc1
ds_read_b128 v[72:75], v7 offset:8192
ds_read_b128 v[76:79], v8 offset:8192
v_lshrrev_b32 v106, 4, v1
v_and_b32 v106, 48, v106
s_waitcnt lgkmcnt(4)
v_mfma_f32_16x16x32_bf16 v[36:39], v[176:179], v[88:91], 0
ds_read_b128 v[80:83], v7 offset:12288
ds_read_b128 v[84:87], v8 offset:12288
v_mfma_f32_16x16x32_bf16 v[40:43], v[180:183], v[88:91], 0
v_mfma_f32_16x16x32_bf16 v[44:47], v[176:179], v[92:95], 0
s_add_u32 m0, s2, 73728
s_add_u32 s29, s17, 0x1009000
v_mfma_f32_16x16x32_bf16 v[48:51], v[180:183], v[92:95], 0
buffer_load_dwordx4 v1, s[4:7], s29 offen sc1 lds
s_waitcnt lgkmcnt(4)
v_mfma_f32_16x16x32_bf16 v[36:39], v[184:187], v[96:99], v[36:39]
ds_read_b128 v[88:91], v7 offset:16384
ds_read_b128 v[92:95], v8 offset:16384
v_mfma_f32_16x16x32_bf16 v[40:43], v[188:191], v[96:99], v[40:43]
v_mfma_f32_16x16x32_bf16 v[44:47], v[184:187], v[100:103], v[44:47]
buffer_load_dwordx4 v1, s[4:7], s29 offen offset:1024 sc1 lds
v_mfma_f32_16x16x32_bf16 v[48:51], v[188:191], v[100:103], v[48:51]
s_waitcnt lgkmcnt(4)
v_mfma_f32_16x16x32_bf16 v[36:39], v[192:195], v[72:75], v[36:39]
ds_read_b128 v[96:99], v7 offset:20480
ds_read_b128 v[100:103], v8 offset:20480
v_mfma_f32_16x16x32_bf16 v[40:43], v[196:199], v[72:75], v[40:43]
s_add_u32 m0, s2, 81920
s_add_u32 s29, s17, 0x100a000
v_mfma_f32_16x16x32_bf16 v[44:47], v[192:195], v[76:79], v[44:47]
buffer_load_dwordx4 v1, s[4:7], s29 offen sc1 lds
v_mfma_f32_16x16x32_bf16 v[48:51], v[196:199], v[76:79], v[48:51]
s_waitcnt lgkmcnt(4)
v_mfma_f32_16x16x32_bf16 v[36:39], v[200:203], v[80:83], v[36:39]
ds_read_b128 v[72:75], v7 offset:24576
ds_read_b128 v[76:79], v8 offset:24576
v_mfma_f32_16x16x32_bf16 v[40:43], v[204:207], v[80:83], v[40:43]
buffer_load_dwordx4 v1, s[4:7], s29 offen offset:1024 sc1 lds
v_add_u32 v15, 8, v15
v_mfma_f32_16x16x32_bf16 v[44:47], v[200:203], v[84:87], v[44:47]
s_waitcnt vmcnt(4)
buffer_store_dword v15, v13, s[4:7], s45 offen sc1
v_mfma_f32_16x16x32_bf16 v[48:51], v[204:207], v[84:87], v[48:51]
s_waitcnt lgkmcnt(4)
v_mfma_f32_16x16x32_bf16 v[36:39], v[208:211], v[88:91], v[36:39]
ds_read_b128 v[80:83], v7 offset:28672
ds_read_b128 v[84:87], v8 offset:28672
v_mfma_f32_16x16x32_bf16 v[40:43], v[212:215], v[88:91], v[40:43]
buffer_load_dwordx4 v[108:111], v106, s[48:51], s95 offen
v_mfma_f32_16x16x32_bf16 v[44:47], v[208:211], v[92:95], v[44:47]
v_mfma_f32_16x16x32_bf16 v[48:51], v[212:215], v[92:95], v[48:51]
s_waitcnt lgkmcnt(4)
v_mfma_f32_16x16x32_bf16 v[36:39], v[216:219], v[96:99], v[36:39]
s_barrier
ds_read_b128 v[88:91], v7 offset:32768
v_mfma_f32_16x16x32_bf16 v[40:43], v[220:223], v[96:99], v[40:43]
ds_read_b128 v[92:95], v8 offset:32768
v_mfma_f32_16x16x32_bf16 v[44:47], v[216:219], v[100:103], v[44:47]
v_mfma_f32_16x16x32_bf16 v[48:51], v[220:223], v[100:103], v[48:51]
s_waitcnt lgkmcnt(4)
v_mfma_f32_16x16x32_bf16 v[36:39], v[224:227], v[72:75], v[36:39]
ds_read_b128 v[96:99], v7 offset:36864
ds_read_b128 v[100:103], v8 offset:36864
v_mfma_f32_16x16x32_bf16 v[40:43], v[228:231], v[72:75], v[40:43]
v_mfma_f32_16x16x32_bf16 v[44:47], v[224:227], v[76:79], v[44:47]
v_mfma_f32_16x16x32_bf16 v[48:51], v[228:231], v[76:79], v[48:51]
s_waitcnt lgkmcnt(4)
v_mfma_f32_16x16x32_bf16 v[36:39], v[232:235], v[80:83], v[36:39]
ds_read_b128 v[72:75], v7 offset:40960
ds_read_b128 v[76:79], v8 offset:40960
v_mfma_f32_16x16x32_bf16 v[40:43], v[236:239], v[80:83], v[40:43]
v_mfma_f32_16x16x32_bf16 v[44:47], v[232:235], v[84:87], v[44:47]
v_mfma_f32_16x16x32_bf16 v[48:51], v[236:239], v[84:87], v[48:51]
s_waitcnt lgkmcnt(4)
v_mfma_f32_16x16x32_bf16 v[36:39], v[240:243], v[88:91], v[36:39]
ds_read_b128 v[80:83], v7 offset:45056
ds_read_b128 v[84:87], v8 offset:45056
v_mfma_f32_16x16x32_bf16 v[40:43], v[244:247], v[88:91], v[40:43]
v_mfma_f32_16x16x32_bf16 v[44:47], v[240:243], v[92:95], v[44:47]
v_mfma_f32_16x16x32_bf16 v[48:51], v[244:247], v[92:95], v[48:51]
s_waitcnt lgkmcnt(4)
v_mfma_f32_16x16x32_bf16 v[36:39], v[248:251], v[96:99], v[36:39]
ds_read_b128 v[88:91], v7 offset:49152
ds_read_b128 v[92:95], v8 offset:49152
v_mfma_f32_16x16x32_bf16 v[40:43], v[252:255], v[96:99], v[40:43]
v_mfma_f32_16x16x32_bf16 v[44:47], v[248:251], v[100:103], v[44:47]
v_mfma_f32_16x16x32_bf16 v[48:51], v[252:255], v[100:103], v[48:51]
s_waitcnt lgkmcnt(4)
v_mfma_f32_16x16x32_bf16 v[36:39], a[96:99], v[72:75], v[36:39]
ds_read_b128 v[96:99], v7 offset:53248
ds_read_b128 v[100:103], v8 offset:53248
v_mfma_f32_16x16x32_bf16 v[40:43], a[100:103], v[72:75], v[40:43]
buffer_load_dword v17, v4, s[4:7], s92 offen sc1
v_mfma_f32_16x16x32_bf16 v[44:47], a[96:99], v[76:79], v[44:47]
v_mfma_f32_16x16x32_bf16 v[48:51], a[100:103], v[76:79], v[48:51]
s_waitcnt lgkmcnt(4)
v_mfma_f32_16x16x32_bf16 v[36:39], a[104:107], v[80:83], v[36:39]
ds_read_b128 v[72:75], v7 offset:57344
ds_read_b128 v[76:79], v8 offset:57344
v_mfma_f32_16x16x32_bf16 v[40:43], a[108:111], v[80:83], v[40:43]
v_mfma_f32_16x16x32_bf16 v[44:47], a[104:107], v[84:87], v[44:47]
v_mfma_f32_16x16x32_bf16 v[48:51], a[108:111], v[84:87], v[48:51]
s_waitcnt lgkmcnt(4)
v_mfma_f32_16x16x32_bf16 v[36:39], a[112:115], v[88:91], v[36:39]
ds_read_b128 v[80:83], v7 offset:61440
ds_read_b128 v[84:87], v8 offset:61440
v_mfma_f32_16x16x32_bf16 v[40:43], a[116:119], v[88:91], v[40:43]
v_mfma_f32_16x16x32_bf16 v[44:47], a[112:115], v[92:95], v[44:47]
v_mfma_f32_16x16x32_bf16 v[48:51], a[116:119], v[92:95], v[48:51]
s_waitcnt lgkmcnt(4)
v_mfma_f32_16x16x32_bf16 v[36:39], a[120:123], v[96:99], v[36:39]
s_waitcnt vmcnt(3)
s_barrier
v_mfma_f32_16x16x32_bf16 v[40:43], a[124:127], v[96:99], v[40:43]
ds_read_b128 v[88:91], v9 offset:0
ds_read_b128 v[92:95], v10 offset:0
v_mfma_f32_16x16x32_bf16 v[44:47], a[120:123], v[100:103], v[44:47]
s_waitcnt vmcnt(1)
v_lshlrev_b32 v112, 16, v108
v_mfma_f32_16x16x32_bf16 v[48:51], a[124:127], v[100:103], v[48:51]
v_and_b32 v113, 0xffff0000, v108
s_waitcnt lgkmcnt(4)
v_mfma_f32_16x16x32_bf16 v[36:39], a[128:131], v[72:75], v[36:39]
ds_read_b128 v[96:99], v9 offset:4096
ds_read_b128 v[100:103], v10 offset:4096
v_mfma_f32_16x16x32_bf16 v[40:43], a[132:135], v[72:75], v[40:43]
s_add_u32 s44, s32, 16
s_waitcnt vmcnt(0)
v_lshrrev_b32 v17, 3, v17
v_mfma_f32_16x16x32_bf16 v[44:47], a[128:131], v[76:79], v[44:47]
v_subrev_u32 v17, s44, v17
v_cmp_lt_u32 vcc, 31, v17
s_cbranch_vccnz L_spin_69
L_ok_68:
s_add_u32 s18, s12, s19
v_mfma_f32_16x16x32_bf16 v[48:51], a[132:135], v[76:79], v[48:51]
s_add_u32 m0, s2, 90112
s_waitcnt lgkmcnt(4)
v_mfma_f32_16x16x32_bf16 v[36:39], a[136:139], v[80:83], v[36:39]
ds_read_b128 v[72:75], v9 offset:8192
ds_read_b128 v[76:79], v10 offset:8192
v_mfma_f32_16x16x32_bf16 v[40:43], a[140:143], v[80:83], v[40:43]
s_add_u32 s29, s18, 0x101b000
buffer_load_dwordx4 v1, s[4:7], s29 offen sc1 lds
v_mfma_f32_16x16x32_bf16 v[44:47], a[136:139], v[84:87], v[44:47]
v_add_f32 v20, v20, v112
v_add_f32 v21, v21, v113
v_mfma_f32_16x16x32_bf16 v[48:51], a[140:143], v[84:87], v[48:51]
v_add_f32 v28, v28, v112
s_waitcnt lgkmcnt(4)
v_mfma_f32_16x16x32_bf16 v[36:39], a[144:147], v[88:91], v[36:39]
ds_read_b128 v[80:83], v9 offset:12288
ds_read_b128 v[84:87], v10 offset:12288
v_mfma_f32_16x16x32_bf16 v[40:43], a[148:151], v[88:91], v[40:43]
buffer_load_dwordx4 v1, s[4:7], s29 offen offset:1024 sc1 lds
v_add_f32 v29, v29, v113
v_mfma_f32_16x16x32_bf16 v[44:47], a[144:147], v[92:95], v[44:47]
v_lshlrev_b32 v112, 16, v109
v_and_b32 v113, 0xffff0000, v109
v_mfma_f32_16x16x32_bf16 v[48:51], a[148:151], v[92:95], v[48:51]
v_add_f32 v22, v22, v112
s_waitcnt lgkmcnt(4)
v_mfma_f32_16x16x32_bf16 v[36:39], a[152:155], v[96:99], v[36:39]
ds_read_b128 v[88:91], v9 offset:16384
ds_read_b128 v[92:95], v10 offset:16384
v_mfma_f32_16x16x32_bf16 v[40:43], a[156:159], v[96:99], v[40:43]
s_add_u32 m0, s2, 98304
s_add_u32 s29, s18, 0x101c000
v_mfma_f32_16x16x32_bf16 v[44:47], a[152:155], v[100:103], v[44:47]
buffer_load_dwordx4 v1, s[4:7], s29 offen sc1 lds
v_add_f32 v23, v23, v113
v_mfma_f32_16x16x32_bf16 v[48:51], a[156:159], v[100:103], v[48:51]
v_add_f32 v30, v30, v112
s_waitcnt lgkmcnt(4)
v_mfma_f32_16x16x32_bf16 v[36:39], a[160:163], v[72:75], v[36:39]
ds_read_b128 v[96:99], v9 offset:20480
ds_read_b128 v[100:103], v10 offset:20480
v_mfma_f32_16x16x32_bf16 v[40:43], a[164:167], v[72:75], v[40:43]
buffer_load_dwordx4 v1, s[4:7], s29 offen offset:1024 sc1 lds
v_add_f32 v31, v31, v113
v_mfma_f32_16x16x32_bf16 v[44:47], a[160:163], v[76:79], v[44:47]
v_lshlrev_b32 v112, 16, v110
v_and_b32 v113, 0xffff0000, v110
v_mfma_f32_16x16x32_bf16 v[48:51], a[164:167], v[76:79], v[48:51]
v_add_f32 v24, v24, v112
s_waitcnt lgkmcnt(4)
v_mfma_f32_16x16x32_bf16 v[44:47], a[168:171], v[84:87], v[44:47]
s_add_u32 m0, s2, 106496
s_add_u32 s29, s18, 0x101d000
v_mfma_f32_16x16x32_bf16 v[48:51], a[172:175], v[84:87], v[48:51]
buffer_load_dwordx4 v1, s[4:7], s29 offen sc1 lds
v_add_f32 v25, v25, v113
s_waitcnt lgkmcnt(2)
v_mfma_f32_16x16x32_bf16 v[44:47], a[176:179], v[92:95], v[44:47]
v_add_f32 v32, v32, v112
v_add_f32 v33, v33, v113
v_mfma_f32_16x16x32_bf16 v[48:51], a[180:183], v[92:95], v[48:51]
v_lshlrev_b32 v112, 16, v111
v_and_b32 v113, 0xffff0000, v111
s_waitcnt lgkmcnt(0)
v_mfma_f32_16x16x32_bf16 v[44:47], a[184:187], v[100:103], v[44:47]
buffer_load_dwordx4 v1, s[4:7], s29 offen offset:1024 sc1 lds
v_add_f32 v26, v26, v112
v_mfma_f32_16x16x32_bf16 v[48:51], a[188:191], v[100:103], v[48:51]
v_add_f32 v27, v27, v113
v_add_f32 v34, v34, v112
v_add_f32 v35, v35, v113
v_mfma_f32_16x16x32_bf16 v[36:39], a[168:171], v[80:83], v[36:39]
s_lshl_b32 s15, s8, 11
s_add_u32 s15, s15, 0x20000
v_mfma_f32_16x16x32_bf16 v[40:43], a[172:175], v[80:83], v[40:43]
s_add_u32 m0, s2, 114688
s_add_u32 s29, s18, 0x101e000
s_xor_b32 s16, s15, 0x1000
v_add_u32 v104, s15, v1
v_mfma_f32_16x16x32_bf16 v[36:39], a[176:179], v[88:91], v[36:39]
buffer_load_dwordx4 v1, s[4:7], s29 offen sc1 lds
v_add_u32 v105, s16, v1
v_mfma_f32_16x16x32_bf16 v[40:43], a[180:183], v[88:91], v[40:43]
ds_write_b128 v104, v[44:47] offset:0
ds_write_b128 v104, v[48:51] offset:1024
v_mfma_f32_16x16x32_bf16 v[36:39], a[184:187], v[96:99], v[36:39]
v_mfma_f32_16x16x32_bf16 v[40:43], a[188:191], v[96:99], v[40:43]
buffer_load_dwordx4 v1, s[4:7], s29 offen offset:1024 sc1 lds
s_waitcnt lgkmcnt(0)
s_barrier
ds_read_b128 v[68:71], v105 offset:0
ds_read_b128 v[72:75], v105 offset:1024
s_nop 1
v_pk_add_f32 v[20:21], v[20:21], v[36:37]
v_pk_add_f32 v[22:23], v[22:23], v[38:39]
v_pk_add_f32 v[24:25], v[24:25], v[40:41]
v_pk_add_f32 v[26:27], v[26:27], v[42:43]
s_add_u32 m0, s2, 122880
s_add_u32 s29, s18, 0x101f000
buffer_load_dwordx4 v1, s[4:7], s29 offen sc1 lds
buffer_load_dwordx4 v1, s[4:7], s29 offen offset:1024 sc1 lds
s_waitcnt lgkmcnt(1)
v_pk_add_f32 v[20:21], v[20:21], v[68:69]
v_pk_add_f32 v[22:23], v[22:23], v[70:71]
s_waitcnt lgkmcnt(0)
v_pk_add_f32 v[24:25], v[24:25], v[72:73]
v_pk_add_f32 v[26:27], v[26:27], v[74:75]
v_cvt_pk_bf16_f32 v76, v20, v21
v_cvt_pk_bf16_f32 v77, v22, v23
v_cvt_pk_bf16_f32 v78, v24, v25
v_cvt_pk_bf16_f32 v79, v26, v27
buffer_store_dwordx4 v[76:79], v12, s[20:23], s53 offen
s_add_u32 m0, s2, 0
s_add_u32 s29, s18, 0x1020000
buffer_load_dwordx4 v1, s[4:7], s29 offen sc1 lds
buffer_load_dwordx4 v1, s[4:7], s29 offen offset:1024 sc1 lds
s_waitcnt vmcnt(9)
s_barrier
ds_read_b128 v[88:91], v9 offset:24576
ds_read_b128 v[92:95], v10 offset:24576
ds_read_b128 v[96:99], v9 offset:28672
ds_read_b128 v[100:103], v10 offset:28672
ds_read_b128 v[72:75], v9 offset:32768
ds_read_b128 v[76:79], v10 offset:32768
s_add_u32 m0, s2, 8192
s_add_u32 s29, s18, 0x1016000
buffer_load_dwordx4 v1, s[4:7], s29 offen sc1 lds
buffer_load_dwordx4 v1, s[4:7], s29 offen offset:1024 sc1 lds
s_waitcnt lgkmcnt(4)
v_mfma_f32_16x16x32_bf16 v[36:39], a[96:99], v[88:91], 0
ds_read_b128 v[80:83], v9 offset:36864
ds_read_b128 v[84:87], v10 offset:36864
v_mfma_f32_16x16x32_bf16 v[40:43], a[100:103], v[88:91], 0
v_mfma_f32_16x16x32_bf16 v[44:47], a[96:99], v[92:95], 0
s_add_u32 m0, s2, 16384
s_add_u32 s29, s18, 0x1017000
v_mfma_f32_16x16x32_bf16 v[48:51], a[100:103], v[92:95], 0
buffer_load_dwordx4 v1, s[4:7], s29 offen sc1 lds
s_waitcnt lgkmcnt(4)
v_mfma_f32_16x16x32_bf16 v[36:39], a[104:107], v[96:99], v[36:39]
s_waitcnt vmcnt(6)
s_barrier
v_mfma_f32_16x16x32_bf16 v[40:43], a[108:111], v[96:99], v[40:43]
ds_read_b128 v[88:91], v9 offset:40960
ds_read_b128 v[92:95], v10 offset:40960
v_mfma_f32_16x16x32_bf16 v[44:47], a[104:107], v[100:103], v[44:47]
buffer_load_dwordx4 v1, s[4:7], s29 offen offset:1024 sc1 lds
v_mfma_f32_16x16x32_bf16 v[48:51], a[108:111], v[100:103], v[48:51]
s_waitcnt lgkmcnt(4)
v_mfma_f32_16x16x32_bf16 v[36:39], a[112:115], v[72:75], v[36:39]
ds_read_b128 v[96:99], v9 offset:45056
ds_read_b128 v[100:103], v10 offset:45056
v_mfma_f32_16x16x32_bf16 v[40:43], a[116:119], v[72:75], v[40:43]
s_add_u32 m0, s2, 24576
s_add_u32 s29, s18, 0x1018000
v_mfma_f32_16x16x32_bf16 v[44:47], a[112:115], v[76:79], v[44:47]
buffer_load_dwordx4 v1, s[4:7], s29 offen sc1 lds
v_mfma_f32_16x16x32_bf16 v[48:51], a[116:119], v[76:79], v[48:51]
s_waitcnt lgkmcnt(4)
v_mfma_f32_16x16x32_bf16 v[36:39], a[120:123], v[80:83], v[36:39]
ds_read_b128 v[72:75], v9 offset:49152
ds_read_b128 v[76:79], v10 offset:49152
v_mfma_f32_16x16x32_bf16 v[40:43], a[124:127], v[80:83], v[40:43]
buffer_load_dwordx4 v1, s[4:7], s29 offen offset:1024 sc1 lds
v_mfma_f32_16x16x32_bf16 v[44:47], a[120:123], v[84:87], v[44:47]
v_mfma_f32_16x16x32_bf16 v[48:51], a[124:127], v[84:87], v[48:51]
s_waitcnt lgkmcnt(4)
v_mfma_f32_16x16x32_bf16 v[36:39], a[128:131], v[88:91], v[36:39]
ds_read_b128 v[80:83], v9 offset:53248
ds_read_b128 v[84:87], v10 offset:53248
v_mfma_f32_16x16x32_bf16 v[40:43], a[132:135], v[88:91], v[40:43]
s_add_u32 m0, s2, 32768
s_add_u32 s29, s18, 0x1019000
v_mfma_f32_16x16x32_bf16 v[44:47], a[128:131], v[92:95], v[44:47]
buffer_load_dwordx4 v1, s[4:7], s29 offen sc1 lds
v_mfma_f32_16x16x32_bf16 v[48:51], a[132:135], v[92:95], v[48:51]
s_waitcnt lgkmcnt(4)
v_mfma_f32_16x16x32_bf16 v[36:39], a[136:139], v[96:99], v[36:39]
ds_read_b128 v[88:91], v9 offset:57344
ds_read_b128 v[92:95], v10 offset:57344
v_mfma_f32_16x16x32_bf16 v[40:43], a[140:143], v[96:99], v[40:43]
buffer_load_dwordx4 v1, s[4:7], s29 offen offset:1024 sc1 lds
v_mfma_f32_16x16x32_bf16 v[44:47], a[136:139], v[100:103], v[44:47]
v_mfma_f32_16x16x32_bf16 v[48:51], a[140:143], v[100:103], v[48:51]
s_waitcnt lgkmcnt(4)
v_mfma_f32_16x16x32_bf16 v[36:39], a[144:147], v[72:75], v[36:39]
ds_read_b128 v[96:99], v9 offset:61440
ds_read_b128 v[100:103], v10 offset:61440
v_mfma_f32_16x16x32_bf16 v[40:43], a[148:151], v[72:75], v[40:43]
s_add_u32 m0, s2, 40960
s_add_u32 s29, s18, 0x101a000
v_mfma_f32_16x16x32_bf16 v[44:47], a[144:147], v[76:79], v[44:47]
buffer_load_dwordx4 v1, s[4:7], s29 offen sc1 lds
v_mfma_f32_16x16x32_bf16 v[48:51], a[148:151], v[76:79], v[48:51]
s_waitcnt lgkmcnt(4)
v_mfma_f32_16x16x32_bf16 v[36:39], a[152:155], v[80:83], v[36:39]
s_waitcnt vmcnt(5)
s_barrier
v_mfma_f32_16x16x32_bf16 v[40:43], a[156:159], v[80:83], v[40:43]
ds_read_b128 v[72:75], v7 offset:0
ds_read_b128 v[76:79], v8 offset:0
v_mfma_f32_16x16x32_bf16 v[44:47], a[152:155], v[84:87], v[44:47]
buffer_load_dwordx4 v1, s[4:7], s29 offen offset:1024 sc1 lds
v_mfma_f32_16x16x32_bf16 v[48:51], a[156:159], v[84:87], v[48:51]
s_waitcnt lgkmcnt(4)
v_mfma_f32_16x16x32_bf16 v[36:39], a[160:163], v[88:91], v[36:39]
ds_read_b128 v[80:83], v7 offset:4096
ds_read_b128 v[84:87], v8 offset:4096
v_mfma_f32_16x16x32_bf16 v[40:43], a[164:167], v[88:91], v[40:43]
v_mfma_f32_16x16x32_bf16 v[44:47], a[160:163], v[92:95], v[44:47]
v_mfma_f32_16x16x32_bf16 v[48:51], a[164:167], v[92:95], v[48:51]
s_waitcnt lgkmcnt(4)
v_mfma_f32_16x16x32_bf16 v[36:39], a[168:171], v[96:99], v[36:39]
ds_read_b128 v[88:91], v7 offset:8192
ds_read_b128 v[92:95], v8 offset:8192
v_mfma_f32_16x16x32_bf16 v[40:43], a[172:175], v[96:99], v[40:43]
v_mfma_f32_16x16x32_bf16 v[44:47], a[168:171], v[100:103], v[44:47]
v_mfma_f32_16x16x32_bf16 v[48:51], a[172:175], v[100:103], v[48:51]
s_waitcnt lgkmcnt(4)
v_mfma_f32_16x16x32_bf16 v[36:39], a[176:179], v[72:75], v[36:39]
ds_read_b128 v[96:99], v7 offset:12288
ds_read_b128 v[100:103], v8 offset:12288
v_mfma_f32_16x16x32_bf16 v[40:43], a[180:183], v[72:75], v[40:43]
v_mfma_f32_16x16x32_bf16 v[44:47], a[176:179], v[76:79], v[44:47]
v_mfma_f32_16x16x32_bf16 v[48:51], a[180:183], v[76:79], v[48:51]
s_waitcnt lgkmcnt(4)
v_mfma_f32_16x16x32_bf16 v[36:39], a[184:187], v[80:83], v[36:39]
ds_read_b128 v[72:75], v7 offset:16384
ds_read_b128 v[76:79], v8 offset:16384
v_mfma_f32_16x16x32_bf16 v[40:43], a[188:191], v[80:83], v[40:43]
v_mfma_f32_16x16x32_bf16 v[44:47], a[184:187], v[84:87], v[44:47]
v_mfma_f32_16x16x32_bf16 v[48:51], a[188:191], v[84:87], v[48:51]
s_waitcnt lgkmcnt(4)
v_mfma_f32_16x16x32_bf16 v[36:39], v[176:179], v[88:91], v[36:39]
ds_read_b128 v[80:83], v7 offset:20480
ds_read_b128 v[84:87], v8 offset:20480
v_mfma_f32_16x16x32_bf16 v[40:43], v[180:183], v[88:91], v[40:43]
v_mfma_f32_16x16x32_bf16 v[44:47], v[176:179], v[92:95], v[44:47]
v_mfma_f32_16x16x32_bf16 v[48:51], v[180:183], v[92:95], v[48:51]
s_waitcnt lgkmcnt(4)
v_mfma_f32_16x16x32_bf16 v[36:39], v[184:187], v[96:99], v[36:39]
s_waitcnt vmcnt(0)
s_barrier
v_mfma_f32_16x16x32_bf16 v[40:43], v[188:191], v[96:99], v[40:43]
ds_read_b128 v[88:91], v7 offset:24576
ds_read_b128 v[92:95], v8 offset:24576
v_mfma_f32_16x16x32_bf16 v[44:47], v[184:187], v[100:103], v[44:47]
v_mfma_f32_16x16x32_bf16 v[48:51], v[188:191], v[100:103], v[48:51]
s_waitcnt lgkmcnt(4)
v_mfma_f32_16x16x32_bf16 v[36:39], v[192:195], v[72:75], v[36:39]
ds_read_b128 v[96:99], v7 offset:28672
ds_read_b128 v[100:103], v8 offset:28672
v_mfma_f32_16x16x32_bf16 v[40:43], v[196:199], v[72:75], v[40:43]
v_mfma_f32_16x16x32_bf16 v[44:47], v[192:195], v[76:79], v[44:47]
v_mfma_f32_16x16x32_bf16 v[48:51], v[196:199], v[76:79], v[48:51]
s_waitcnt lgkmcnt(4)
v_mfma_f32_16x16x32_bf16 v[36:39], v[200:203], v[80:83], v[36:39]
ds_read_b128 v[72:75], v7 offset:32768
ds_read_b128 v[76:79], v8 offset:32768
v_mfma_f32_16x16x32_bf16 v[40:43], v[204:207], v[80:83], v[40:43]
v_mfma_f32_16x16x32_bf16 v[44:47], v[200:203], v[84:87], v[44:47]
v_mfma_f32_16x16x32_bf16 v[48:51], v[204:207], v[84:87], v[48:51]
s_waitcnt lgkmcnt(4)
v_mfma_f32_16x16x32_bf16 v[36:39], v[208:211], v[88:91], v[36:39]
ds_read_b128 v[80:83], v7 offset:36864
ds_read_b128 v[84:87], v8 offset:36864
v_mfma_f32_16x16x32_bf16 v[40:43], v[212:215], v[88:91], v[40:43]
v_mfma_f32_16x16x32_bf16 v[44:47], v[208:211], v[92:95], v[44:47]
v_mfma_f32_16x16x32_bf16 v[48:51], v[212:215], v[92:95], v[48:51]
s_waitcnt lgkmcnt(4)
v_mfma_f32_16x16x32_bf16 v[36:39], v[216:219], v[96:99], v[36:39]
ds_read_b128 v[88:91], v7 offset:40960
ds_read_b128 v[92:95], v8 offset:40960
v_mfma_f32_16x16x32_bf16 v[40:43], v[220:223], v[96:99], v[40:43]
v_mfma_f32_16x16x32_bf16 v[44:47], v[216:219], v[100:103], v[44:47]
v_mfma_f32_16x16x32_bf16 v[48:51], v[220:223], v[100:103], v[48:51]
s_waitcnt lgkmcnt(4)
v_mfma_f32_16x16x32_bf16 v[36:39], v[224:227], v[72:75], v[36:39]
ds_read_b128 v[96:99], v7 offset:45056
ds_read_b128 v[100:103], v8 offset:45056
v_mfma_f32_16x16x32_bf16 v[40:43], v[228:231], v[72:75], v[40:43]
v_mfma_f32_16x16x32_bf16 v[44:47], v[224:227], v[76:79], v[44:47]
v_mfma_f32_16x16x32_bf16 v[48:51], v[228:231], v[76:79], v[48:51]
s_waitcnt lgkmcnt(4)
v_mfma_f32_16x16x32_bf16 v[44:47], v[232:235], v[84:87], v[44:47]
v_mfma_f32_16x16x32_bf16 v[48:51], v[236:239], v[84:87], v[48:51]
s_waitcnt lgkmcnt(2)
v_mfma_f32_16x16x32_bf16 v[44:47], v[240:243], v[92:95], v[44:47]
v_mfma_f32_16x16x32_bf16 v[48:51], v[244:247], v[92:95], v[48:51]
s_waitcnt lgkmcnt(0)
v_mfma_f32_16x16x32_bf16 v[44:47], v[248:251], v[100:103], v[44:47]
v_mfma_f32_16x16x32_bf16 v[48:51], v[252:255], v[100:103], v[48:51]
v_mfma_f32_16x16x32_bf16 v[36:39], v[232:235], v[80:83], v[36:39]
s_lshl_b32 s15, s8, 11
s_add_u32 s15, s15, 0x20000
v_mfma_f32_16x16x32_bf16 v[40:43], v[236:239], v[80:83], v[40:43]
s_xor_b32 s16, s15, 0x1000
v_add_u32 v104, s15, v1
v_mfma_f32_16x16x32_bf16 v[36:39], v[240:243], v[88:91], v[36:39]
v_add_u32 v105, s16, v1
v_mfma_f32_16x16x32_bf16 v[40:43], v[244:247], v[88:91], v[40:43]
ds_write_b128 v104, v[44:47] offset:0
ds_write_b128 v104, v[48:51] offset:1024
v_mfma_f32_16x16x32_bf16 v[36:39], v[248:251], v[96:99], v[36:39]
v_mfma_f32_16x16x32_bf16 v[40:43], v[252:255], v[96:99], v[40:43]
s_waitcnt lgkmcnt(0)
s_barrier
ds_read_b128 v[68:71], v105 offset:0
ds_read_b128 v[72:75], v105 offset:1024
s_nop 2
v_pk_add_f32 v[28:29], v[28:29], v[36:37]
v_pk_add_f32 v[30:31], v[30:31], v[38:39]
v_pk_add_f32 v[32:33], v[32:33], v[40:41]
v_pk_add_f32 v[34:35], v[34:35], v[42:43]
s_waitcnt lgkmcnt(1)
v_pk_add_f32 v[28:29], v[28:29], v[68:69]
v_pk_add_f32 v[30:31], v[30:31], v[70:71]
s_waitcnt lgkmcnt(0)
v_pk_add_f32 v[32:33], v[32:33], v[72:73]
v_pk_add_f32 v[34:35], v[34:35], v[74:75]
v_cvt_pk_bf16_f32 v76, v28, v29
v_cvt_pk_bf16_f32 v77, v30, v31
v_cvt_pk_bf16_f32 v78, v32, v33
v_cvt_pk_bf16_f32 v79, v34, v35
buffer_store_dwordx4 v[76:79], v12, s[20:23], s54 offen
s_waitcnt vmcnt(0)
s_endpgm
L_spin_39:
s_mov_b32 s44, 0
L_spin_39_l:
buffer_load_dword v17, v19, s[4:7], 0 offen sc1
s_add_u32 s44, s44, 1
s_cmp_gt_u32 s44, 0x40000
s_cbranch_scc1 L_abort
s_waitcnt vmcnt(0)
v_lshrrev_b32 v17, 3, v17
v_subrev_u32 v17, s46, v17
v_cmp_lt_u32 vcc, 31, v17
s_cbranch_vccnz L_spin_39_l
s_branch L_ok_38
L_spin_41:
s_mov_b32 s44, 0
L_spin_41_l:
buffer_load_dword v17, v4, s[4:7], s92 offen sc1
s_add_u32 s44, s44, 1
s_cmp_gt_u32 s44, 0x40000
s_cbranch_scc1 L_abort
s_waitcnt vmcnt(0)
v_lshrrev_b32 v17, 3, v17
v_subrev_u32 v17, s46, v17
v_cmp_lt_u32 vcc, 31, v17
s_cbranch_vccnz L_spin_41_l
s_branch L_ok_40
L_spin_43:
s_mov_b32 s44, 0
L_spin_43_l:
buffer_load_dword v17, v4, s[4:7], s92 offen sc1
s_add_u32 s44, s44, 1
s_cmp_gt_u32 s44, 0x40000
s_cbranch_scc1 L_abort
s_waitcnt vmcnt(0)
v_lshrrev_b32 v17, 3, v17
v_subrev_u32 v17, s46, v17
v_cmp_lt_u32 vcc, 31, v17
s_cbranch_vccnz L_spin_43_l
s_branch L_ok_42
L_spin_45:
s_mov_b32 s55, 0
L_spin_45_l:
buffer_load_dword v17, v4, s[4:7], s92 offen sc1
s_add_u32 s55, s55, 1
s_cmp_gt_u32 s55, 0x40000
s_cbranch_scc1 L_abort
s_waitcnt vmcnt(0)
v_lshrrev_b32 v17, 3, v17
v_subrev_u32 v17, s44, v17
v_cmp_lt_u32 vcc, 31, v17
s_cbranch_vccnz L_spin_45_l
s_branch L_ok_44
L_spin_47:
s_mov_b32 s55, 0
L_spin_47_l:
buffer_load_dword v17, v4, s[4:7], s92 offen sc1
s_add_u32 s55, s55, 1
s_cmp_gt_u32 s55, 0x40000
s_cbranch_scc1 L_abort
s_waitcnt vmcnt(0)
v_lshrrev_b32 v17, 3, v17
v_subrev_u32 v17, s44, v17
v_cmp_lt_u32 vcc, 31, v17
s_cbranch_vccnz L_spin_47_l
s_branch L_ok_46
L_spin_49:
s_mov_b32 s44, 0
L_spin_49_l:
buffer_load_dword v17, v4, s[4:7], s92 offen sc1
s_add_u32 s44, s44, 1
s_cmp_gt_u32 s44, 0x40000
s_cbranch_scc1 L_abort
s_waitcnt vmcnt(0)
v_lshrrev_b32 v17, 3, v17
v_subrev_u32 v17, s46, v17
v_cmp_lt_u32 vcc, 31, v17
s_cbranch_vccnz L_spin_49_l
s_branch L_ok_48
L_spin_51:
s_mov_b32 s55, 0
L_spin_51_l:
buffer_load_dword v17, v4, s[4:7], s92 offen sc1
s_add_u32 s55, s55, 1
s_cmp_gt_u32 s55, 0x40000
s_cbranch_scc1 L_abort
s_waitcnt vmcnt(0)
v_lshrrev_b32 v17, 3, v17
v_subrev_u32 v17, s44, v17
v_cmp_lt_u32 vcc, 31, v17
s_cbranch_vccnz L_spin_51_l
s_branch L_ok_50
L_spin_53:
s_mov_b32 s55, 0
L_spin_53_l:
buffer_load_dword v17, v4, s[4:7], s92 offen sc1
s_add_u32 s55, s55, 1
s_cmp_gt_u32 s55, 0x40000
s_cbranch_scc1 L_abort
s_waitcnt vmcnt(0)
v_lshrrev_b32 v17, 3, v17
v_subrev_u32 v17, s44, v17
v_cmp_lt_u32 vcc, 31, v17
s_cbranch_vccnz L_spin_53_l
s_branch L_ok_52
L_spin_55:
s_cmp_lg_u32 s33, 0
s_cbranch_scc1 L_ok_54
s_mov_b32 s55, 0
L_spin_55_l:
buffer_load_dword v17, v4, s[4:7], s90 offen sc1
s_add_u32 s55, s55, 1
s_cmp_gt_u32 s55, 0x40000
s_cbranch_scc1 L_abort
s_waitcnt vmcnt(0)
v_lshrrev_b32 v17, 3, v17
v_subrev_u32 v17, s44, v17
v_cmp_lt_u32 vcc, 31, v17
s_cbranch_vccnz L_spin_55_l
s_branch L_ok_54
L_spin_57:
s_mov_b32 s55, 0
L_spin_57_l:
buffer_load_dword v17, v4, s[4:7], s92 offen sc1
s_add_u32 s55, s55, 1
s_cmp_gt_u32 s55, 0x40000
s_cbranch_scc1 L_abort
s_waitcnt vmcnt(0)
v_lshrrev_b32 v17, 3, v17
v_subrev_u32 v17, s44, v17
v_cmp_lt_u32 vcc, 31, v17
s_cbranch_vccnz L_spin_57_l
s_branch L_ok_56
L_spin_59:
s_mov_b32 s44, 0
L_spin_59_l:
buffer_load_dword v17, v4, s[4:7], s92 offen sc1
s_add_u32 s44, s44, 1
s_cmp_gt_u32 s44, 0x40000
s_cbranch_scc1 L_abort
s_waitcnt vmcnt(0)
v_lshrrev_b32 v17, 3, v17
v_subrev_u32 v17, s46, v17
v_cmp_lt_u32 vcc, 31, v17
s_cbranch_vccnz L_spin_59_l
s_branch L_ok_58
L_spin_61:
s_mov_b32 s44, 0
L_spin_61_l:
buffer_load_dword v17, v4, s[4:7], s92 offen sc1
s_add_u32 s44, s44, 1
s_cmp_gt_u32 s44, 0x40000
s_cbranch_scc1 L_abort
s_waitcnt vmcnt(0)
v_lshrrev_b32 v17, 3, v17
v_subrev_u32 v17, s46, v17
v_cmp_lt_u32 vcc, 31, v17
s_cbranch_vccnz L_spin_61_l
s_branch L_ok_60
L_spin_63:
s_mov_b32 s44, 0
L_spin_63_l:
buffer_load_dword v17, v4, s[4:7], s92 offen sc1
s_add_u32 s44, s44, 1
s_cmp_gt_u32 s44, 0x40000
s_cbranch_scc1 L_abort
s_waitcnt vmcnt(0)
v_lshrrev_b32 v17, 3, v17
v_subrev_u32 v17, s46, v17
v_cmp_lt_u32 vcc, 31, v17
s_cbranch_vccnz L_spin_63_l
s_branch L_ok_62
L_spin_65:
s_mov_b32 s55, 0
L_spin_65_l:
buffer_load_dword v17, v4, s[4:7], s92 offen sc1
s_add_u32 s55, s55, 1
s_cmp_gt_u32 s55, 0x40000
s_cbranch_scc1 L_abort
s_waitcnt vmcnt(0)
v_lshrrev_b32 v17, 3, v17
v_subrev_u32 v17, s44, v17
v_cmp_lt_u32 vcc, 31, v17
s_cbranch_vccnz L_spin_65_l
s_branch L_ok_64
L_spin_67:
s_mov_b32 s44, 0
L_spin_67_l:
buffer_load_dword v17, v4, s[4:7], s92 offen sc1
s_add_u32 s44, s44, 1
s_cmp_gt_u32 s44, 0x40000
s_cbranch_scc1 L_abort
s_waitcnt vmcnt(0)
v_lshrrev_b32 v17, 3, v17
v_subrev_u32 v17, s46, v17
v_cmp_lt_u32 vcc, 31, v17
s_cbranch_vccnz L_spin_67_l
s_branch L_ok_66
L_spin_69:
s_mov_b32 s55, 0
L_spin_69_l:
buffer_load_dword v17, v4, s[4:7], s92 offen sc1
s_add_u32 s55, s55, 1
s_cmp_gt_u32 s55, 0x40000
s_cbranch_scc1 L_abort
s_waitcnt vmcnt(0)
v_lshrrev_b32 v17, 3, v17
v_subrev_u32 v17, s44, v17
v_cmp_lt_u32 vcc, 31, v17
s_cbranch_vccnz L_spin_69_l
s_branch L_ok_68
L_abort:
    s_endpgm
.section .rodata,"a"
.p2align 6
.amdhsa_kernel interleave_layers__sliding_local_dilated__dense_activation_gelu__prompt_kernel
  .amdhsa_next_free_vgpr 512
  .amdhsa_next_free_sgpr 102
  .amdhsa_accum_offset 256
  .amdhsa_group_segment_fixed_size 0
  .amdhsa_kernarg_size 88
  .amdhsa_user_sgpr_count 2
  .amdhsa_user_sgpr_kernarg_segment_ptr 1
  .amdhsa_system_sgpr_workgroup_id_x 1
.end_amdhsa_kernel
```
